```python
import torch

def _softmax(x, axis=-1):
    return torch.softmax(x, dim=axis)
def _gelu(x):
    return torch.nn.functional.gelu(x, approximate="tanh")
def _silu(x):
    return torch.nn.functional.silu(x)
def _sigmoid(x):
    return torch.sigmoid(x)
def _layernorm(x, axis=-1, eps=1e-5):
    m = x.mean(dim=axis, keepdim=True)
    v = x.var(dim=axis, keepdim=True, unbiased=False)
    return (x - m) / torch.sqrt(v + eps)
def _scatter_add(tgt, idx, src, axis=0):
    return tgt.clone().index_add_(axis, idx, src)
def _segment_sum(src, seg, n):
    out = torch.zeros((n,) + src.shape[1:], dtype=src.dtype)
    return out.index_add_(0, seg, src)
def _pad(x, pw):
    flat = tuple(v for pair in reversed(pw) for v in pair)
    return torch.nn.functional.pad(x, flat)

kernel_name = 'concat_heads__gqa_block_cached__gqa_block_cached__near_ridge'

def setup_inputs():

    _w = (lambda a: (lambda t: t.to(torch.bfloat16) if t.is_floating_point() else t)(torch.as_tensor(a)))
    def _A_setup():
        B, Sq, D = 16, 128, 640
        Hq, Hkv, Sk, Dh = 32, 32, 512, 192
        assert Hq % Hkv == 0, (Hq, Hkv)
        return {
            "x": _w((lambda *s: torch.randn(*s, dtype=torch.bfloat16) * 0.8)(B, Sq, D)),
            "k_cache": _w((lambda *s: torch.randn(*s, dtype=torch.bfloat16) * 0.8)(B, Hkv, Sk, Dh)),
            "v_cache": _w((lambda *s: torch.randn(*s, dtype=torch.bfloat16) * 0.05)(B, Hkv, Sk, Dh)),
            "wq": _w((lambda *s: torch.randn(*s, dtype=torch.bfloat16) * 0.8)(D, Hq * Dh) * (D ** -0.5)),
            "wo": _w((lambda *s: torch.randn(*s, dtype=torch.bfloat16) * 0.05)(Hq * Dh, D) * ((Hq * Dh) ** -0.5)),
        }
    _A_in = _A_setup()

    def _B_setup():
        B, Sq, D = 16, 128, 640
        Hq, Hkv, Sk, Dh = 32, 32, 512, 192
        assert Hq % Hkv == 0, (Hq, Hkv)
        return {
            "x": _w((lambda *s: torch.randn(*s, dtype=torch.bfloat16) * 0.8)(B, Sq, D)),
            "k_cache": _w((lambda *s: torch.randn(*s, dtype=torch.bfloat16) * 0.8)(B, Hkv, Sk, Dh)),
            "v_cache": _w((lambda *s: torch.randn(*s, dtype=torch.bfloat16) * 0.05)(B, Hkv, Sk, Dh)),
            "wq": _w((lambda *s: torch.randn(*s, dtype=torch.bfloat16) * 0.8)(D, Hq * Dh) * (D ** -0.5)),
            "wo": _w((lambda *s: torch.randn(*s, dtype=torch.bfloat16) * 0.05)(Hq * Dh, D) * ((Hq * Dh) ** -0.5)),
        }
    _B_in = _B_setup()

    return {
        "A_x": _A_in["x"],
        "A_k_cache": _A_in["k_cache"],
        "A_v_cache": _A_in["v_cache"],
        "A_wq": _A_in["wq"],
        "A_wo": _A_in["wo"],
        "B_x": _B_in["x"],
        "B_k_cache": _B_in["k_cache"],
        "B_v_cache": _B_in["v_cache"],
        "B_wq": _B_in["wq"],
        "B_wo": _B_in["wo"],
    }

def reference(A_x, A_k_cache, A_v_cache, A_wq, A_wo, B_x, B_k_cache, B_v_cache, B_wq, B_wo):
    def _A_ref(x, k_cache, v_cache, wq, wo):
        B, Sq, D = x.shape
        Hq, Dh = 32, 192
        Hkv = k_cache.shape[1]
        rep = Hq // Hkv
        q = (lambda x, *d: x.permute(*d))((x @ wq).reshape(B, Sq, Hq, Dh), 0, 2, 1, 3)
        k = (lambda x, n, axis: torch.repeat_interleave(x, n, dim=axis))(k_cache, rep, axis=1)
        v = (lambda x, n, axis: torch.repeat_interleave(x, n, dim=axis))(v_cache, rep, axis=1)
        scores = torch.einsum("bhqd,bhkd->bhqk", q, k) * (Dh ** -0.5)
        p = _softmax(scores, axis=-1)
        o = torch.einsum("bhqk,bhkd->bhqd", p, v)
        return (lambda x, *d: x.permute(*d))(o, 0, 2, 1, 3).reshape(B, Sq, Hq * Dh) @ wo

    def _B_ref(x, k_cache, v_cache, wq, wo):
        B, Sq, D = x.shape
        Hq, Dh = 32, 192
        Hkv = k_cache.shape[1]
        rep = Hq // Hkv
        q = (lambda x, *d: x.permute(*d))((x @ wq).reshape(B, Sq, Hq, Dh), 0, 2, 1, 3)
        k = (lambda x, n, axis: torch.repeat_interleave(x, n, dim=axis))(k_cache, rep, axis=1)
        v = (lambda x, n, axis: torch.repeat_interleave(x, n, dim=axis))(v_cache, rep, axis=1)
        scores = torch.einsum("bhqd,bhkd->bhqk", q, k) * (Dh ** -0.5)
        p = _softmax(scores, axis=-1)
        o = torch.einsum("bhqk,bhkd->bhqd", p, v)
        return (lambda x, *d: x.permute(*d))(o, 0, 2, 1, 3).reshape(B, Sq, Hq * Dh) @ wo

    a = _A_ref(A_x, A_k_cache, A_v_cache, A_wq, A_wo)
    b = _B_ref(B_x, B_k_cache, B_v_cache, B_wq, B_wo)
    return torch.concatenate([a, b], axis=-1)
```

```asm
; @launch kernel=concat_heads__gqa_block_cached__gqa_block_cached__near_ridge_k1_kernel grid=(256,1,1) block=(512,1,1) lds=163840
; @launch kernel=concat_heads__gqa_block_cached__gqa_block_cached__near_ridge_k2_kernel grid=(256,1,1) block=(512,1,1) lds=122880
.amdgcn_target "amdgcn-amd-amdhsa--gfx950"
.text
.globl concat_heads__gqa_block_cached__gqa_block_cached__near_ridge_k1_kernel
.p2align 8
.type concat_heads__gqa_block_cached__gqa_block_cached__near_ridge_k1_kernel,@function
concat_heads__gqa_block_cached__gqa_block_cached__near_ridge_k1_kernel:
    s_cmp_ge_u32 s2, 256
    s_cbranch_scc1 K1_END
    s_load_dwordx8 s[8:15], s[0:1], 0
    s_load_dwordx8 s[16:23], s[0:1], 40
    s_load_dwordx2 s[4:5], s[0:1], 96
    v_lshrrev_b32 v1, 6, v0
    v_and_b32 v2, 63, v0
    s_nop 0
    v_readfirstlane_b32 s44, v1
    s_and_b32 s7, s2, 31
    s_lshr_b32 s6, s2, 5
    s_lshr_b32 s53, s44, 2
    s_and_b32 s54, s44, 3
    s_lshl_b32 s6, s6, 1
    s_add_u32 s6, s6, s53
    s_mul_i32 s52, s53, 12288
    s_mul_i32 s62, s7, 384
    s_mul_i32 s47, s53, 393216
    s_add_u32 s62, s62, s47
    s_mul_i32 s63, s6, 163840
    s_lshl_b32 s3, s6, 5
    s_add_u32 s3, s3, s7
    s_mul_i32 s64, s3, 196608
    s_mul_i32 s47, s54, 192
    s_add_u32 s48, s47, 0
    v_add_u32 v3, s48, v2
    v_mul_u32_u24 v4, 2731, v3
    v_lshrrev_b32 v4, 16, v4
    v_mul_u32_u24 v5, 24, v4
    v_sub_u32 v5, v3, v5
    v_and_b32 v6, 6, v4
    v_xor_b32 v5, v5, v6
    v_lshlrev_b32 v5, 4, v5
    v_mul_u32_u24 v6, 384, v4
    v_add_u32 v238, v5, v6
    v_bfe_u32 v6, v4, 2, 2
    v_lshlrev_b32 v6, 3, v6
    v_lshrrev_b32 v7, 4, v4
    v_lshl_add_u32 v6, v7, 2, v6
    v_and_b32 v7, 3, v4
    v_add_u32 v6, v6, v7
    v_mul_u32_u24 v6, 12288, v6
    v_add_u32 v241, v5, v6
    s_add_u32 s48, s47, 64
    v_add_u32 v3, s48, v2
    v_mul_u32_u24 v4, 2731, v3
    v_lshrrev_b32 v4, 16, v4
    v_mul_u32_u24 v5, 24, v4
    v_sub_u32 v5, v3, v5
    v_and_b32 v6, 6, v4
    v_xor_b32 v5, v5, v6
    v_lshlrev_b32 v5, 4, v5
    v_subrev_u32 v5, 1024, v5
    v_mul_u32_u24 v6, 384, v4
    v_add_u32 v239, v5, v6
    v_bfe_u32 v6, v4, 2, 2
    v_lshlrev_b32 v6, 3, v6
    v_lshrrev_b32 v7, 4, v4
    v_lshl_add_u32 v6, v7, 2, v6
    v_and_b32 v7, 3, v4
    v_add_u32 v6, v6, v7
    v_mul_u32_u24 v6, 12288, v6
    v_add_u32 v242, v5, v6
    s_add_u32 s48, s47, 128
    v_add_u32 v3, s48, v2
    v_mul_u32_u24 v4, 2731, v3
    v_lshrrev_b32 v4, 16, v4
    v_mul_u32_u24 v5, 24, v4
    v_sub_u32 v5, v3, v5
    v_and_b32 v6, 6, v4
    v_xor_b32 v5, v5, v6
    v_lshlrev_b32 v5, 4, v5
    v_subrev_u32 v5, 2048, v5
    v_mul_u32_u24 v6, 384, v4
    v_add_u32 v240, v5, v6
    v_bfe_u32 v6, v4, 2, 2
    v_lshlrev_b32 v6, 3, v6
    v_lshrrev_b32 v7, 4, v4
    v_lshl_add_u32 v6, v7, 2, v6
    v_and_b32 v7, 3, v4
    v_add_u32 v6, v6, v7
    v_mul_u32_u24 v6, 12288, v6
    v_add_u32 v243, v5, v6
    v_lshrrev_b32 v3, 3, v2
    v_and_b32 v4, 6, v3
    v_and_b32 v5, 7, v2
    v_xor_b32 v5, v5, v4
    s_lshl_b32 s47, s54, 5
    v_add_u32 v3, s47, v3
    v_mul_u32_u24 v3, 1280, v3
    v_lshl_add_u32 v244, v5, 4, v3
    s_lshl_b32 s55, s44, 13
    s_add_u32 s55, s55, 98304
    s_mul_i32 s45, s44, 3072
    s_waitcnt lgkmcnt(0)
    s_mov_b32 s26, 196608
    s_mov_b32 s30, 196608
    s_mov_b32 s27, 0x00020000
    s_mov_b32 s31, 0x00020000
    s_mov_b32 s35, 0x00020000
    s_mov_b32 s39, 0x00020000
    s_mov_b32 s43, 0x00020000
    s_add_u32 s32, s14, s62
    s_addc_u32 s33, s15, 0
    s_add_u32 s36, s8, s63
    s_addc_u32 s37, s9, 0
    s_sub_u32 s34, 7864320, s62
    s_mov_b32 s38, 163840
    s_add_u32 s24, s10, s64
    s_addc_u32 s25, s11, 0
    s_add_u32 s28, s12, s64
    s_addc_u32 s29, s13, 0
    s_mov_b32 s61, 0
    s_lshr_b32 s95, s2, 5
    s_mul_i32 s95, s95, 1
    s_lshr_b32 s47, s7, 3
    s_mul_i32 s47, s47, 2
    s_add_u32 s95, s95, s47
    s_sub_u32 s47, s95, 10
    s_cmp_ge_u32 s95, 10
    s_cselect_b32 s95, s47, s95
    s_sub_u32 s47, s95, 10
    s_cmp_ge_u32 s95, 10
    s_cselect_b32 s95, s47, s95
    s_sub_u32 s47, s95, 10
    s_cmp_ge_u32 s95, 10
    s_cselect_b32 s95, s47, s95
    s_lshl_b32 s65, s54, 13
    s_add_u32 m0, s55, 0
    s_add_u32 s49, s95, 0
    s_sub_u32 s94, s49, 10
    s_cmp_ge_u32 s49, 10
    s_cselect_b32 s49, s94, s49
    s_lshl_b32 s97, s49, 7
    buffer_load_dwordx4 v244, s[36:39], s97 offen lds
    s_add_u32 m0, s55, 0
    s_add_u32 s97, s97, 9216
    buffer_load_dwordx4 v244, s[36:39], s97 offen offset:1024 lds
    s_add_u32 m0, s55, 0
    s_add_u32 s97, s97, 9216
    buffer_load_dwordx4 v244, s[36:39], s97 offen offset:2048 lds
    s_add_u32 m0, s55, 0
    s_add_u32 s97, s97, 9216
    buffer_load_dwordx4 v244, s[36:39], s97 offen offset:3072 lds
    s_add_u32 m0, s55, 4096
    s_add_u32 s49, s95, 1
    s_sub_u32 s94, s49, 10
    s_cmp_ge_u32 s49, 10
    s_cselect_b32 s49, s94, s49
    s_lshl_b32 s97, s49, 7
    buffer_load_dwordx4 v244, s[36:39], s97 offen lds
    s_add_u32 m0, s55, 4096
    s_add_u32 s97, s97, 9216
    buffer_load_dwordx4 v244, s[36:39], s97 offen offset:1024 lds
    s_add_u32 m0, s55, 4096
    s_add_u32 s97, s97, 9216
    buffer_load_dwordx4 v244, s[36:39], s97 offen offset:2048 lds
    s_add_u32 m0, s55, 4096
    s_add_u32 s97, s97, 9216
    buffer_load_dwordx4 v244, s[36:39], s97 offen offset:3072 lds
    s_add_u32 m0, s45, 0
    s_add_u32 s49, s95, 0
    s_sub_u32 s94, s49, 10
    s_cmp_ge_u32 s49, 10
    s_cselect_b32 s49, s94, s49
    s_mul_i32 s96, s49, 786432
    buffer_load_dwordx4 v241, s[32:35], s96 offen lds
    s_add_u32 m0, s45, 0
    s_nop 0
    buffer_load_dwordx4 v242, s[32:35], s96 offen offset:1024 lds
    s_add_u32 m0, s45, 0
    s_nop 0
    buffer_load_dwordx4 v243, s[32:35], s96 offen offset:2048 lds
    s_add_u32 m0, s45, 24576
    s_add_u32 s49, s95, 1
    s_sub_u32 s94, s49, 10
    s_cmp_ge_u32 s49, 10
    s_cselect_b32 s49, s94, s49
    s_mul_i32 s96, s49, 786432
    buffer_load_dwordx4 v241, s[32:35], s96 offen lds
    s_add_u32 m0, s45, 24576
    s_nop 0
    buffer_load_dwordx4 v242, s[32:35], s96 offen offset:1024 lds
    s_add_u32 m0, s45, 24576
    s_nop 0
    buffer_load_dwordx4 v243, s[32:35], s96 offen offset:2048 lds
    s_add_u32 m0, s45, 49152
    s_add_u32 s49, s95, 2
    s_sub_u32 s94, s49, 10
    s_cmp_ge_u32 s49, 10
    s_cselect_b32 s49, s94, s49
    s_mul_i32 s96, s49, 786432
    buffer_load_dwordx4 v241, s[32:35], s96 offen lds
    s_add_u32 m0, s45, 49152
    s_nop 0
    buffer_load_dwordx4 v242, s[32:35], s96 offen offset:1024 lds
    s_add_u32 m0, s45, 49152
    s_nop 0
    buffer_load_dwordx4 v243, s[32:35], s96 offen offset:2048 lds
    v_and_b32 v3, 15, v2
    v_lshrrev_b32 v4, 4, v2
    v_and_b32 v5, 6, v3
    v_xor_b32 v6, v4, v5
    v_lshlrev_b32 v6, 4, v6
    v_mul_u32_u24 v7, 384, v3
    v_add_u32 v226, v6, v7
    v_xor_b32 v8, 64, v6
    v_add_u32 v227, v8, v7
    v_lshlrev_b32 v7, 7, v3
    v_add_u32 v7, s55, v7
    v_add_u32 v232, v6, v7
    v_add_u32 v233, v8, v7
    v_lshrrev_b32 v3, 2, v2
    v_and_b32 v4, 6, v3
    v_lshlrev_b32 v4, 4, v4
    v_mul_u32_u24 v5, 384, v3
    v_bfe_u32 v6, v2, 1, 1
    v_lshl_add_u32 v5, v6, 4, v5
    v_and_b32 v6, 1, v2
    v_lshl_add_u32 v5, v6, 3, v5
    v_xor_b32 v6, 0, v4
    v_add_u32 v228, v5, v6
    v_xor_b32 v6, 32, v4
    v_add_u32 v229, v5, v6
    v_xor_b32 v6, 64, v4
    v_add_u32 v230, v5, v6
    v_xor_b32 v6, 96, v4
    v_add_u32 v231, v5, v6
    s_mul_i32 s47, s54, 12288
    v_lshlrev_b32 v5, 4, v2
    v_add_u32 v245, s47, v5
    s_mov_b32 s46, 0x3dd53b95
    s_mov_b32 s51, 0x41000000
    s_mul_i32 s47, s3, 49152
    s_add_u32 s40, s4, s47
    s_addc_u32 s41, s5, 0
    s_mov_b32 s42, 0
    s_add_u32 s68, s4, 100663296
    s_addc_u32 s69, s5, 0
    s_mov_b32 s70, 65536
    s_mov_b32 s71, 0x00020000
    s_mov_b32 s66, 4096
    s_mov_b32 s67, 8192
K1_LOOP:
    v_add_u32 v234, 0, v228
    v_add_u32 v235, 0, v229
    v_add_u32 v236, 0, v230
    v_add_u32 v237, 0, v231
    s_waitcnt lgkmcnt(0)
    s_waitcnt vmcnt(6)
    ds_read_b128 v[144:147], v232 offset:0
    ds_read_b128 v[148:151], v232 offset:2048
    s_barrier
    ds_read_b64_tr_b16 v[184:185], v234 offset:0
    ds_read_b64_tr_b16 v[186:187], v234 offset:6144
    ds_read_b64_tr_b16 v[188:189], v235 offset:0
    ds_read_b64_tr_b16 v[190:191], v235 offset:6144
    ds_read_b64_tr_b16 v[192:193], v236 offset:0
    ds_read_b64_tr_b16 v[194:195], v236 offset:6144
    ds_read_b128 v[152:155], v233 offset:0
    ds_read_b128 v[156:159], v233 offset:2048
    s_add_u32 m0, s45, 73728
    s_add_u32 s49, s95, 3
    s_sub_u32 s94, s49, 10
    s_cmp_ge_u32 s49, 10
    s_cselect_b32 s49, s94, s49
    s_mul_i32 s96, s49, 786432
    buffer_load_dwordx4 v241, s[32:35], s96 offen lds
    s_cmp_lg_u32 s61, 0
    s_cbranch_scc1 K1_TAIL
    ds_read_b64_tr_b16 v[196:197], v237 offset:0
    ds_read_b64_tr_b16 v[198:199], v237 offset:6144
    ds_read_b64_tr_b16 v[200:201], v234 offset:128
    ds_read_b64_tr_b16 v[202:203], v234 offset:6272
    ds_read_b64_tr_b16 v[204:205], v235 offset:128
    ds_read_b64_tr_b16 v[206:207], v235 offset:6272
    s_branch K1_BODY
K1_TAIL:
    v_mfma_f32_16x16x32_bf16 v[72:75], v[204:207], v[176:179], v[72:75]
    v_mfma_f32_16x16x32_bf16 v[76:79], v[204:207], v[180:183], v[76:79]
    ds_read_b64_tr_b16 v[196:197], v237 offset:0
    ds_read_b64_tr_b16 v[198:199], v237 offset:6144
    v_mfma_f32_16x16x32_bf16 v[80:83], v[208:211], v[176:179], v[80:83]
    v_mfma_f32_16x16x32_bf16 v[84:87], v[208:211], v[180:183], v[84:87]
    ds_read_b64_tr_b16 v[200:201], v234 offset:128
    ds_read_b64_tr_b16 v[202:203], v234 offset:6272
    v_mfma_f32_16x16x32_bf16 v[88:91], v[212:215], v[176:179], v[88:91]
    v_mfma_f32_16x16x32_bf16 v[92:95], v[212:215], v[180:183], v[92:95]
    ds_read_b64_tr_b16 v[204:205], v235 offset:128
    ds_read_b64_tr_b16 v[206:207], v235 offset:6272
    s_nop 7
    v_mov_b32 v246, v224
    v_mov_b32 v247, v225
    s_nop 1
    v_permlane32_swap_b32 v224, v246
    v_permlane32_swap_b32 v225, v247
    s_nop 0
    v_add_f32 v224, v224, v246
    v_mov_b32 v246, v224
    v_add_f32 v225, v225, v247
    v_mov_b32 v247, v225
    s_nop 1
    v_permlane16_swap_b32 v224, v246
    v_permlane16_swap_b32 v225, v247
    s_nop 0
    v_add_f32 v224, v224, v246
    v_add_f32 v225, v225, v247
    v_rcp_f32 v246, v224
    v_rcp_f32 v247, v225
    s_nop 0
    v_mul_f32 v0, v0, v246
    v_mul_f32 v1, v1, v246
    v_mul_f32 v2, v2, v246
    v_mul_f32 v3, v3, v246
    v_mul_f32 v8, v8, v246
    v_mul_f32 v9, v9, v246
    v_mul_f32 v10, v10, v246
    v_mul_f32 v11, v11, v246
    v_cvt_pk_bf16_f32 v96, v0, v1
    v_cvt_pk_bf16_f32 v97, v2, v3
    v_cvt_pk_bf16_f32 v98, v8, v9
    v_cvt_pk_bf16_f32 v99, v10, v11
    v_mul_f32 v16, v16, v246
    v_mul_f32 v17, v17, v246
    v_mul_f32 v18, v18, v246
    v_mul_f32 v19, v19, v246
    v_mul_f32 v24, v24, v246
    v_mul_f32 v25, v25, v246
    v_mul_f32 v26, v26, v246
    v_mul_f32 v27, v27, v246
    v_cvt_pk_bf16_f32 v100, v16, v17
    v_cvt_pk_bf16_f32 v101, v18, v19
    v_cvt_pk_bf16_f32 v102, v24, v25
    v_cvt_pk_bf16_f32 v103, v26, v27
    v_mul_f32 v32, v32, v246
    v_mul_f32 v33, v33, v246
    v_mul_f32 v34, v34, v246
    v_mul_f32 v35, v35, v246
    v_mul_f32 v40, v40, v246
    v_mul_f32 v41, v41, v246
    v_mul_f32 v42, v42, v246
    v_mul_f32 v43, v43, v246
    v_cvt_pk_bf16_f32 v104, v32, v33
    v_cvt_pk_bf16_f32 v105, v34, v35
    v_cvt_pk_bf16_f32 v106, v40, v41
    v_cvt_pk_bf16_f32 v107, v42, v43
    v_mul_f32 v48, v48, v246
    v_mul_f32 v49, v49, v246
    v_mul_f32 v50, v50, v246
    v_mul_f32 v51, v51, v246
    v_mul_f32 v56, v56, v246
    v_mul_f32 v57, v57, v246
    v_mul_f32 v58, v58, v246
    v_mul_f32 v59, v59, v246
    v_cvt_pk_bf16_f32 v108, v48, v49
    v_cvt_pk_bf16_f32 v109, v50, v51
    v_cvt_pk_bf16_f32 v110, v56, v57
    v_cvt_pk_bf16_f32 v111, v58, v59
    v_mul_f32 v64, v64, v246
    v_mul_f32 v65, v65, v246
    v_mul_f32 v66, v66, v246
    v_mul_f32 v67, v67, v246
    v_mul_f32 v72, v72, v246
    v_mul_f32 v73, v73, v246
    v_mul_f32 v74, v74, v246
    v_mul_f32 v75, v75, v246
    v_cvt_pk_bf16_f32 v112, v64, v65
    v_cvt_pk_bf16_f32 v113, v66, v67
    v_cvt_pk_bf16_f32 v114, v72, v73
    v_cvt_pk_bf16_f32 v115, v74, v75
    v_mul_f32 v80, v80, v246
    v_mul_f32 v81, v81, v246
    v_mul_f32 v82, v82, v246
    v_mul_f32 v83, v83, v246
    v_mul_f32 v88, v88, v246
    v_mul_f32 v89, v89, v246
    v_mul_f32 v90, v90, v246
    v_mul_f32 v91, v91, v246
    v_cvt_pk_bf16_f32 v116, v80, v81
    v_cvt_pk_bf16_f32 v117, v82, v83
    v_cvt_pk_bf16_f32 v118, v88, v89
    v_cvt_pk_bf16_f32 v119, v90, v91
    v_mul_f32 v4, v4, v247
    v_mul_f32 v5, v5, v247
    v_mul_f32 v6, v6, v247
    v_mul_f32 v7, v7, v247
    v_mul_f32 v12, v12, v247
    v_mul_f32 v13, v13, v247
    v_mul_f32 v14, v14, v247
    v_mul_f32 v15, v15, v247
    v_cvt_pk_bf16_f32 v120, v4, v5
    v_cvt_pk_bf16_f32 v121, v6, v7
    v_cvt_pk_bf16_f32 v122, v12, v13
    v_cvt_pk_bf16_f32 v123, v14, v15
    v_mul_f32 v20, v20, v247
    v_mul_f32 v21, v21, v247
    v_mul_f32 v22, v22, v247
    v_mul_f32 v23, v23, v247
    v_mul_f32 v28, v28, v247
    v_mul_f32 v29, v29, v247
    v_mul_f32 v30, v30, v247
    v_mul_f32 v31, v31, v247
    v_cvt_pk_bf16_f32 v124, v20, v21
    v_cvt_pk_bf16_f32 v125, v22, v23
    v_cvt_pk_bf16_f32 v126, v28, v29
    v_cvt_pk_bf16_f32 v127, v30, v31
    v_mul_f32 v36, v36, v247
    v_mul_f32 v37, v37, v247
    v_mul_f32 v38, v38, v247
    v_mul_f32 v39, v39, v247
    v_mul_f32 v44, v44, v247
    v_mul_f32 v45, v45, v247
    v_mul_f32 v46, v46, v247
    v_mul_f32 v47, v47, v247
    v_cvt_pk_bf16_f32 v128, v36, v37
    v_cvt_pk_bf16_f32 v129, v38, v39
    v_cvt_pk_bf16_f32 v130, v44, v45
    v_cvt_pk_bf16_f32 v131, v46, v47
    v_mul_f32 v52, v52, v247
    v_mul_f32 v53, v53, v247
    v_mul_f32 v54, v54, v247
    v_mul_f32 v55, v55, v247
    v_mul_f32 v60, v60, v247
    v_mul_f32 v61, v61, v247
    v_mul_f32 v62, v62, v247
    v_mul_f32 v63, v63, v247
    v_cvt_pk_bf16_f32 v132, v52, v53
    v_cvt_pk_bf16_f32 v133, v54, v55
    v_cvt_pk_bf16_f32 v134, v60, v61
    v_cvt_pk_bf16_f32 v135, v62, v63
    v_mul_f32 v68, v68, v247
    v_mul_f32 v69, v69, v247
    v_mul_f32 v70, v70, v247
    v_mul_f32 v71, v71, v247
    v_mul_f32 v76, v76, v247
    v_mul_f32 v77, v77, v247
    v_mul_f32 v78, v78, v247
    v_mul_f32 v79, v79, v247
    v_cvt_pk_bf16_f32 v136, v68, v69
    v_cvt_pk_bf16_f32 v137, v70, v71
    v_cvt_pk_bf16_f32 v138, v76, v77
    v_cvt_pk_bf16_f32 v139, v78, v79
    v_mul_f32 v84, v84, v247
    v_mul_f32 v85, v85, v247
    v_mul_f32 v86, v86, v247
    v_mul_f32 v87, v87, v247
    v_mul_f32 v92, v92, v247
    v_mul_f32 v93, v93, v247
    v_mul_f32 v94, v94, v247
    v_mul_f32 v95, v95, v247
    v_cvt_pk_bf16_f32 v140, v84, v85
    v_cvt_pk_bf16_f32 v141, v86, v87
    v_cvt_pk_bf16_f32 v142, v92, v93
    v_cvt_pk_bf16_f32 v143, v94, v95
    s_nop 1
K1_BODY:
    s_waitcnt lgkmcnt(14)
    s_waitcnt lgkmcnt(12)
    v_mfma_f32_16x16x32_bf16 v[0:3], v[184:187], v[144:147], 0
    v_mfma_f32_16x16x32_bf16 v[4:7], v[184:187], v[148:151], 0
    ds_read_b64_tr_b16 v[208:209], v236 offset:128
    ds_read_b64_tr_b16 v[210:211], v236 offset:6272
    s_waitcnt lgkmcnt(8)
    v_mfma_f32_16x16x32_bf16 v[8:11], v[188:191], v[144:147], 0
    v_mfma_f32_16x16x32_bf16 v[12:15], v[188:191], v[148:151], 0
    ds_read_b64_tr_b16 v[212:213], v237 offset:128
    ds_read_b64_tr_b16 v[214:215], v237 offset:6272
    v_mfma_f32_16x16x32_bf16 v[16:19], v[192:195], v[144:147], 0
    v_mfma_f32_16x16x32_bf16 v[20:23], v[192:195], v[148:151], 0
    ds_read_b64_tr_b16 v[184:185], v234 offset:256
    ds_read_b64_tr_b16 v[186:187], v234 offset:6400
    s_add_u32 m0, s55, 0
    s_add_u32 s49, s95, 2
    s_sub_u32 s94, s49, 10
    s_cmp_ge_u32 s49, 10
    s_cselect_b32 s49, s94, s49
    s_lshl_b32 s97, s49, 7
    buffer_load_dwordx4 v244, s[36:39], s97 offen lds
    s_waitcnt lgkmcnt(10)
    v_mfma_f32_16x16x32_bf16 v[24:27], v[196:199], v[144:147], 0
    v_mfma_f32_16x16x32_bf16 v[28:31], v[196:199], v[148:151], 0
    ds_read_b64_tr_b16 v[188:189], v235 offset:256
    ds_read_b64_tr_b16 v[190:191], v235 offset:6400
    s_waitcnt lgkmcnt(10)
    v_mfma_f32_16x16x32_bf16 v[32:35], v[200:203], v[144:147], 0
    v_mfma_f32_16x16x32_bf16 v[36:39], v[200:203], v[148:151], 0
    ds_read_b64_tr_b16 v[192:193], v236 offset:256
    ds_read_b64_tr_b16 v[194:195], v236 offset:6400
    buffer_store_dwordx4 v[96:99], v245, s[40:43], 0 offen offset:0
    s_waitcnt lgkmcnt(10)
    v_mfma_f32_16x16x32_bf16 v[40:43], v[204:207], v[144:147], 0
    v_mfma_f32_16x16x32_bf16 v[44:47], v[204:207], v[148:151], 0
    ds_read_b64_tr_b16 v[196:197], v237 offset:256
    ds_read_b64_tr_b16 v[198:199], v237 offset:6400
    s_waitcnt lgkmcnt(10)
    v_mfma_f32_16x16x32_bf16 v[48:51], v[208:211], v[144:147], 0
    v_mfma_f32_16x16x32_bf16 v[52:55], v[208:211], v[148:151], 0
    ds_read_b64_tr_b16 v[200:201], v234 offset:12288
    ds_read_b64_tr_b16 v[202:203], v234 offset:18432
    s_add_u32 m0, s55, 0
    s_add_u32 s97, s97, 9216
    buffer_load_dwordx4 v244, s[36:39], s97 offen offset:1024 lds
    s_waitcnt lgkmcnt(10)
    v_mfma_f32_16x16x32_bf16 v[56:59], v[212:215], v[144:147], 0
    v_mfma_f32_16x16x32_bf16 v[60:63], v[212:215], v[148:151], 0
    ds_read_b64_tr_b16 v[204:205], v235 offset:12288
    ds_read_b64_tr_b16 v[206:207], v235 offset:18432
    s_waitcnt lgkmcnt(10)
    v_mfma_f32_16x16x32_bf16 v[64:67], v[184:187], v[144:147], 0
    v_mfma_f32_16x16x32_bf16 v[68:71], v[184:187], v[148:151], 0
    ds_read_b64_tr_b16 v[208:209], v236 offset:12288
    ds_read_b64_tr_b16 v[210:211], v236 offset:18432
    s_waitcnt lgkmcnt(10)
    v_mfma_f32_16x16x32_bf16 v[72:75], v[188:191], v[144:147], 0
    v_mfma_f32_16x16x32_bf16 v[76:79], v[188:191], v[148:151], 0
    ds_read_b64_tr_b16 v[212:213], v237 offset:12288
    ds_read_b64_tr_b16 v[214:215], v237 offset:18432
    s_add_u32 m0, s45, 73728
    s_nop 0
    buffer_load_dwordx4 v242, s[32:35], s96 offen offset:1024 lds
    s_waitcnt lgkmcnt(10)
    v_mfma_f32_16x16x32_bf16 v[80:83], v[192:195], v[144:147], 0
    v_mfma_f32_16x16x32_bf16 v[84:87], v[192:195], v[148:151], 0
    ds_read_b64_tr_b16 v[184:185], v234 offset:12416
    ds_read_b64_tr_b16 v[186:187], v234 offset:18560
    s_waitcnt lgkmcnt(10)
    v_mfma_f32_16x16x32_bf16 v[88:91], v[196:199], v[144:147], 0
    v_mfma_f32_16x16x32_bf16 v[92:95], v[196:199], v[148:151], 0
    ds_read_b64_tr_b16 v[188:189], v235 offset:12416
    ds_read_b64_tr_b16 v[190:191], v235 offset:18560
    s_waitcnt lgkmcnt(10)
    v_mfma_f32_16x16x32_bf16 v[0:3], v[200:203], v[152:155], v[0:3]
    v_mfma_f32_16x16x32_bf16 v[4:7], v[200:203], v[156:159], v[4:7]
    ds_read_b64_tr_b16 v[192:193], v236 offset:12416
    ds_read_b64_tr_b16 v[194:195], v236 offset:18560
    s_add_u32 m0, s55, 0
    s_add_u32 s97, s97, 9216
    buffer_load_dwordx4 v244, s[36:39], s97 offen offset:2048 lds
    s_waitcnt lgkmcnt(10)
    v_mfma_f32_16x16x32_bf16 v[8:11], v[204:207], v[152:155], v[8:11]
    v_mfma_f32_16x16x32_bf16 v[12:15], v[204:207], v[156:159], v[12:15]
    ds_read_b64_tr_b16 v[196:197], v237 offset:12416
    ds_read_b64_tr_b16 v[198:199], v237 offset:18560
    s_waitcnt lgkmcnt(10)
    v_mfma_f32_16x16x32_bf16 v[16:19], v[208:211], v[152:155], v[16:19]
    v_mfma_f32_16x16x32_bf16 v[20:23], v[208:211], v[156:159], v[20:23]
    ds_read_b64_tr_b16 v[200:201], v234 offset:12544
    ds_read_b64_tr_b16 v[202:203], v234 offset:18688
    buffer_store_dwordx4 v[100:103], v245, s[40:43], 0 offen offset:1024
    s_waitcnt lgkmcnt(10)
    v_mfma_f32_16x16x32_bf16 v[24:27], v[212:215], v[152:155], v[24:27]
    v_mfma_f32_16x16x32_bf16 v[28:31], v[212:215], v[156:159], v[28:31]
    ds_read_b64_tr_b16 v[204:205], v235 offset:12544
    ds_read_b64_tr_b16 v[206:207], v235 offset:18688
    s_waitcnt lgkmcnt(10)
    v_mfma_f32_16x16x32_bf16 v[32:35], v[184:187], v[152:155], v[32:35]
    v_mfma_f32_16x16x32_bf16 v[36:39], v[184:187], v[156:159], v[36:39]
    ds_read_b64_tr_b16 v[208:209], v236 offset:12544
    ds_read_b64_tr_b16 v[210:211], v236 offset:18688
    s_waitcnt lgkmcnt(10)
    v_mfma_f32_16x16x32_bf16 v[40:43], v[188:191], v[152:155], v[40:43]
    v_mfma_f32_16x16x32_bf16 v[44:47], v[188:191], v[156:159], v[44:47]
    ds_read_b64_tr_b16 v[212:213], v237 offset:12544
    ds_read_b64_tr_b16 v[214:215], v237 offset:18688
    s_add_u32 m0, s45, 73728
    s_nop 0
    buffer_load_dwordx4 v243, s[32:35], s96 offen offset:2048 lds
    s_waitcnt lgkmcnt(10)
    v_mfma_f32_16x16x32_bf16 v[48:51], v[192:195], v[152:155], v[48:51]
    v_mfma_f32_16x16x32_bf16 v[52:55], v[192:195], v[156:159], v[52:55]
    s_waitcnt lgkmcnt(8)
    v_mfma_f32_16x16x32_bf16 v[56:59], v[196:199], v[152:155], v[56:59]
    v_mfma_f32_16x16x32_bf16 v[60:63], v[196:199], v[156:159], v[60:63]
    s_add_u32 m0, s55, 0
    s_add_u32 s97, s97, 9216
    buffer_load_dwordx4 v244, s[36:39], s97 offen offset:3072 lds
    s_waitcnt lgkmcnt(6)
    v_mfma_f32_16x16x32_bf16 v[64:67], v[200:203], v[152:155], v[64:67]
    v_mfma_f32_16x16x32_bf16 v[68:71], v[200:203], v[156:159], v[68:71]
    v_add_u32 v234, 24576, v228
    v_add_u32 v235, 24576, v229
    v_add_u32 v236, 24576, v230
    v_add_u32 v237, 24576, v231
    s_waitcnt lgkmcnt(0)
    s_waitcnt vmcnt(12)
    ds_read_b128 v[160:163], v232 offset:4096
    ds_read_b128 v[164:167], v232 offset:6144
    s_barrier
    ds_read_b64_tr_b16 v[184:185], v234 offset:0
    ds_read_b64_tr_b16 v[186:187], v234 offset:6144
    ds_read_b64_tr_b16 v[188:189], v235 offset:0
    ds_read_b64_tr_b16 v[190:191], v235 offset:6144
    ds_read_b64_tr_b16 v[192:193], v236 offset:0
    ds_read_b64_tr_b16 v[194:195], v236 offset:6144
    ds_read_b128 v[168:171], v233 offset:4096
    ds_read_b128 v[172:175], v233 offset:6144
    s_add_u32 m0, s45, 0
    s_add_u32 s49, s95, 4
    s_sub_u32 s94, s49, 10
    s_cmp_ge_u32 s49, 10
    s_cselect_b32 s49, s94, s49
    s_mul_i32 s96, s49, 786432
    buffer_load_dwordx4 v241, s[32:35], s96 offen lds
    s_lshl_b32 s47, s3, 7
    v_mov_b32 v248, 0
    v_mbcnt_lo_u32_b32 v249, -1, 0
    v_lshlrev_b32 v249, 5, v249
    s_mov_b64 exec, 15
    buffer_store_dword v248, v249, s[68:71], s47 offen
    s_mov_b64 exec, -1
    v_mfma_f32_16x16x32_bf16 v[72:75], v[204:207], v[152:155], v[72:75]
    v_mfma_f32_16x16x32_bf16 v[76:79], v[204:207], v[156:159], v[76:79]
    ds_read_b64_tr_b16 v[196:197], v237 offset:0
    ds_read_b64_tr_b16 v[198:199], v237 offset:6144
    v_mfma_f32_16x16x32_bf16 v[80:83], v[208:211], v[152:155], v[80:83]
    v_mfma_f32_16x16x32_bf16 v[84:87], v[208:211], v[156:159], v[84:87]
    ds_read_b64_tr_b16 v[200:201], v234 offset:128
    ds_read_b64_tr_b16 v[202:203], v234 offset:6272
    v_mfma_f32_16x16x32_bf16 v[88:91], v[212:215], v[152:155], v[88:91]
    v_mfma_f32_16x16x32_bf16 v[92:95], v[212:215], v[156:159], v[92:95]
    ds_read_b64_tr_b16 v[204:205], v235 offset:128
    ds_read_b64_tr_b16 v[206:207], v235 offset:6272
    s_waitcnt lgkmcnt(14)
    s_waitcnt lgkmcnt(12)
    v_mfma_f32_16x16x32_bf16 v[0:3], v[184:187], v[160:163], v[0:3]
    v_mfma_f32_16x16x32_bf16 v[4:7], v[184:187], v[164:167], v[4:7]
    ds_read_b64_tr_b16 v[208:209], v236 offset:128
    ds_read_b64_tr_b16 v[210:211], v236 offset:6272
    s_waitcnt lgkmcnt(8)
    v_mfma_f32_16x16x32_bf16 v[8:11], v[188:191], v[160:163], v[8:11]
    v_mfma_f32_16x16x32_bf16 v[12:15], v[188:191], v[164:167], v[12:15]
    ds_read_b64_tr_b16 v[212:213], v237 offset:128
    ds_read_b64_tr_b16 v[214:215], v237 offset:6272
    v_mfma_f32_16x16x32_bf16 v[16:19], v[192:195], v[160:163], v[16:19]
    v_mfma_f32_16x16x32_bf16 v[20:23], v[192:195], v[164:167], v[20:23]
    ds_read_b64_tr_b16 v[184:185], v234 offset:256
    ds_read_b64_tr_b16 v[186:187], v234 offset:6400
    s_add_u32 m0, s55, 4096
    s_add_u32 s49, s95, 3
    s_sub_u32 s94, s49, 10
    s_cmp_ge_u32 s49, 10
    s_cselect_b32 s49, s94, s49
    s_lshl_b32 s97, s49, 7
    buffer_load_dwordx4 v244, s[36:39], s97 offen lds
    s_waitcnt lgkmcnt(10)
    v_mfma_f32_16x16x32_bf16 v[24:27], v[196:199], v[160:163], v[24:27]
    v_mfma_f32_16x16x32_bf16 v[28:31], v[196:199], v[164:167], v[28:31]
    ds_read_b64_tr_b16 v[188:189], v235 offset:256
    ds_read_b64_tr_b16 v[190:191], v235 offset:6400
    s_waitcnt lgkmcnt(10)
    v_mfma_f32_16x16x32_bf16 v[32:35], v[200:203], v[160:163], v[32:35]
    v_mfma_f32_16x16x32_bf16 v[36:39], v[200:203], v[164:167], v[36:39]
    ds_read_b64_tr_b16 v[192:193], v236 offset:256
    ds_read_b64_tr_b16 v[194:195], v236 offset:6400
    buffer_store_dwordx4 v[104:107], v245, s[40:43], 0 offen offset:2048
    s_waitcnt lgkmcnt(10)
    v_mfma_f32_16x16x32_bf16 v[40:43], v[204:207], v[160:163], v[40:43]
    v_mfma_f32_16x16x32_bf16 v[44:47], v[204:207], v[164:167], v[44:47]
    ds_read_b64_tr_b16 v[196:197], v237 offset:256
    ds_read_b64_tr_b16 v[198:199], v237 offset:6400
    s_waitcnt lgkmcnt(10)
    v_mfma_f32_16x16x32_bf16 v[48:51], v[208:211], v[160:163], v[48:51]
    v_mfma_f32_16x16x32_bf16 v[52:55], v[208:211], v[164:167], v[52:55]
    ds_read_b64_tr_b16 v[200:201], v234 offset:12288
    ds_read_b64_tr_b16 v[202:203], v234 offset:18432
    s_add_u32 m0, s55, 4096
    s_add_u32 s97, s97, 9216
    buffer_load_dwordx4 v244, s[36:39], s97 offen offset:1024 lds
    s_waitcnt lgkmcnt(10)
    v_mfma_f32_16x16x32_bf16 v[56:59], v[212:215], v[160:163], v[56:59]
    v_mfma_f32_16x16x32_bf16 v[60:63], v[212:215], v[164:167], v[60:63]
    ds_read_b64_tr_b16 v[204:205], v235 offset:12288
    ds_read_b64_tr_b16 v[206:207], v235 offset:18432
    s_waitcnt lgkmcnt(10)
    v_mfma_f32_16x16x32_bf16 v[64:67], v[184:187], v[160:163], v[64:67]
    v_mfma_f32_16x16x32_bf16 v[68:71], v[184:187], v[164:167], v[68:71]
    ds_read_b64_tr_b16 v[208:209], v236 offset:12288
    ds_read_b64_tr_b16 v[210:211], v236 offset:18432
    s_waitcnt lgkmcnt(10)
    v_mfma_f32_16x16x32_bf16 v[72:75], v[188:191], v[160:163], v[72:75]
    v_mfma_f32_16x16x32_bf16 v[76:79], v[188:191], v[164:167], v[76:79]
    ds_read_b64_tr_b16 v[212:213], v237 offset:12288
    ds_read_b64_tr_b16 v[214:215], v237 offset:18432
    s_add_u32 m0, s45, 0
    s_nop 0
    buffer_load_dwordx4 v242, s[32:35], s96 offen offset:1024 lds
    s_waitcnt lgkmcnt(10)
    v_mfma_f32_16x16x32_bf16 v[80:83], v[192:195], v[160:163], v[80:83]
    v_mfma_f32_16x16x32_bf16 v[84:87], v[192:195], v[164:167], v[84:87]
    ds_read_b64_tr_b16 v[184:185], v234 offset:12416
    ds_read_b64_tr_b16 v[186:187], v234 offset:18560
    s_waitcnt lgkmcnt(10)
    v_mfma_f32_16x16x32_bf16 v[88:91], v[196:199], v[160:163], v[88:91]
    v_mfma_f32_16x16x32_bf16 v[92:95], v[196:199], v[164:167], v[92:95]
    ds_read_b64_tr_b16 v[188:189], v235 offset:12416
    ds_read_b64_tr_b16 v[190:191], v235 offset:18560
    s_waitcnt lgkmcnt(10)
    v_mfma_f32_16x16x32_bf16 v[0:3], v[200:203], v[168:171], v[0:3]
    v_mfma_f32_16x16x32_bf16 v[4:7], v[200:203], v[172:175], v[4:7]
    ds_read_b64_tr_b16 v[192:193], v236 offset:12416
    ds_read_b64_tr_b16 v[194:195], v236 offset:18560
    s_add_u32 m0, s55, 4096
    s_add_u32 s97, s97, 9216
    buffer_load_dwordx4 v244, s[36:39], s97 offen offset:2048 lds
    s_waitcnt lgkmcnt(10)
    v_mfma_f32_16x16x32_bf16 v[8:11], v[204:207], v[168:171], v[8:11]
    v_mfma_f32_16x16x32_bf16 v[12:15], v[204:207], v[172:175], v[12:15]
    ds_read_b64_tr_b16 v[196:197], v237 offset:12416
    ds_read_b64_tr_b16 v[198:199], v237 offset:18560
    s_waitcnt lgkmcnt(10)
    v_mfma_f32_16x16x32_bf16 v[16:19], v[208:211], v[168:171], v[16:19]
    v_mfma_f32_16x16x32_bf16 v[20:23], v[208:211], v[172:175], v[20:23]
    ds_read_b64_tr_b16 v[200:201], v234 offset:12544
    ds_read_b64_tr_b16 v[202:203], v234 offset:18688
    buffer_store_dwordx4 v[108:111], v245, s[40:43], 0 offen offset:3072
    s_waitcnt lgkmcnt(10)
    v_mfma_f32_16x16x32_bf16 v[24:27], v[212:215], v[168:171], v[24:27]
    v_mfma_f32_16x16x32_bf16 v[28:31], v[212:215], v[172:175], v[28:31]
    ds_read_b64_tr_b16 v[204:205], v235 offset:12544
    ds_read_b64_tr_b16 v[206:207], v235 offset:18688
    s_waitcnt lgkmcnt(10)
    v_mfma_f32_16x16x32_bf16 v[32:35], v[184:187], v[168:171], v[32:35]
    v_mfma_f32_16x16x32_bf16 v[36:39], v[184:187], v[172:175], v[36:39]
    ds_read_b64_tr_b16 v[208:209], v236 offset:12544
    ds_read_b64_tr_b16 v[210:211], v236 offset:18688
    s_waitcnt lgkmcnt(10)
    v_mfma_f32_16x16x32_bf16 v[40:43], v[188:191], v[168:171], v[40:43]
    v_mfma_f32_16x16x32_bf16 v[44:47], v[188:191], v[172:175], v[44:47]
    ds_read_b64_tr_b16 v[212:213], v237 offset:12544
    ds_read_b64_tr_b16 v[214:215], v237 offset:18688
    s_add_u32 m0, s45, 0
    s_nop 0
    buffer_load_dwordx4 v243, s[32:35], s96 offen offset:2048 lds
    s_waitcnt lgkmcnt(10)
    v_mfma_f32_16x16x32_bf16 v[48:51], v[192:195], v[168:171], v[48:51]
    v_mfma_f32_16x16x32_bf16 v[52:55], v[192:195], v[172:175], v[52:55]
    s_waitcnt lgkmcnt(8)
    v_mfma_f32_16x16x32_bf16 v[56:59], v[196:199], v[168:171], v[56:59]
    v_mfma_f32_16x16x32_bf16 v[60:63], v[196:199], v[172:175], v[60:63]
    s_add_u32 m0, s55, 4096
    s_add_u32 s97, s97, 9216
    buffer_load_dwordx4 v244, s[36:39], s97 offen offset:3072 lds
    s_waitcnt lgkmcnt(6)
    v_mfma_f32_16x16x32_bf16 v[64:67], v[200:203], v[168:171], v[64:67]
    v_mfma_f32_16x16x32_bf16 v[68:71], v[200:203], v[172:175], v[68:71]
    v_add_u32 v234, 49152, v228
    v_add_u32 v235, 49152, v229
    v_add_u32 v236, 49152, v230
    v_add_u32 v237, 49152, v231
    s_waitcnt lgkmcnt(0)
    s_waitcnt vmcnt(10)
    ds_read_b128 v[144:147], v232 offset:0
    ds_read_b128 v[148:151], v232 offset:2048
    s_barrier
    ds_read_b64_tr_b16 v[184:185], v234 offset:0
    ds_read_b64_tr_b16 v[186:187], v234 offset:6144
    ds_read_b64_tr_b16 v[188:189], v235 offset:0
    ds_read_b64_tr_b16 v[190:191], v235 offset:6144
    ds_read_b64_tr_b16 v[192:193], v236 offset:0
    ds_read_b64_tr_b16 v[194:195], v236 offset:6144
    ds_read_b128 v[152:155], v233 offset:0
    ds_read_b128 v[156:159], v233 offset:2048
    s_add_u32 m0, s45, 24576
    s_add_u32 s49, s95, 5
    s_sub_u32 s94, s49, 10
    s_cmp_ge_u32 s49, 10
    s_cselect_b32 s49, s94, s49
    s_mul_i32 s96, s49, 786432
    buffer_load_dwordx4 v241, s[32:35], s96 offen lds
    v_mfma_f32_16x16x32_bf16 v[72:75], v[204:207], v[168:171], v[72:75]
    v_mfma_f32_16x16x32_bf16 v[76:79], v[204:207], v[172:175], v[76:79]
    ds_read_b64_tr_b16 v[196:197], v237 offset:0
    ds_read_b64_tr_b16 v[198:199], v237 offset:6144
    v_mfma_f32_16x16x32_bf16 v[80:83], v[208:211], v[168:171], v[80:83]
    v_mfma_f32_16x16x32_bf16 v[84:87], v[208:211], v[172:175], v[84:87]
    ds_read_b64_tr_b16 v[200:201], v234 offset:128
    ds_read_b64_tr_b16 v[202:203], v234 offset:6272
    v_mfma_f32_16x16x32_bf16 v[88:91], v[212:215], v[168:171], v[88:91]
    v_mfma_f32_16x16x32_bf16 v[92:95], v[212:215], v[172:175], v[92:95]
    ds_read_b64_tr_b16 v[204:205], v235 offset:128
    ds_read_b64_tr_b16 v[206:207], v235 offset:6272
    s_waitcnt lgkmcnt(14)
    s_waitcnt lgkmcnt(12)
    v_mfma_f32_16x16x32_bf16 v[0:3], v[184:187], v[144:147], v[0:3]
    v_mfma_f32_16x16x32_bf16 v[4:7], v[184:187], v[148:151], v[4:7]
    ds_read_b64_tr_b16 v[208:209], v236 offset:128
    ds_read_b64_tr_b16 v[210:211], v236 offset:6272
    s_waitcnt lgkmcnt(8)
    v_mfma_f32_16x16x32_bf16 v[8:11], v[188:191], v[144:147], v[8:11]
    v_mfma_f32_16x16x32_bf16 v[12:15], v[188:191], v[148:151], v[12:15]
    ds_read_b64_tr_b16 v[212:213], v237 offset:128
    ds_read_b64_tr_b16 v[214:215], v237 offset:6272
    v_mfma_f32_16x16x32_bf16 v[16:19], v[192:195], v[144:147], v[16:19]
    v_mfma_f32_16x16x32_bf16 v[20:23], v[192:195], v[148:151], v[20:23]
    ds_read_b64_tr_b16 v[184:185], v234 offset:256
    ds_read_b64_tr_b16 v[186:187], v234 offset:6400
    s_add_u32 m0, s55, 0
    s_add_u32 s49, s95, 4
    s_sub_u32 s94, s49, 10
    s_cmp_ge_u32 s49, 10
    s_cselect_b32 s49, s94, s49
    s_lshl_b32 s97, s49, 7
    buffer_load_dwordx4 v244, s[36:39], s97 offen lds
    s_waitcnt lgkmcnt(10)
    v_mfma_f32_16x16x32_bf16 v[24:27], v[196:199], v[144:147], v[24:27]
    v_mfma_f32_16x16x32_bf16 v[28:31], v[196:199], v[148:151], v[28:31]
    ds_read_b64_tr_b16 v[188:189], v235 offset:256
    ds_read_b64_tr_b16 v[190:191], v235 offset:6400
    s_waitcnt lgkmcnt(10)
    v_mfma_f32_16x16x32_bf16 v[32:35], v[200:203], v[144:147], v[32:35]
    v_mfma_f32_16x16x32_bf16 v[36:39], v[200:203], v[148:151], v[36:39]
    ds_read_b64_tr_b16 v[192:193], v236 offset:256
    ds_read_b64_tr_b16 v[194:195], v236 offset:6400
    buffer_store_dwordx4 v[112:115], v245, s[40:43], s66 offen offset:0
    s_waitcnt lgkmcnt(10)
    v_mfma_f32_16x16x32_bf16 v[40:43], v[204:207], v[144:147], v[40:43]
    v_mfma_f32_16x16x32_bf16 v[44:47], v[204:207], v[148:151], v[44:47]
    ds_read_b64_tr_b16 v[196:197], v237 offset:256
    ds_read_b64_tr_b16 v[198:199], v237 offset:6400
    s_waitcnt lgkmcnt(10)
    v_mfma_f32_16x16x32_bf16 v[48:51], v[208:211], v[144:147], v[48:51]
    v_mfma_f32_16x16x32_bf16 v[52:55], v[208:211], v[148:151], v[52:55]
    ds_read_b64_tr_b16 v[200:201], v234 offset:12288
    ds_read_b64_tr_b16 v[202:203], v234 offset:18432
    s_add_u32 m0, s55, 0
    s_add_u32 s97, s97, 9216
    buffer_load_dwordx4 v244, s[36:39], s97 offen offset:1024 lds
    s_waitcnt lgkmcnt(10)
    v_mfma_f32_16x16x32_bf16 v[56:59], v[212:215], v[144:147], v[56:59]
    v_mfma_f32_16x16x32_bf16 v[60:63], v[212:215], v[148:151], v[60:63]
    ds_read_b64_tr_b16 v[204:205], v235 offset:12288
    ds_read_b64_tr_b16 v[206:207], v235 offset:18432
    s_waitcnt lgkmcnt(10)
    v_mfma_f32_16x16x32_bf16 v[64:67], v[184:187], v[144:147], v[64:67]
    v_mfma_f32_16x16x32_bf16 v[68:71], v[184:187], v[148:151], v[68:71]
    ds_read_b64_tr_b16 v[208:209], v236 offset:12288
    ds_read_b64_tr_b16 v[210:211], v236 offset:18432
    s_waitcnt lgkmcnt(10)
    v_mfma_f32_16x16x32_bf16 v[72:75], v[188:191], v[144:147], v[72:75]
    v_mfma_f32_16x16x32_bf16 v[76:79], v[188:191], v[148:151], v[76:79]
    ds_read_b64_tr_b16 v[212:213], v237 offset:12288
    ds_read_b64_tr_b16 v[214:215], v237 offset:18432
    s_add_u32 m0, s45, 24576
    s_nop 0
    buffer_load_dwordx4 v242, s[32:35], s96 offen offset:1024 lds
    s_waitcnt lgkmcnt(10)
    v_mfma_f32_16x16x32_bf16 v[80:83], v[192:195], v[144:147], v[80:83]
    v_mfma_f32_16x16x32_bf16 v[84:87], v[192:195], v[148:151], v[84:87]
    ds_read_b64_tr_b16 v[184:185], v234 offset:12416
    ds_read_b64_tr_b16 v[186:187], v234 offset:18560
    s_waitcnt lgkmcnt(10)
    v_mfma_f32_16x16x32_bf16 v[88:91], v[196:199], v[144:147], v[88:91]
    v_mfma_f32_16x16x32_bf16 v[92:95], v[196:199], v[148:151], v[92:95]
    ds_read_b64_tr_b16 v[188:189], v235 offset:12416
    ds_read_b64_tr_b16 v[190:191], v235 offset:18560
    s_waitcnt lgkmcnt(10)
    v_mfma_f32_16x16x32_bf16 v[0:3], v[200:203], v[152:155], v[0:3]
    v_mfma_f32_16x16x32_bf16 v[4:7], v[200:203], v[156:159], v[4:7]
    ds_read_b64_tr_b16 v[192:193], v236 offset:12416
    ds_read_b64_tr_b16 v[194:195], v236 offset:18560
    s_add_u32 m0, s55, 0
    s_add_u32 s97, s97, 9216
    buffer_load_dwordx4 v244, s[36:39], s97 offen offset:2048 lds
    s_waitcnt lgkmcnt(10)
    v_mfma_f32_16x16x32_bf16 v[8:11], v[204:207], v[152:155], v[8:11]
    v_mfma_f32_16x16x32_bf16 v[12:15], v[204:207], v[156:159], v[12:15]
    ds_read_b64_tr_b16 v[196:197], v237 offset:12416
    ds_read_b64_tr_b16 v[198:199], v237 offset:18560
    s_waitcnt lgkmcnt(10)
    v_mfma_f32_16x16x32_bf16 v[16:19], v[208:211], v[152:155], v[16:19]
    v_mfma_f32_16x16x32_bf16 v[20:23], v[208:211], v[156:159], v[20:23]
    ds_read_b64_tr_b16 v[200:201], v234 offset:12544
    ds_read_b64_tr_b16 v[202:203], v234 offset:18688
    buffer_store_dwordx4 v[116:119], v245, s[40:43], s66 offen offset:1024
    s_waitcnt lgkmcnt(10)
    v_mfma_f32_16x16x32_bf16 v[24:27], v[212:215], v[152:155], v[24:27]
    v_mfma_f32_16x16x32_bf16 v[28:31], v[212:215], v[156:159], v[28:31]
    ds_read_b64_tr_b16 v[204:205], v235 offset:12544
    ds_read_b64_tr_b16 v[206:207], v235 offset:18688
    s_waitcnt lgkmcnt(10)
    v_mfma_f32_16x16x32_bf16 v[32:35], v[184:187], v[152:155], v[32:35]
    v_mfma_f32_16x16x32_bf16 v[36:39], v[184:187], v[156:159], v[36:39]
    ds_read_b64_tr_b16 v[208:209], v236 offset:12544
    ds_read_b64_tr_b16 v[210:211], v236 offset:18688
    s_waitcnt lgkmcnt(10)
    v_mfma_f32_16x16x32_bf16 v[40:43], v[188:191], v[152:155], v[40:43]
    v_mfma_f32_16x16x32_bf16 v[44:47], v[188:191], v[156:159], v[44:47]
    ds_read_b64_tr_b16 v[212:213], v237 offset:12544
    ds_read_b64_tr_b16 v[214:215], v237 offset:18688
    s_add_u32 m0, s45, 24576
    s_nop 0
    buffer_load_dwordx4 v243, s[32:35], s96 offen offset:2048 lds
    s_waitcnt lgkmcnt(10)
    v_mfma_f32_16x16x32_bf16 v[48:51], v[192:195], v[152:155], v[48:51]
    v_mfma_f32_16x16x32_bf16 v[52:55], v[192:195], v[156:159], v[52:55]
    s_waitcnt lgkmcnt(8)
    v_mfma_f32_16x16x32_bf16 v[56:59], v[196:199], v[152:155], v[56:59]
    v_mfma_f32_16x16x32_bf16 v[60:63], v[196:199], v[156:159], v[60:63]
    s_add_u32 m0, s55, 0
    s_add_u32 s97, s97, 9216
    buffer_load_dwordx4 v244, s[36:39], s97 offen offset:3072 lds
    s_waitcnt lgkmcnt(6)
    v_mfma_f32_16x16x32_bf16 v[64:67], v[200:203], v[152:155], v[64:67]
    v_mfma_f32_16x16x32_bf16 v[68:71], v[200:203], v[156:159], v[68:71]
    v_add_u32 v234, 73728, v228
    v_add_u32 v235, 73728, v229
    v_add_u32 v236, 73728, v230
    v_add_u32 v237, 73728, v231
    s_waitcnt lgkmcnt(0)
    s_waitcnt vmcnt(9)
    ds_read_b128 v[160:163], v232 offset:4096
    ds_read_b128 v[164:167], v232 offset:6144
    s_barrier
    ds_read_b64_tr_b16 v[184:185], v234 offset:0
    ds_read_b64_tr_b16 v[186:187], v234 offset:6144
    ds_read_b64_tr_b16 v[188:189], v235 offset:0
    ds_read_b64_tr_b16 v[190:191], v235 offset:6144
    ds_read_b64_tr_b16 v[192:193], v236 offset:0
    ds_read_b64_tr_b16 v[194:195], v236 offset:6144
    ds_read_b128 v[168:171], v233 offset:4096
    ds_read_b128 v[172:175], v233 offset:6144
    s_add_u32 m0, s45, 49152
    s_add_u32 s49, s95, 6
    s_sub_u32 s94, s49, 10
    s_cmp_ge_u32 s49, 10
    s_cselect_b32 s49, s94, s49
    s_mul_i32 s96, s49, 786432
    buffer_load_dwordx4 v241, s[32:35], s96 offen lds
    v_mfma_f32_16x16x32_bf16 v[72:75], v[204:207], v[152:155], v[72:75]
    v_mfma_f32_16x16x32_bf16 v[76:79], v[204:207], v[156:159], v[76:79]
    ds_read_b64_tr_b16 v[196:197], v237 offset:0
    ds_read_b64_tr_b16 v[198:199], v237 offset:6144
    v_mfma_f32_16x16x32_bf16 v[80:83], v[208:211], v[152:155], v[80:83]
    v_mfma_f32_16x16x32_bf16 v[84:87], v[208:211], v[156:159], v[84:87]
    ds_read_b64_tr_b16 v[200:201], v234 offset:128
    ds_read_b64_tr_b16 v[202:203], v234 offset:6272
    v_mfma_f32_16x16x32_bf16 v[88:91], v[212:215], v[152:155], v[88:91]
    v_mfma_f32_16x16x32_bf16 v[92:95], v[212:215], v[156:159], v[92:95]
    ds_read_b64_tr_b16 v[204:205], v235 offset:128
    ds_read_b64_tr_b16 v[206:207], v235 offset:6272
    s_waitcnt lgkmcnt(14)
    s_waitcnt lgkmcnt(12)
    v_mfma_f32_16x16x32_bf16 v[0:3], v[184:187], v[160:163], v[0:3]
    v_mfma_f32_16x16x32_bf16 v[4:7], v[184:187], v[164:167], v[4:7]
    ds_read_b64_tr_b16 v[208:209], v236 offset:128
    ds_read_b64_tr_b16 v[210:211], v236 offset:6272
    s_waitcnt lgkmcnt(8)
    v_mfma_f32_16x16x32_bf16 v[8:11], v[188:191], v[160:163], v[8:11]
    v_mfma_f32_16x16x32_bf16 v[12:15], v[188:191], v[164:167], v[12:15]
    ds_read_b64_tr_b16 v[212:213], v237 offset:128
    ds_read_b64_tr_b16 v[214:215], v237 offset:6272
    v_mfma_f32_16x16x32_bf16 v[16:19], v[192:195], v[160:163], v[16:19]
    v_mfma_f32_16x16x32_bf16 v[20:23], v[192:195], v[164:167], v[20:23]
    ds_read_b64_tr_b16 v[184:185], v234 offset:256
    ds_read_b64_tr_b16 v[186:187], v234 offset:6400
    s_add_u32 m0, s55, 4096
    s_add_u32 s49, s95, 5
    s_sub_u32 s94, s49, 10
    s_cmp_ge_u32 s49, 10
    s_cselect_b32 s49, s94, s49
    s_lshl_b32 s97, s49, 7
    buffer_load_dwordx4 v244, s[36:39], s97 offen lds
    s_waitcnt lgkmcnt(10)
    v_mfma_f32_16x16x32_bf16 v[24:27], v[196:199], v[160:163], v[24:27]
    v_mfma_f32_16x16x32_bf16 v[28:31], v[196:199], v[164:167], v[28:31]
    ds_read_b64_tr_b16 v[188:189], v235 offset:256
    ds_read_b64_tr_b16 v[190:191], v235 offset:6400
    s_waitcnt lgkmcnt(10)
    v_mfma_f32_16x16x32_bf16 v[32:35], v[200:203], v[160:163], v[32:35]
    v_mfma_f32_16x16x32_bf16 v[36:39], v[200:203], v[164:167], v[36:39]
    ds_read_b64_tr_b16 v[192:193], v236 offset:256
    ds_read_b64_tr_b16 v[194:195], v236 offset:6400
    buffer_store_dwordx4 v[120:123], v245, s[40:43], s66 offen offset:2048
    s_waitcnt lgkmcnt(10)
    v_mfma_f32_16x16x32_bf16 v[40:43], v[204:207], v[160:163], v[40:43]
    v_mfma_f32_16x16x32_bf16 v[44:47], v[204:207], v[164:167], v[44:47]
    ds_read_b64_tr_b16 v[196:197], v237 offset:256
    ds_read_b64_tr_b16 v[198:199], v237 offset:6400
    s_waitcnt lgkmcnt(10)
    v_mfma_f32_16x16x32_bf16 v[48:51], v[208:211], v[160:163], v[48:51]
    v_mfma_f32_16x16x32_bf16 v[52:55], v[208:211], v[164:167], v[52:55]
    ds_read_b64_tr_b16 v[200:201], v234 offset:12288
    ds_read_b64_tr_b16 v[202:203], v234 offset:18432
    s_add_u32 m0, s55, 4096
    s_add_u32 s97, s97, 9216
    buffer_load_dwordx4 v244, s[36:39], s97 offen offset:1024 lds
    s_waitcnt lgkmcnt(10)
    v_mfma_f32_16x16x32_bf16 v[56:59], v[212:215], v[160:163], v[56:59]
    v_mfma_f32_16x16x32_bf16 v[60:63], v[212:215], v[164:167], v[60:63]
    ds_read_b64_tr_b16 v[204:205], v235 offset:12288
    ds_read_b64_tr_b16 v[206:207], v235 offset:18432
    s_waitcnt lgkmcnt(10)
    v_mfma_f32_16x16x32_bf16 v[64:67], v[184:187], v[160:163], v[64:67]
    v_mfma_f32_16x16x32_bf16 v[68:71], v[184:187], v[164:167], v[68:71]
    ds_read_b64_tr_b16 v[208:209], v236 offset:12288
    ds_read_b64_tr_b16 v[210:211], v236 offset:18432
    s_waitcnt lgkmcnt(10)
    v_mfma_f32_16x16x32_bf16 v[72:75], v[188:191], v[160:163], v[72:75]
    v_mfma_f32_16x16x32_bf16 v[76:79], v[188:191], v[164:167], v[76:79]
    ds_read_b64_tr_b16 v[212:213], v237 offset:12288
    ds_read_b64_tr_b16 v[214:215], v237 offset:18432
    s_add_u32 m0, s45, 49152
    s_nop 0
    buffer_load_dwordx4 v242, s[32:35], s96 offen offset:1024 lds
    s_waitcnt lgkmcnt(10)
    v_mfma_f32_16x16x32_bf16 v[80:83], v[192:195], v[160:163], v[80:83]
    v_mfma_f32_16x16x32_bf16 v[84:87], v[192:195], v[164:167], v[84:87]
    ds_read_b64_tr_b16 v[184:185], v234 offset:12416
    ds_read_b64_tr_b16 v[186:187], v234 offset:18560
    s_waitcnt lgkmcnt(10)
    v_mfma_f32_16x16x32_bf16 v[88:91], v[196:199], v[160:163], v[88:91]
    v_mfma_f32_16x16x32_bf16 v[92:95], v[196:199], v[164:167], v[92:95]
    ds_read_b64_tr_b16 v[188:189], v235 offset:12416
    ds_read_b64_tr_b16 v[190:191], v235 offset:18560
    s_waitcnt lgkmcnt(10)
    v_mfma_f32_16x16x32_bf16 v[0:3], v[200:203], v[168:171], v[0:3]
    v_mfma_f32_16x16x32_bf16 v[4:7], v[200:203], v[172:175], v[4:7]
    ds_read_b64_tr_b16 v[192:193], v236 offset:12416
    ds_read_b64_tr_b16 v[194:195], v236 offset:18560
    s_add_u32 m0, s55, 4096
    s_add_u32 s97, s97, 9216
    buffer_load_dwordx4 v244, s[36:39], s97 offen offset:2048 lds
    s_waitcnt lgkmcnt(10)
    v_mfma_f32_16x16x32_bf16 v[8:11], v[204:207], v[168:171], v[8:11]
    v_mfma_f32_16x16x32_bf16 v[12:15], v[204:207], v[172:175], v[12:15]
    ds_read_b64_tr_b16 v[196:197], v237 offset:12416
    ds_read_b64_tr_b16 v[198:199], v237 offset:18560
    s_waitcnt lgkmcnt(10)
    v_mfma_f32_16x16x32_bf16 v[16:19], v[208:211], v[168:171], v[16:19]
    v_mfma_f32_16x16x32_bf16 v[20:23], v[208:211], v[172:175], v[20:23]
    ds_read_b64_tr_b16 v[200:201], v234 offset:12544
    ds_read_b64_tr_b16 v[202:203], v234 offset:18688
    buffer_store_dwordx4 v[124:127], v245, s[40:43], s66 offen offset:3072
    s_waitcnt lgkmcnt(10)
    v_mfma_f32_16x16x32_bf16 v[24:27], v[212:215], v[168:171], v[24:27]
    v_mfma_f32_16x16x32_bf16 v[28:31], v[212:215], v[172:175], v[28:31]
    ds_read_b64_tr_b16 v[204:205], v235 offset:12544
    ds_read_b64_tr_b16 v[206:207], v235 offset:18688
    s_waitcnt lgkmcnt(10)
    v_mfma_f32_16x16x32_bf16 v[32:35], v[184:187], v[168:171], v[32:35]
    v_mfma_f32_16x16x32_bf16 v[36:39], v[184:187], v[172:175], v[36:39]
    ds_read_b64_tr_b16 v[208:209], v236 offset:12544
    ds_read_b64_tr_b16 v[210:211], v236 offset:18688
    s_waitcnt lgkmcnt(10)
    v_mfma_f32_16x16x32_bf16 v[40:43], v[188:191], v[168:171], v[40:43]
    v_mfma_f32_16x16x32_bf16 v[44:47], v[188:191], v[172:175], v[44:47]
    ds_read_b64_tr_b16 v[212:213], v237 offset:12544
    ds_read_b64_tr_b16 v[214:215], v237 offset:18688
    s_add_u32 m0, s45, 49152
    s_nop 0
    buffer_load_dwordx4 v243, s[32:35], s96 offen offset:2048 lds
    s_waitcnt lgkmcnt(10)
    v_mfma_f32_16x16x32_bf16 v[48:51], v[192:195], v[168:171], v[48:51]
    v_mfma_f32_16x16x32_bf16 v[52:55], v[192:195], v[172:175], v[52:55]
    s_waitcnt lgkmcnt(8)
    v_mfma_f32_16x16x32_bf16 v[56:59], v[196:199], v[168:171], v[56:59]
    v_mfma_f32_16x16x32_bf16 v[60:63], v[196:199], v[172:175], v[60:63]
    s_add_u32 m0, s55, 4096
    s_add_u32 s97, s97, 9216
    buffer_load_dwordx4 v244, s[36:39], s97 offen offset:3072 lds
    s_waitcnt lgkmcnt(6)
    v_mfma_f32_16x16x32_bf16 v[64:67], v[200:203], v[168:171], v[64:67]
    v_mfma_f32_16x16x32_bf16 v[68:71], v[200:203], v[172:175], v[68:71]
    v_add_u32 v234, 0, v228
    v_add_u32 v235, 0, v229
    v_add_u32 v236, 0, v230
    v_add_u32 v237, 0, v231
    s_waitcnt lgkmcnt(0)
    s_waitcnt vmcnt(9)
    ds_read_b128 v[144:147], v232 offset:0
    ds_read_b128 v[148:151], v232 offset:2048
    s_barrier
    ds_read_b64_tr_b16 v[184:185], v234 offset:0
    ds_read_b64_tr_b16 v[186:187], v234 offset:6144
    ds_read_b64_tr_b16 v[188:189], v235 offset:0
    ds_read_b64_tr_b16 v[190:191], v235 offset:6144
    ds_read_b64_tr_b16 v[192:193], v236 offset:0
    ds_read_b64_tr_b16 v[194:195], v236 offset:6144
    ds_read_b128 v[152:155], v233 offset:0
    ds_read_b128 v[156:159], v233 offset:2048
    s_add_u32 m0, s45, 73728
    s_add_u32 s49, s95, 7
    s_sub_u32 s94, s49, 10
    s_cmp_ge_u32 s49, 10
    s_cselect_b32 s49, s94, s49
    s_mul_i32 s96, s49, 786432
    buffer_load_dwordx4 v241, s[32:35], s96 offen lds
    v_mfma_f32_16x16x32_bf16 v[72:75], v[204:207], v[168:171], v[72:75]
    v_mfma_f32_16x16x32_bf16 v[76:79], v[204:207], v[172:175], v[76:79]
    ds_read_b64_tr_b16 v[196:197], v237 offset:0
    ds_read_b64_tr_b16 v[198:199], v237 offset:6144
    v_mfma_f32_16x16x32_bf16 v[80:83], v[208:211], v[168:171], v[80:83]
    v_mfma_f32_16x16x32_bf16 v[84:87], v[208:211], v[172:175], v[84:87]
    ds_read_b64_tr_b16 v[200:201], v234 offset:128
    ds_read_b64_tr_b16 v[202:203], v234 offset:6272
    v_mfma_f32_16x16x32_bf16 v[88:91], v[212:215], v[168:171], v[88:91]
    v_mfma_f32_16x16x32_bf16 v[92:95], v[212:215], v[172:175], v[92:95]
    ds_read_b64_tr_b16 v[204:205], v235 offset:128
    ds_read_b64_tr_b16 v[206:207], v235 offset:6272
    s_waitcnt lgkmcnt(14)
    s_waitcnt lgkmcnt(12)
    v_mfma_f32_16x16x32_bf16 v[0:3], v[184:187], v[144:147], v[0:3]
    v_mfma_f32_16x16x32_bf16 v[4:7], v[184:187], v[148:151], v[4:7]
    ds_read_b64_tr_b16 v[208:209], v236 offset:128
    ds_read_b64_tr_b16 v[210:211], v236 offset:6272
    s_waitcnt lgkmcnt(8)
    v_mfma_f32_16x16x32_bf16 v[8:11], v[188:191], v[144:147], v[8:11]
    v_mfma_f32_16x16x32_bf16 v[12:15], v[188:191], v[148:151], v[12:15]
    ds_read_b64_tr_b16 v[212:213], v237 offset:128
    ds_read_b64_tr_b16 v[214:215], v237 offset:6272
    v_mfma_f32_16x16x32_bf16 v[16:19], v[192:195], v[144:147], v[16:19]
    v_mfma_f32_16x16x32_bf16 v[20:23], v[192:195], v[148:151], v[20:23]
    ds_read_b64_tr_b16 v[184:185], v234 offset:256
    ds_read_b64_tr_b16 v[186:187], v234 offset:6400
    s_add_u32 m0, s55, 0
    s_add_u32 s49, s95, 6
    s_sub_u32 s94, s49, 10
    s_cmp_ge_u32 s49, 10
    s_cselect_b32 s49, s94, s49
    s_lshl_b32 s97, s49, 7
    buffer_load_dwordx4 v244, s[36:39], s97 offen lds
    s_waitcnt lgkmcnt(10)
    v_mfma_f32_16x16x32_bf16 v[24:27], v[196:199], v[144:147], v[24:27]
    v_mfma_f32_16x16x32_bf16 v[28:31], v[196:199], v[148:151], v[28:31]
    ds_read_b64_tr_b16 v[188:189], v235 offset:256
    ds_read_b64_tr_b16 v[190:191], v235 offset:6400
    s_waitcnt lgkmcnt(10)
    v_mfma_f32_16x16x32_bf16 v[32:35], v[200:203], v[144:147], v[32:35]
    v_mfma_f32_16x16x32_bf16 v[36:39], v[200:203], v[148:151], v[36:39]
    ds_read_b64_tr_b16 v[192:193], v236 offset:256
    ds_read_b64_tr_b16 v[194:195], v236 offset:6400
    buffer_store_dwordx4 v[128:131], v245, s[40:43], s67 offen offset:0
    s_waitcnt lgkmcnt(10)
    v_mfma_f32_16x16x32_bf16 v[40:43], v[204:207], v[144:147], v[40:43]
    v_mfma_f32_16x16x32_bf16 v[44:47], v[204:207], v[148:151], v[44:47]
    ds_read_b64_tr_b16 v[196:197], v237 offset:256
    ds_read_b64_tr_b16 v[198:199], v237 offset:6400
    s_waitcnt lgkmcnt(10)
    v_mfma_f32_16x16x32_bf16 v[48:51], v[208:211], v[144:147], v[48:51]
    v_mfma_f32_16x16x32_bf16 v[52:55], v[208:211], v[148:151], v[52:55]
    ds_read_b64_tr_b16 v[200:201], v234 offset:12288
    ds_read_b64_tr_b16 v[202:203], v234 offset:18432
    s_add_u32 m0, s55, 0
    s_add_u32 s97, s97, 9216
    buffer_load_dwordx4 v244, s[36:39], s97 offen offset:1024 lds
    s_waitcnt lgkmcnt(10)
    v_mfma_f32_16x16x32_bf16 v[56:59], v[212:215], v[144:147], v[56:59]
    v_mfma_f32_16x16x32_bf16 v[60:63], v[212:215], v[148:151], v[60:63]
    ds_read_b64_tr_b16 v[204:205], v235 offset:12288
    ds_read_b64_tr_b16 v[206:207], v235 offset:18432
    s_waitcnt lgkmcnt(10)
    v_mfma_f32_16x16x32_bf16 v[64:67], v[184:187], v[144:147], v[64:67]
    v_mfma_f32_16x16x32_bf16 v[68:71], v[184:187], v[148:151], v[68:71]
    ds_read_b64_tr_b16 v[208:209], v236 offset:12288
    ds_read_b64_tr_b16 v[210:211], v236 offset:18432
    s_waitcnt lgkmcnt(10)
    v_mfma_f32_16x16x32_bf16 v[72:75], v[188:191], v[144:147], v[72:75]
    v_mfma_f32_16x16x32_bf16 v[76:79], v[188:191], v[148:151], v[76:79]
    ds_read_b64_tr_b16 v[212:213], v237 offset:12288
    ds_read_b64_tr_b16 v[214:215], v237 offset:18432
    s_add_u32 m0, s45, 73728
    s_nop 0
    buffer_load_dwordx4 v242, s[32:35], s96 offen offset:1024 lds
    s_waitcnt lgkmcnt(10)
    v_mfma_f32_16x16x32_bf16 v[80:83], v[192:195], v[144:147], v[80:83]
    v_mfma_f32_16x16x32_bf16 v[84:87], v[192:195], v[148:151], v[84:87]
    ds_read_b64_tr_b16 v[184:185], v234 offset:12416
    ds_read_b64_tr_b16 v[186:187], v234 offset:18560
    s_waitcnt lgkmcnt(10)
    v_mfma_f32_16x16x32_bf16 v[88:91], v[196:199], v[144:147], v[88:91]
    v_mfma_f32_16x16x32_bf16 v[92:95], v[196:199], v[148:151], v[92:95]
    ds_read_b64_tr_b16 v[188:189], v235 offset:12416
    ds_read_b64_tr_b16 v[190:191], v235 offset:18560
    s_waitcnt lgkmcnt(10)
    v_mfma_f32_16x16x32_bf16 v[0:3], v[200:203], v[152:155], v[0:3]
    v_mfma_f32_16x16x32_bf16 v[4:7], v[200:203], v[156:159], v[4:7]
    ds_read_b64_tr_b16 v[192:193], v236 offset:12416
    ds_read_b64_tr_b16 v[194:195], v236 offset:18560
    s_add_u32 m0, s55, 0
    s_add_u32 s97, s97, 9216
    buffer_load_dwordx4 v244, s[36:39], s97 offen offset:2048 lds
    s_waitcnt lgkmcnt(10)
    v_mfma_f32_16x16x32_bf16 v[8:11], v[204:207], v[152:155], v[8:11]
    v_mfma_f32_16x16x32_bf16 v[12:15], v[204:207], v[156:159], v[12:15]
    ds_read_b64_tr_b16 v[196:197], v237 offset:12416
    ds_read_b64_tr_b16 v[198:199], v237 offset:18560
    s_waitcnt lgkmcnt(10)
    v_mfma_f32_16x16x32_bf16 v[16:19], v[208:211], v[152:155], v[16:19]
    v_mfma_f32_16x16x32_bf16 v[20:23], v[208:211], v[156:159], v[20:23]
    ds_read_b64_tr_b16 v[200:201], v234 offset:12544
    ds_read_b64_tr_b16 v[202:203], v234 offset:18688
    buffer_store_dwordx4 v[132:135], v245, s[40:43], s67 offen offset:1024
    s_waitcnt lgkmcnt(10)
    v_mfma_f32_16x16x32_bf16 v[24:27], v[212:215], v[152:155], v[24:27]
    v_mfma_f32_16x16x32_bf16 v[28:31], v[212:215], v[156:159], v[28:31]
    ds_read_b64_tr_b16 v[204:205], v235 offset:12544
    ds_read_b64_tr_b16 v[206:207], v235 offset:18688
    s_waitcnt lgkmcnt(10)
    v_mfma_f32_16x16x32_bf16 v[32:35], v[184:187], v[152:155], v[32:35]
    v_mfma_f32_16x16x32_bf16 v[36:39], v[184:187], v[156:159], v[36:39]
    ds_read_b64_tr_b16 v[208:209], v236 offset:12544
    ds_read_b64_tr_b16 v[210:211], v236 offset:18688
    s_waitcnt lgkmcnt(10)
    v_mfma_f32_16x16x32_bf16 v[40:43], v[188:191], v[152:155], v[40:43]
    v_mfma_f32_16x16x32_bf16 v[44:47], v[188:191], v[156:159], v[44:47]
    ds_read_b64_tr_b16 v[212:213], v237 offset:12544
    ds_read_b64_tr_b16 v[214:215], v237 offset:18688
    s_add_u32 m0, s45, 73728
    s_nop 0
    buffer_load_dwordx4 v243, s[32:35], s96 offen offset:2048 lds
    s_waitcnt lgkmcnt(10)
    v_mfma_f32_16x16x32_bf16 v[48:51], v[192:195], v[152:155], v[48:51]
    v_mfma_f32_16x16x32_bf16 v[52:55], v[192:195], v[156:159], v[52:55]
    s_waitcnt lgkmcnt(8)
    v_mfma_f32_16x16x32_bf16 v[56:59], v[196:199], v[152:155], v[56:59]
    v_mfma_f32_16x16x32_bf16 v[60:63], v[196:199], v[156:159], v[60:63]
    s_add_u32 m0, s55, 0
    s_add_u32 s97, s97, 9216
    buffer_load_dwordx4 v244, s[36:39], s97 offen offset:3072 lds
    s_waitcnt lgkmcnt(6)
    v_mfma_f32_16x16x32_bf16 v[64:67], v[200:203], v[152:155], v[64:67]
    v_mfma_f32_16x16x32_bf16 v[68:71], v[200:203], v[156:159], v[68:71]
    v_add_u32 v234, 24576, v228
    v_add_u32 v235, 24576, v229
    v_add_u32 v236, 24576, v230
    v_add_u32 v237, 24576, v231
    s_waitcnt lgkmcnt(0)
    s_waitcnt vmcnt(9)
    ds_read_b128 v[160:163], v232 offset:4096
    ds_read_b128 v[164:167], v232 offset:6144
    s_barrier
    ds_read_b64_tr_b16 v[184:185], v234 offset:0
    ds_read_b64_tr_b16 v[186:187], v234 offset:6144
    ds_read_b64_tr_b16 v[188:189], v235 offset:0
    ds_read_b64_tr_b16 v[190:191], v235 offset:6144
    ds_read_b64_tr_b16 v[192:193], v236 offset:0
    ds_read_b64_tr_b16 v[194:195], v236 offset:6144
    ds_read_b128 v[168:171], v233 offset:4096
    ds_read_b128 v[172:175], v233 offset:6144
    s_add_u32 m0, s45, 0
    s_add_u32 s49, s95, 8
    s_sub_u32 s94, s49, 10
    s_cmp_ge_u32 s49, 10
    s_cselect_b32 s49, s94, s49
    s_mul_i32 s96, s49, 786432
    buffer_load_dwordx4 v241, s[32:35], s96 offen lds
    v_mfma_f32_16x16x32_bf16 v[72:75], v[204:207], v[152:155], v[72:75]
    v_mfma_f32_16x16x32_bf16 v[76:79], v[204:207], v[156:159], v[76:79]
    ds_read_b64_tr_b16 v[196:197], v237 offset:0
    ds_read_b64_tr_b16 v[198:199], v237 offset:6144
    v_mfma_f32_16x16x32_bf16 v[80:83], v[208:211], v[152:155], v[80:83]
    v_mfma_f32_16x16x32_bf16 v[84:87], v[208:211], v[156:159], v[84:87]
    ds_read_b64_tr_b16 v[200:201], v234 offset:128
    ds_read_b64_tr_b16 v[202:203], v234 offset:6272
    v_mfma_f32_16x16x32_bf16 v[88:91], v[212:215], v[152:155], v[88:91]
    v_mfma_f32_16x16x32_bf16 v[92:95], v[212:215], v[156:159], v[92:95]
    ds_read_b64_tr_b16 v[204:205], v235 offset:128
    ds_read_b64_tr_b16 v[206:207], v235 offset:6272
    s_waitcnt lgkmcnt(14)
    s_waitcnt lgkmcnt(12)
    v_mfma_f32_16x16x32_bf16 v[0:3], v[184:187], v[160:163], v[0:3]
    v_mfma_f32_16x16x32_bf16 v[4:7], v[184:187], v[164:167], v[4:7]
    ds_read_b64_tr_b16 v[208:209], v236 offset:128
    ds_read_b64_tr_b16 v[210:211], v236 offset:6272
    s_waitcnt lgkmcnt(8)
    v_mfma_f32_16x16x32_bf16 v[8:11], v[188:191], v[160:163], v[8:11]
    v_mfma_f32_16x16x32_bf16 v[12:15], v[188:191], v[164:167], v[12:15]
    ds_read_b64_tr_b16 v[212:213], v237 offset:128
    ds_read_b64_tr_b16 v[214:215], v237 offset:6272
    v_mfma_f32_16x16x32_bf16 v[16:19], v[192:195], v[160:163], v[16:19]
    v_mfma_f32_16x16x32_bf16 v[20:23], v[192:195], v[164:167], v[20:23]
    ds_read_b64_tr_b16 v[184:185], v234 offset:256
    ds_read_b64_tr_b16 v[186:187], v234 offset:6400
    s_add_u32 m0, s55, 4096
    s_add_u32 s49, s95, 7
    s_sub_u32 s94, s49, 10
    s_cmp_ge_u32 s49, 10
    s_cselect_b32 s49, s94, s49
    s_lshl_b32 s97, s49, 7
    buffer_load_dwordx4 v244, s[36:39], s97 offen lds
    s_waitcnt lgkmcnt(10)
    v_mfma_f32_16x16x32_bf16 v[24:27], v[196:199], v[160:163], v[24:27]
    v_mfma_f32_16x16x32_bf16 v[28:31], v[196:199], v[164:167], v[28:31]
    ds_read_b64_tr_b16 v[188:189], v235 offset:256
    ds_read_b64_tr_b16 v[190:191], v235 offset:6400
    s_waitcnt lgkmcnt(10)
    v_mfma_f32_16x16x32_bf16 v[32:35], v[200:203], v[160:163], v[32:35]
    v_mfma_f32_16x16x32_bf16 v[36:39], v[200:203], v[164:167], v[36:39]
    ds_read_b64_tr_b16 v[192:193], v236 offset:256
    ds_read_b64_tr_b16 v[194:195], v236 offset:6400
    buffer_store_dwordx4 v[136:139], v245, s[40:43], s67 offen offset:2048
    s_waitcnt lgkmcnt(10)
    v_mfma_f32_16x16x32_bf16 v[40:43], v[204:207], v[160:163], v[40:43]
    v_mfma_f32_16x16x32_bf16 v[44:47], v[204:207], v[164:167], v[44:47]
    ds_read_b64_tr_b16 v[196:197], v237 offset:256
    ds_read_b64_tr_b16 v[198:199], v237 offset:6400
    s_waitcnt lgkmcnt(10)
    v_mfma_f32_16x16x32_bf16 v[48:51], v[208:211], v[160:163], v[48:51]
    v_mfma_f32_16x16x32_bf16 v[52:55], v[208:211], v[164:167], v[52:55]
    ds_read_b64_tr_b16 v[200:201], v234 offset:12288
    ds_read_b64_tr_b16 v[202:203], v234 offset:18432
    s_add_u32 m0, s55, 4096
    s_add_u32 s97, s97, 9216
    buffer_load_dwordx4 v244, s[36:39], s97 offen offset:1024 lds
    s_waitcnt lgkmcnt(10)
    v_mfma_f32_16x16x32_bf16 v[56:59], v[212:215], v[160:163], v[56:59]
    v_mfma_f32_16x16x32_bf16 v[60:63], v[212:215], v[164:167], v[60:63]
    ds_read_b64_tr_b16 v[204:205], v235 offset:12288
    ds_read_b64_tr_b16 v[206:207], v235 offset:18432
    s_waitcnt lgkmcnt(10)
    v_mfma_f32_16x16x32_bf16 v[64:67], v[184:187], v[160:163], v[64:67]
    v_mfma_f32_16x16x32_bf16 v[68:71], v[184:187], v[164:167], v[68:71]
    ds_read_b64_tr_b16 v[208:209], v236 offset:12288
    ds_read_b64_tr_b16 v[210:211], v236 offset:18432
    s_waitcnt lgkmcnt(10)
    v_mfma_f32_16x16x32_bf16 v[72:75], v[188:191], v[160:163], v[72:75]
    v_mfma_f32_16x16x32_bf16 v[76:79], v[188:191], v[164:167], v[76:79]
    ds_read_b64_tr_b16 v[212:213], v237 offset:12288
    ds_read_b64_tr_b16 v[214:215], v237 offset:18432
    s_add_u32 m0, s45, 0
    s_nop 0
    buffer_load_dwordx4 v242, s[32:35], s96 offen offset:1024 lds
    s_waitcnt lgkmcnt(10)
    v_mfma_f32_16x16x32_bf16 v[80:83], v[192:195], v[160:163], v[80:83]
    v_mfma_f32_16x16x32_bf16 v[84:87], v[192:195], v[164:167], v[84:87]
    ds_read_b64_tr_b16 v[184:185], v234 offset:12416
    ds_read_b64_tr_b16 v[186:187], v234 offset:18560
    s_waitcnt lgkmcnt(10)
    v_mfma_f32_16x16x32_bf16 v[88:91], v[196:199], v[160:163], v[88:91]
    v_mfma_f32_16x16x32_bf16 v[92:95], v[196:199], v[164:167], v[92:95]
    ds_read_b64_tr_b16 v[188:189], v235 offset:12416
    ds_read_b64_tr_b16 v[190:191], v235 offset:18560
    s_waitcnt lgkmcnt(10)
    v_mfma_f32_16x16x32_bf16 v[0:3], v[200:203], v[168:171], v[0:3]
    v_mfma_f32_16x16x32_bf16 v[4:7], v[200:203], v[172:175], v[4:7]
    ds_read_b64_tr_b16 v[192:193], v236 offset:12416
    ds_read_b64_tr_b16 v[194:195], v236 offset:18560
    s_add_u32 m0, s55, 4096
    s_add_u32 s97, s97, 9216
    buffer_load_dwordx4 v244, s[36:39], s97 offen offset:2048 lds
    s_waitcnt lgkmcnt(10)
    v_mfma_f32_16x16x32_bf16 v[8:11], v[204:207], v[168:171], v[8:11]
    v_mfma_f32_16x16x32_bf16 v[12:15], v[204:207], v[172:175], v[12:15]
    ds_read_b64_tr_b16 v[196:197], v237 offset:12416
    ds_read_b64_tr_b16 v[198:199], v237 offset:18560
    s_waitcnt lgkmcnt(10)
    v_mfma_f32_16x16x32_bf16 v[16:19], v[208:211], v[168:171], v[16:19]
    v_mfma_f32_16x16x32_bf16 v[20:23], v[208:211], v[172:175], v[20:23]
    ds_read_b64_tr_b16 v[200:201], v234 offset:12544
    ds_read_b64_tr_b16 v[202:203], v234 offset:18688
    buffer_store_dwordx4 v[140:143], v245, s[40:43], s67 offen offset:3072
    s_waitcnt lgkmcnt(10)
    v_mfma_f32_16x16x32_bf16 v[24:27], v[212:215], v[168:171], v[24:27]
    v_mfma_f32_16x16x32_bf16 v[28:31], v[212:215], v[172:175], v[28:31]
    ds_read_b64_tr_b16 v[204:205], v235 offset:12544
    ds_read_b64_tr_b16 v[206:207], v235 offset:18688
    s_waitcnt lgkmcnt(10)
    v_mfma_f32_16x16x32_bf16 v[32:35], v[184:187], v[168:171], v[32:35]
    v_mfma_f32_16x16x32_bf16 v[36:39], v[184:187], v[172:175], v[36:39]
    ds_read_b64_tr_b16 v[208:209], v236 offset:12544
    ds_read_b64_tr_b16 v[210:211], v236 offset:18688
    s_waitcnt lgkmcnt(10)
    v_mfma_f32_16x16x32_bf16 v[40:43], v[188:191], v[168:171], v[40:43]
    v_mfma_f32_16x16x32_bf16 v[44:47], v[188:191], v[172:175], v[44:47]
    ds_read_b64_tr_b16 v[212:213], v237 offset:12544
    ds_read_b64_tr_b16 v[214:215], v237 offset:18688
    s_add_u32 m0, s45, 0
    s_nop 0
    buffer_load_dwordx4 v243, s[32:35], s96 offen offset:2048 lds
    s_waitcnt lgkmcnt(10)
    v_mfma_f32_16x16x32_bf16 v[48:51], v[192:195], v[168:171], v[48:51]
    v_mfma_f32_16x16x32_bf16 v[52:55], v[192:195], v[172:175], v[52:55]
    s_waitcnt lgkmcnt(8)
    v_mfma_f32_16x16x32_bf16 v[56:59], v[196:199], v[168:171], v[56:59]
    v_mfma_f32_16x16x32_bf16 v[60:63], v[196:199], v[172:175], v[60:63]
    s_add_u32 m0, s55, 4096
    s_add_u32 s97, s97, 9216
    buffer_load_dwordx4 v244, s[36:39], s97 offen offset:3072 lds
    s_waitcnt lgkmcnt(6)
    v_mfma_f32_16x16x32_bf16 v[64:67], v[200:203], v[168:171], v[64:67]
    v_mfma_f32_16x16x32_bf16 v[68:71], v[200:203], v[172:175], v[68:71]
    v_add_u32 v234, 49152, v228
    v_add_u32 v235, 49152, v229
    v_add_u32 v236, 49152, v230
    v_add_u32 v237, 49152, v231
    s_waitcnt lgkmcnt(0)
    s_waitcnt vmcnt(9)
    ds_read_b128 v[144:147], v232 offset:0
    ds_read_b128 v[148:151], v232 offset:2048
    s_barrier
    ds_read_b64_tr_b16 v[184:185], v234 offset:0
    ds_read_b64_tr_b16 v[186:187], v234 offset:6144
    ds_read_b64_tr_b16 v[188:189], v235 offset:0
    ds_read_b64_tr_b16 v[190:191], v235 offset:6144
    ds_read_b64_tr_b16 v[192:193], v236 offset:0
    ds_read_b64_tr_b16 v[194:195], v236 offset:6144
    ds_read_b128 v[152:155], v233 offset:0
    ds_read_b128 v[156:159], v233 offset:2048
    s_add_u32 m0, s45, 24576
    s_add_u32 s49, s95, 9
    s_sub_u32 s94, s49, 10
    s_cmp_ge_u32 s49, 10
    s_cselect_b32 s49, s94, s49
    s_mul_i32 s96, s49, 786432
    buffer_load_dwordx4 v241, s[32:35], s96 offen lds
    v_mfma_f32_16x16x32_bf16 v[72:75], v[204:207], v[168:171], v[72:75]
    v_mfma_f32_16x16x32_bf16 v[76:79], v[204:207], v[172:175], v[76:79]
    ds_read_b64_tr_b16 v[196:197], v237 offset:0
    ds_read_b64_tr_b16 v[198:199], v237 offset:6144
    v_mfma_f32_16x16x32_bf16 v[80:83], v[208:211], v[168:171], v[80:83]
    v_mfma_f32_16x16x32_bf16 v[84:87], v[208:211], v[172:175], v[84:87]
    ds_read_b64_tr_b16 v[200:201], v234 offset:128
    ds_read_b64_tr_b16 v[202:203], v234 offset:6272
    v_mfma_f32_16x16x32_bf16 v[88:91], v[212:215], v[168:171], v[88:91]
    v_mfma_f32_16x16x32_bf16 v[92:95], v[212:215], v[172:175], v[92:95]
    ds_read_b64_tr_b16 v[204:205], v235 offset:128
    ds_read_b64_tr_b16 v[206:207], v235 offset:6272
    s_waitcnt lgkmcnt(14)
    s_waitcnt lgkmcnt(12)
    v_mfma_f32_16x16x32_bf16 v[0:3], v[184:187], v[144:147], v[0:3]
    v_mfma_f32_16x16x32_bf16 v[4:7], v[184:187], v[148:151], v[4:7]
    ds_read_b64_tr_b16 v[208:209], v236 offset:128
    ds_read_b64_tr_b16 v[210:211], v236 offset:6272
    s_waitcnt lgkmcnt(8)
    v_mfma_f32_16x16x32_bf16 v[8:11], v[188:191], v[144:147], v[8:11]
    v_mfma_f32_16x16x32_bf16 v[12:15], v[188:191], v[148:151], v[12:15]
    ds_read_b64_tr_b16 v[212:213], v237 offset:128
    ds_read_b64_tr_b16 v[214:215], v237 offset:6272
    v_mfma_f32_16x16x32_bf16 v[16:19], v[192:195], v[144:147], v[16:19]
    v_mfma_f32_16x16x32_bf16 v[20:23], v[192:195], v[148:151], v[20:23]
    ds_read_b64_tr_b16 v[184:185], v234 offset:256
    ds_read_b64_tr_b16 v[186:187], v234 offset:6400
    s_add_u32 m0, s55, 0
    s_add_u32 s49, s95, 8
    s_sub_u32 s94, s49, 10
    s_cmp_ge_u32 s49, 10
    s_cselect_b32 s49, s94, s49
    s_lshl_b32 s97, s49, 7
    buffer_load_dwordx4 v244, s[36:39], s97 offen lds
    s_waitcnt lgkmcnt(10)
    v_mfma_f32_16x16x32_bf16 v[24:27], v[196:199], v[144:147], v[24:27]
    v_mfma_f32_16x16x32_bf16 v[28:31], v[196:199], v[148:151], v[28:31]
    ds_read_b64_tr_b16 v[188:189], v235 offset:256
    ds_read_b64_tr_b16 v[190:191], v235 offset:6400
    s_waitcnt lgkmcnt(10)
    v_mfma_f32_16x16x32_bf16 v[32:35], v[200:203], v[144:147], v[32:35]
    v_mfma_f32_16x16x32_bf16 v[36:39], v[200:203], v[148:151], v[36:39]
    ds_read_b64_tr_b16 v[192:193], v236 offset:256
    ds_read_b64_tr_b16 v[194:195], v236 offset:6400
    s_waitcnt lgkmcnt(10)
    v_mfma_f32_16x16x32_bf16 v[40:43], v[204:207], v[144:147], v[40:43]
    v_mfma_f32_16x16x32_bf16 v[44:47], v[204:207], v[148:151], v[44:47]
    ds_read_b64_tr_b16 v[196:197], v237 offset:256
    ds_read_b64_tr_b16 v[198:199], v237 offset:6400
    s_waitcnt lgkmcnt(10)
    v_mfma_f32_16x16x32_bf16 v[48:51], v[208:211], v[144:147], v[48:51]
    v_mfma_f32_16x16x32_bf16 v[52:55], v[208:211], v[148:151], v[52:55]
    ds_read_b64_tr_b16 v[200:201], v234 offset:12288
    ds_read_b64_tr_b16 v[202:203], v234 offset:18432
    s_add_u32 m0, s55, 0
    s_add_u32 s97, s97, 9216
    buffer_load_dwordx4 v244, s[36:39], s97 offen offset:1024 lds
    s_waitcnt lgkmcnt(10)
    v_mfma_f32_16x16x32_bf16 v[56:59], v[212:215], v[144:147], v[56:59]
    v_mfma_f32_16x16x32_bf16 v[60:63], v[212:215], v[148:151], v[60:63]
    ds_read_b64_tr_b16 v[204:205], v235 offset:12288
    ds_read_b64_tr_b16 v[206:207], v235 offset:18432
    s_waitcnt lgkmcnt(10)
    v_mfma_f32_16x16x32_bf16 v[64:67], v[184:187], v[144:147], v[64:67]
    v_mfma_f32_16x16x32_bf16 v[68:71], v[184:187], v[148:151], v[68:71]
    ds_read_b64_tr_b16 v[208:209], v236 offset:12288
    ds_read_b64_tr_b16 v[210:211], v236 offset:18432
    s_waitcnt lgkmcnt(10)
    v_mfma_f32_16x16x32_bf16 v[72:75], v[188:191], v[144:147], v[72:75]
    v_mfma_f32_16x16x32_bf16 v[76:79], v[188:191], v[148:151], v[76:79]
    ds_read_b64_tr_b16 v[212:213], v237 offset:12288
    ds_read_b64_tr_b16 v[214:215], v237 offset:18432
    s_add_u32 m0, s45, 24576
    s_nop 0
    buffer_load_dwordx4 v242, s[32:35], s96 offen offset:1024 lds
    s_waitcnt lgkmcnt(10)
    v_mfma_f32_16x16x32_bf16 v[80:83], v[192:195], v[144:147], v[80:83]
    v_mfma_f32_16x16x32_bf16 v[84:87], v[192:195], v[148:151], v[84:87]
    ds_read_b64_tr_b16 v[184:185], v234 offset:12416
    ds_read_b64_tr_b16 v[186:187], v234 offset:18560
    s_waitcnt lgkmcnt(10)
    v_mfma_f32_16x16x32_bf16 v[88:91], v[196:199], v[144:147], v[88:91]
    v_mfma_f32_16x16x32_bf16 v[92:95], v[196:199], v[148:151], v[92:95]
    ds_read_b64_tr_b16 v[188:189], v235 offset:12416
    ds_read_b64_tr_b16 v[190:191], v235 offset:18560
    s_waitcnt lgkmcnt(10)
    v_mfma_f32_16x16x32_bf16 v[0:3], v[200:203], v[152:155], v[0:3]
    v_mfma_f32_16x16x32_bf16 v[4:7], v[200:203], v[156:159], v[4:7]
    ds_read_b64_tr_b16 v[192:193], v236 offset:12416
    ds_read_b64_tr_b16 v[194:195], v236 offset:18560
    s_add_u32 m0, s55, 0
    s_add_u32 s97, s97, 9216
    buffer_load_dwordx4 v244, s[36:39], s97 offen offset:2048 lds
    s_waitcnt lgkmcnt(10)
    v_mfma_f32_16x16x32_bf16 v[8:11], v[204:207], v[152:155], v[8:11]
    v_mfma_f32_16x16x32_bf16 v[12:15], v[204:207], v[156:159], v[12:15]
    ds_read_b64_tr_b16 v[196:197], v237 offset:12416
    ds_read_b64_tr_b16 v[198:199], v237 offset:18560
    s_waitcnt lgkmcnt(10)
    v_mfma_f32_16x16x32_bf16 v[16:19], v[208:211], v[152:155], v[16:19]
    v_mfma_f32_16x16x32_bf16 v[20:23], v[208:211], v[156:159], v[20:23]
    ds_read_b64_tr_b16 v[200:201], v234 offset:12544
    ds_read_b64_tr_b16 v[202:203], v234 offset:18688
    s_waitcnt lgkmcnt(10)
    v_mfma_f32_16x16x32_bf16 v[24:27], v[212:215], v[152:155], v[24:27]
    v_mfma_f32_16x16x32_bf16 v[28:31], v[212:215], v[156:159], v[28:31]
    ds_read_b64_tr_b16 v[204:205], v235 offset:12544
    ds_read_b64_tr_b16 v[206:207], v235 offset:18688
    s_waitcnt lgkmcnt(10)
    v_mfma_f32_16x16x32_bf16 v[32:35], v[184:187], v[152:155], v[32:35]
    v_mfma_f32_16x16x32_bf16 v[36:39], v[184:187], v[156:159], v[36:39]
    ds_read_b64_tr_b16 v[208:209], v236 offset:12544
    ds_read_b64_tr_b16 v[210:211], v236 offset:18688
    s_waitcnt lgkmcnt(10)
    v_mfma_f32_16x16x32_bf16 v[40:43], v[188:191], v[152:155], v[40:43]
    v_mfma_f32_16x16x32_bf16 v[44:47], v[188:191], v[156:159], v[44:47]
    ds_read_b64_tr_b16 v[212:213], v237 offset:12544
    ds_read_b64_tr_b16 v[214:215], v237 offset:18688
    s_add_u32 m0, s45, 24576
    s_nop 0
    buffer_load_dwordx4 v243, s[32:35], s96 offen offset:2048 lds
    s_waitcnt lgkmcnt(10)
    v_mfma_f32_16x16x32_bf16 v[48:51], v[192:195], v[152:155], v[48:51]
    v_mfma_f32_16x16x32_bf16 v[52:55], v[192:195], v[156:159], v[52:55]
    s_waitcnt lgkmcnt(8)
    v_mfma_f32_16x16x32_bf16 v[56:59], v[196:199], v[152:155], v[56:59]
    v_mfma_f32_16x16x32_bf16 v[60:63], v[196:199], v[156:159], v[60:63]
    s_add_u32 m0, s55, 0
    s_add_u32 s97, s97, 9216
    buffer_load_dwordx4 v244, s[36:39], s97 offen offset:3072 lds
    s_waitcnt lgkmcnt(6)
    v_mfma_f32_16x16x32_bf16 v[64:67], v[200:203], v[152:155], v[64:67]
    v_mfma_f32_16x16x32_bf16 v[68:71], v[200:203], v[156:159], v[68:71]
    v_add_u32 v234, 73728, v228
    v_add_u32 v235, 73728, v229
    v_add_u32 v236, 73728, v230
    v_add_u32 v237, 73728, v231
    s_waitcnt lgkmcnt(0)
    s_waitcnt vmcnt(7)
    ds_read_b128 v[160:163], v232 offset:4096
    ds_read_b128 v[164:167], v232 offset:6144
    s_barrier
    ds_read_b64_tr_b16 v[184:185], v234 offset:0
    ds_read_b64_tr_b16 v[186:187], v234 offset:6144
    ds_read_b64_tr_b16 v[188:189], v235 offset:0
    ds_read_b64_tr_b16 v[190:191], v235 offset:6144
    ds_read_b64_tr_b16 v[192:193], v236 offset:0
    ds_read_b64_tr_b16 v[194:195], v236 offset:6144
    ds_read_b128 v[168:171], v233 offset:4096
    ds_read_b128 v[172:175], v233 offset:6144
    s_add_u32 m0, s45, 49152
    s_mov_b32 s96, 0
    buffer_load_dwordx4 v238, s[24:27], s96 offen nt lds
    v_mfma_f32_16x16x32_bf16 v[72:75], v[204:207], v[152:155], v[72:75]
    v_mfma_f32_16x16x32_bf16 v[76:79], v[204:207], v[156:159], v[76:79]
    ds_read_b64_tr_b16 v[196:197], v237 offset:0
    ds_read_b64_tr_b16 v[198:199], v237 offset:6144
    v_mfma_f32_16x16x32_bf16 v[80:83], v[208:211], v[152:155], v[80:83]
    v_mfma_f32_16x16x32_bf16 v[84:87], v[208:211], v[156:159], v[84:87]
    ds_read_b64_tr_b16 v[200:201], v234 offset:128
    ds_read_b64_tr_b16 v[202:203], v234 offset:6272
    v_mfma_f32_16x16x32_bf16 v[88:91], v[212:215], v[152:155], v[88:91]
    v_mfma_f32_16x16x32_bf16 v[92:95], v[212:215], v[156:159], v[92:95]
    ds_read_b64_tr_b16 v[204:205], v235 offset:128
    ds_read_b64_tr_b16 v[206:207], v235 offset:6272
    s_waitcnt lgkmcnt(14)
    s_waitcnt lgkmcnt(12)
    v_mfma_f32_16x16x32_bf16 v[0:3], v[184:187], v[160:163], v[0:3]
    v_mfma_f32_16x16x32_bf16 v[4:7], v[184:187], v[164:167], v[4:7]
    ds_read_b64_tr_b16 v[208:209], v236 offset:128
    ds_read_b64_tr_b16 v[210:211], v236 offset:6272
    s_waitcnt lgkmcnt(8)
    v_mfma_f32_16x16x32_bf16 v[8:11], v[188:191], v[160:163], v[8:11]
    v_mfma_f32_16x16x32_bf16 v[12:15], v[188:191], v[164:167], v[12:15]
    ds_read_b64_tr_b16 v[212:213], v237 offset:128
    ds_read_b64_tr_b16 v[214:215], v237 offset:6272
    v_mfma_f32_16x16x32_bf16 v[16:19], v[192:195], v[160:163], v[16:19]
    v_mfma_f32_16x16x32_bf16 v[20:23], v[192:195], v[164:167], v[20:23]
    ds_read_b64_tr_b16 v[184:185], v234 offset:256
    ds_read_b64_tr_b16 v[186:187], v234 offset:6400
    s_add_u32 m0, s55, 4096
    s_add_u32 s49, s95, 9
    s_sub_u32 s94, s49, 10
    s_cmp_ge_u32 s49, 10
    s_cselect_b32 s49, s94, s49
    s_lshl_b32 s97, s49, 7
    buffer_load_dwordx4 v244, s[36:39], s97 offen lds
    s_waitcnt lgkmcnt(10)
    v_mfma_f32_16x16x32_bf16 v[24:27], v[196:199], v[160:163], v[24:27]
    v_mfma_f32_16x16x32_bf16 v[28:31], v[196:199], v[164:167], v[28:31]
    ds_read_b64_tr_b16 v[188:189], v235 offset:256
    ds_read_b64_tr_b16 v[190:191], v235 offset:6400
    s_waitcnt lgkmcnt(10)
    v_mfma_f32_16x16x32_bf16 v[32:35], v[200:203], v[160:163], v[32:35]
    v_mfma_f32_16x16x32_bf16 v[36:39], v[200:203], v[164:167], v[36:39]
    ds_read_b64_tr_b16 v[192:193], v236 offset:256
    ds_read_b64_tr_b16 v[194:195], v236 offset:6400
    s_waitcnt lgkmcnt(10)
    v_mfma_f32_16x16x32_bf16 v[40:43], v[204:207], v[160:163], v[40:43]
    v_mfma_f32_16x16x32_bf16 v[44:47], v[204:207], v[164:167], v[44:47]
    ds_read_b64_tr_b16 v[196:197], v237 offset:256
    ds_read_b64_tr_b16 v[198:199], v237 offset:6400
    s_waitcnt lgkmcnt(10)
    v_mfma_f32_16x16x32_bf16 v[48:51], v[208:211], v[160:163], v[48:51]
    v_mfma_f32_16x16x32_bf16 v[52:55], v[208:211], v[164:167], v[52:55]
    ds_read_b64_tr_b16 v[200:201], v234 offset:12288
    ds_read_b64_tr_b16 v[202:203], v234 offset:18432
    s_add_u32 m0, s55, 4096
    s_add_u32 s97, s97, 9216
    buffer_load_dwordx4 v244, s[36:39], s97 offen offset:1024 lds
    s_waitcnt lgkmcnt(10)
    v_mfma_f32_16x16x32_bf16 v[56:59], v[212:215], v[160:163], v[56:59]
    v_mfma_f32_16x16x32_bf16 v[60:63], v[212:215], v[164:167], v[60:63]
    ds_read_b64_tr_b16 v[204:205], v235 offset:12288
    ds_read_b64_tr_b16 v[206:207], v235 offset:18432
    s_waitcnt lgkmcnt(10)
    v_mfma_f32_16x16x32_bf16 v[64:67], v[184:187], v[160:163], v[64:67]
    v_mfma_f32_16x16x32_bf16 v[68:71], v[184:187], v[164:167], v[68:71]
    ds_read_b64_tr_b16 v[208:209], v236 offset:12288
    ds_read_b64_tr_b16 v[210:211], v236 offset:18432
    s_waitcnt lgkmcnt(10)
    v_mfma_f32_16x16x32_bf16 v[72:75], v[188:191], v[160:163], v[72:75]
    v_mfma_f32_16x16x32_bf16 v[76:79], v[188:191], v[164:167], v[76:79]
    ds_read_b64_tr_b16 v[212:213], v237 offset:12288
    ds_read_b64_tr_b16 v[214:215], v237 offset:18432
    s_add_u32 m0, s45, 49152
    s_nop 0
    buffer_load_dwordx4 v239, s[24:27], s96 offen offset:1024 nt lds
    s_waitcnt lgkmcnt(10)
    v_mfma_f32_16x16x32_bf16 v[80:83], v[192:195], v[160:163], v[80:83]
    v_mfma_f32_16x16x32_bf16 v[84:87], v[192:195], v[164:167], v[84:87]
    ds_read_b64_tr_b16 v[184:185], v234 offset:12416
    ds_read_b64_tr_b16 v[186:187], v234 offset:18560
    s_waitcnt lgkmcnt(10)
    v_mfma_f32_16x16x32_bf16 v[88:91], v[196:199], v[160:163], v[88:91]
    v_mfma_f32_16x16x32_bf16 v[92:95], v[196:199], v[164:167], v[92:95]
    ds_read_b64_tr_b16 v[188:189], v235 offset:12416
    ds_read_b64_tr_b16 v[190:191], v235 offset:18560
    s_waitcnt lgkmcnt(10)
    v_mfma_f32_16x16x32_bf16 v[0:3], v[200:203], v[168:171], v[0:3]
    v_mfma_f32_16x16x32_bf16 v[4:7], v[200:203], v[172:175], v[4:7]
    ds_read_b64_tr_b16 v[192:193], v236 offset:12416
    ds_read_b64_tr_b16 v[194:195], v236 offset:18560
    s_add_u32 m0, s55, 4096
    s_add_u32 s97, s97, 9216
    buffer_load_dwordx4 v244, s[36:39], s97 offen offset:2048 lds
    s_waitcnt lgkmcnt(10)
    v_mfma_f32_16x16x32_bf16 v[8:11], v[204:207], v[168:171], v[8:11]
    v_mfma_f32_16x16x32_bf16 v[12:15], v[204:207], v[172:175], v[12:15]
    ds_read_b64_tr_b16 v[196:197], v237 offset:12416
    ds_read_b64_tr_b16 v[198:199], v237 offset:18560
    s_waitcnt lgkmcnt(10)
    v_mfma_f32_16x16x32_bf16 v[16:19], v[208:211], v[168:171], v[16:19]
    v_mfma_f32_16x16x32_bf16 v[20:23], v[208:211], v[172:175], v[20:23]
    ds_read_b64_tr_b16 v[200:201], v234 offset:12544
    ds_read_b64_tr_b16 v[202:203], v234 offset:18688
    s_waitcnt lgkmcnt(10)
    v_mfma_f32_16x16x32_bf16 v[24:27], v[212:215], v[168:171], v[24:27]
    v_mfma_f32_16x16x32_bf16 v[28:31], v[212:215], v[172:175], v[28:31]
    ds_read_b64_tr_b16 v[204:205], v235 offset:12544
    ds_read_b64_tr_b16 v[206:207], v235 offset:18688
    s_waitcnt lgkmcnt(10)
    v_mfma_f32_16x16x32_bf16 v[32:35], v[184:187], v[168:171], v[32:35]
    v_mfma_f32_16x16x32_bf16 v[36:39], v[184:187], v[172:175], v[36:39]
    ds_read_b64_tr_b16 v[208:209], v236 offset:12544
    ds_read_b64_tr_b16 v[210:211], v236 offset:18688
    s_waitcnt lgkmcnt(10)
    v_mfma_f32_16x16x32_bf16 v[40:43], v[188:191], v[168:171], v[40:43]
    v_mfma_f32_16x16x32_bf16 v[44:47], v[188:191], v[172:175], v[44:47]
    ds_read_b64_tr_b16 v[212:213], v237 offset:12544
    ds_read_b64_tr_b16 v[214:215], v237 offset:18688
    s_add_u32 m0, s45, 49152
    s_nop 0
    buffer_load_dwordx4 v240, s[24:27], s96 offen offset:2048 nt lds
    s_waitcnt lgkmcnt(10)
    v_mfma_f32_16x16x32_bf16 v[48:51], v[192:195], v[168:171], v[48:51]
    v_mfma_f32_16x16x32_bf16 v[52:55], v[192:195], v[172:175], v[52:55]
    s_waitcnt lgkmcnt(8)
    v_mfma_f32_16x16x32_bf16 v[56:59], v[196:199], v[168:171], v[56:59]
    v_mfma_f32_16x16x32_bf16 v[60:63], v[196:199], v[172:175], v[60:63]
    s_add_u32 m0, s55, 4096
    s_add_u32 s97, s97, 9216
    buffer_load_dwordx4 v244, s[36:39], s97 offen offset:3072 lds
    s_waitcnt lgkmcnt(6)
    v_mfma_f32_16x16x32_bf16 v[64:67], v[200:203], v[168:171], v[64:67]
    v_mfma_f32_16x16x32_bf16 v[68:71], v[200:203], v[172:175], v[68:71]
    v_add_u32 v234, 0, v228
    v_add_u32 v235, 0, v229
    v_add_u32 v236, 0, v230
    v_add_u32 v237, 0, v231
    s_waitcnt lgkmcnt(0)
    s_waitcnt vmcnt(7)
    ds_read_b128 v[144:147], v232 offset:0
    ds_read_b128 v[148:151], v232 offset:2048
    s_barrier
    ds_read_b64_tr_b16 v[184:185], v234 offset:0
    ds_read_b64_tr_b16 v[186:187], v234 offset:6144
    ds_read_b64_tr_b16 v[188:189], v235 offset:0
    ds_read_b64_tr_b16 v[190:191], v235 offset:6144
    ds_read_b64_tr_b16 v[192:193], v236 offset:0
    ds_read_b64_tr_b16 v[194:195], v236 offset:6144
    ds_read_b128 v[152:155], v233 offset:0
    ds_read_b128 v[156:159], v233 offset:2048
    s_add_u32 m0, s45, 73728
    s_mov_b32 s96, 12288
    buffer_load_dwordx4 v238, s[24:27], s96 offen nt lds
    v_mfma_f32_16x16x32_bf16 v[72:75], v[204:207], v[168:171], v[72:75]
    v_mfma_f32_16x16x32_bf16 v[76:79], v[204:207], v[172:175], v[76:79]
    ds_read_b64_tr_b16 v[196:197], v237 offset:0
    ds_read_b64_tr_b16 v[198:199], v237 offset:6144
    v_mfma_f32_16x16x32_bf16 v[80:83], v[208:211], v[168:171], v[80:83]
    v_mfma_f32_16x16x32_bf16 v[84:87], v[208:211], v[172:175], v[84:87]
    ds_read_b64_tr_b16 v[200:201], v234 offset:128
    ds_read_b64_tr_b16 v[202:203], v234 offset:6272
    v_mfma_f32_16x16x32_bf16 v[88:91], v[212:215], v[168:171], v[88:91]
    v_mfma_f32_16x16x32_bf16 v[92:95], v[212:215], v[172:175], v[92:95]
    ds_read_b64_tr_b16 v[204:205], v235 offset:128
    ds_read_b64_tr_b16 v[206:207], v235 offset:6272
    s_waitcnt lgkmcnt(14)
    s_waitcnt lgkmcnt(12)
    v_mfma_f32_16x16x32_bf16 v[0:3], v[184:187], v[144:147], v[0:3]
    v_mfma_f32_16x16x32_bf16 v[4:7], v[184:187], v[148:151], v[4:7]
    ds_read_b64_tr_b16 v[208:209], v236 offset:128
    ds_read_b64_tr_b16 v[210:211], v236 offset:6272
    s_waitcnt lgkmcnt(8)
    v_mfma_f32_16x16x32_bf16 v[8:11], v[188:191], v[144:147], v[8:11]
    v_mfma_f32_16x16x32_bf16 v[12:15], v[188:191], v[148:151], v[12:15]
    ds_read_b64_tr_b16 v[212:213], v237 offset:128
    ds_read_b64_tr_b16 v[214:215], v237 offset:6272
    v_mfma_f32_16x16x32_bf16 v[16:19], v[192:195], v[144:147], v[16:19]
    v_mfma_f32_16x16x32_bf16 v[20:23], v[192:195], v[148:151], v[20:23]
    ds_read_b64_tr_b16 v[184:185], v234 offset:256
    ds_read_b64_tr_b16 v[186:187], v234 offset:6400
    s_waitcnt lgkmcnt(10)
    v_mfma_f32_16x16x32_bf16 v[24:27], v[196:199], v[144:147], v[24:27]
    v_mfma_f32_16x16x32_bf16 v[28:31], v[196:199], v[148:151], v[28:31]
    ds_read_b64_tr_b16 v[188:189], v235 offset:256
    ds_read_b64_tr_b16 v[190:191], v235 offset:6400
    s_waitcnt lgkmcnt(10)
    v_mfma_f32_16x16x32_bf16 v[32:35], v[200:203], v[144:147], v[32:35]
    v_mfma_f32_16x16x32_bf16 v[36:39], v[200:203], v[148:151], v[36:39]
    ds_read_b64_tr_b16 v[192:193], v236 offset:256
    ds_read_b64_tr_b16 v[194:195], v236 offset:6400
    s_waitcnt vmcnt(1)
    ds_read_b128 v[160:163], v232 offset:4096
    ds_read_b128 v[164:167], v232 offset:6144
    ds_read_b128 v[168:171], v233 offset:4096
    ds_read_b128 v[172:175], v233 offset:6144
    s_waitcnt lgkmcnt(14)
    v_mfma_f32_16x16x32_bf16 v[40:43], v[204:207], v[144:147], v[40:43]
    v_mfma_f32_16x16x32_bf16 v[44:47], v[204:207], v[148:151], v[44:47]
    ds_read_b64_tr_b16 v[196:197], v237 offset:256
    ds_read_b64_tr_b16 v[198:199], v237 offset:6400
    s_waitcnt lgkmcnt(14)
    v_mfma_f32_16x16x32_bf16 v[48:51], v[208:211], v[144:147], v[48:51]
    v_mfma_f32_16x16x32_bf16 v[52:55], v[208:211], v[148:151], v[52:55]
    ds_read_b64_tr_b16 v[200:201], v234 offset:12288
    ds_read_b64_tr_b16 v[202:203], v234 offset:18432
    s_waitcnt lgkmcnt(14)
    v_mfma_f32_16x16x32_bf16 v[56:59], v[212:215], v[144:147], v[56:59]
    v_mfma_f32_16x16x32_bf16 v[60:63], v[212:215], v[148:151], v[60:63]
    ds_read_b64_tr_b16 v[204:205], v235 offset:12288
    ds_read_b64_tr_b16 v[206:207], v235 offset:18432
    s_waitcnt lgkmcnt(14)
    v_mfma_f32_16x16x32_bf16 v[64:67], v[184:187], v[144:147], v[64:67]
    v_mfma_f32_16x16x32_bf16 v[68:71], v[184:187], v[148:151], v[68:71]
    ds_read_b64_tr_b16 v[208:209], v236 offset:12288
    ds_read_b64_tr_b16 v[210:211], v236 offset:18432
    s_waitcnt lgkmcnt(14)
    v_mfma_f32_16x16x32_bf16 v[72:75], v[188:191], v[144:147], v[72:75]
    v_mfma_f32_16x16x32_bf16 v[76:79], v[188:191], v[148:151], v[76:79]
    ds_read_b64_tr_b16 v[212:213], v237 offset:12288
    ds_read_b64_tr_b16 v[214:215], v237 offset:18432
    s_add_u32 m0, s45, 73728
    s_nop 0
    buffer_load_dwordx4 v239, s[24:27], s96 offen offset:1024 nt lds
    s_waitcnt lgkmcnt(14)
    v_mfma_f32_16x16x32_bf16 v[80:83], v[192:195], v[144:147], v[80:83]
    v_mfma_f32_16x16x32_bf16 v[84:87], v[192:195], v[148:151], v[84:87]
    ds_read_b64_tr_b16 v[184:185], v234 offset:12416
    ds_read_b64_tr_b16 v[186:187], v234 offset:18560
    s_waitcnt lgkmcnt(10)
    v_mfma_f32_16x16x32_bf16 v[88:91], v[196:199], v[144:147], v[88:91]
    v_mfma_f32_16x16x32_bf16 v[92:95], v[196:199], v[148:151], v[92:95]
    ds_read_b64_tr_b16 v[188:189], v235 offset:12416
    ds_read_b64_tr_b16 v[190:191], v235 offset:18560
    s_waitcnt lgkmcnt(10)
    v_mfma_f32_16x16x32_bf16 v[0:3], v[200:203], v[152:155], v[0:3]
    v_mfma_f32_16x16x32_bf16 v[4:7], v[200:203], v[156:159], v[4:7]
    ds_read_b64_tr_b16 v[192:193], v236 offset:12416
    ds_read_b64_tr_b16 v[194:195], v236 offset:18560
    s_waitcnt lgkmcnt(10)
    v_mfma_f32_16x16x32_bf16 v[8:11], v[204:207], v[152:155], v[8:11]
    v_mfma_f32_16x16x32_bf16 v[12:15], v[204:207], v[156:159], v[12:15]
    ds_read_b64_tr_b16 v[196:197], v237 offset:12416
    ds_read_b64_tr_b16 v[198:199], v237 offset:18560
    s_waitcnt lgkmcnt(10)
    v_mfma_f32_16x16x32_bf16 v[16:19], v[208:211], v[152:155], v[16:19]
    v_mfma_f32_16x16x32_bf16 v[20:23], v[208:211], v[156:159], v[20:23]
    ds_read_b64_tr_b16 v[200:201], v234 offset:12544
    ds_read_b64_tr_b16 v[202:203], v234 offset:18688
    s_waitcnt lgkmcnt(10)
    v_mfma_f32_16x16x32_bf16 v[24:27], v[212:215], v[152:155], v[24:27]
    v_mfma_f32_16x16x32_bf16 v[28:31], v[212:215], v[156:159], v[28:31]
    ds_read_b64_tr_b16 v[204:205], v235 offset:12544
    ds_read_b64_tr_b16 v[206:207], v235 offset:18688
    s_waitcnt lgkmcnt(10)
    v_mfma_f32_16x16x32_bf16 v[32:35], v[184:187], v[152:155], v[32:35]
    v_mfma_f32_16x16x32_bf16 v[36:39], v[184:187], v[156:159], v[36:39]
    ds_read_b64_tr_b16 v[208:209], v236 offset:12544
    ds_read_b64_tr_b16 v[210:211], v236 offset:18688
    s_waitcnt lgkmcnt(10)
    v_mfma_f32_16x16x32_bf16 v[40:43], v[188:191], v[152:155], v[40:43]
    v_mfma_f32_16x16x32_bf16 v[44:47], v[188:191], v[156:159], v[44:47]
    ds_read_b64_tr_b16 v[212:213], v237 offset:12544
    ds_read_b64_tr_b16 v[214:215], v237 offset:18688
    s_add_u32 m0, s45, 73728
    s_nop 0
    buffer_load_dwordx4 v240, s[24:27], s96 offen offset:2048 nt lds
    s_waitcnt lgkmcnt(10)
    v_mfma_f32_16x16x32_bf16 v[48:51], v[192:195], v[152:155], v[48:51]
    v_mfma_f32_16x16x32_bf16 v[52:55], v[192:195], v[156:159], v[52:55]
    s_waitcnt lgkmcnt(8)
    v_mfma_f32_16x16x32_bf16 v[56:59], v[196:199], v[152:155], v[56:59]
    v_mfma_f32_16x16x32_bf16 v[60:63], v[196:199], v[156:159], v[60:63]
    s_waitcnt lgkmcnt(6)
    v_mfma_f32_16x16x32_bf16 v[64:67], v[200:203], v[152:155], v[64:67]
    v_mfma_f32_16x16x32_bf16 v[68:71], v[200:203], v[156:159], v[68:71]
    v_add_u32 v234, 24576, v228
    v_add_u32 v235, 24576, v229
    v_add_u32 v236, 24576, v230
    v_add_u32 v237, 24576, v231
    s_waitcnt lgkmcnt(0)
    s_barrier
    ds_read_b64_tr_b16 v[184:185], v234 offset:0
    ds_read_b64_tr_b16 v[186:187], v234 offset:6144
    ds_read_b64_tr_b16 v[188:189], v235 offset:0
    ds_read_b64_tr_b16 v[190:191], v235 offset:6144
    ds_read_b64_tr_b16 v[192:193], v236 offset:0
    ds_read_b64_tr_b16 v[194:195], v236 offset:6144
    s_add_u32 m0, s45, 98304
    s_mov_b32 s96, 0
    buffer_load_dwordx4 v238, s[28:31], s96 offen nt lds
    v_mfma_f32_16x16x32_bf16 v[72:75], v[204:207], v[152:155], v[72:75]
    v_mfma_f32_16x16x32_bf16 v[76:79], v[204:207], v[156:159], v[76:79]
    ds_read_b64_tr_b16 v[196:197], v237 offset:0
    ds_read_b64_tr_b16 v[198:199], v237 offset:6144
    v_mfma_f32_16x16x32_bf16 v[80:83], v[208:211], v[152:155], v[80:83]
    v_mfma_f32_16x16x32_bf16 v[84:87], v[208:211], v[156:159], v[84:87]
    ds_read_b64_tr_b16 v[200:201], v234 offset:128
    ds_read_b64_tr_b16 v[202:203], v234 offset:6272
    v_mfma_f32_16x16x32_bf16 v[88:91], v[212:215], v[152:155], v[88:91]
    v_mfma_f32_16x16x32_bf16 v[92:95], v[212:215], v[156:159], v[92:95]
    ds_read_b64_tr_b16 v[204:205], v235 offset:128
    ds_read_b64_tr_b16 v[206:207], v235 offset:6272
    s_waitcnt lgkmcnt(10)
    v_mfma_f32_16x16x32_bf16 v[0:3], v[184:187], v[160:163], v[0:3]
    v_mfma_f32_16x16x32_bf16 v[4:7], v[184:187], v[164:167], v[4:7]
    ds_read_b64_tr_b16 v[208:209], v236 offset:128
    ds_read_b64_tr_b16 v[210:211], v236 offset:6272
    s_waitcnt lgkmcnt(10)
    v_mfma_f32_16x16x32_bf16 v[8:11], v[188:191], v[160:163], v[8:11]
    v_mfma_f32_16x16x32_bf16 v[12:15], v[188:191], v[164:167], v[12:15]
    ds_read_b64_tr_b16 v[212:213], v237 offset:128
    ds_read_b64_tr_b16 v[214:215], v237 offset:6272
    s_waitcnt lgkmcnt(10)
    v_mfma_f32_16x16x32_bf16 v[16:19], v[192:195], v[160:163], v[16:19]
    v_mfma_f32_16x16x32_bf16 v[20:23], v[192:195], v[164:167], v[20:23]
    ds_read_b64_tr_b16 v[184:185], v234 offset:256
    ds_read_b64_tr_b16 v[186:187], v234 offset:6400
    s_add_u32 m0, s45, 98304
    s_nop 0
    buffer_load_dwordx4 v239, s[28:31], s96 offen offset:1024 nt lds
    s_waitcnt lgkmcnt(10)
    v_mfma_f32_16x16x32_bf16 v[24:27], v[196:199], v[160:163], v[24:27]
    v_mfma_f32_16x16x32_bf16 v[28:31], v[196:199], v[164:167], v[28:31]
    ds_read_b64_tr_b16 v[188:189], v235 offset:256
    ds_read_b64_tr_b16 v[190:191], v235 offset:6400
    s_waitcnt lgkmcnt(10)
    v_mfma_f32_16x16x32_bf16 v[32:35], v[200:203], v[160:163], v[32:35]
    v_mfma_f32_16x16x32_bf16 v[36:39], v[200:203], v[164:167], v[36:39]
    ds_read_b64_tr_b16 v[192:193], v236 offset:256
    ds_read_b64_tr_b16 v[194:195], v236 offset:6400
    s_add_u32 m0, s45, 98304
    s_nop 0
    buffer_load_dwordx4 v240, s[28:31], s96 offen offset:2048 nt lds
    s_waitcnt lgkmcnt(10)
    v_mfma_f32_16x16x32_bf16 v[40:43], v[204:207], v[160:163], v[40:43]
    v_mfma_f32_16x16x32_bf16 v[44:47], v[204:207], v[164:167], v[44:47]
    ds_read_b64_tr_b16 v[196:197], v237 offset:256
    ds_read_b64_tr_b16 v[198:199], v237 offset:6400
    s_waitcnt lgkmcnt(10)
    v_mfma_f32_16x16x32_bf16 v[48:51], v[208:211], v[160:163], v[48:51]
    v_mfma_f32_16x16x32_bf16 v[52:55], v[208:211], v[164:167], v[52:55]
    ds_read_b64_tr_b16 v[200:201], v234 offset:12288
    ds_read_b64_tr_b16 v[202:203], v234 offset:18432
    s_add_u32 m0, s45, 122880
    s_mov_b32 s96, 24576
    buffer_load_dwordx4 v238, s[24:27], s96 offen nt lds
    s_waitcnt lgkmcnt(10)
    v_mfma_f32_16x16x32_bf16 v[56:59], v[212:215], v[160:163], v[56:59]
    v_mfma_f32_16x16x32_bf16 v[60:63], v[212:215], v[164:167], v[60:63]
    ds_read_b64_tr_b16 v[204:205], v235 offset:12288
    ds_read_b64_tr_b16 v[206:207], v235 offset:18432
    s_waitcnt lgkmcnt(10)
    v_mfma_f32_16x16x32_bf16 v[64:67], v[184:187], v[160:163], v[64:67]
    v_mfma_f32_16x16x32_bf16 v[68:71], v[184:187], v[164:167], v[68:71]
    ds_read_b64_tr_b16 v[208:209], v236 offset:12288
    ds_read_b64_tr_b16 v[210:211], v236 offset:18432
    s_add_u32 m0, s45, 122880
    s_nop 0
    buffer_load_dwordx4 v239, s[24:27], s96 offen offset:1024 nt lds
    s_waitcnt lgkmcnt(10)
    v_mfma_f32_16x16x32_bf16 v[72:75], v[188:191], v[160:163], v[72:75]
    v_mfma_f32_16x16x32_bf16 v[76:79], v[188:191], v[164:167], v[76:79]
    ds_read_b64_tr_b16 v[212:213], v237 offset:12288
    ds_read_b64_tr_b16 v[214:215], v237 offset:18432
    s_waitcnt lgkmcnt(10)
    v_mfma_f32_16x16x32_bf16 v[80:83], v[192:195], v[160:163], v[80:83]
    v_mfma_f32_16x16x32_bf16 v[84:87], v[192:195], v[164:167], v[84:87]
    ds_read_b64_tr_b16 v[184:185], v234 offset:12416
    ds_read_b64_tr_b16 v[186:187], v234 offset:18560
    s_add_u32 m0, s45, 122880
    s_nop 0
    buffer_load_dwordx4 v240, s[24:27], s96 offen offset:2048 nt lds
    s_waitcnt lgkmcnt(10)
    v_mfma_f32_16x16x32_bf16 v[88:91], v[196:199], v[160:163], v[88:91]
    v_mfma_f32_16x16x32_bf16 v[92:95], v[196:199], v[164:167], v[92:95]
    ds_read_b64_tr_b16 v[188:189], v235 offset:12416
    ds_read_b64_tr_b16 v[190:191], v235 offset:18560
    s_waitcnt lgkmcnt(10)
    v_mfma_f32_16x16x32_bf16 v[0:3], v[200:203], v[168:171], v[0:3]
    v_mfma_f32_16x16x32_bf16 v[4:7], v[200:203], v[172:175], v[4:7]
    ds_read_b64_tr_b16 v[192:193], v236 offset:12416
    ds_read_b64_tr_b16 v[194:195], v236 offset:18560
    s_add_u32 m0, s45, 0
    s_mov_b32 s96, 12288
    buffer_load_dwordx4 v238, s[28:31], s96 offen nt lds
    s_waitcnt lgkmcnt(10)
    v_mfma_f32_16x16x32_bf16 v[8:11], v[204:207], v[168:171], v[8:11]
    v_mfma_f32_16x16x32_bf16 v[12:15], v[204:207], v[172:175], v[12:15]
    ds_read_b64_tr_b16 v[196:197], v237 offset:12416
    ds_read_b64_tr_b16 v[198:199], v237 offset:18560
    s_waitcnt lgkmcnt(10)
    v_mfma_f32_16x16x32_bf16 v[16:19], v[208:211], v[168:171], v[16:19]
    v_mfma_f32_16x16x32_bf16 v[20:23], v[208:211], v[172:175], v[20:23]
    ds_read_b64_tr_b16 v[200:201], v234 offset:12544
    ds_read_b64_tr_b16 v[202:203], v234 offset:18688
    s_add_u32 m0, s45, 0
    s_nop 0
    buffer_load_dwordx4 v239, s[28:31], s96 offen offset:1024 nt lds
    s_waitcnt lgkmcnt(10)
    v_mfma_f32_16x16x32_bf16 v[24:27], v[212:215], v[168:171], v[24:27]
    v_mfma_f32_16x16x32_bf16 v[28:31], v[212:215], v[172:175], v[28:31]
    ds_read_b64_tr_b16 v[204:205], v235 offset:12544
    ds_read_b64_tr_b16 v[206:207], v235 offset:18688
    s_waitcnt lgkmcnt(10)
    v_mfma_f32_16x16x32_bf16 v[32:35], v[184:187], v[168:171], v[32:35]
    v_mfma_f32_16x16x32_bf16 v[36:39], v[184:187], v[172:175], v[36:39]
    ds_read_b64_tr_b16 v[208:209], v236 offset:12544
    ds_read_b64_tr_b16 v[210:211], v236 offset:18688
    s_add_u32 m0, s45, 0
    s_nop 0
    buffer_load_dwordx4 v240, s[28:31], s96 offen offset:2048 nt lds
    s_waitcnt lgkmcnt(10)
    v_mfma_f32_16x16x32_bf16 v[40:43], v[188:191], v[168:171], v[40:43]
    v_mfma_f32_16x16x32_bf16 v[44:47], v[188:191], v[172:175], v[44:47]
    ds_read_b64_tr_b16 v[212:213], v237 offset:12544
    ds_read_b64_tr_b16 v[214:215], v237 offset:18688
    s_waitcnt lgkmcnt(10)
    v_mfma_f32_16x16x32_bf16 v[48:51], v[192:195], v[168:171], v[48:51]
    v_mfma_f32_16x16x32_bf16 v[52:55], v[192:195], v[172:175], v[52:55]
    s_waitcnt lgkmcnt(8)
    v_mfma_f32_16x16x32_bf16 v[56:59], v[196:199], v[168:171], v[56:59]
    v_mfma_f32_16x16x32_bf16 v[60:63], v[196:199], v[172:175], v[60:63]
    s_waitcnt lgkmcnt(6)
    v_mfma_f32_16x16x32_bf16 v[64:67], v[200:203], v[168:171], v[64:67]
    v_mfma_f32_16x16x32_bf16 v[68:71], v[200:203], v[172:175], v[68:71]
    s_add_u32 s48, s52, 49152
    v_add_u32 v234, s48, v226
    v_add_u32 v235, s48, v227
    s_waitcnt lgkmcnt(0)
    s_barrier
    ds_read_b128 v[184:187], v234 offset:0
    ds_read_b128 v[188:191], v234 offset:6144
    ds_read_b128 v[192:195], v235 offset:0
    s_add_u32 m0, s45, 24576
    s_mov_b32 s96, 36864
    buffer_load_dwordx4 v238, s[24:27], s96 offen nt lds
    v_mfma_f32_16x16x32_bf16 v[72:75], v[204:207], v[168:171], v[72:75]
    v_mfma_f32_16x16x32_bf16 v[76:79], v[204:207], v[172:175], v[76:79]
    ds_read_b128 v[196:199], v235 offset:6144
    v_mfma_f32_16x16x32_bf16 v[80:83], v[208:211], v[168:171], v[80:83]
    v_mfma_f32_16x16x32_bf16 v[84:87], v[208:211], v[172:175], v[84:87]
    ds_read_b128 v[200:203], v234 offset:128
    v_mfma_f32_16x16x32_bf16 v[88:91], v[212:215], v[168:171], v[88:91]
    v_mfma_f32_16x16x32_bf16 v[92:95], v[212:215], v[172:175], v[92:95]
    ds_read_b128 v[204:207], v234 offset:6272
    s_nop 7
    v_mul_f32 v0, s46, v0
    v_mul_f32 v1, s46, v1
    v_mul_f32 v2, s46, v2
    v_mul_f32 v3, s46, v3
    v_mul_f32 v4, s46, v4
    v_mul_f32 v5, s46, v5
    v_mul_f32 v6, s46, v6
    v_mul_f32 v7, s46, v7
    v_mul_f32 v8, s46, v8
    v_mul_f32 v9, s46, v9
    v_mul_f32 v10, s46, v10
    v_mul_f32 v11, s46, v11
    v_mul_f32 v12, s46, v12
    v_mul_f32 v13, s46, v13
    v_mul_f32 v14, s46, v14
    v_mul_f32 v15, s46, v15
    v_mul_f32 v16, s46, v16
    v_mul_f32 v17, s46, v17
    v_mul_f32 v18, s46, v18
    v_mul_f32 v19, s46, v19
    v_mul_f32 v20, s46, v20
    v_mul_f32 v21, s46, v21
    v_mul_f32 v22, s46, v22
    v_mul_f32 v23, s46, v23
    v_mul_f32 v24, s46, v24
    v_mul_f32 v25, s46, v25
    v_mul_f32 v26, s46, v26
    v_mul_f32 v27, s46, v27
    v_mul_f32 v28, s46, v28
    v_mul_f32 v29, s46, v29
    v_mul_f32 v30, s46, v30
    v_mul_f32 v31, s46, v31
    v_mul_f32 v32, s46, v32
    v_mul_f32 v33, s46, v33
    v_mul_f32 v34, s46, v34
    v_mul_f32 v35, s46, v35
    v_mul_f32 v36, s46, v36
    v_mul_f32 v37, s46, v37
    v_mul_f32 v38, s46, v38
    v_mul_f32 v39, s46, v39
    v_mul_f32 v40, s46, v40
    v_mul_f32 v41, s46, v41
    v_mul_f32 v42, s46, v42
    v_mul_f32 v43, s46, v43
    v_mul_f32 v44, s46, v44
    v_mul_f32 v45, s46, v45
    v_mul_f32 v46, s46, v46
    v_mul_f32 v47, s46, v47
    v_mul_f32 v48, s46, v48
    v_mul_f32 v49, s46, v49
    v_mul_f32 v50, s46, v50
    v_mul_f32 v51, s46, v51
    v_mul_f32 v52, s46, v52
    v_mul_f32 v53, s46, v53
    v_mul_f32 v54, s46, v54
    v_mul_f32 v55, s46, v55
    v_mul_f32 v56, s46, v56
    v_mul_f32 v57, s46, v57
    v_mul_f32 v58, s46, v58
    v_mul_f32 v59, s46, v59
    v_mul_f32 v60, s46, v60
    v_mul_f32 v61, s46, v61
    v_mul_f32 v62, s46, v62
    v_mul_f32 v63, s46, v63
    v_mul_f32 v64, s46, v64
    v_mul_f32 v65, s46, v65
    v_mul_f32 v66, s46, v66
    v_mul_f32 v67, s46, v67
    v_mul_f32 v68, s46, v68
    v_mul_f32 v69, s46, v69
    v_mul_f32 v70, s46, v70
    v_mul_f32 v71, s46, v71
    v_mul_f32 v72, s46, v72
    v_mul_f32 v73, s46, v73
    v_mul_f32 v74, s46, v74
    v_mul_f32 v75, s46, v75
    v_mul_f32 v76, s46, v76
    v_mul_f32 v77, s46, v77
    v_mul_f32 v78, s46, v78
    v_mul_f32 v79, s46, v79
    v_mul_f32 v80, s46, v80
    v_mul_f32 v81, s46, v81
    v_mul_f32 v82, s46, v82
    v_mul_f32 v83, s46, v83
    v_mul_f32 v84, s46, v84
    v_mul_f32 v85, s46, v85
    v_mul_f32 v86, s46, v86
    v_mul_f32 v87, s46, v87
    v_mul_f32 v88, s46, v88
    v_mul_f32 v89, s46, v89
    v_mul_f32 v90, s46, v90
    v_mul_f32 v91, s46, v91
    v_mul_f32 v92, s46, v92
    v_mul_f32 v93, s46, v93
    v_mul_f32 v94, s46, v94
    v_mul_f32 v95, s46, v95
    v_mov_b32 v216, 0
    v_mov_b32 v217, 0
    v_mov_b32 v218, 0
    v_mov_b32 v219, 0
    v_mov_b32 v220, 0
    v_mov_b32 v221, 0
    v_mov_b32 v222, 0
    v_mov_b32 v223, 0
    v_mov_b32 v224, 0
    v_mov_b32 v225, 0
    v_cvt_pk_bf16_f32 v96, v0, v1
    v_cvt_pk_bf16_f32 v97, v2, v3
    v_cvt_pk_bf16_f32 v98, v8, v9
    v_cvt_pk_bf16_f32 v99, v10, v11
    v_cvt_pk_bf16_f32 v100, v4, v5
    v_cvt_pk_bf16_f32 v101, v6, v7
    v_cvt_pk_bf16_f32 v102, v12, v13
    v_cvt_pk_bf16_f32 v103, v14, v15
    v_cvt_pk_bf16_f32 v104, v16, v17
    v_cvt_pk_bf16_f32 v105, v18, v19
    v_cvt_pk_bf16_f32 v106, v24, v25
    v_cvt_pk_bf16_f32 v107, v26, v27
    v_cvt_pk_bf16_f32 v108, v20, v21
    v_cvt_pk_bf16_f32 v109, v22, v23
    v_cvt_pk_bf16_f32 v110, v28, v29
    v_cvt_pk_bf16_f32 v111, v30, v31
    v_cvt_pk_bf16_f32 v112, v32, v33
    v_cvt_pk_bf16_f32 v113, v34, v35
    v_cvt_pk_bf16_f32 v114, v40, v41
    v_cvt_pk_bf16_f32 v115, v42, v43
    v_cvt_pk_bf16_f32 v116, v36, v37
    v_cvt_pk_bf16_f32 v117, v38, v39
    v_cvt_pk_bf16_f32 v118, v44, v45
    v_cvt_pk_bf16_f32 v119, v46, v47
    v_cvt_pk_bf16_f32 v120, v48, v49
    v_cvt_pk_bf16_f32 v121, v50, v51
    v_cvt_pk_bf16_f32 v122, v56, v57
    v_cvt_pk_bf16_f32 v123, v58, v59
    v_cvt_pk_bf16_f32 v124, v52, v53
    v_cvt_pk_bf16_f32 v125, v54, v55
    v_cvt_pk_bf16_f32 v126, v60, v61
    v_cvt_pk_bf16_f32 v127, v62, v63
    v_cvt_pk_bf16_f32 v128, v64, v65
    v_cvt_pk_bf16_f32 v129, v66, v67
    v_cvt_pk_bf16_f32 v130, v72, v73
    v_cvt_pk_bf16_f32 v131, v74, v75
    v_cvt_pk_bf16_f32 v132, v68, v69
    v_cvt_pk_bf16_f32 v133, v70, v71
    v_cvt_pk_bf16_f32 v134, v76, v77
    v_cvt_pk_bf16_f32 v135, v78, v79
    v_cvt_pk_bf16_f32 v136, v80, v81
    v_cvt_pk_bf16_f32 v137, v82, v83
    v_cvt_pk_bf16_f32 v138, v88, v89
    v_cvt_pk_bf16_f32 v139, v90, v91
    v_cvt_pk_bf16_f32 v140, v84, v85
    v_cvt_pk_bf16_f32 v141, v86, v87
    v_cvt_pk_bf16_f32 v142, v92, v93
    v_cvt_pk_bf16_f32 v143, v94, v95
    s_nop 0
    v_permlane32_swap_b32 v96, v98
    v_permlane32_swap_b32 v97, v99
    v_permlane32_swap_b32 v100, v102
    v_permlane32_swap_b32 v101, v103
    v_permlane32_swap_b32 v104, v106
    v_permlane32_swap_b32 v105, v107
    v_permlane32_swap_b32 v108, v110
    v_permlane32_swap_b32 v109, v111
    v_permlane32_swap_b32 v112, v114
    v_permlane32_swap_b32 v113, v115
    v_permlane32_swap_b32 v116, v118
    v_permlane32_swap_b32 v117, v119
    v_permlane32_swap_b32 v120, v122
    v_permlane32_swap_b32 v121, v123
    v_permlane32_swap_b32 v124, v126
    v_permlane32_swap_b32 v125, v127
    v_permlane32_swap_b32 v128, v130
    v_permlane32_swap_b32 v129, v131
    v_permlane32_swap_b32 v132, v134
    v_permlane32_swap_b32 v133, v135
    v_permlane32_swap_b32 v136, v138
    v_permlane32_swap_b32 v137, v139
    v_permlane32_swap_b32 v140, v142
    v_permlane32_swap_b32 v141, v143
    s_nop 0
    v_permlane16_swap_b32 v96, v98
    v_permlane16_swap_b32 v97, v99
    v_permlane16_swap_b32 v100, v102
    v_permlane16_swap_b32 v101, v103
    v_permlane16_swap_b32 v104, v106
    v_permlane16_swap_b32 v105, v107
    v_permlane16_swap_b32 v108, v110
    v_permlane16_swap_b32 v109, v111
    v_permlane16_swap_b32 v112, v114
    v_permlane16_swap_b32 v113, v115
    v_permlane16_swap_b32 v116, v118
    v_permlane16_swap_b32 v117, v119
    v_permlane16_swap_b32 v120, v122
    v_permlane16_swap_b32 v121, v123
    v_permlane16_swap_b32 v124, v126
    v_permlane16_swap_b32 v125, v127
    v_permlane16_swap_b32 v128, v130
    v_permlane16_swap_b32 v129, v131
    v_permlane16_swap_b32 v132, v134
    v_permlane16_swap_b32 v133, v135
    v_permlane16_swap_b32 v136, v138
    v_permlane16_swap_b32 v137, v139
    v_permlane16_swap_b32 v140, v142
    v_permlane16_swap_b32 v141, v143
    s_nop 1
    s_waitcnt lgkmcnt(5)
    v_mfma_f32_16x16x32_bf16 v[144:147], v[184:187], v[96:99], v[216:219]
    v_mfma_f32_16x16x32_bf16 v[148:151], v[184:187], v[100:103], v[220:223]
    ds_read_b128 v[208:211], v235 offset:128
    s_waitcnt lgkmcnt(5)
    v_mfma_f32_16x16x32_bf16 v[152:155], v[188:191], v[96:99], v[216:219]
    v_mfma_f32_16x16x32_bf16 v[156:159], v[188:191], v[100:103], v[220:223]
    ds_read_b128 v[212:215], v235 offset:6272
    s_waitcnt lgkmcnt(5)
    v_mfma_f32_16x16x32_bf16 v[144:147], v[192:195], v[104:107], v[144:147]
    v_mfma_f32_16x16x32_bf16 v[148:151], v[192:195], v[108:111], v[148:151]
    ds_read_b128 v[184:187], v234 offset:256
    s_waitcnt lgkmcnt(5)
    v_mfma_f32_16x16x32_bf16 v[152:155], v[196:199], v[104:107], v[152:155]
    v_mfma_f32_16x16x32_bf16 v[156:159], v[196:199], v[108:111], v[156:159]
    ds_read_b128 v[188:191], v234 offset:6400
    s_add_u32 m0, s45, 24576
    s_nop 0
    buffer_load_dwordx4 v239, s[24:27], s96 offen offset:1024 nt lds
    s_waitcnt lgkmcnt(5)
    v_mfma_f32_16x16x32_bf16 v[144:147], v[200:203], v[112:115], v[144:147]
    v_mfma_f32_16x16x32_bf16 v[148:151], v[200:203], v[116:119], v[148:151]
    ds_read_b128 v[192:195], v235 offset:256
    s_waitcnt lgkmcnt(5)
    v_mfma_f32_16x16x32_bf16 v[152:155], v[204:207], v[112:115], v[152:155]
    v_mfma_f32_16x16x32_bf16 v[156:159], v[204:207], v[116:119], v[156:159]
    ds_read_b128 v[196:199], v235 offset:6400
    s_waitcnt lgkmcnt(5)
    v_mfma_f32_16x16x32_bf16 v[144:147], v[208:211], v[120:123], v[144:147]
    v_mfma_f32_16x16x32_bf16 v[148:151], v[208:211], v[124:127], v[148:151]
    s_add_u32 m0, s45, 24576
    s_nop 0
    buffer_load_dwordx4 v240, s[24:27], s96 offen offset:2048 nt lds
    s_waitcnt lgkmcnt(4)
    v_mfma_f32_16x16x32_bf16 v[152:155], v[212:215], v[120:123], v[152:155]
    v_mfma_f32_16x16x32_bf16 v[156:159], v[212:215], v[124:127], v[156:159]
    s_waitcnt lgkmcnt(3)
    v_mfma_f32_16x16x32_bf16 v[144:147], v[184:187], v[128:131], v[144:147]
    v_mfma_f32_16x16x32_bf16 v[148:151], v[184:187], v[132:135], v[148:151]
    s_add_u32 s48, s52, 73728
    v_add_u32 v234, s48, v226
    v_add_u32 v235, s48, v227
    s_waitcnt lgkmcnt(0)
    s_waitcnt vmcnt(12)
    s_barrier
    ds_read_b128 v[200:203], v234 offset:0
    ds_read_b128 v[204:207], v234 offset:6144
    ds_read_b128 v[208:211], v235 offset:0
    s_add_u32 m0, s45, 49152
    s_mov_b32 s96, 24576
    buffer_load_dwordx4 v238, s[28:31], s96 offen nt lds
    v_mfma_f32_16x16x32_bf16 v[152:155], v[188:191], v[128:131], v[152:155]
    v_mfma_f32_16x16x32_bf16 v[156:159], v[188:191], v[132:135], v[156:159]
    ds_read_b128 v[212:215], v235 offset:6144
    v_mfma_f32_16x16x32_bf16 v[144:147], v[192:195], v[136:139], v[144:147]
    v_mfma_f32_16x16x32_bf16 v[148:151], v[192:195], v[140:143], v[148:151]
    ds_read_b128 v[184:187], v234 offset:128
    v_mfma_f32_16x16x32_bf16 v[152:155], v[196:199], v[136:139], v[152:155]
    v_mfma_f32_16x16x32_bf16 v[156:159], v[196:199], v[140:143], v[156:159]
    ds_read_b128 v[188:191], v234 offset:6272
    s_nop 7
    s_nop 3
    v_max3_f32 v246, v144, v145, v146
    v_max3_f32 v247, v147, v152, v153
    v_max3_f32 v246, v246, v154, v155
    v_max_f32 v246, v246, v247
    v_mov_b32 v247, v246
    v_max3_f32 v248, v148, v149, v150
    v_max3_f32 v249, v151, v156, v157
    v_max3_f32 v248, v248, v158, v159
    v_max_f32 v248, v248, v249
    v_mov_b32 v249, v248
    s_nop 1
    v_permlane32_swap_b32 v246, v247
    v_permlane32_swap_b32 v248, v249
    s_nop 0
    v_max_f32 v246, v246, v247
    v_mov_b32 v247, v246
    v_max_f32 v248, v248, v249
    v_mov_b32 v249, v248
    s_nop 1
    v_permlane16_swap_b32 v246, v247
    v_permlane16_swap_b32 v248, v249
    s_nop 0
    v_max_f32 v246, v246, v247
    v_sub_f32 v144, v144, v246
    v_sub_f32 v145, v145, v246
    v_sub_f32 v146, v146, v246
    v_sub_f32 v147, v147, v246
    v_sub_f32 v152, v152, v246
    v_sub_f32 v153, v153, v246
    v_sub_f32 v154, v154, v246
    v_sub_f32 v155, v155, v246
    v_sub_f32 v216, v216, v246
    v_mov_b32 v217, v216
    v_mov_b32 v218, v216
    v_mov_b32 v219, v216
    v_max_f32 v248, v248, v249
    v_sub_f32 v148, v148, v248
    v_sub_f32 v149, v149, v248
    v_sub_f32 v150, v150, v248
    v_sub_f32 v151, v151, v248
    v_sub_f32 v156, v156, v248
    v_sub_f32 v157, v157, v248
    v_sub_f32 v158, v158, v248
    v_sub_f32 v159, v159, v248
    v_sub_f32 v220, v220, v248
    v_mov_b32 v221, v220
    v_mov_b32 v222, v220
    v_mov_b32 v223, v220
    s_nop 1
    s_waitcnt lgkmcnt(5)
    v_mfma_f32_16x16x32_bf16 v[160:163], v[200:203], v[96:99], v[216:219]
    v_mfma_f32_16x16x32_bf16 v[164:167], v[200:203], v[100:103], v[220:223]
    ds_read_b128 v[192:195], v235 offset:128
    v_exp_f32 v144, v144
    v_exp_f32 v145, v145
    v_exp_f32 v146, v146
    v_exp_f32 v147, v147
    s_waitcnt lgkmcnt(5)
    v_mfma_f32_16x16x32_bf16 v[168:171], v[204:207], v[96:99], v[216:219]
    v_mfma_f32_16x16x32_bf16 v[172:175], v[204:207], v[100:103], v[220:223]
    ds_read_b128 v[196:199], v235 offset:6272
    v_exp_f32 v152, v152
    v_exp_f32 v153, v153
    v_exp_f32 v154, v154
    s_waitcnt lgkmcnt(5)
    v_mfma_f32_16x16x32_bf16 v[160:163], v[208:211], v[104:107], v[160:163]
    v_mfma_f32_16x16x32_bf16 v[164:167], v[208:211], v[108:111], v[164:167]
    ds_read_b128 v[200:203], v234 offset:256
    v_exp_f32 v155, v155
    v_add_f32 v251, v144, v145
    v_add_f32 v255, v146, v147
    v_add_f32 v251, v251, v255
    s_waitcnt lgkmcnt(5)
    v_mfma_f32_16x16x32_bf16 v[168:171], v[212:215], v[104:107], v[168:171]
    v_mfma_f32_16x16x32_bf16 v[172:175], v[212:215], v[108:111], v[172:175]
    ds_read_b128 v[204:207], v234 offset:6400
    s_add_u32 m0, s45, 49152
    s_nop 0
    buffer_load_dwordx4 v239, s[28:31], s96 offen offset:1024 nt lds
    v_cvt_pk_bf16_f32 v176, v144, v145
    v_cvt_pk_bf16_f32 v177, v146, v147
    v_exp_f32 v148, v148
    s_waitcnt lgkmcnt(5)
    v_mfma_f32_16x16x32_bf16 v[160:163], v[184:187], v[112:115], v[160:163]
    v_mfma_f32_16x16x32_bf16 v[164:167], v[184:187], v[116:119], v[164:167]
    ds_read_b128 v[208:211], v235 offset:256
    v_exp_f32 v149, v149
    v_exp_f32 v150, v150
    v_exp_f32 v151, v151
    v_add_f32 v253, v152, v153
    s_waitcnt lgkmcnt(5)
    v_mfma_f32_16x16x32_bf16 v[168:171], v[188:191], v[112:115], v[168:171]
    v_mfma_f32_16x16x32_bf16 v[172:175], v[188:191], v[116:119], v[172:175]
    ds_read_b128 v[212:215], v235 offset:6400
    v_add_f32 v255, v154, v155
    v_add_f32 v253, v253, v255
    v_add_f32 v251, v251, v253
    s_waitcnt lgkmcnt(5)
    v_mfma_f32_16x16x32_bf16 v[160:163], v[192:195], v[120:123], v[160:163]
    v_mfma_f32_16x16x32_bf16 v[164:167], v[192:195], v[124:127], v[164:167]
    s_add_u32 m0, s45, 49152
    s_nop 0
    buffer_load_dwordx4 v240, s[28:31], s96 offen offset:2048 nt lds
    v_add_f32 v224, v224, v251
    v_cvt_pk_bf16_f32 v178, v152, v153
    v_cvt_pk_bf16_f32 v179, v154, v155
    s_waitcnt lgkmcnt(4)
    v_mfma_f32_16x16x32_bf16 v[168:171], v[196:199], v[120:123], v[168:171]
    v_mfma_f32_16x16x32_bf16 v[172:175], v[196:199], v[124:127], v[172:175]
    v_exp_f32 v156, v156
    v_exp_f32 v157, v157
    v_exp_f32 v158, v158
    v_exp_f32 v159, v159
    s_waitcnt lgkmcnt(3)
    v_mfma_f32_16x16x32_bf16 v[160:163], v[200:203], v[128:131], v[160:163]
    v_mfma_f32_16x16x32_bf16 v[164:167], v[200:203], v[132:135], v[164:167]
    s_add_u32 s48, s52, 98304
    v_add_u32 v234, s48, v228
    v_add_u32 v235, s48, v229
    v_add_u32 v236, s48, v230
    v_add_u32 v237, s48, v231
    s_waitcnt lgkmcnt(0)
    s_waitcnt vmcnt(12)
    s_barrier
    ds_read_b64_tr_b16 v[184:185], v234 offset:0
    ds_read_b64_tr_b16 v[186:187], v234 offset:6144
    ds_read_b64_tr_b16 v[188:189], v235 offset:0
    ds_read_b64_tr_b16 v[190:191], v235 offset:6144
    ds_read_b64_tr_b16 v[192:193], v236 offset:0
    ds_read_b64_tr_b16 v[194:195], v236 offset:6144
    s_add_u32 m0, s45, 73728
    s_mov_b32 s96, 49152
    buffer_load_dwordx4 v238, s[24:27], s96 offen nt lds
    v_add_f32 v252, v148, v149
    v_add_f32 v255, v150, v151
    v_add_f32 v252, v252, v255
    v_mfma_f32_16x16x32_bf16 v[168:171], v[204:207], v[128:131], v[168:171]
    v_mfma_f32_16x16x32_bf16 v[172:175], v[204:207], v[132:135], v[172:175]
    ds_read_b64_tr_b16 v[196:197], v237 offset:0
    ds_read_b64_tr_b16 v[198:199], v237 offset:6144
    v_cvt_pk_bf16_f32 v180, v148, v149
    v_cvt_pk_bf16_f32 v181, v150, v151
    v_add_f32 v254, v156, v157
    v_add_f32 v255, v158, v159
    v_mfma_f32_16x16x32_bf16 v[160:163], v[208:211], v[136:139], v[160:163]
    v_mfma_f32_16x16x32_bf16 v[164:167], v[208:211], v[140:143], v[164:167]
    ds_read_b64_tr_b16 v[200:201], v234 offset:128
    ds_read_b64_tr_b16 v[202:203], v234 offset:6272
    v_add_f32 v254, v254, v255
    v_add_f32 v252, v252, v254
    v_add_f32 v225, v225, v252
    v_mfma_f32_16x16x32_bf16 v[168:171], v[212:215], v[136:139], v[168:171]
    v_mfma_f32_16x16x32_bf16 v[172:175], v[212:215], v[140:143], v[172:175]
    ds_read_b64_tr_b16 v[204:205], v235 offset:128
    ds_read_b64_tr_b16 v[206:207], v235 offset:6272
    v_cvt_pk_bf16_f32 v182, v156, v157
    v_cvt_pk_bf16_f32 v183, v158, v159
    s_nop 1
    s_waitcnt lgkmcnt(10)
    v_mfma_f32_16x16x32_bf16 v[0:3], v[184:187], v[176:179], 0
    v_mfma_f32_16x16x32_bf16 v[4:7], v[184:187], v[180:183], 0
    ds_read_b64_tr_b16 v[208:209], v236 offset:128
    ds_read_b64_tr_b16 v[210:211], v236 offset:6272
    s_waitcnt lgkmcnt(10)
    v_mfma_f32_16x16x32_bf16 v[8:11], v[188:191], v[176:179], 0
    v_mfma_f32_16x16x32_bf16 v[12:15], v[188:191], v[180:183], 0
    ds_read_b64_tr_b16 v[212:213], v237 offset:128
    ds_read_b64_tr_b16 v[214:215], v237 offset:6272
    s_waitcnt lgkmcnt(10)
    v_mfma_f32_16x16x32_bf16 v[16:19], v[192:195], v[176:179], 0
    v_mfma_f32_16x16x32_bf16 v[20:23], v[192:195], v[180:183], 0
    ds_read_b64_tr_b16 v[184:185], v234 offset:256
    ds_read_b64_tr_b16 v[186:187], v234 offset:6400
    s_waitcnt lgkmcnt(10)
    v_mfma_f32_16x16x32_bf16 v[24:27], v[196:199], v[176:179], 0
    v_mfma_f32_16x16x32_bf16 v[28:31], v[196:199], v[180:183], 0
    ds_read_b64_tr_b16 v[188:189], v235 offset:256
    ds_read_b64_tr_b16 v[190:191], v235 offset:6400
    s_add_u32 m0, s45, 73728
    s_nop 0
    buffer_load_dwordx4 v239, s[24:27], s96 offen offset:1024 nt lds
    v_max3_f32 v246, v160, v161, v162
    v_max3_f32 v247, v163, v168, v169
    s_waitcnt lgkmcnt(10)
    v_mfma_f32_16x16x32_bf16 v[32:35], v[200:203], v[176:179], 0
    v_mfma_f32_16x16x32_bf16 v[36:39], v[200:203], v[180:183], 0
    ds_read_b64_tr_b16 v[192:193], v236 offset:256
    ds_read_b64_tr_b16 v[194:195], v236 offset:6400
    v_max3_f32 v248, v170, v171, v164
    s_waitcnt lgkmcnt(10)
    v_mfma_f32_16x16x32_bf16 v[40:43], v[204:207], v[176:179], 0
    v_mfma_f32_16x16x32_bf16 v[44:47], v[204:207], v[180:183], 0
    ds_read_b64_tr_b16 v[196:197], v237 offset:256
    ds_read_b64_tr_b16 v[198:199], v237 offset:6400
    v_max3_f32 v249, v165, v166, v167
    v_max3_f32 v250, v172, v173, v174
    s_waitcnt lgkmcnt(10)
    v_mfma_f32_16x16x32_bf16 v[48:51], v[208:211], v[176:179], 0
    v_mfma_f32_16x16x32_bf16 v[52:55], v[208:211], v[180:183], 0
    s_add_u32 m0, s45, 73728
    s_nop 0
    buffer_load_dwordx4 v240, s[24:27], s96 offen offset:2048 nt lds
    v_max3_f32 v246, v246, v247, v175
    s_waitcnt lgkmcnt(8)
    v_mfma_f32_16x16x32_bf16 v[56:59], v[212:215], v[176:179], 0
    v_mfma_f32_16x16x32_bf16 v[60:63], v[212:215], v[180:183], 0
    v_max3_f32 v248, v248, v249, v250
    v_max_f32 v246, v246, v248
    s_waitcnt lgkmcnt(6)
    v_mfma_f32_16x16x32_bf16 v[64:67], v[184:187], v[176:179], 0
    v_mfma_f32_16x16x32_bf16 v[68:71], v[184:187], v[180:183], 0
    s_add_u32 s48, s52, 122880
    v_add_u32 v234, s48, v226
    v_add_u32 v235, s48, v227
    s_waitcnt lgkmcnt(0)
    s_waitcnt vmcnt(12)
    s_barrier
    ds_read_b128 v[200:203], v234 offset:0
    ds_read_b128 v[204:207], v234 offset:6144
    ds_read_b128 v[208:211], v235 offset:0
    s_add_u32 m0, s45, 98304
    s_mov_b32 s96, 36864
    buffer_load_dwordx4 v238, s[28:31], s96 offen nt lds
    v_cmp_lt_f32 vcc, s51, v246
    v_mfma_f32_16x16x32_bf16 v[72:75], v[188:191], v[176:179], 0
    v_mfma_f32_16x16x32_bf16 v[76:79], v[188:191], v[180:183], 0
    ds_read_b128 v[212:215], v235 offset:6144
    v_mfma_f32_16x16x32_bf16 v[80:83], v[192:195], v[176:179], 0
    v_mfma_f32_16x16x32_bf16 v[84:87], v[192:195], v[180:183], 0
    ds_read_b128 v[184:187], v234 offset:128
    v_mfma_f32_16x16x32_bf16 v[88:91], v[196:199], v[176:179], 0
    v_mfma_f32_16x16x32_bf16 v[92:95], v[196:199], v[180:183], 0
    ds_read_b128 v[188:191], v234 offset:6272
    s_cbranch_vccnz K1_SLOW1
K1_BACK1:
    s_waitcnt lgkmcnt(5)
    v_mfma_f32_16x16x32_bf16 v[144:147], v[200:203], v[96:99], v[216:219]
    v_mfma_f32_16x16x32_bf16 v[148:151], v[200:203], v[100:103], v[220:223]
    ds_read_b128 v[192:195], v235 offset:128
    v_exp_f32 v160, v160
    v_exp_f32 v161, v161
    v_exp_f32 v162, v162
    v_exp_f32 v163, v163
    s_waitcnt lgkmcnt(5)
    v_mfma_f32_16x16x32_bf16 v[152:155], v[204:207], v[96:99], v[216:219]
    v_mfma_f32_16x16x32_bf16 v[156:159], v[204:207], v[100:103], v[220:223]
    ds_read_b128 v[196:199], v235 offset:6272
    v_exp_f32 v168, v168
    v_exp_f32 v169, v169
    v_exp_f32 v170, v170
    s_waitcnt lgkmcnt(5)
    v_mfma_f32_16x16x32_bf16 v[144:147], v[208:211], v[104:107], v[144:147]
    v_mfma_f32_16x16x32_bf16 v[148:151], v[208:211], v[108:111], v[148:151]
    ds_read_b128 v[200:203], v234 offset:256
    v_exp_f32 v171, v171
    v_add_f32 v251, v160, v161
    v_add_f32 v255, v162, v163
    v_add_f32 v251, v251, v255
    s_waitcnt lgkmcnt(5)
    v_mfma_f32_16x16x32_bf16 v[152:155], v[212:215], v[104:107], v[152:155]
    v_mfma_f32_16x16x32_bf16 v[156:159], v[212:215], v[108:111], v[156:159]
    ds_read_b128 v[204:207], v234 offset:6400
    s_add_u32 m0, s45, 98304
    s_nop 0
    buffer_load_dwordx4 v239, s[28:31], s96 offen offset:1024 nt lds
    v_cvt_pk_bf16_f32 v176, v160, v161
    v_cvt_pk_bf16_f32 v177, v162, v163
    v_exp_f32 v164, v164
    s_waitcnt lgkmcnt(5)
    v_mfma_f32_16x16x32_bf16 v[144:147], v[184:187], v[112:115], v[144:147]
    v_mfma_f32_16x16x32_bf16 v[148:151], v[184:187], v[116:119], v[148:151]
    ds_read_b128 v[208:211], v235 offset:256
    v_exp_f32 v165, v165
    v_exp_f32 v166, v166
    v_exp_f32 v167, v167
    v_add_f32 v253, v168, v169
    s_waitcnt lgkmcnt(5)
    v_mfma_f32_16x16x32_bf16 v[152:155], v[188:191], v[112:115], v[152:155]
    v_mfma_f32_16x16x32_bf16 v[156:159], v[188:191], v[116:119], v[156:159]
    ds_read_b128 v[212:215], v235 offset:6400
    v_add_f32 v255, v170, v171
    v_add_f32 v253, v253, v255
    v_add_f32 v251, v251, v253
    s_waitcnt lgkmcnt(5)
    v_mfma_f32_16x16x32_bf16 v[144:147], v[192:195], v[120:123], v[144:147]
    v_mfma_f32_16x16x32_bf16 v[148:151], v[192:195], v[124:127], v[148:151]
    s_add_u32 m0, s45, 98304
    s_nop 0
    buffer_load_dwordx4 v240, s[28:31], s96 offen offset:2048 nt lds
    v_add_f32 v224, v224, v251
    v_cvt_pk_bf16_f32 v178, v168, v169
    v_cvt_pk_bf16_f32 v179, v170, v171
    s_waitcnt lgkmcnt(4)
    v_mfma_f32_16x16x32_bf16 v[152:155], v[196:199], v[120:123], v[152:155]
    v_mfma_f32_16x16x32_bf16 v[156:159], v[196:199], v[124:127], v[156:159]
    v_exp_f32 v172, v172
    v_exp_f32 v173, v173
    v_exp_f32 v174, v174
    v_exp_f32 v175, v175
    s_waitcnt lgkmcnt(3)
    v_mfma_f32_16x16x32_bf16 v[144:147], v[200:203], v[128:131], v[144:147]
    v_mfma_f32_16x16x32_bf16 v[148:151], v[200:203], v[132:135], v[148:151]
    s_add_u32 s48, s52, 0
    v_add_u32 v234, s48, v228
    v_add_u32 v235, s48, v229
    v_add_u32 v236, s48, v230
    v_add_u32 v237, s48, v231
    s_waitcnt lgkmcnt(0)
    s_waitcnt vmcnt(12)
    s_barrier
    ds_read_b64_tr_b16 v[184:185], v234 offset:0
    ds_read_b64_tr_b16 v[186:187], v234 offset:6144
    ds_read_b64_tr_b16 v[188:189], v235 offset:0
    ds_read_b64_tr_b16 v[190:191], v235 offset:6144
    ds_read_b64_tr_b16 v[192:193], v236 offset:0
    ds_read_b64_tr_b16 v[194:195], v236 offset:6144
    s_add_u32 m0, s45, 122880
    s_mov_b32 s96, 61440
    buffer_load_dwordx4 v238, s[24:27], s96 offen nt lds
    v_add_f32 v252, v164, v165
    v_add_f32 v255, v166, v167
    v_add_f32 v252, v252, v255
    v_mfma_f32_16x16x32_bf16 v[152:155], v[204:207], v[128:131], v[152:155]
    v_mfma_f32_16x16x32_bf16 v[156:159], v[204:207], v[132:135], v[156:159]
    ds_read_b64_tr_b16 v[196:197], v237 offset:0
    ds_read_b64_tr_b16 v[198:199], v237 offset:6144
    v_cvt_pk_bf16_f32 v180, v164, v165
    v_cvt_pk_bf16_f32 v181, v166, v167
    v_add_f32 v254, v172, v173
    v_add_f32 v255, v174, v175
    v_mfma_f32_16x16x32_bf16 v[144:147], v[208:211], v[136:139], v[144:147]
    v_mfma_f32_16x16x32_bf16 v[148:151], v[208:211], v[140:143], v[148:151]
    ds_read_b64_tr_b16 v[200:201], v234 offset:128
    ds_read_b64_tr_b16 v[202:203], v234 offset:6272
    v_add_f32 v254, v254, v255
    v_add_f32 v252, v252, v254
    v_add_f32 v225, v225, v252
    v_mfma_f32_16x16x32_bf16 v[152:155], v[212:215], v[136:139], v[152:155]
    v_mfma_f32_16x16x32_bf16 v[156:159], v[212:215], v[140:143], v[156:159]
    ds_read_b64_tr_b16 v[204:205], v235 offset:128
    ds_read_b64_tr_b16 v[206:207], v235 offset:6272
    v_cvt_pk_bf16_f32 v182, v172, v173
    v_cvt_pk_bf16_f32 v183, v174, v175
    s_nop 1
    s_waitcnt lgkmcnt(10)
    v_mfma_f32_16x16x32_bf16 v[0:3], v[184:187], v[176:179], v[0:3]
    v_mfma_f32_16x16x32_bf16 v[4:7], v[184:187], v[180:183], v[4:7]
    ds_read_b64_tr_b16 v[208:209], v236 offset:128
    ds_read_b64_tr_b16 v[210:211], v236 offset:6272
    s_waitcnt lgkmcnt(10)
    v_mfma_f32_16x16x32_bf16 v[8:11], v[188:191], v[176:179], v[8:11]
    v_mfma_f32_16x16x32_bf16 v[12:15], v[188:191], v[180:183], v[12:15]
    ds_read_b64_tr_b16 v[212:213], v237 offset:128
    ds_read_b64_tr_b16 v[214:215], v237 offset:6272
    s_waitcnt lgkmcnt(10)
    v_mfma_f32_16x16x32_bf16 v[16:19], v[192:195], v[176:179], v[16:19]
    v_mfma_f32_16x16x32_bf16 v[20:23], v[192:195], v[180:183], v[20:23]
    ds_read_b64_tr_b16 v[184:185], v234 offset:256
    ds_read_b64_tr_b16 v[186:187], v234 offset:6400
    s_waitcnt lgkmcnt(10)
    v_mfma_f32_16x16x32_bf16 v[24:27], v[196:199], v[176:179], v[24:27]
    v_mfma_f32_16x16x32_bf16 v[28:31], v[196:199], v[180:183], v[28:31]
    ds_read_b64_tr_b16 v[188:189], v235 offset:256
    ds_read_b64_tr_b16 v[190:191], v235 offset:6400
    s_add_u32 m0, s45, 122880
    s_nop 0
    buffer_load_dwordx4 v239, s[24:27], s96 offen offset:1024 nt lds
    v_max3_f32 v246, v144, v145, v146
    v_max3_f32 v247, v147, v152, v153
    s_waitcnt lgkmcnt(10)
    v_mfma_f32_16x16x32_bf16 v[32:35], v[200:203], v[176:179], v[32:35]
    v_mfma_f32_16x16x32_bf16 v[36:39], v[200:203], v[180:183], v[36:39]
    ds_read_b64_tr_b16 v[192:193], v236 offset:256
    ds_read_b64_tr_b16 v[194:195], v236 offset:6400
    v_max3_f32 v248, v154, v155, v148
    s_waitcnt lgkmcnt(10)
    v_mfma_f32_16x16x32_bf16 v[40:43], v[204:207], v[176:179], v[40:43]
    v_mfma_f32_16x16x32_bf16 v[44:47], v[204:207], v[180:183], v[44:47]
    ds_read_b64_tr_b16 v[196:197], v237 offset:256
    ds_read_b64_tr_b16 v[198:199], v237 offset:6400
    v_max3_f32 v249, v149, v150, v151
    v_max3_f32 v250, v156, v157, v158
    s_waitcnt lgkmcnt(10)
    v_mfma_f32_16x16x32_bf16 v[48:51], v[208:211], v[176:179], v[48:51]
    v_mfma_f32_16x16x32_bf16 v[52:55], v[208:211], v[180:183], v[52:55]
    s_add_u32 m0, s45, 122880
    s_nop 0
    buffer_load_dwordx4 v240, s[24:27], s96 offen offset:2048 nt lds
    v_max3_f32 v246, v246, v247, v159
    s_waitcnt lgkmcnt(8)
    v_mfma_f32_16x16x32_bf16 v[56:59], v[212:215], v[176:179], v[56:59]
    v_mfma_f32_16x16x32_bf16 v[60:63], v[212:215], v[180:183], v[60:63]
    v_max3_f32 v248, v248, v249, v250
    v_max_f32 v246, v246, v248
    s_waitcnt lgkmcnt(6)
    v_mfma_f32_16x16x32_bf16 v[64:67], v[184:187], v[176:179], v[64:67]
    v_mfma_f32_16x16x32_bf16 v[68:71], v[184:187], v[180:183], v[68:71]
    s_add_u32 s48, s52, 24576
    v_add_u32 v234, s48, v226
    v_add_u32 v235, s48, v227
    s_waitcnt lgkmcnt(0)
    s_waitcnt vmcnt(12)
    s_barrier
    ds_read_b128 v[200:203], v234 offset:0
    ds_read_b128 v[204:207], v234 offset:6144
    ds_read_b128 v[208:211], v235 offset:0
    s_add_u32 m0, s45, 0
    s_mov_b32 s96, 49152
    buffer_load_dwordx4 v238, s[28:31], s96 offen nt lds
    v_cmp_lt_f32 vcc, s51, v246
    v_mfma_f32_16x16x32_bf16 v[72:75], v[188:191], v[176:179], v[72:75]
    v_mfma_f32_16x16x32_bf16 v[76:79], v[188:191], v[180:183], v[76:79]
    ds_read_b128 v[212:215], v235 offset:6144
    v_mfma_f32_16x16x32_bf16 v[80:83], v[192:195], v[176:179], v[80:83]
    v_mfma_f32_16x16x32_bf16 v[84:87], v[192:195], v[180:183], v[84:87]
    ds_read_b128 v[184:187], v234 offset:128
    v_mfma_f32_16x16x32_bf16 v[88:91], v[196:199], v[176:179], v[88:91]
    v_mfma_f32_16x16x32_bf16 v[92:95], v[196:199], v[180:183], v[92:95]
    ds_read_b128 v[188:191], v234 offset:6272
    s_cbranch_vccnz K1_SLOW2
K1_BACK2:
    s_waitcnt lgkmcnt(5)
    v_mfma_f32_16x16x32_bf16 v[160:163], v[200:203], v[96:99], v[216:219]
    v_mfma_f32_16x16x32_bf16 v[164:167], v[200:203], v[100:103], v[220:223]
    ds_read_b128 v[192:195], v235 offset:128
    v_exp_f32 v144, v144
    v_exp_f32 v145, v145
    v_exp_f32 v146, v146
    v_exp_f32 v147, v147
    s_waitcnt lgkmcnt(5)
    v_mfma_f32_16x16x32_bf16 v[168:171], v[204:207], v[96:99], v[216:219]
    v_mfma_f32_16x16x32_bf16 v[172:175], v[204:207], v[100:103], v[220:223]
    ds_read_b128 v[196:199], v235 offset:6272
    v_exp_f32 v152, v152
    v_exp_f32 v153, v153
    v_exp_f32 v154, v154
    s_waitcnt lgkmcnt(5)
    v_mfma_f32_16x16x32_bf16 v[160:163], v[208:211], v[104:107], v[160:163]
    v_mfma_f32_16x16x32_bf16 v[164:167], v[208:211], v[108:111], v[164:167]
    ds_read_b128 v[200:203], v234 offset:256
    v_exp_f32 v155, v155
    v_add_f32 v251, v144, v145
    v_add_f32 v255, v146, v147
    v_add_f32 v251, v251, v255
    s_waitcnt lgkmcnt(5)
    v_mfma_f32_16x16x32_bf16 v[168:171], v[212:215], v[104:107], v[168:171]
    v_mfma_f32_16x16x32_bf16 v[172:175], v[212:215], v[108:111], v[172:175]
    ds_read_b128 v[204:207], v234 offset:6400
    s_add_u32 m0, s45, 0
    s_nop 0
    buffer_load_dwordx4 v239, s[28:31], s96 offen offset:1024 nt lds
    v_cvt_pk_bf16_f32 v176, v144, v145
    v_cvt_pk_bf16_f32 v177, v146, v147
    v_exp_f32 v148, v148
    s_waitcnt lgkmcnt(5)
    v_mfma_f32_16x16x32_bf16 v[160:163], v[184:187], v[112:115], v[160:163]
    v_mfma_f32_16x16x32_bf16 v[164:167], v[184:187], v[116:119], v[164:167]
    ds_read_b128 v[208:211], v235 offset:256
    v_exp_f32 v149, v149
    v_exp_f32 v150, v150
    v_exp_f32 v151, v151
    v_add_f32 v253, v152, v153
    s_waitcnt lgkmcnt(5)
    v_mfma_f32_16x16x32_bf16 v[168:171], v[188:191], v[112:115], v[168:171]
    v_mfma_f32_16x16x32_bf16 v[172:175], v[188:191], v[116:119], v[172:175]
    ds_read_b128 v[212:215], v235 offset:6400
    v_add_f32 v255, v154, v155
    v_add_f32 v253, v253, v255
    v_add_f32 v251, v251, v253
    s_waitcnt lgkmcnt(5)
    v_mfma_f32_16x16x32_bf16 v[160:163], v[192:195], v[120:123], v[160:163]
    v_mfma_f32_16x16x32_bf16 v[164:167], v[192:195], v[124:127], v[164:167]
    s_add_u32 m0, s45, 0
    s_nop 0
    buffer_load_dwordx4 v240, s[28:31], s96 offen offset:2048 nt lds
    v_add_f32 v224, v224, v251
    v_cvt_pk_bf16_f32 v178, v152, v153
    v_cvt_pk_bf16_f32 v179, v154, v155
    s_waitcnt lgkmcnt(4)
    v_mfma_f32_16x16x32_bf16 v[168:171], v[196:199], v[120:123], v[168:171]
    v_mfma_f32_16x16x32_bf16 v[172:175], v[196:199], v[124:127], v[172:175]
    v_exp_f32 v156, v156
    v_exp_f32 v157, v157
    v_exp_f32 v158, v158
    v_exp_f32 v159, v159
    s_waitcnt lgkmcnt(3)
    v_mfma_f32_16x16x32_bf16 v[160:163], v[200:203], v[128:131], v[160:163]
    v_mfma_f32_16x16x32_bf16 v[164:167], v[200:203], v[132:135], v[164:167]
    s_add_u32 s48, s52, 49152
    v_add_u32 v234, s48, v228
    v_add_u32 v235, s48, v229
    v_add_u32 v236, s48, v230
    v_add_u32 v237, s48, v231
    s_waitcnt lgkmcnt(0)
    s_waitcnt vmcnt(12)
    s_barrier
    ds_read_b64_tr_b16 v[184:185], v234 offset:0
    ds_read_b64_tr_b16 v[186:187], v234 offset:6144
    ds_read_b64_tr_b16 v[188:189], v235 offset:0
    ds_read_b64_tr_b16 v[190:191], v235 offset:6144
    ds_read_b64_tr_b16 v[192:193], v236 offset:0
    ds_read_b64_tr_b16 v[194:195], v236 offset:6144
    s_add_u32 m0, s45, 24576
    s_mov_b32 s96, 73728
    buffer_load_dwordx4 v238, s[24:27], s96 offen nt lds
    v_add_f32 v252, v148, v149
    v_add_f32 v255, v150, v151
    v_add_f32 v252, v252, v255
    v_mfma_f32_16x16x32_bf16 v[168:171], v[204:207], v[128:131], v[168:171]
    v_mfma_f32_16x16x32_bf16 v[172:175], v[204:207], v[132:135], v[172:175]
    ds_read_b64_tr_b16 v[196:197], v237 offset:0
    ds_read_b64_tr_b16 v[198:199], v237 offset:6144
    v_cvt_pk_bf16_f32 v180, v148, v149
    v_cvt_pk_bf16_f32 v181, v150, v151
    v_add_f32 v254, v156, v157
    v_add_f32 v255, v158, v159
    v_mfma_f32_16x16x32_bf16 v[160:163], v[208:211], v[136:139], v[160:163]
    v_mfma_f32_16x16x32_bf16 v[164:167], v[208:211], v[140:143], v[164:167]
    ds_read_b64_tr_b16 v[200:201], v234 offset:128
    ds_read_b64_tr_b16 v[202:203], v234 offset:6272
    v_add_f32 v254, v254, v255
    v_add_f32 v252, v252, v254
    v_add_f32 v225, v225, v252
    v_mfma_f32_16x16x32_bf16 v[168:171], v[212:215], v[136:139], v[168:171]
    v_mfma_f32_16x16x32_bf16 v[172:175], v[212:215], v[140:143], v[172:175]
    ds_read_b64_tr_b16 v[204:205], v235 offset:128
    ds_read_b64_tr_b16 v[206:207], v235 offset:6272
    v_cvt_pk_bf16_f32 v182, v156, v157
    v_cvt_pk_bf16_f32 v183, v158, v159
    s_nop 1
    s_waitcnt lgkmcnt(10)
    v_mfma_f32_16x16x32_bf16 v[0:3], v[184:187], v[176:179], v[0:3]
    v_mfma_f32_16x16x32_bf16 v[4:7], v[184:187], v[180:183], v[4:7]
    ds_read_b64_tr_b16 v[208:209], v236 offset:128
    ds_read_b64_tr_b16 v[210:211], v236 offset:6272
    s_waitcnt lgkmcnt(10)
    v_mfma_f32_16x16x32_bf16 v[8:11], v[188:191], v[176:179], v[8:11]
    v_mfma_f32_16x16x32_bf16 v[12:15], v[188:191], v[180:183], v[12:15]
    ds_read_b64_tr_b16 v[212:213], v237 offset:128
    ds_read_b64_tr_b16 v[214:215], v237 offset:6272
    s_waitcnt lgkmcnt(10)
    v_mfma_f32_16x16x32_bf16 v[16:19], v[192:195], v[176:179], v[16:19]
    v_mfma_f32_16x16x32_bf16 v[20:23], v[192:195], v[180:183], v[20:23]
    ds_read_b64_tr_b16 v[184:185], v234 offset:256
    ds_read_b64_tr_b16 v[186:187], v234 offset:6400
    s_waitcnt lgkmcnt(10)
    v_mfma_f32_16x16x32_bf16 v[24:27], v[196:199], v[176:179], v[24:27]
    v_mfma_f32_16x16x32_bf16 v[28:31], v[196:199], v[180:183], v[28:31]
    ds_read_b64_tr_b16 v[188:189], v235 offset:256
    ds_read_b64_tr_b16 v[190:191], v235 offset:6400
    s_add_u32 m0, s45, 24576
    s_nop 0
    buffer_load_dwordx4 v239, s[24:27], s96 offen offset:1024 nt lds
    v_max3_f32 v246, v160, v161, v162
    v_max3_f32 v247, v163, v168, v169
    s_waitcnt lgkmcnt(10)
    v_mfma_f32_16x16x32_bf16 v[32:35], v[200:203], v[176:179], v[32:35]
    v_mfma_f32_16x16x32_bf16 v[36:39], v[200:203], v[180:183], v[36:39]
    ds_read_b64_tr_b16 v[192:193], v236 offset:256
    ds_read_b64_tr_b16 v[194:195], v236 offset:6400
    v_max3_f32 v248, v170, v171, v164
    s_waitcnt lgkmcnt(10)
    v_mfma_f32_16x16x32_bf16 v[40:43], v[204:207], v[176:179], v[40:43]
    v_mfma_f32_16x16x32_bf16 v[44:47], v[204:207], v[180:183], v[44:47]
    ds_read_b64_tr_b16 v[196:197], v237 offset:256
    ds_read_b64_tr_b16 v[198:199], v237 offset:6400
    v_max3_f32 v249, v165, v166, v167
    v_max3_f32 v250, v172, v173, v174
    s_waitcnt lgkmcnt(10)
    v_mfma_f32_16x16x32_bf16 v[48:51], v[208:211], v[176:179], v[48:51]
    v_mfma_f32_16x16x32_bf16 v[52:55], v[208:211], v[180:183], v[52:55]
    s_add_u32 m0, s45, 24576
    s_nop 0
    buffer_load_dwordx4 v240, s[24:27], s96 offen offset:2048 nt lds
    v_max3_f32 v246, v246, v247, v175
    s_waitcnt lgkmcnt(8)
    v_mfma_f32_16x16x32_bf16 v[56:59], v[212:215], v[176:179], v[56:59]
    v_mfma_f32_16x16x32_bf16 v[60:63], v[212:215], v[180:183], v[60:63]
    v_max3_f32 v248, v248, v249, v250
    v_max_f32 v246, v246, v248
    s_waitcnt lgkmcnt(6)
    v_mfma_f32_16x16x32_bf16 v[64:67], v[184:187], v[176:179], v[64:67]
    v_mfma_f32_16x16x32_bf16 v[68:71], v[184:187], v[180:183], v[68:71]
    s_add_u32 s48, s52, 73728
    v_add_u32 v234, s48, v226
    v_add_u32 v235, s48, v227
    s_waitcnt lgkmcnt(0)
    s_waitcnt vmcnt(12)
    s_barrier
    ds_read_b128 v[200:203], v234 offset:0
    ds_read_b128 v[204:207], v234 offset:6144
    ds_read_b128 v[208:211], v235 offset:0
    s_add_u32 m0, s45, 49152
    s_mov_b32 s96, 61440
    buffer_load_dwordx4 v238, s[28:31], s96 offen nt lds
    v_cmp_lt_f32 vcc, s51, v246
    v_mfma_f32_16x16x32_bf16 v[72:75], v[188:191], v[176:179], v[72:75]
    v_mfma_f32_16x16x32_bf16 v[76:79], v[188:191], v[180:183], v[76:79]
    ds_read_b128 v[212:215], v235 offset:6144
    v_mfma_f32_16x16x32_bf16 v[80:83], v[192:195], v[176:179], v[80:83]
    v_mfma_f32_16x16x32_bf16 v[84:87], v[192:195], v[180:183], v[84:87]
    ds_read_b128 v[184:187], v234 offset:128
    v_mfma_f32_16x16x32_bf16 v[88:91], v[196:199], v[176:179], v[88:91]
    v_mfma_f32_16x16x32_bf16 v[92:95], v[196:199], v[180:183], v[92:95]
    ds_read_b128 v[188:191], v234 offset:6272
    s_cbranch_vccnz K1_SLOW3
K1_BACK3:
    s_waitcnt lgkmcnt(5)
    v_mfma_f32_16x16x32_bf16 v[144:147], v[200:203], v[96:99], v[216:219]
    v_mfma_f32_16x16x32_bf16 v[148:151], v[200:203], v[100:103], v[220:223]
    ds_read_b128 v[192:195], v235 offset:128
    v_exp_f32 v160, v160
    v_exp_f32 v161, v161
    v_exp_f32 v162, v162
    v_exp_f32 v163, v163
    s_waitcnt lgkmcnt(5)
    v_mfma_f32_16x16x32_bf16 v[152:155], v[204:207], v[96:99], v[216:219]
    v_mfma_f32_16x16x32_bf16 v[156:159], v[204:207], v[100:103], v[220:223]
    ds_read_b128 v[196:199], v235 offset:6272
    v_exp_f32 v168, v168
    v_exp_f32 v169, v169
    v_exp_f32 v170, v170
    s_waitcnt lgkmcnt(5)
    v_mfma_f32_16x16x32_bf16 v[144:147], v[208:211], v[104:107], v[144:147]
    v_mfma_f32_16x16x32_bf16 v[148:151], v[208:211], v[108:111], v[148:151]
    ds_read_b128 v[200:203], v234 offset:256
    v_exp_f32 v171, v171
    v_add_f32 v251, v160, v161
    v_add_f32 v255, v162, v163
    v_add_f32 v251, v251, v255
    s_waitcnt lgkmcnt(5)
    v_mfma_f32_16x16x32_bf16 v[152:155], v[212:215], v[104:107], v[152:155]
    v_mfma_f32_16x16x32_bf16 v[156:159], v[212:215], v[108:111], v[156:159]
    ds_read_b128 v[204:207], v234 offset:6400
    s_add_u32 m0, s45, 49152
    s_nop 0
    buffer_load_dwordx4 v239, s[28:31], s96 offen offset:1024 nt lds
    v_cvt_pk_bf16_f32 v176, v160, v161
    v_cvt_pk_bf16_f32 v177, v162, v163
    v_exp_f32 v164, v164
    s_waitcnt lgkmcnt(5)
    v_mfma_f32_16x16x32_bf16 v[144:147], v[184:187], v[112:115], v[144:147]
    v_mfma_f32_16x16x32_bf16 v[148:151], v[184:187], v[116:119], v[148:151]
    ds_read_b128 v[208:211], v235 offset:256
    v_exp_f32 v165, v165
    v_exp_f32 v166, v166
    v_exp_f32 v167, v167
    v_add_f32 v253, v168, v169
    s_waitcnt lgkmcnt(5)
    v_mfma_f32_16x16x32_bf16 v[152:155], v[188:191], v[112:115], v[152:155]
    v_mfma_f32_16x16x32_bf16 v[156:159], v[188:191], v[116:119], v[156:159]
    ds_read_b128 v[212:215], v235 offset:6400
    v_add_f32 v255, v170, v171
    v_add_f32 v253, v253, v255
    v_add_f32 v251, v251, v253
    s_waitcnt lgkmcnt(5)
    v_mfma_f32_16x16x32_bf16 v[144:147], v[192:195], v[120:123], v[144:147]
    v_mfma_f32_16x16x32_bf16 v[148:151], v[192:195], v[124:127], v[148:151]
    s_add_u32 m0, s45, 49152
    s_nop 0
    buffer_load_dwordx4 v240, s[28:31], s96 offen offset:2048 nt lds
    v_add_f32 v224, v224, v251
    v_cvt_pk_bf16_f32 v178, v168, v169
    v_cvt_pk_bf16_f32 v179, v170, v171
    s_waitcnt lgkmcnt(4)
    v_mfma_f32_16x16x32_bf16 v[152:155], v[196:199], v[120:123], v[152:155]
    v_mfma_f32_16x16x32_bf16 v[156:159], v[196:199], v[124:127], v[156:159]
    v_exp_f32 v172, v172
    v_exp_f32 v173, v173
    v_exp_f32 v174, v174
    v_exp_f32 v175, v175
    s_waitcnt lgkmcnt(3)
    v_mfma_f32_16x16x32_bf16 v[144:147], v[200:203], v[128:131], v[144:147]
    v_mfma_f32_16x16x32_bf16 v[148:151], v[200:203], v[132:135], v[148:151]
    s_add_u32 s48, s52, 98304
    v_add_u32 v234, s48, v228
    v_add_u32 v235, s48, v229
    v_add_u32 v236, s48, v230
    v_add_u32 v237, s48, v231
    s_waitcnt lgkmcnt(0)
    s_waitcnt vmcnt(12)
    s_barrier
    ds_read_b64_tr_b16 v[184:185], v234 offset:0
    ds_read_b64_tr_b16 v[186:187], v234 offset:6144
    ds_read_b64_tr_b16 v[188:189], v235 offset:0
    ds_read_b64_tr_b16 v[190:191], v235 offset:6144
    ds_read_b64_tr_b16 v[192:193], v236 offset:0
    ds_read_b64_tr_b16 v[194:195], v236 offset:6144
    s_add_u32 m0, s45, 73728
    s_mov_b32 s96, 86016
    buffer_load_dwordx4 v238, s[24:27], s96 offen nt lds
    v_add_f32 v252, v164, v165
    v_add_f32 v255, v166, v167
    v_add_f32 v252, v252, v255
    v_mfma_f32_16x16x32_bf16 v[152:155], v[204:207], v[128:131], v[152:155]
    v_mfma_f32_16x16x32_bf16 v[156:159], v[204:207], v[132:135], v[156:159]
    ds_read_b64_tr_b16 v[196:197], v237 offset:0
    ds_read_b64_tr_b16 v[198:199], v237 offset:6144
    v_cvt_pk_bf16_f32 v180, v164, v165
    v_cvt_pk_bf16_f32 v181, v166, v167
    v_add_f32 v254, v172, v173
    v_add_f32 v255, v174, v175
    v_mfma_f32_16x16x32_bf16 v[144:147], v[208:211], v[136:139], v[144:147]
    v_mfma_f32_16x16x32_bf16 v[148:151], v[208:211], v[140:143], v[148:151]
    ds_read_b64_tr_b16 v[200:201], v234 offset:128
    ds_read_b64_tr_b16 v[202:203], v234 offset:6272
    v_add_f32 v254, v254, v255
    v_add_f32 v252, v252, v254
    v_add_f32 v225, v225, v252
    v_mfma_f32_16x16x32_bf16 v[152:155], v[212:215], v[136:139], v[152:155]
    v_mfma_f32_16x16x32_bf16 v[156:159], v[212:215], v[140:143], v[156:159]
    ds_read_b64_tr_b16 v[204:205], v235 offset:128
    ds_read_b64_tr_b16 v[206:207], v235 offset:6272
    v_cvt_pk_bf16_f32 v182, v172, v173
    v_cvt_pk_bf16_f32 v183, v174, v175
    s_nop 1
    s_waitcnt lgkmcnt(10)
    v_mfma_f32_16x16x32_bf16 v[0:3], v[184:187], v[176:179], v[0:3]
    v_mfma_f32_16x16x32_bf16 v[4:7], v[184:187], v[180:183], v[4:7]
    ds_read_b64_tr_b16 v[208:209], v236 offset:128
    ds_read_b64_tr_b16 v[210:211], v236 offset:6272
    s_waitcnt lgkmcnt(10)
    v_mfma_f32_16x16x32_bf16 v[8:11], v[188:191], v[176:179], v[8:11]
    v_mfma_f32_16x16x32_bf16 v[12:15], v[188:191], v[180:183], v[12:15]
    ds_read_b64_tr_b16 v[212:213], v237 offset:128
    ds_read_b64_tr_b16 v[214:215], v237 offset:6272
    s_waitcnt lgkmcnt(10)
    v_mfma_f32_16x16x32_bf16 v[16:19], v[192:195], v[176:179], v[16:19]
    v_mfma_f32_16x16x32_bf16 v[20:23], v[192:195], v[180:183], v[20:23]
    ds_read_b64_tr_b16 v[184:185], v234 offset:256
    ds_read_b64_tr_b16 v[186:187], v234 offset:6400
    s_waitcnt lgkmcnt(10)
    v_mfma_f32_16x16x32_bf16 v[24:27], v[196:199], v[176:179], v[24:27]
    v_mfma_f32_16x16x32_bf16 v[28:31], v[196:199], v[180:183], v[28:31]
    ds_read_b64_tr_b16 v[188:189], v235 offset:256
    ds_read_b64_tr_b16 v[190:191], v235 offset:6400
    s_add_u32 m0, s45, 73728
    s_nop 0
    buffer_load_dwordx4 v239, s[24:27], s96 offen offset:1024 nt lds
    v_max3_f32 v246, v144, v145, v146
    v_max3_f32 v247, v147, v152, v153
    s_waitcnt lgkmcnt(10)
    v_mfma_f32_16x16x32_bf16 v[32:35], v[200:203], v[176:179], v[32:35]
    v_mfma_f32_16x16x32_bf16 v[36:39], v[200:203], v[180:183], v[36:39]
    ds_read_b64_tr_b16 v[192:193], v236 offset:256
    ds_read_b64_tr_b16 v[194:195], v236 offset:6400
    v_max3_f32 v248, v154, v155, v148
    s_waitcnt lgkmcnt(10)
    v_mfma_f32_16x16x32_bf16 v[40:43], v[204:207], v[176:179], v[40:43]
    v_mfma_f32_16x16x32_bf16 v[44:47], v[204:207], v[180:183], v[44:47]
    ds_read_b64_tr_b16 v[196:197], v237 offset:256
    ds_read_b64_tr_b16 v[198:199], v237 offset:6400
    v_max3_f32 v249, v149, v150, v151
    v_max3_f32 v250, v156, v157, v158
    s_waitcnt lgkmcnt(10)
    v_mfma_f32_16x16x32_bf16 v[48:51], v[208:211], v[176:179], v[48:51]
    v_mfma_f32_16x16x32_bf16 v[52:55], v[208:211], v[180:183], v[52:55]
    s_add_u32 m0, s45, 73728
    s_nop 0
    buffer_load_dwordx4 v240, s[24:27], s96 offen offset:2048 nt lds
    v_max3_f32 v246, v246, v247, v159
    s_waitcnt lgkmcnt(8)
    v_mfma_f32_16x16x32_bf16 v[56:59], v[212:215], v[176:179], v[56:59]
    v_mfma_f32_16x16x32_bf16 v[60:63], v[212:215], v[180:183], v[60:63]
    v_max3_f32 v248, v248, v249, v250
    v_max_f32 v246, v246, v248
    s_waitcnt lgkmcnt(6)
    v_mfma_f32_16x16x32_bf16 v[64:67], v[184:187], v[176:179], v[64:67]
    v_mfma_f32_16x16x32_bf16 v[68:71], v[184:187], v[180:183], v[68:71]
    s_add_u32 s48, s52, 122880
    v_add_u32 v234, s48, v226
    v_add_u32 v235, s48, v227
    s_waitcnt lgkmcnt(0)
    s_waitcnt vmcnt(12)
    s_barrier
    ds_read_b128 v[200:203], v234 offset:0
    ds_read_b128 v[204:207], v234 offset:6144
    ds_read_b128 v[208:211], v235 offset:0
    s_add_u32 m0, s45, 98304
    s_mov_b32 s96, 73728
    buffer_load_dwordx4 v238, s[28:31], s96 offen nt lds
    v_cmp_lt_f32 vcc, s51, v246
    v_mfma_f32_16x16x32_bf16 v[72:75], v[188:191], v[176:179], v[72:75]
    v_mfma_f32_16x16x32_bf16 v[76:79], v[188:191], v[180:183], v[76:79]
    ds_read_b128 v[212:215], v235 offset:6144
    v_mfma_f32_16x16x32_bf16 v[80:83], v[192:195], v[176:179], v[80:83]
    v_mfma_f32_16x16x32_bf16 v[84:87], v[192:195], v[180:183], v[84:87]
    ds_read_b128 v[184:187], v234 offset:128
    v_mfma_f32_16x16x32_bf16 v[88:91], v[196:199], v[176:179], v[88:91]
    v_mfma_f32_16x16x32_bf16 v[92:95], v[196:199], v[180:183], v[92:95]
    ds_read_b128 v[188:191], v234 offset:6272
    s_cbranch_vccnz K1_SLOW4
K1_BACK4:
    s_waitcnt lgkmcnt(5)
    v_mfma_f32_16x16x32_bf16 v[160:163], v[200:203], v[96:99], v[216:219]
    v_mfma_f32_16x16x32_bf16 v[164:167], v[200:203], v[100:103], v[220:223]
    ds_read_b128 v[192:195], v235 offset:128
    v_exp_f32 v144, v144
    v_exp_f32 v145, v145
    v_exp_f32 v146, v146
    v_exp_f32 v147, v147
    s_waitcnt lgkmcnt(5)
    v_mfma_f32_16x16x32_bf16 v[168:171], v[204:207], v[96:99], v[216:219]
    v_mfma_f32_16x16x32_bf16 v[172:175], v[204:207], v[100:103], v[220:223]
    ds_read_b128 v[196:199], v235 offset:6272
    v_exp_f32 v152, v152
    v_exp_f32 v153, v153
    v_exp_f32 v154, v154
    s_waitcnt lgkmcnt(5)
    v_mfma_f32_16x16x32_bf16 v[160:163], v[208:211], v[104:107], v[160:163]
    v_mfma_f32_16x16x32_bf16 v[164:167], v[208:211], v[108:111], v[164:167]
    ds_read_b128 v[200:203], v234 offset:256
    v_exp_f32 v155, v155
    v_add_f32 v251, v144, v145
    v_add_f32 v255, v146, v147
    v_add_f32 v251, v251, v255
    s_waitcnt lgkmcnt(5)
    v_mfma_f32_16x16x32_bf16 v[168:171], v[212:215], v[104:107], v[168:171]
    v_mfma_f32_16x16x32_bf16 v[172:175], v[212:215], v[108:111], v[172:175]
    ds_read_b128 v[204:207], v234 offset:6400
    s_add_u32 m0, s45, 98304
    s_nop 0
    buffer_load_dwordx4 v239, s[28:31], s96 offen offset:1024 nt lds
    v_cvt_pk_bf16_f32 v176, v144, v145
    v_cvt_pk_bf16_f32 v177, v146, v147
    v_exp_f32 v148, v148
    s_waitcnt lgkmcnt(5)
    v_mfma_f32_16x16x32_bf16 v[160:163], v[184:187], v[112:115], v[160:163]
    v_mfma_f32_16x16x32_bf16 v[164:167], v[184:187], v[116:119], v[164:167]
    ds_read_b128 v[208:211], v235 offset:256
    v_exp_f32 v149, v149
    v_exp_f32 v150, v150
    v_exp_f32 v151, v151
    v_add_f32 v253, v152, v153
    s_waitcnt lgkmcnt(5)
    v_mfma_f32_16x16x32_bf16 v[168:171], v[188:191], v[112:115], v[168:171]
    v_mfma_f32_16x16x32_bf16 v[172:175], v[188:191], v[116:119], v[172:175]
    ds_read_b128 v[212:215], v235 offset:6400
    v_add_f32 v255, v154, v155
    v_add_f32 v253, v253, v255
    v_add_f32 v251, v251, v253
    s_waitcnt lgkmcnt(5)
    v_mfma_f32_16x16x32_bf16 v[160:163], v[192:195], v[120:123], v[160:163]
    v_mfma_f32_16x16x32_bf16 v[164:167], v[192:195], v[124:127], v[164:167]
    s_add_u32 m0, s45, 98304
    s_nop 0
    buffer_load_dwordx4 v240, s[28:31], s96 offen offset:2048 nt lds
    v_add_f32 v224, v224, v251
    v_cvt_pk_bf16_f32 v178, v152, v153
    v_cvt_pk_bf16_f32 v179, v154, v155
    s_waitcnt lgkmcnt(4)
    v_mfma_f32_16x16x32_bf16 v[168:171], v[196:199], v[120:123], v[168:171]
    v_mfma_f32_16x16x32_bf16 v[172:175], v[196:199], v[124:127], v[172:175]
    v_exp_f32 v156, v156
    v_exp_f32 v157, v157
    v_exp_f32 v158, v158
    v_exp_f32 v159, v159
    s_waitcnt lgkmcnt(3)
    v_mfma_f32_16x16x32_bf16 v[160:163], v[200:203], v[128:131], v[160:163]
    v_mfma_f32_16x16x32_bf16 v[164:167], v[200:203], v[132:135], v[164:167]
    s_add_u32 s48, s52, 0
    v_add_u32 v234, s48, v228
    v_add_u32 v235, s48, v229
    v_add_u32 v236, s48, v230
    v_add_u32 v237, s48, v231
    s_waitcnt lgkmcnt(0)
    s_waitcnt vmcnt(12)
    s_barrier
    ds_read_b64_tr_b16 v[184:185], v234 offset:0
    ds_read_b64_tr_b16 v[186:187], v234 offset:6144
    ds_read_b64_tr_b16 v[188:189], v235 offset:0
    ds_read_b64_tr_b16 v[190:191], v235 offset:6144
    ds_read_b64_tr_b16 v[192:193], v236 offset:0
    ds_read_b64_tr_b16 v[194:195], v236 offset:6144
    s_add_u32 m0, s45, 122880
    s_mov_b32 s96, 98304
    buffer_load_dwordx4 v238, s[24:27], s96 offen nt lds
    v_add_f32 v252, v148, v149
    v_add_f32 v255, v150, v151
    v_add_f32 v252, v252, v255
    v_mfma_f32_16x16x32_bf16 v[168:171], v[204:207], v[128:131], v[168:171]
    v_mfma_f32_16x16x32_bf16 v[172:175], v[204:207], v[132:135], v[172:175]
    ds_read_b64_tr_b16 v[196:197], v237 offset:0
    ds_read_b64_tr_b16 v[198:199], v237 offset:6144
    v_cvt_pk_bf16_f32 v180, v148, v149
    v_cvt_pk_bf16_f32 v181, v150, v151
    v_add_f32 v254, v156, v157
    v_add_f32 v255, v158, v159
    v_mfma_f32_16x16x32_bf16 v[160:163], v[208:211], v[136:139], v[160:163]
    v_mfma_f32_16x16x32_bf16 v[164:167], v[208:211], v[140:143], v[164:167]
    ds_read_b64_tr_b16 v[200:201], v234 offset:128
    ds_read_b64_tr_b16 v[202:203], v234 offset:6272
    v_add_f32 v254, v254, v255
    v_add_f32 v252, v252, v254
    v_add_f32 v225, v225, v252
    v_mfma_f32_16x16x32_bf16 v[168:171], v[212:215], v[136:139], v[168:171]
    v_mfma_f32_16x16x32_bf16 v[172:175], v[212:215], v[140:143], v[172:175]
    ds_read_b64_tr_b16 v[204:205], v235 offset:128
    ds_read_b64_tr_b16 v[206:207], v235 offset:6272
    v_cvt_pk_bf16_f32 v182, v156, v157
    v_cvt_pk_bf16_f32 v183, v158, v159
    s_nop 1
    s_waitcnt lgkmcnt(10)
    v_mfma_f32_16x16x32_bf16 v[0:3], v[184:187], v[176:179], v[0:3]
    v_mfma_f32_16x16x32_bf16 v[4:7], v[184:187], v[180:183], v[4:7]
    ds_read_b64_tr_b16 v[208:209], v236 offset:128
    ds_read_b64_tr_b16 v[210:211], v236 offset:6272
    s_waitcnt lgkmcnt(10)
    v_mfma_f32_16x16x32_bf16 v[8:11], v[188:191], v[176:179], v[8:11]
    v_mfma_f32_16x16x32_bf16 v[12:15], v[188:191], v[180:183], v[12:15]
    ds_read_b64_tr_b16 v[212:213], v237 offset:128
    ds_read_b64_tr_b16 v[214:215], v237 offset:6272
    s_waitcnt lgkmcnt(10)
    v_mfma_f32_16x16x32_bf16 v[16:19], v[192:195], v[176:179], v[16:19]
    v_mfma_f32_16x16x32_bf16 v[20:23], v[192:195], v[180:183], v[20:23]
    ds_read_b64_tr_b16 v[184:185], v234 offset:256
    ds_read_b64_tr_b16 v[186:187], v234 offset:6400
    s_waitcnt lgkmcnt(10)
    v_mfma_f32_16x16x32_bf16 v[24:27], v[196:199], v[176:179], v[24:27]
    v_mfma_f32_16x16x32_bf16 v[28:31], v[196:199], v[180:183], v[28:31]
    ds_read_b64_tr_b16 v[188:189], v235 offset:256
    ds_read_b64_tr_b16 v[190:191], v235 offset:6400
    s_add_u32 m0, s45, 122880
    s_nop 0
    buffer_load_dwordx4 v239, s[24:27], s96 offen offset:1024 nt lds
    v_max3_f32 v246, v160, v161, v162
    v_max3_f32 v247, v163, v168, v169
    s_waitcnt lgkmcnt(10)
    v_mfma_f32_16x16x32_bf16 v[32:35], v[200:203], v[176:179], v[32:35]
    v_mfma_f32_16x16x32_bf16 v[36:39], v[200:203], v[180:183], v[36:39]
    ds_read_b64_tr_b16 v[192:193], v236 offset:256
    ds_read_b64_tr_b16 v[194:195], v236 offset:6400
    v_max3_f32 v248, v170, v171, v164
    s_waitcnt lgkmcnt(10)
    v_mfma_f32_16x16x32_bf16 v[40:43], v[204:207], v[176:179], v[40:43]
    v_mfma_f32_16x16x32_bf16 v[44:47], v[204:207], v[180:183], v[44:47]
    ds_read_b64_tr_b16 v[196:197], v237 offset:256
    ds_read_b64_tr_b16 v[198:199], v237 offset:6400
    v_max3_f32 v249, v165, v166, v167
    v_max3_f32 v250, v172, v173, v174
    s_waitcnt lgkmcnt(10)
    v_mfma_f32_16x16x32_bf16 v[48:51], v[208:211], v[176:179], v[48:51]
    v_mfma_f32_16x16x32_bf16 v[52:55], v[208:211], v[180:183], v[52:55]
    s_add_u32 m0, s45, 122880
    s_nop 0
    buffer_load_dwordx4 v240, s[24:27], s96 offen offset:2048 nt lds
    v_max3_f32 v246, v246, v247, v175
    s_waitcnt lgkmcnt(8)
    v_mfma_f32_16x16x32_bf16 v[56:59], v[212:215], v[176:179], v[56:59]
    v_mfma_f32_16x16x32_bf16 v[60:63], v[212:215], v[180:183], v[60:63]
    v_max3_f32 v248, v248, v249, v250
    v_max_f32 v246, v246, v248
    s_waitcnt lgkmcnt(6)
    v_mfma_f32_16x16x32_bf16 v[64:67], v[184:187], v[176:179], v[64:67]
    v_mfma_f32_16x16x32_bf16 v[68:71], v[184:187], v[180:183], v[68:71]
    s_add_u32 s48, s52, 24576
    v_add_u32 v234, s48, v226
    v_add_u32 v235, s48, v227
    s_waitcnt lgkmcnt(0)
    s_waitcnt vmcnt(12)
    s_barrier
    ds_read_b128 v[200:203], v234 offset:0
    ds_read_b128 v[204:207], v234 offset:6144
    ds_read_b128 v[208:211], v235 offset:0
    s_add_u32 m0, s45, 0
    s_mov_b32 s96, 86016
    buffer_load_dwordx4 v238, s[28:31], s96 offen nt lds
    v_cmp_lt_f32 vcc, s51, v246
    v_mfma_f32_16x16x32_bf16 v[72:75], v[188:191], v[176:179], v[72:75]
    v_mfma_f32_16x16x32_bf16 v[76:79], v[188:191], v[180:183], v[76:79]
    ds_read_b128 v[212:215], v235 offset:6144
    v_mfma_f32_16x16x32_bf16 v[80:83], v[192:195], v[176:179], v[80:83]
    v_mfma_f32_16x16x32_bf16 v[84:87], v[192:195], v[180:183], v[84:87]
    ds_read_b128 v[184:187], v234 offset:128
    v_mfma_f32_16x16x32_bf16 v[88:91], v[196:199], v[176:179], v[88:91]
    v_mfma_f32_16x16x32_bf16 v[92:95], v[196:199], v[180:183], v[92:95]
    ds_read_b128 v[188:191], v234 offset:6272
    s_cbranch_vccnz K1_SLOW5
K1_BACK5:
    s_waitcnt lgkmcnt(5)
    v_mfma_f32_16x16x32_bf16 v[144:147], v[200:203], v[96:99], v[216:219]
    v_mfma_f32_16x16x32_bf16 v[148:151], v[200:203], v[100:103], v[220:223]
    ds_read_b128 v[192:195], v235 offset:128
    v_exp_f32 v160, v160
    v_exp_f32 v161, v161
    v_exp_f32 v162, v162
    v_exp_f32 v163, v163
    s_waitcnt lgkmcnt(5)
    v_mfma_f32_16x16x32_bf16 v[152:155], v[204:207], v[96:99], v[216:219]
    v_mfma_f32_16x16x32_bf16 v[156:159], v[204:207], v[100:103], v[220:223]
    ds_read_b128 v[196:199], v235 offset:6272
    v_exp_f32 v168, v168
    v_exp_f32 v169, v169
    v_exp_f32 v170, v170
    s_waitcnt lgkmcnt(5)
    v_mfma_f32_16x16x32_bf16 v[144:147], v[208:211], v[104:107], v[144:147]
    v_mfma_f32_16x16x32_bf16 v[148:151], v[208:211], v[108:111], v[148:151]
    ds_read_b128 v[200:203], v234 offset:256
    v_exp_f32 v171, v171
    v_add_f32 v251, v160, v161
    v_add_f32 v255, v162, v163
    v_add_f32 v251, v251, v255
    s_waitcnt lgkmcnt(5)
    v_mfma_f32_16x16x32_bf16 v[152:155], v[212:215], v[104:107], v[152:155]
    v_mfma_f32_16x16x32_bf16 v[156:159], v[212:215], v[108:111], v[156:159]
    ds_read_b128 v[204:207], v234 offset:6400
    s_add_u32 m0, s45, 0
    s_nop 0
    buffer_load_dwordx4 v239, s[28:31], s96 offen offset:1024 nt lds
    v_cvt_pk_bf16_f32 v176, v160, v161
    v_cvt_pk_bf16_f32 v177, v162, v163
    v_exp_f32 v164, v164
    s_waitcnt lgkmcnt(5)
    v_mfma_f32_16x16x32_bf16 v[144:147], v[184:187], v[112:115], v[144:147]
    v_mfma_f32_16x16x32_bf16 v[148:151], v[184:187], v[116:119], v[148:151]
    ds_read_b128 v[208:211], v235 offset:256
    v_exp_f32 v165, v165
    v_exp_f32 v166, v166
    v_exp_f32 v167, v167
    v_add_f32 v253, v168, v169
    s_waitcnt lgkmcnt(5)
    v_mfma_f32_16x16x32_bf16 v[152:155], v[188:191], v[112:115], v[152:155]
    v_mfma_f32_16x16x32_bf16 v[156:159], v[188:191], v[116:119], v[156:159]
    ds_read_b128 v[212:215], v235 offset:6400
    v_add_f32 v255, v170, v171
    v_add_f32 v253, v253, v255
    v_add_f32 v251, v251, v253
    s_waitcnt lgkmcnt(5)
    v_mfma_f32_16x16x32_bf16 v[144:147], v[192:195], v[120:123], v[144:147]
    v_mfma_f32_16x16x32_bf16 v[148:151], v[192:195], v[124:127], v[148:151]
    s_add_u32 m0, s45, 0
    s_nop 0
    buffer_load_dwordx4 v240, s[28:31], s96 offen offset:2048 nt lds
    v_add_f32 v224, v224, v251
    v_cvt_pk_bf16_f32 v178, v168, v169
    v_cvt_pk_bf16_f32 v179, v170, v171
    s_waitcnt lgkmcnt(4)
    v_mfma_f32_16x16x32_bf16 v[152:155], v[196:199], v[120:123], v[152:155]
    v_mfma_f32_16x16x32_bf16 v[156:159], v[196:199], v[124:127], v[156:159]
    v_exp_f32 v172, v172
    v_exp_f32 v173, v173
    v_exp_f32 v174, v174
    v_exp_f32 v175, v175
    s_waitcnt lgkmcnt(3)
    v_mfma_f32_16x16x32_bf16 v[144:147], v[200:203], v[128:131], v[144:147]
    v_mfma_f32_16x16x32_bf16 v[148:151], v[200:203], v[132:135], v[148:151]
    s_add_u32 s48, s52, 49152
    v_add_u32 v234, s48, v228
    v_add_u32 v235, s48, v229
    v_add_u32 v236, s48, v230
    v_add_u32 v237, s48, v231
    s_waitcnt lgkmcnt(0)
    s_waitcnt vmcnt(12)
    s_barrier
    ds_read_b64_tr_b16 v[184:185], v234 offset:0
    ds_read_b64_tr_b16 v[186:187], v234 offset:6144
    ds_read_b64_tr_b16 v[188:189], v235 offset:0
    ds_read_b64_tr_b16 v[190:191], v235 offset:6144
    ds_read_b64_tr_b16 v[192:193], v236 offset:0
    ds_read_b64_tr_b16 v[194:195], v236 offset:6144
    s_add_u32 m0, s45, 24576
    s_mov_b32 s96, 110592
    buffer_load_dwordx4 v238, s[24:27], s96 offen nt lds
    v_add_f32 v252, v164, v165
    v_add_f32 v255, v166, v167
    v_add_f32 v252, v252, v255
    v_mfma_f32_16x16x32_bf16 v[152:155], v[204:207], v[128:131], v[152:155]
    v_mfma_f32_16x16x32_bf16 v[156:159], v[204:207], v[132:135], v[156:159]
    ds_read_b64_tr_b16 v[196:197], v237 offset:0
    ds_read_b64_tr_b16 v[198:199], v237 offset:6144
    v_cvt_pk_bf16_f32 v180, v164, v165
    v_cvt_pk_bf16_f32 v181, v166, v167
    v_add_f32 v254, v172, v173
    v_add_f32 v255, v174, v175
    v_mfma_f32_16x16x32_bf16 v[144:147], v[208:211], v[136:139], v[144:147]
    v_mfma_f32_16x16x32_bf16 v[148:151], v[208:211], v[140:143], v[148:151]
    ds_read_b64_tr_b16 v[200:201], v234 offset:128
    ds_read_b64_tr_b16 v[202:203], v234 offset:6272
    v_add_f32 v254, v254, v255
    v_add_f32 v252, v252, v254
    v_add_f32 v225, v225, v252
    v_mfma_f32_16x16x32_bf16 v[152:155], v[212:215], v[136:139], v[152:155]
    v_mfma_f32_16x16x32_bf16 v[156:159], v[212:215], v[140:143], v[156:159]
    ds_read_b64_tr_b16 v[204:205], v235 offset:128
    ds_read_b64_tr_b16 v[206:207], v235 offset:6272
    v_cvt_pk_bf16_f32 v182, v172, v173
    v_cvt_pk_bf16_f32 v183, v174, v175
    s_nop 1
    s_waitcnt lgkmcnt(10)
    v_mfma_f32_16x16x32_bf16 v[0:3], v[184:187], v[176:179], v[0:3]
    v_mfma_f32_16x16x32_bf16 v[4:7], v[184:187], v[180:183], v[4:7]
    ds_read_b64_tr_b16 v[208:209], v236 offset:128
    ds_read_b64_tr_b16 v[210:211], v236 offset:6272
    s_waitcnt lgkmcnt(10)
    v_mfma_f32_16x16x32_bf16 v[8:11], v[188:191], v[176:179], v[8:11]
    v_mfma_f32_16x16x32_bf16 v[12:15], v[188:191], v[180:183], v[12:15]
    ds_read_b64_tr_b16 v[212:213], v237 offset:128
    ds_read_b64_tr_b16 v[214:215], v237 offset:6272
    s_waitcnt lgkmcnt(10)
    v_mfma_f32_16x16x32_bf16 v[16:19], v[192:195], v[176:179], v[16:19]
    v_mfma_f32_16x16x32_bf16 v[20:23], v[192:195], v[180:183], v[20:23]
    ds_read_b64_tr_b16 v[184:185], v234 offset:256
    ds_read_b64_tr_b16 v[186:187], v234 offset:6400
    s_waitcnt lgkmcnt(10)
    v_mfma_f32_16x16x32_bf16 v[24:27], v[196:199], v[176:179], v[24:27]
    v_mfma_f32_16x16x32_bf16 v[28:31], v[196:199], v[180:183], v[28:31]
    ds_read_b64_tr_b16 v[188:189], v235 offset:256
    ds_read_b64_tr_b16 v[190:191], v235 offset:6400
    s_add_u32 m0, s45, 24576
    s_nop 0
    buffer_load_dwordx4 v239, s[24:27], s96 offen offset:1024 nt lds
    v_max3_f32 v246, v144, v145, v146
    v_max3_f32 v247, v147, v152, v153
    s_waitcnt lgkmcnt(10)
    v_mfma_f32_16x16x32_bf16 v[32:35], v[200:203], v[176:179], v[32:35]
    v_mfma_f32_16x16x32_bf16 v[36:39], v[200:203], v[180:183], v[36:39]
    ds_read_b64_tr_b16 v[192:193], v236 offset:256
    ds_read_b64_tr_b16 v[194:195], v236 offset:6400
    v_max3_f32 v248, v154, v155, v148
    s_waitcnt lgkmcnt(10)
    v_mfma_f32_16x16x32_bf16 v[40:43], v[204:207], v[176:179], v[40:43]
    v_mfma_f32_16x16x32_bf16 v[44:47], v[204:207], v[180:183], v[44:47]
    ds_read_b64_tr_b16 v[196:197], v237 offset:256
    ds_read_b64_tr_b16 v[198:199], v237 offset:6400
    v_max3_f32 v249, v149, v150, v151
    v_max3_f32 v250, v156, v157, v158
    s_waitcnt lgkmcnt(10)
    v_mfma_f32_16x16x32_bf16 v[48:51], v[208:211], v[176:179], v[48:51]
    v_mfma_f32_16x16x32_bf16 v[52:55], v[208:211], v[180:183], v[52:55]
    s_add_u32 m0, s45, 24576
    s_nop 0
    buffer_load_dwordx4 v240, s[24:27], s96 offen offset:2048 nt lds
    v_max3_f32 v246, v246, v247, v159
    s_waitcnt lgkmcnt(8)
    v_mfma_f32_16x16x32_bf16 v[56:59], v[212:215], v[176:179], v[56:59]
    v_mfma_f32_16x16x32_bf16 v[60:63], v[212:215], v[180:183], v[60:63]
    v_max3_f32 v248, v248, v249, v250
    v_max_f32 v246, v246, v248
    s_waitcnt lgkmcnt(6)
    v_mfma_f32_16x16x32_bf16 v[64:67], v[184:187], v[176:179], v[64:67]
    v_mfma_f32_16x16x32_bf16 v[68:71], v[184:187], v[180:183], v[68:71]
    s_add_u32 s48, s52, 73728
    v_add_u32 v234, s48, v226
    v_add_u32 v235, s48, v227
    s_waitcnt lgkmcnt(0)
    s_waitcnt vmcnt(12)
    s_barrier
    ds_read_b128 v[200:203], v234 offset:0
    ds_read_b128 v[204:207], v234 offset:6144
    ds_read_b128 v[208:211], v235 offset:0
    s_add_u32 m0, s45, 49152
    s_mov_b32 s96, 98304
    buffer_load_dwordx4 v238, s[28:31], s96 offen nt lds
    v_cmp_lt_f32 vcc, s51, v246
    v_mfma_f32_16x16x32_bf16 v[72:75], v[188:191], v[176:179], v[72:75]
    v_mfma_f32_16x16x32_bf16 v[76:79], v[188:191], v[180:183], v[76:79]
    ds_read_b128 v[212:215], v235 offset:6144
    v_mfma_f32_16x16x32_bf16 v[80:83], v[192:195], v[176:179], v[80:83]
    v_mfma_f32_16x16x32_bf16 v[84:87], v[192:195], v[180:183], v[84:87]
    ds_read_b128 v[184:187], v234 offset:128
    v_mfma_f32_16x16x32_bf16 v[88:91], v[196:199], v[176:179], v[88:91]
    v_mfma_f32_16x16x32_bf16 v[92:95], v[196:199], v[180:183], v[92:95]
    ds_read_b128 v[188:191], v234 offset:6272
    s_cbranch_vccnz K1_SLOW6
K1_BACK6:
    s_waitcnt lgkmcnt(5)
    v_mfma_f32_16x16x32_bf16 v[160:163], v[200:203], v[96:99], v[216:219]
    v_mfma_f32_16x16x32_bf16 v[164:167], v[200:203], v[100:103], v[220:223]
    ds_read_b128 v[192:195], v235 offset:128
    v_exp_f32 v144, v144
    v_exp_f32 v145, v145
    v_exp_f32 v146, v146
    v_exp_f32 v147, v147
    s_waitcnt lgkmcnt(5)
    v_mfma_f32_16x16x32_bf16 v[168:171], v[204:207], v[96:99], v[216:219]
    v_mfma_f32_16x16x32_bf16 v[172:175], v[204:207], v[100:103], v[220:223]
    ds_read_b128 v[196:199], v235 offset:6272
    v_exp_f32 v152, v152
    v_exp_f32 v153, v153
    v_exp_f32 v154, v154
    s_waitcnt lgkmcnt(5)
    v_mfma_f32_16x16x32_bf16 v[160:163], v[208:211], v[104:107], v[160:163]
    v_mfma_f32_16x16x32_bf16 v[164:167], v[208:211], v[108:111], v[164:167]
    ds_read_b128 v[200:203], v234 offset:256
    v_exp_f32 v155, v155
    v_add_f32 v251, v144, v145
    v_add_f32 v255, v146, v147
    v_add_f32 v251, v251, v255
    s_waitcnt lgkmcnt(5)
    v_mfma_f32_16x16x32_bf16 v[168:171], v[212:215], v[104:107], v[168:171]
    v_mfma_f32_16x16x32_bf16 v[172:175], v[212:215], v[108:111], v[172:175]
    ds_read_b128 v[204:207], v234 offset:6400
    s_add_u32 m0, s45, 49152
    s_nop 0
    buffer_load_dwordx4 v239, s[28:31], s96 offen offset:1024 nt lds
    v_cvt_pk_bf16_f32 v176, v144, v145
    v_cvt_pk_bf16_f32 v177, v146, v147
    v_exp_f32 v148, v148
    s_waitcnt lgkmcnt(5)
    v_mfma_f32_16x16x32_bf16 v[160:163], v[184:187], v[112:115], v[160:163]
    v_mfma_f32_16x16x32_bf16 v[164:167], v[184:187], v[116:119], v[164:167]
    ds_read_b128 v[208:211], v235 offset:256
    v_exp_f32 v149, v149
    v_exp_f32 v150, v150
    v_exp_f32 v151, v151
    v_add_f32 v253, v152, v153
    s_waitcnt lgkmcnt(5)
    v_mfma_f32_16x16x32_bf16 v[168:171], v[188:191], v[112:115], v[168:171]
    v_mfma_f32_16x16x32_bf16 v[172:175], v[188:191], v[116:119], v[172:175]
    ds_read_b128 v[212:215], v235 offset:6400
    v_add_f32 v255, v154, v155
    v_add_f32 v253, v253, v255
    v_add_f32 v251, v251, v253
    s_waitcnt lgkmcnt(5)
    v_mfma_f32_16x16x32_bf16 v[160:163], v[192:195], v[120:123], v[160:163]
    v_mfma_f32_16x16x32_bf16 v[164:167], v[192:195], v[124:127], v[164:167]
    s_add_u32 m0, s45, 49152
    s_nop 0
    buffer_load_dwordx4 v240, s[28:31], s96 offen offset:2048 nt lds
    v_add_f32 v224, v224, v251
    v_cvt_pk_bf16_f32 v178, v152, v153
    v_cvt_pk_bf16_f32 v179, v154, v155
    s_waitcnt lgkmcnt(4)
    v_mfma_f32_16x16x32_bf16 v[168:171], v[196:199], v[120:123], v[168:171]
    v_mfma_f32_16x16x32_bf16 v[172:175], v[196:199], v[124:127], v[172:175]
    v_exp_f32 v156, v156
    v_exp_f32 v157, v157
    v_exp_f32 v158, v158
    v_exp_f32 v159, v159
    s_waitcnt lgkmcnt(3)
    v_mfma_f32_16x16x32_bf16 v[160:163], v[200:203], v[128:131], v[160:163]
    v_mfma_f32_16x16x32_bf16 v[164:167], v[200:203], v[132:135], v[164:167]
    s_add_u32 s48, s52, 98304
    v_add_u32 v234, s48, v228
    v_add_u32 v235, s48, v229
    v_add_u32 v236, s48, v230
    v_add_u32 v237, s48, v231
    s_waitcnt lgkmcnt(0)
    s_waitcnt vmcnt(12)
    s_barrier
    ds_read_b64_tr_b16 v[184:185], v234 offset:0
    ds_read_b64_tr_b16 v[186:187], v234 offset:6144
    ds_read_b64_tr_b16 v[188:189], v235 offset:0
    ds_read_b64_tr_b16 v[190:191], v235 offset:6144
    ds_read_b64_tr_b16 v[192:193], v236 offset:0
    ds_read_b64_tr_b16 v[194:195], v236 offset:6144
    s_add_u32 m0, s45, 73728
    s_mov_b32 s96, 122880
    buffer_load_dwordx4 v238, s[24:27], s96 offen nt lds
    v_add_f32 v252, v148, v149
    v_add_f32 v255, v150, v151
    v_add_f32 v252, v252, v255
    v_mfma_f32_16x16x32_bf16 v[168:171], v[204:207], v[128:131], v[168:171]
    v_mfma_f32_16x16x32_bf16 v[172:175], v[204:207], v[132:135], v[172:175]
    ds_read_b64_tr_b16 v[196:197], v237 offset:0
    ds_read_b64_tr_b16 v[198:199], v237 offset:6144
    v_cvt_pk_bf16_f32 v180, v148, v149
    v_cvt_pk_bf16_f32 v181, v150, v151
    v_add_f32 v254, v156, v157
    v_add_f32 v255, v158, v159
    v_mfma_f32_16x16x32_bf16 v[160:163], v[208:211], v[136:139], v[160:163]
    v_mfma_f32_16x16x32_bf16 v[164:167], v[208:211], v[140:143], v[164:167]
    ds_read_b64_tr_b16 v[200:201], v234 offset:128
    ds_read_b64_tr_b16 v[202:203], v234 offset:6272
    v_add_f32 v254, v254, v255
    v_add_f32 v252, v252, v254
    v_add_f32 v225, v225, v252
    v_mfma_f32_16x16x32_bf16 v[168:171], v[212:215], v[136:139], v[168:171]
    v_mfma_f32_16x16x32_bf16 v[172:175], v[212:215], v[140:143], v[172:175]
    ds_read_b64_tr_b16 v[204:205], v235 offset:128
    ds_read_b64_tr_b16 v[206:207], v235 offset:6272
    v_cvt_pk_bf16_f32 v182, v156, v157
    v_cvt_pk_bf16_f32 v183, v158, v159
    s_nop 1
    s_waitcnt lgkmcnt(10)
    v_mfma_f32_16x16x32_bf16 v[0:3], v[184:187], v[176:179], v[0:3]
    v_mfma_f32_16x16x32_bf16 v[4:7], v[184:187], v[180:183], v[4:7]
    ds_read_b64_tr_b16 v[208:209], v236 offset:128
    ds_read_b64_tr_b16 v[210:211], v236 offset:6272
    s_waitcnt lgkmcnt(10)
    v_mfma_f32_16x16x32_bf16 v[8:11], v[188:191], v[176:179], v[8:11]
    v_mfma_f32_16x16x32_bf16 v[12:15], v[188:191], v[180:183], v[12:15]
    ds_read_b64_tr_b16 v[212:213], v237 offset:128
    ds_read_b64_tr_b16 v[214:215], v237 offset:6272
    s_waitcnt lgkmcnt(10)
    v_mfma_f32_16x16x32_bf16 v[16:19], v[192:195], v[176:179], v[16:19]
    v_mfma_f32_16x16x32_bf16 v[20:23], v[192:195], v[180:183], v[20:23]
    ds_read_b64_tr_b16 v[184:185], v234 offset:256
    ds_read_b64_tr_b16 v[186:187], v234 offset:6400
    s_waitcnt lgkmcnt(10)
    v_mfma_f32_16x16x32_bf16 v[24:27], v[196:199], v[176:179], v[24:27]
    v_mfma_f32_16x16x32_bf16 v[28:31], v[196:199], v[180:183], v[28:31]
    ds_read_b64_tr_b16 v[188:189], v235 offset:256
    ds_read_b64_tr_b16 v[190:191], v235 offset:6400
    s_add_u32 m0, s45, 73728
    s_nop 0
    buffer_load_dwordx4 v239, s[24:27], s96 offen offset:1024 nt lds
    v_max3_f32 v246, v160, v161, v162
    v_max3_f32 v247, v163, v168, v169
    s_waitcnt lgkmcnt(10)
    v_mfma_f32_16x16x32_bf16 v[32:35], v[200:203], v[176:179], v[32:35]
    v_mfma_f32_16x16x32_bf16 v[36:39], v[200:203], v[180:183], v[36:39]
    ds_read_b64_tr_b16 v[192:193], v236 offset:256
    ds_read_b64_tr_b16 v[194:195], v236 offset:6400
    v_max3_f32 v248, v170, v171, v164
    s_waitcnt lgkmcnt(10)
    v_mfma_f32_16x16x32_bf16 v[40:43], v[204:207], v[176:179], v[40:43]
    v_mfma_f32_16x16x32_bf16 v[44:47], v[204:207], v[180:183], v[44:47]
    ds_read_b64_tr_b16 v[196:197], v237 offset:256
    ds_read_b64_tr_b16 v[198:199], v237 offset:6400
    v_max3_f32 v249, v165, v166, v167
    v_max3_f32 v250, v172, v173, v174
    s_waitcnt lgkmcnt(10)
    v_mfma_f32_16x16x32_bf16 v[48:51], v[208:211], v[176:179], v[48:51]
    v_mfma_f32_16x16x32_bf16 v[52:55], v[208:211], v[180:183], v[52:55]
    s_add_u32 m0, s45, 73728
    s_nop 0
    buffer_load_dwordx4 v240, s[24:27], s96 offen offset:2048 nt lds
    v_max3_f32 v246, v246, v247, v175
    s_waitcnt lgkmcnt(8)
    v_mfma_f32_16x16x32_bf16 v[56:59], v[212:215], v[176:179], v[56:59]
    v_mfma_f32_16x16x32_bf16 v[60:63], v[212:215], v[180:183], v[60:63]
    v_max3_f32 v248, v248, v249, v250
    v_max_f32 v246, v246, v248
    s_waitcnt lgkmcnt(6)
    v_mfma_f32_16x16x32_bf16 v[64:67], v[184:187], v[176:179], v[64:67]
    v_mfma_f32_16x16x32_bf16 v[68:71], v[184:187], v[180:183], v[68:71]
    s_add_u32 s48, s52, 122880
    v_add_u32 v234, s48, v226
    v_add_u32 v235, s48, v227
    s_waitcnt lgkmcnt(0)
    s_waitcnt vmcnt(12)
    s_barrier
    ds_read_b128 v[200:203], v234 offset:0
    ds_read_b128 v[204:207], v234 offset:6144
    ds_read_b128 v[208:211], v235 offset:0
    s_add_u32 m0, s45, 98304
    s_mov_b32 s96, 110592
    buffer_load_dwordx4 v238, s[28:31], s96 offen nt lds
    v_cmp_lt_f32 vcc, s51, v246
    v_mfma_f32_16x16x32_bf16 v[72:75], v[188:191], v[176:179], v[72:75]
    v_mfma_f32_16x16x32_bf16 v[76:79], v[188:191], v[180:183], v[76:79]
    ds_read_b128 v[212:215], v235 offset:6144
    v_mfma_f32_16x16x32_bf16 v[80:83], v[192:195], v[176:179], v[80:83]
    v_mfma_f32_16x16x32_bf16 v[84:87], v[192:195], v[180:183], v[84:87]
    ds_read_b128 v[184:187], v234 offset:128
    v_mfma_f32_16x16x32_bf16 v[88:91], v[196:199], v[176:179], v[88:91]
    v_mfma_f32_16x16x32_bf16 v[92:95], v[196:199], v[180:183], v[92:95]
    ds_read_b128 v[188:191], v234 offset:6272
    s_cbranch_vccnz K1_SLOW7
K1_BACK7:
    s_waitcnt lgkmcnt(5)
    v_mfma_f32_16x16x32_bf16 v[144:147], v[200:203], v[96:99], v[216:219]
    v_mfma_f32_16x16x32_bf16 v[148:151], v[200:203], v[100:103], v[220:223]
    ds_read_b128 v[192:195], v235 offset:128
    v_exp_f32 v160, v160
    v_exp_f32 v161, v161
    v_exp_f32 v162, v162
    v_exp_f32 v163, v163
    s_waitcnt lgkmcnt(5)
    v_mfma_f32_16x16x32_bf16 v[152:155], v[204:207], v[96:99], v[216:219]
    v_mfma_f32_16x16x32_bf16 v[156:159], v[204:207], v[100:103], v[220:223]
    ds_read_b128 v[196:199], v235 offset:6272
    v_exp_f32 v168, v168
    v_exp_f32 v169, v169
    v_exp_f32 v170, v170
    s_waitcnt lgkmcnt(5)
    v_mfma_f32_16x16x32_bf16 v[144:147], v[208:211], v[104:107], v[144:147]
    v_mfma_f32_16x16x32_bf16 v[148:151], v[208:211], v[108:111], v[148:151]
    ds_read_b128 v[200:203], v234 offset:256
    v_exp_f32 v171, v171
    v_add_f32 v251, v160, v161
    v_add_f32 v255, v162, v163
    v_add_f32 v251, v251, v255
    s_waitcnt lgkmcnt(5)
    v_mfma_f32_16x16x32_bf16 v[152:155], v[212:215], v[104:107], v[152:155]
    v_mfma_f32_16x16x32_bf16 v[156:159], v[212:215], v[108:111], v[156:159]
    ds_read_b128 v[204:207], v234 offset:6400
    s_add_u32 m0, s45, 98304
    s_nop 0
    buffer_load_dwordx4 v239, s[28:31], s96 offen offset:1024 nt lds
    v_cvt_pk_bf16_f32 v176, v160, v161
    v_cvt_pk_bf16_f32 v177, v162, v163
    v_exp_f32 v164, v164
    s_waitcnt lgkmcnt(5)
    v_mfma_f32_16x16x32_bf16 v[144:147], v[184:187], v[112:115], v[144:147]
    v_mfma_f32_16x16x32_bf16 v[148:151], v[184:187], v[116:119], v[148:151]
    ds_read_b128 v[208:211], v235 offset:256
    v_exp_f32 v165, v165
    v_exp_f32 v166, v166
    v_exp_f32 v167, v167
    v_add_f32 v253, v168, v169
    s_waitcnt lgkmcnt(5)
    v_mfma_f32_16x16x32_bf16 v[152:155], v[188:191], v[112:115], v[152:155]
    v_mfma_f32_16x16x32_bf16 v[156:159], v[188:191], v[116:119], v[156:159]
    ds_read_b128 v[212:215], v235 offset:6400
    v_add_f32 v255, v170, v171
    v_add_f32 v253, v253, v255
    v_add_f32 v251, v251, v253
    s_waitcnt lgkmcnt(5)
    v_mfma_f32_16x16x32_bf16 v[144:147], v[192:195], v[120:123], v[144:147]
    v_mfma_f32_16x16x32_bf16 v[148:151], v[192:195], v[124:127], v[148:151]
    s_add_u32 m0, s45, 98304
    s_nop 0
    buffer_load_dwordx4 v240, s[28:31], s96 offen offset:2048 nt lds
    v_add_f32 v224, v224, v251
    v_cvt_pk_bf16_f32 v178, v168, v169
    v_cvt_pk_bf16_f32 v179, v170, v171
    s_waitcnt lgkmcnt(4)
    v_mfma_f32_16x16x32_bf16 v[152:155], v[196:199], v[120:123], v[152:155]
    v_mfma_f32_16x16x32_bf16 v[156:159], v[196:199], v[124:127], v[156:159]
    v_exp_f32 v172, v172
    v_exp_f32 v173, v173
    v_exp_f32 v174, v174
    v_exp_f32 v175, v175
    s_waitcnt lgkmcnt(3)
    v_mfma_f32_16x16x32_bf16 v[144:147], v[200:203], v[128:131], v[144:147]
    v_mfma_f32_16x16x32_bf16 v[148:151], v[200:203], v[132:135], v[148:151]
    s_add_u32 s48, s52, 0
    v_add_u32 v234, s48, v228
    v_add_u32 v235, s48, v229
    v_add_u32 v236, s48, v230
    v_add_u32 v237, s48, v231
    s_waitcnt lgkmcnt(0)
    s_waitcnt vmcnt(12)
    s_barrier
    ds_read_b64_tr_b16 v[184:185], v234 offset:0
    ds_read_b64_tr_b16 v[186:187], v234 offset:6144
    ds_read_b64_tr_b16 v[188:189], v235 offset:0
    ds_read_b64_tr_b16 v[190:191], v235 offset:6144
    ds_read_b64_tr_b16 v[192:193], v236 offset:0
    ds_read_b64_tr_b16 v[194:195], v236 offset:6144
    s_add_u32 m0, s45, 122880
    s_mov_b32 s96, 135168
    buffer_load_dwordx4 v238, s[24:27], s96 offen nt lds
    v_add_f32 v252, v164, v165
    v_add_f32 v255, v166, v167
    v_add_f32 v252, v252, v255
    v_mfma_f32_16x16x32_bf16 v[152:155], v[204:207], v[128:131], v[152:155]
    v_mfma_f32_16x16x32_bf16 v[156:159], v[204:207], v[132:135], v[156:159]
    ds_read_b64_tr_b16 v[196:197], v237 offset:0
    ds_read_b64_tr_b16 v[198:199], v237 offset:6144
    v_cvt_pk_bf16_f32 v180, v164, v165
    v_cvt_pk_bf16_f32 v181, v166, v167
    v_add_f32 v254, v172, v173
    v_add_f32 v255, v174, v175
    v_mfma_f32_16x16x32_bf16 v[144:147], v[208:211], v[136:139], v[144:147]
    v_mfma_f32_16x16x32_bf16 v[148:151], v[208:211], v[140:143], v[148:151]
    ds_read_b64_tr_b16 v[200:201], v234 offset:128
    ds_read_b64_tr_b16 v[202:203], v234 offset:6272
    v_add_f32 v254, v254, v255
    v_add_f32 v252, v252, v254
    v_add_f32 v225, v225, v252
    v_mfma_f32_16x16x32_bf16 v[152:155], v[212:215], v[136:139], v[152:155]
    v_mfma_f32_16x16x32_bf16 v[156:159], v[212:215], v[140:143], v[156:159]
    ds_read_b64_tr_b16 v[204:205], v235 offset:128
    ds_read_b64_tr_b16 v[206:207], v235 offset:6272
    v_cvt_pk_bf16_f32 v182, v172, v173
    v_cvt_pk_bf16_f32 v183, v174, v175
    s_nop 1
    s_waitcnt lgkmcnt(10)
    v_mfma_f32_16x16x32_bf16 v[0:3], v[184:187], v[176:179], v[0:3]
    v_mfma_f32_16x16x32_bf16 v[4:7], v[184:187], v[180:183], v[4:7]
    ds_read_b64_tr_b16 v[208:209], v236 offset:128
    ds_read_b64_tr_b16 v[210:211], v236 offset:6272
    s_waitcnt lgkmcnt(10)
    v_mfma_f32_16x16x32_bf16 v[8:11], v[188:191], v[176:179], v[8:11]
    v_mfma_f32_16x16x32_bf16 v[12:15], v[188:191], v[180:183], v[12:15]
    ds_read_b64_tr_b16 v[212:213], v237 offset:128
    ds_read_b64_tr_b16 v[214:215], v237 offset:6272
    s_waitcnt lgkmcnt(10)
    v_mfma_f32_16x16x32_bf16 v[16:19], v[192:195], v[176:179], v[16:19]
    v_mfma_f32_16x16x32_bf16 v[20:23], v[192:195], v[180:183], v[20:23]
    ds_read_b64_tr_b16 v[184:185], v234 offset:256
    ds_read_b64_tr_b16 v[186:187], v234 offset:6400
    s_waitcnt lgkmcnt(10)
    v_mfma_f32_16x16x32_bf16 v[24:27], v[196:199], v[176:179], v[24:27]
    v_mfma_f32_16x16x32_bf16 v[28:31], v[196:199], v[180:183], v[28:31]
    ds_read_b64_tr_b16 v[188:189], v235 offset:256
    ds_read_b64_tr_b16 v[190:191], v235 offset:6400
    s_add_u32 m0, s45, 122880
    s_nop 0
    buffer_load_dwordx4 v239, s[24:27], s96 offen offset:1024 nt lds
    v_max3_f32 v246, v144, v145, v146
    v_max3_f32 v247, v147, v152, v153
    s_waitcnt lgkmcnt(10)
    v_mfma_f32_16x16x32_bf16 v[32:35], v[200:203], v[176:179], v[32:35]
    v_mfma_f32_16x16x32_bf16 v[36:39], v[200:203], v[180:183], v[36:39]
    ds_read_b64_tr_b16 v[192:193], v236 offset:256
    ds_read_b64_tr_b16 v[194:195], v236 offset:6400
    v_max3_f32 v248, v154, v155, v148
    s_waitcnt lgkmcnt(10)
    v_mfma_f32_16x16x32_bf16 v[40:43], v[204:207], v[176:179], v[40:43]
    v_mfma_f32_16x16x32_bf16 v[44:47], v[204:207], v[180:183], v[44:47]
    ds_read_b64_tr_b16 v[196:197], v237 offset:256
    ds_read_b64_tr_b16 v[198:199], v237 offset:6400
    v_max3_f32 v249, v149, v150, v151
    v_max3_f32 v250, v156, v157, v158
    s_waitcnt lgkmcnt(10)
    v_mfma_f32_16x16x32_bf16 v[48:51], v[208:211], v[176:179], v[48:51]
    v_mfma_f32_16x16x32_bf16 v[52:55], v[208:211], v[180:183], v[52:55]
    s_add_u32 m0, s45, 122880
    s_nop 0
    buffer_load_dwordx4 v240, s[24:27], s96 offen offset:2048 nt lds
    v_max3_f32 v246, v246, v247, v159
    s_waitcnt lgkmcnt(8)
    v_mfma_f32_16x16x32_bf16 v[56:59], v[212:215], v[176:179], v[56:59]
    v_mfma_f32_16x16x32_bf16 v[60:63], v[212:215], v[180:183], v[60:63]
    v_max3_f32 v248, v248, v249, v250
    v_max_f32 v246, v246, v248
    s_waitcnt lgkmcnt(6)
    v_mfma_f32_16x16x32_bf16 v[64:67], v[184:187], v[176:179], v[64:67]
    v_mfma_f32_16x16x32_bf16 v[68:71], v[184:187], v[180:183], v[68:71]
    s_add_u32 s48, s52, 24576
    v_add_u32 v234, s48, v226
    v_add_u32 v235, s48, v227
    s_waitcnt lgkmcnt(0)
    s_waitcnt vmcnt(12)
    s_barrier
    ds_read_b128 v[200:203], v234 offset:0
    ds_read_b128 v[204:207], v234 offset:6144
    ds_read_b128 v[208:211], v235 offset:0
    s_add_u32 m0, s45, 0
    s_mov_b32 s96, 122880
    buffer_load_dwordx4 v238, s[28:31], s96 offen nt lds
    v_cmp_lt_f32 vcc, s51, v246
    v_mfma_f32_16x16x32_bf16 v[72:75], v[188:191], v[176:179], v[72:75]
    v_mfma_f32_16x16x32_bf16 v[76:79], v[188:191], v[180:183], v[76:79]
    ds_read_b128 v[212:215], v235 offset:6144
    v_mfma_f32_16x16x32_bf16 v[80:83], v[192:195], v[176:179], v[80:83]
    v_mfma_f32_16x16x32_bf16 v[84:87], v[192:195], v[180:183], v[84:87]
    ds_read_b128 v[184:187], v234 offset:128
    v_mfma_f32_16x16x32_bf16 v[88:91], v[196:199], v[176:179], v[88:91]
    v_mfma_f32_16x16x32_bf16 v[92:95], v[196:199], v[180:183], v[92:95]
    ds_read_b128 v[188:191], v234 offset:6272
    s_cbranch_vccnz K1_SLOW8
K1_BACK8:
    s_waitcnt lgkmcnt(5)
    v_mfma_f32_16x16x32_bf16 v[160:163], v[200:203], v[96:99], v[216:219]
    v_mfma_f32_16x16x32_bf16 v[164:167], v[200:203], v[100:103], v[220:223]
    ds_read_b128 v[192:195], v235 offset:128
    v_exp_f32 v144, v144
    v_exp_f32 v145, v145
    v_exp_f32 v146, v146
    v_exp_f32 v147, v147
    s_waitcnt lgkmcnt(5)
    v_mfma_f32_16x16x32_bf16 v[168:171], v[204:207], v[96:99], v[216:219]
    v_mfma_f32_16x16x32_bf16 v[172:175], v[204:207], v[100:103], v[220:223]
    ds_read_b128 v[196:199], v235 offset:6272
    v_exp_f32 v152, v152
    v_exp_f32 v153, v153
    v_exp_f32 v154, v154
    s_waitcnt lgkmcnt(5)
    v_mfma_f32_16x16x32_bf16 v[160:163], v[208:211], v[104:107], v[160:163]
    v_mfma_f32_16x16x32_bf16 v[164:167], v[208:211], v[108:111], v[164:167]
    ds_read_b128 v[200:203], v234 offset:256
    v_exp_f32 v155, v155
    v_add_f32 v251, v144, v145
    v_add_f32 v255, v146, v147
    v_add_f32 v251, v251, v255
    s_waitcnt lgkmcnt(5)
    v_mfma_f32_16x16x32_bf16 v[168:171], v[212:215], v[104:107], v[168:171]
    v_mfma_f32_16x16x32_bf16 v[172:175], v[212:215], v[108:111], v[172:175]
    ds_read_b128 v[204:207], v234 offset:6400
    s_add_u32 m0, s45, 0
    s_nop 0
    buffer_load_dwordx4 v239, s[28:31], s96 offen offset:1024 nt lds
    v_cvt_pk_bf16_f32 v176, v144, v145
    v_cvt_pk_bf16_f32 v177, v146, v147
    v_exp_f32 v148, v148
    s_waitcnt lgkmcnt(5)
    v_mfma_f32_16x16x32_bf16 v[160:163], v[184:187], v[112:115], v[160:163]
    v_mfma_f32_16x16x32_bf16 v[164:167], v[184:187], v[116:119], v[164:167]
    ds_read_b128 v[208:211], v235 offset:256
    v_exp_f32 v149, v149
    v_exp_f32 v150, v150
    v_exp_f32 v151, v151
    v_add_f32 v253, v152, v153
    s_waitcnt lgkmcnt(5)
    v_mfma_f32_16x16x32_bf16 v[168:171], v[188:191], v[112:115], v[168:171]
    v_mfma_f32_16x16x32_bf16 v[172:175], v[188:191], v[116:119], v[172:175]
    ds_read_b128 v[212:215], v235 offset:6400
    v_add_f32 v255, v154, v155
    v_add_f32 v253, v253, v255
    v_add_f32 v251, v251, v253
    s_waitcnt lgkmcnt(5)
    v_mfma_f32_16x16x32_bf16 v[160:163], v[192:195], v[120:123], v[160:163]
    v_mfma_f32_16x16x32_bf16 v[164:167], v[192:195], v[124:127], v[164:167]
    s_add_u32 m0, s45, 0
    s_nop 0
    buffer_load_dwordx4 v240, s[28:31], s96 offen offset:2048 nt lds
    v_add_f32 v224, v224, v251
    v_cvt_pk_bf16_f32 v178, v152, v153
    v_cvt_pk_bf16_f32 v179, v154, v155
    s_waitcnt lgkmcnt(4)
    v_mfma_f32_16x16x32_bf16 v[168:171], v[196:199], v[120:123], v[168:171]
    v_mfma_f32_16x16x32_bf16 v[172:175], v[196:199], v[124:127], v[172:175]
    v_exp_f32 v156, v156
    v_exp_f32 v157, v157
    v_exp_f32 v158, v158
    v_exp_f32 v159, v159
    s_waitcnt lgkmcnt(3)
    v_mfma_f32_16x16x32_bf16 v[160:163], v[200:203], v[128:131], v[160:163]
    v_mfma_f32_16x16x32_bf16 v[164:167], v[200:203], v[132:135], v[164:167]
    s_add_u32 s48, s52, 49152
    v_add_u32 v234, s48, v228
    v_add_u32 v235, s48, v229
    v_add_u32 v236, s48, v230
    v_add_u32 v237, s48, v231
    s_waitcnt lgkmcnt(0)
    s_waitcnt vmcnt(12)
    s_barrier
    ds_read_b64_tr_b16 v[184:185], v234 offset:0
    ds_read_b64_tr_b16 v[186:187], v234 offset:6144
    ds_read_b64_tr_b16 v[188:189], v235 offset:0
    ds_read_b64_tr_b16 v[190:191], v235 offset:6144
    ds_read_b64_tr_b16 v[192:193], v236 offset:0
    ds_read_b64_tr_b16 v[194:195], v236 offset:6144
    s_add_u32 m0, s45, 24576
    s_mov_b32 s96, 147456
    buffer_load_dwordx4 v238, s[24:27], s96 offen nt lds
    v_add_f32 v252, v148, v149
    v_add_f32 v255, v150, v151
    v_add_f32 v252, v252, v255
    v_mfma_f32_16x16x32_bf16 v[168:171], v[204:207], v[128:131], v[168:171]
    v_mfma_f32_16x16x32_bf16 v[172:175], v[204:207], v[132:135], v[172:175]
    ds_read_b64_tr_b16 v[196:197], v237 offset:0
    ds_read_b64_tr_b16 v[198:199], v237 offset:6144
    v_cvt_pk_bf16_f32 v180, v148, v149
    v_cvt_pk_bf16_f32 v181, v150, v151
    v_add_f32 v254, v156, v157
    v_add_f32 v255, v158, v159
    v_mfma_f32_16x16x32_bf16 v[160:163], v[208:211], v[136:139], v[160:163]
    v_mfma_f32_16x16x32_bf16 v[164:167], v[208:211], v[140:143], v[164:167]
    ds_read_b64_tr_b16 v[200:201], v234 offset:128
    ds_read_b64_tr_b16 v[202:203], v234 offset:6272
    v_add_f32 v254, v254, v255
    v_add_f32 v252, v252, v254
    v_add_f32 v225, v225, v252
    v_mfma_f32_16x16x32_bf16 v[168:171], v[212:215], v[136:139], v[168:171]
    v_mfma_f32_16x16x32_bf16 v[172:175], v[212:215], v[140:143], v[172:175]
    ds_read_b64_tr_b16 v[204:205], v235 offset:128
    ds_read_b64_tr_b16 v[206:207], v235 offset:6272
    v_cvt_pk_bf16_f32 v182, v156, v157
    v_cvt_pk_bf16_f32 v183, v158, v159
    s_nop 1
    s_waitcnt lgkmcnt(10)
    v_mfma_f32_16x16x32_bf16 v[0:3], v[184:187], v[176:179], v[0:3]
    v_mfma_f32_16x16x32_bf16 v[4:7], v[184:187], v[180:183], v[4:7]
    ds_read_b64_tr_b16 v[208:209], v236 offset:128
    ds_read_b64_tr_b16 v[210:211], v236 offset:6272
    s_waitcnt lgkmcnt(10)
    v_mfma_f32_16x16x32_bf16 v[8:11], v[188:191], v[176:179], v[8:11]
    v_mfma_f32_16x16x32_bf16 v[12:15], v[188:191], v[180:183], v[12:15]
    ds_read_b64_tr_b16 v[212:213], v237 offset:128
    ds_read_b64_tr_b16 v[214:215], v237 offset:6272
    s_waitcnt lgkmcnt(10)
    v_mfma_f32_16x16x32_bf16 v[16:19], v[192:195], v[176:179], v[16:19]
    v_mfma_f32_16x16x32_bf16 v[20:23], v[192:195], v[180:183], v[20:23]
    ds_read_b64_tr_b16 v[184:185], v234 offset:256
    ds_read_b64_tr_b16 v[186:187], v234 offset:6400
    s_waitcnt lgkmcnt(10)
    v_mfma_f32_16x16x32_bf16 v[24:27], v[196:199], v[176:179], v[24:27]
    v_mfma_f32_16x16x32_bf16 v[28:31], v[196:199], v[180:183], v[28:31]
    ds_read_b64_tr_b16 v[188:189], v235 offset:256
    ds_read_b64_tr_b16 v[190:191], v235 offset:6400
    s_add_u32 m0, s45, 24576
    s_nop 0
    buffer_load_dwordx4 v239, s[24:27], s96 offen offset:1024 nt lds
    v_max3_f32 v246, v160, v161, v162
    v_max3_f32 v247, v163, v168, v169
    s_waitcnt lgkmcnt(10)
    v_mfma_f32_16x16x32_bf16 v[32:35], v[200:203], v[176:179], v[32:35]
    v_mfma_f32_16x16x32_bf16 v[36:39], v[200:203], v[180:183], v[36:39]
    ds_read_b64_tr_b16 v[192:193], v236 offset:256
    ds_read_b64_tr_b16 v[194:195], v236 offset:6400
    v_max3_f32 v248, v170, v171, v164
    s_waitcnt lgkmcnt(10)
    v_mfma_f32_16x16x32_bf16 v[40:43], v[204:207], v[176:179], v[40:43]
    v_mfma_f32_16x16x32_bf16 v[44:47], v[204:207], v[180:183], v[44:47]
    ds_read_b64_tr_b16 v[196:197], v237 offset:256
    ds_read_b64_tr_b16 v[198:199], v237 offset:6400
    v_max3_f32 v249, v165, v166, v167
    v_max3_f32 v250, v172, v173, v174
    s_waitcnt lgkmcnt(10)
    v_mfma_f32_16x16x32_bf16 v[48:51], v[208:211], v[176:179], v[48:51]
    v_mfma_f32_16x16x32_bf16 v[52:55], v[208:211], v[180:183], v[52:55]
    s_add_u32 m0, s45, 24576
    s_nop 0
    buffer_load_dwordx4 v240, s[24:27], s96 offen offset:2048 nt lds
    v_max3_f32 v246, v246, v247, v175
    s_waitcnt lgkmcnt(8)
    v_mfma_f32_16x16x32_bf16 v[56:59], v[212:215], v[176:179], v[56:59]
    v_mfma_f32_16x16x32_bf16 v[60:63], v[212:215], v[180:183], v[60:63]
    v_max3_f32 v248, v248, v249, v250
    v_max_f32 v246, v246, v248
    s_waitcnt lgkmcnt(6)
    v_mfma_f32_16x16x32_bf16 v[64:67], v[184:187], v[176:179], v[64:67]
    v_mfma_f32_16x16x32_bf16 v[68:71], v[184:187], v[180:183], v[68:71]
    s_add_u32 s48, s52, 73728
    v_add_u32 v234, s48, v226
    v_add_u32 v235, s48, v227
    s_waitcnt lgkmcnt(0)
    s_waitcnt vmcnt(12)
    s_barrier
    ds_read_b128 v[200:203], v234 offset:0
    ds_read_b128 v[204:207], v234 offset:6144
    ds_read_b128 v[208:211], v235 offset:0
    s_add_u32 m0, s45, 49152
    s_mov_b32 s96, 135168
    buffer_load_dwordx4 v238, s[28:31], s96 offen nt lds
    v_cmp_lt_f32 vcc, s51, v246
    v_mfma_f32_16x16x32_bf16 v[72:75], v[188:191], v[176:179], v[72:75]
    v_mfma_f32_16x16x32_bf16 v[76:79], v[188:191], v[180:183], v[76:79]
    ds_read_b128 v[212:215], v235 offset:6144
    v_mfma_f32_16x16x32_bf16 v[80:83], v[192:195], v[176:179], v[80:83]
    v_mfma_f32_16x16x32_bf16 v[84:87], v[192:195], v[180:183], v[84:87]
    ds_read_b128 v[184:187], v234 offset:128
    v_mfma_f32_16x16x32_bf16 v[88:91], v[196:199], v[176:179], v[88:91]
    v_mfma_f32_16x16x32_bf16 v[92:95], v[196:199], v[180:183], v[92:95]
    ds_read_b128 v[188:191], v234 offset:6272
    s_cbranch_vccnz K1_SLOW9
K1_BACK9:
    s_waitcnt lgkmcnt(5)
    v_mfma_f32_16x16x32_bf16 v[144:147], v[200:203], v[96:99], v[216:219]
    v_mfma_f32_16x16x32_bf16 v[148:151], v[200:203], v[100:103], v[220:223]
    ds_read_b128 v[192:195], v235 offset:128
    v_exp_f32 v160, v160
    v_exp_f32 v161, v161
    v_exp_f32 v162, v162
    v_exp_f32 v163, v163
    s_waitcnt lgkmcnt(5)
    v_mfma_f32_16x16x32_bf16 v[152:155], v[204:207], v[96:99], v[216:219]
    v_mfma_f32_16x16x32_bf16 v[156:159], v[204:207], v[100:103], v[220:223]
    ds_read_b128 v[196:199], v235 offset:6272
    v_exp_f32 v168, v168
    v_exp_f32 v169, v169
    v_exp_f32 v170, v170
    s_waitcnt lgkmcnt(5)
    v_mfma_f32_16x16x32_bf16 v[144:147], v[208:211], v[104:107], v[144:147]
    v_mfma_f32_16x16x32_bf16 v[148:151], v[208:211], v[108:111], v[148:151]
    ds_read_b128 v[200:203], v234 offset:256
    v_exp_f32 v171, v171
    v_add_f32 v251, v160, v161
    v_add_f32 v255, v162, v163
    v_add_f32 v251, v251, v255
    s_waitcnt lgkmcnt(5)
    v_mfma_f32_16x16x32_bf16 v[152:155], v[212:215], v[104:107], v[152:155]
    v_mfma_f32_16x16x32_bf16 v[156:159], v[212:215], v[108:111], v[156:159]
    ds_read_b128 v[204:207], v234 offset:6400
    s_add_u32 m0, s45, 49152
    s_nop 0
    buffer_load_dwordx4 v239, s[28:31], s96 offen offset:1024 nt lds
    v_cvt_pk_bf16_f32 v176, v160, v161
    v_cvt_pk_bf16_f32 v177, v162, v163
    v_exp_f32 v164, v164
    s_waitcnt lgkmcnt(5)
    v_mfma_f32_16x16x32_bf16 v[144:147], v[184:187], v[112:115], v[144:147]
    v_mfma_f32_16x16x32_bf16 v[148:151], v[184:187], v[116:119], v[148:151]
    ds_read_b128 v[208:211], v235 offset:256
    v_exp_f32 v165, v165
    v_exp_f32 v166, v166
    v_exp_f32 v167, v167
    v_add_f32 v253, v168, v169
    s_waitcnt lgkmcnt(5)
    v_mfma_f32_16x16x32_bf16 v[152:155], v[188:191], v[112:115], v[152:155]
    v_mfma_f32_16x16x32_bf16 v[156:159], v[188:191], v[116:119], v[156:159]
    ds_read_b128 v[212:215], v235 offset:6400
    v_add_f32 v255, v170, v171
    v_add_f32 v253, v253, v255
    v_add_f32 v251, v251, v253
    s_waitcnt lgkmcnt(5)
    v_mfma_f32_16x16x32_bf16 v[144:147], v[192:195], v[120:123], v[144:147]
    v_mfma_f32_16x16x32_bf16 v[148:151], v[192:195], v[124:127], v[148:151]
    s_add_u32 m0, s45, 49152
    s_nop 0
    buffer_load_dwordx4 v240, s[28:31], s96 offen offset:2048 nt lds
    v_add_f32 v224, v224, v251
    v_cvt_pk_bf16_f32 v178, v168, v169
    v_cvt_pk_bf16_f32 v179, v170, v171
    s_waitcnt lgkmcnt(4)
    v_mfma_f32_16x16x32_bf16 v[152:155], v[196:199], v[120:123], v[152:155]
    v_mfma_f32_16x16x32_bf16 v[156:159], v[196:199], v[124:127], v[156:159]
    v_exp_f32 v172, v172
    v_exp_f32 v173, v173
    v_exp_f32 v174, v174
    v_exp_f32 v175, v175
    s_waitcnt lgkmcnt(3)
    v_mfma_f32_16x16x32_bf16 v[144:147], v[200:203], v[128:131], v[144:147]
    v_mfma_f32_16x16x32_bf16 v[148:151], v[200:203], v[132:135], v[148:151]
    s_add_u32 s48, s52, 98304
    v_add_u32 v234, s48, v228
    v_add_u32 v235, s48, v229
    v_add_u32 v236, s48, v230
    v_add_u32 v237, s48, v231
    s_waitcnt lgkmcnt(0)
    s_waitcnt vmcnt(12)
    s_barrier
    ds_read_b64_tr_b16 v[184:185], v234 offset:0
    ds_read_b64_tr_b16 v[186:187], v234 offset:6144
    ds_read_b64_tr_b16 v[188:189], v235 offset:0
    ds_read_b64_tr_b16 v[190:191], v235 offset:6144
    ds_read_b64_tr_b16 v[192:193], v236 offset:0
    ds_read_b64_tr_b16 v[194:195], v236 offset:6144
    s_add_u32 m0, s45, 73728
    s_mov_b32 s96, 159744
    buffer_load_dwordx4 v238, s[24:27], s96 offen nt lds
    s_add_u32 s32, s22, s62
    s_addc_u32 s33, s23, 0
    s_add_u32 s36, s16, s63
    s_addc_u32 s37, s17, 0
    s_sub_u32 s34, 7864320, s62
    s_mov_b32 s38, 163840
    s_cmp_eq_u32 s61, 0
    s_cselect_b32 s34, s34, 0
    s_cselect_b32 s38, s38, 0
    s_mul_i32 s47, s61, 25165824
    s_add_u32 s40, s40, s47
    s_addc_u32 s41, s41, 0
    s_mov_b32 s42, 49152
    v_add_f32 v252, v164, v165
    v_add_f32 v255, v166, v167
    v_add_f32 v252, v252, v255
    v_mfma_f32_16x16x32_bf16 v[152:155], v[204:207], v[128:131], v[152:155]
    v_mfma_f32_16x16x32_bf16 v[156:159], v[204:207], v[132:135], v[156:159]
    ds_read_b64_tr_b16 v[196:197], v237 offset:0
    ds_read_b64_tr_b16 v[198:199], v237 offset:6144
    v_cvt_pk_bf16_f32 v180, v164, v165
    v_cvt_pk_bf16_f32 v181, v166, v167
    v_add_f32 v254, v172, v173
    v_add_f32 v255, v174, v175
    v_mfma_f32_16x16x32_bf16 v[144:147], v[208:211], v[136:139], v[144:147]
    v_mfma_f32_16x16x32_bf16 v[148:151], v[208:211], v[140:143], v[148:151]
    ds_read_b64_tr_b16 v[200:201], v234 offset:128
    ds_read_b64_tr_b16 v[202:203], v234 offset:6272
    v_add_f32 v254, v254, v255
    v_add_f32 v252, v252, v254
    v_add_f32 v225, v225, v252
    v_mfma_f32_16x16x32_bf16 v[152:155], v[212:215], v[136:139], v[152:155]
    v_mfma_f32_16x16x32_bf16 v[156:159], v[212:215], v[140:143], v[156:159]
    ds_read_b64_tr_b16 v[204:205], v235 offset:128
    ds_read_b64_tr_b16 v[206:207], v235 offset:6272
    v_cvt_pk_bf16_f32 v182, v172, v173
    v_cvt_pk_bf16_f32 v183, v174, v175
    s_nop 1
    s_waitcnt lgkmcnt(10)
    v_mfma_f32_16x16x32_bf16 v[0:3], v[184:187], v[176:179], v[0:3]
    v_mfma_f32_16x16x32_bf16 v[4:7], v[184:187], v[180:183], v[4:7]
    ds_read_b64_tr_b16 v[208:209], v236 offset:128
    ds_read_b64_tr_b16 v[210:211], v236 offset:6272
    s_waitcnt lgkmcnt(10)
    v_mfma_f32_16x16x32_bf16 v[8:11], v[188:191], v[176:179], v[8:11]
    v_mfma_f32_16x16x32_bf16 v[12:15], v[188:191], v[180:183], v[12:15]
    ds_read_b64_tr_b16 v[212:213], v237 offset:128
    ds_read_b64_tr_b16 v[214:215], v237 offset:6272
    s_waitcnt lgkmcnt(10)
    v_mfma_f32_16x16x32_bf16 v[16:19], v[192:195], v[176:179], v[16:19]
    v_mfma_f32_16x16x32_bf16 v[20:23], v[192:195], v[180:183], v[20:23]
    ds_read_b64_tr_b16 v[184:185], v234 offset:256
    ds_read_b64_tr_b16 v[186:187], v234 offset:6400
    s_waitcnt lgkmcnt(10)
    v_mfma_f32_16x16x32_bf16 v[24:27], v[196:199], v[176:179], v[24:27]
    v_mfma_f32_16x16x32_bf16 v[28:31], v[196:199], v[180:183], v[28:31]
    ds_read_b64_tr_b16 v[188:189], v235 offset:256
    ds_read_b64_tr_b16 v[190:191], v235 offset:6400
    s_add_u32 m0, s45, 73728
    s_nop 0
    buffer_load_dwordx4 v239, s[24:27], s96 offen offset:1024 nt lds
    v_max3_f32 v246, v144, v145, v146
    v_max3_f32 v247, v147, v152, v153
    s_waitcnt lgkmcnt(10)
    v_mfma_f32_16x16x32_bf16 v[32:35], v[200:203], v[176:179], v[32:35]
    v_mfma_f32_16x16x32_bf16 v[36:39], v[200:203], v[180:183], v[36:39]
    ds_read_b64_tr_b16 v[192:193], v236 offset:256
    ds_read_b64_tr_b16 v[194:195], v236 offset:6400
    v_max3_f32 v248, v154, v155, v148
    s_waitcnt lgkmcnt(10)
    v_mfma_f32_16x16x32_bf16 v[40:43], v[204:207], v[176:179], v[40:43]
    v_mfma_f32_16x16x32_bf16 v[44:47], v[204:207], v[180:183], v[44:47]
    ds_read_b64_tr_b16 v[196:197], v237 offset:256
    ds_read_b64_tr_b16 v[198:199], v237 offset:6400
    v_max3_f32 v249, v149, v150, v151
    v_max3_f32 v250, v156, v157, v158
    s_waitcnt lgkmcnt(10)
    v_mfma_f32_16x16x32_bf16 v[48:51], v[208:211], v[176:179], v[48:51]
    v_mfma_f32_16x16x32_bf16 v[52:55], v[208:211], v[180:183], v[52:55]
    s_add_u32 m0, s45, 73728
    s_nop 0
    buffer_load_dwordx4 v240, s[24:27], s96 offen offset:2048 nt lds
    v_max3_f32 v246, v246, v247, v159
    s_waitcnt lgkmcnt(8)
    v_mfma_f32_16x16x32_bf16 v[56:59], v[212:215], v[176:179], v[56:59]
    v_mfma_f32_16x16x32_bf16 v[60:63], v[212:215], v[180:183], v[60:63]
    v_max3_f32 v248, v248, v249, v250
    v_max_f32 v246, v246, v248
    s_waitcnt lgkmcnt(6)
    v_mfma_f32_16x16x32_bf16 v[64:67], v[184:187], v[176:179], v[64:67]
    v_mfma_f32_16x16x32_bf16 v[68:71], v[184:187], v[180:183], v[68:71]
    s_add_u32 s48, s52, 122880
    v_add_u32 v234, s48, v226
    v_add_u32 v235, s48, v227
    s_waitcnt lgkmcnt(0)
    s_waitcnt vmcnt(12)
    s_barrier
    ds_read_b128 v[200:203], v234 offset:0
    ds_read_b128 v[204:207], v234 offset:6144
    ds_read_b128 v[208:211], v235 offset:0
    s_add_u32 m0, s45, 98304
    s_mov_b32 s96, 147456
    buffer_load_dwordx4 v238, s[28:31], s96 offen nt lds
    v_cmp_lt_f32 vcc, s51, v246
    v_mfma_f32_16x16x32_bf16 v[72:75], v[188:191], v[176:179], v[72:75]
    v_mfma_f32_16x16x32_bf16 v[76:79], v[188:191], v[180:183], v[76:79]
    ds_read_b128 v[212:215], v235 offset:6144
    v_mfma_f32_16x16x32_bf16 v[80:83], v[192:195], v[176:179], v[80:83]
    v_mfma_f32_16x16x32_bf16 v[84:87], v[192:195], v[180:183], v[84:87]
    ds_read_b128 v[184:187], v234 offset:128
    v_mfma_f32_16x16x32_bf16 v[88:91], v[196:199], v[176:179], v[88:91]
    v_mfma_f32_16x16x32_bf16 v[92:95], v[196:199], v[180:183], v[92:95]
    ds_read_b128 v[188:191], v234 offset:6272
    s_cbranch_vccnz K1_SLOW10
K1_BACK10:
    s_waitcnt lgkmcnt(5)
    v_mfma_f32_16x16x32_bf16 v[160:163], v[200:203], v[96:99], v[216:219]
    v_mfma_f32_16x16x32_bf16 v[164:167], v[200:203], v[100:103], v[220:223]
    ds_read_b128 v[192:195], v235 offset:128
    v_exp_f32 v144, v144
    v_exp_f32 v145, v145
    v_exp_f32 v146, v146
    v_exp_f32 v147, v147
    s_waitcnt lgkmcnt(5)
    v_mfma_f32_16x16x32_bf16 v[168:171], v[204:207], v[96:99], v[216:219]
    v_mfma_f32_16x16x32_bf16 v[172:175], v[204:207], v[100:103], v[220:223]
    ds_read_b128 v[196:199], v235 offset:6272
    v_exp_f32 v152, v152
    v_exp_f32 v153, v153
    v_exp_f32 v154, v154
    s_waitcnt lgkmcnt(5)
    v_mfma_f32_16x16x32_bf16 v[160:163], v[208:211], v[104:107], v[160:163]
    v_mfma_f32_16x16x32_bf16 v[164:167], v[208:211], v[108:111], v[164:167]
    ds_read_b128 v[200:203], v234 offset:256
    v_exp_f32 v155, v155
    v_add_f32 v251, v144, v145
    v_add_f32 v255, v146, v147
    v_add_f32 v251, v251, v255
    s_waitcnt lgkmcnt(5)
    v_mfma_f32_16x16x32_bf16 v[168:171], v[212:215], v[104:107], v[168:171]
    v_mfma_f32_16x16x32_bf16 v[172:175], v[212:215], v[108:111], v[172:175]
    ds_read_b128 v[204:207], v234 offset:6400
    s_add_u32 m0, s45, 98304
    s_nop 0
    buffer_load_dwordx4 v239, s[28:31], s96 offen offset:1024 nt lds
    v_cvt_pk_bf16_f32 v176, v144, v145
    v_cvt_pk_bf16_f32 v177, v146, v147
    v_exp_f32 v148, v148
    s_waitcnt lgkmcnt(5)
    v_mfma_f32_16x16x32_bf16 v[160:163], v[184:187], v[112:115], v[160:163]
    v_mfma_f32_16x16x32_bf16 v[164:167], v[184:187], v[116:119], v[164:167]
    ds_read_b128 v[208:211], v235 offset:256
    v_exp_f32 v149, v149
    v_exp_f32 v150, v150
    v_exp_f32 v151, v151
    v_add_f32 v253, v152, v153
    s_waitcnt lgkmcnt(5)
    v_mfma_f32_16x16x32_bf16 v[168:171], v[188:191], v[112:115], v[168:171]
    v_mfma_f32_16x16x32_bf16 v[172:175], v[188:191], v[116:119], v[172:175]
    ds_read_b128 v[212:215], v235 offset:6400
    v_add_f32 v255, v154, v155
    v_add_f32 v253, v253, v255
    v_add_f32 v251, v251, v253
    s_waitcnt lgkmcnt(5)
    v_mfma_f32_16x16x32_bf16 v[160:163], v[192:195], v[120:123], v[160:163]
    v_mfma_f32_16x16x32_bf16 v[164:167], v[192:195], v[124:127], v[164:167]
    s_add_u32 m0, s45, 98304
    s_nop 0
    buffer_load_dwordx4 v240, s[28:31], s96 offen offset:2048 nt lds
    v_add_f32 v224, v224, v251
    v_cvt_pk_bf16_f32 v178, v152, v153
    v_cvt_pk_bf16_f32 v179, v154, v155
    s_waitcnt lgkmcnt(4)
    v_mfma_f32_16x16x32_bf16 v[168:171], v[196:199], v[120:123], v[168:171]
    v_mfma_f32_16x16x32_bf16 v[172:175], v[196:199], v[124:127], v[172:175]
    v_exp_f32 v156, v156
    v_exp_f32 v157, v157
    v_exp_f32 v158, v158
    v_exp_f32 v159, v159
    s_waitcnt lgkmcnt(3)
    v_mfma_f32_16x16x32_bf16 v[160:163], v[200:203], v[128:131], v[160:163]
    v_mfma_f32_16x16x32_bf16 v[164:167], v[200:203], v[132:135], v[164:167]
    s_add_u32 s48, s52, 0
    v_add_u32 v234, s48, v228
    v_add_u32 v235, s48, v229
    v_add_u32 v236, s48, v230
    v_add_u32 v237, s48, v231
    s_waitcnt lgkmcnt(0)
    s_waitcnt vmcnt(12)
    s_barrier
    ds_read_b64_tr_b16 v[184:185], v234 offset:0
    ds_read_b64_tr_b16 v[186:187], v234 offset:6144
    ds_read_b64_tr_b16 v[188:189], v235 offset:0
    ds_read_b64_tr_b16 v[190:191], v235 offset:6144
    ds_read_b64_tr_b16 v[192:193], v236 offset:0
    ds_read_b64_tr_b16 v[194:195], v236 offset:6144
    s_add_u32 m0, s45, 122880
    s_mov_b32 s96, 172032
    buffer_load_dwordx4 v238, s[24:27], s96 offen nt lds
    v_add_f32 v252, v148, v149
    v_add_f32 v255, v150, v151
    v_add_f32 v252, v252, v255
    v_mfma_f32_16x16x32_bf16 v[168:171], v[204:207], v[128:131], v[168:171]
    v_mfma_f32_16x16x32_bf16 v[172:175], v[204:207], v[132:135], v[172:175]
    ds_read_b64_tr_b16 v[196:197], v237 offset:0
    ds_read_b64_tr_b16 v[198:199], v237 offset:6144
    v_cvt_pk_bf16_f32 v180, v148, v149
    v_cvt_pk_bf16_f32 v181, v150, v151
    v_add_f32 v254, v156, v157
    v_add_f32 v255, v158, v159
    v_mfma_f32_16x16x32_bf16 v[160:163], v[208:211], v[136:139], v[160:163]
    v_mfma_f32_16x16x32_bf16 v[164:167], v[208:211], v[140:143], v[164:167]
    ds_read_b64_tr_b16 v[200:201], v234 offset:128
    ds_read_b64_tr_b16 v[202:203], v234 offset:6272
    v_add_f32 v254, v254, v255
    v_add_f32 v252, v252, v254
    v_add_f32 v225, v225, v252
    v_mfma_f32_16x16x32_bf16 v[168:171], v[212:215], v[136:139], v[168:171]
    v_mfma_f32_16x16x32_bf16 v[172:175], v[212:215], v[140:143], v[172:175]
    ds_read_b64_tr_b16 v[204:205], v235 offset:128
    ds_read_b64_tr_b16 v[206:207], v235 offset:6272
    v_cvt_pk_bf16_f32 v182, v156, v157
    v_cvt_pk_bf16_f32 v183, v158, v159
    s_nop 1
    s_waitcnt lgkmcnt(10)
    v_mfma_f32_16x16x32_bf16 v[0:3], v[184:187], v[176:179], v[0:3]
    v_mfma_f32_16x16x32_bf16 v[4:7], v[184:187], v[180:183], v[4:7]
    ds_read_b64_tr_b16 v[208:209], v236 offset:128
    ds_read_b64_tr_b16 v[210:211], v236 offset:6272
    s_waitcnt lgkmcnt(10)
    v_mfma_f32_16x16x32_bf16 v[8:11], v[188:191], v[176:179], v[8:11]
    v_mfma_f32_16x16x32_bf16 v[12:15], v[188:191], v[180:183], v[12:15]
    ds_read_b64_tr_b16 v[212:213], v237 offset:128
    ds_read_b64_tr_b16 v[214:215], v237 offset:6272
    s_waitcnt lgkmcnt(10)
    v_mfma_f32_16x16x32_bf16 v[16:19], v[192:195], v[176:179], v[16:19]
    v_mfma_f32_16x16x32_bf16 v[20:23], v[192:195], v[180:183], v[20:23]
    ds_read_b64_tr_b16 v[184:185], v234 offset:256
    ds_read_b64_tr_b16 v[186:187], v234 offset:6400
    s_waitcnt lgkmcnt(10)
    v_mfma_f32_16x16x32_bf16 v[24:27], v[196:199], v[176:179], v[24:27]
    v_mfma_f32_16x16x32_bf16 v[28:31], v[196:199], v[180:183], v[28:31]
    ds_read_b64_tr_b16 v[188:189], v235 offset:256
    ds_read_b64_tr_b16 v[190:191], v235 offset:6400
    s_add_u32 m0, s45, 122880
    s_nop 0
    buffer_load_dwordx4 v239, s[24:27], s96 offen offset:1024 nt lds
    v_max3_f32 v246, v160, v161, v162
    v_max3_f32 v247, v163, v168, v169
    s_waitcnt lgkmcnt(10)
    v_mfma_f32_16x16x32_bf16 v[32:35], v[200:203], v[176:179], v[32:35]
    v_mfma_f32_16x16x32_bf16 v[36:39], v[200:203], v[180:183], v[36:39]
    ds_read_b64_tr_b16 v[192:193], v236 offset:256
    ds_read_b64_tr_b16 v[194:195], v236 offset:6400
    v_max3_f32 v248, v170, v171, v164
    s_waitcnt lgkmcnt(10)
    v_mfma_f32_16x16x32_bf16 v[40:43], v[204:207], v[176:179], v[40:43]
    v_mfma_f32_16x16x32_bf16 v[44:47], v[204:207], v[180:183], v[44:47]
    ds_read_b64_tr_b16 v[196:197], v237 offset:256
    ds_read_b64_tr_b16 v[198:199], v237 offset:6400
    v_max3_f32 v249, v165, v166, v167
    v_max3_f32 v250, v172, v173, v174
    s_waitcnt lgkmcnt(10)
    v_mfma_f32_16x16x32_bf16 v[48:51], v[208:211], v[176:179], v[48:51]
    v_mfma_f32_16x16x32_bf16 v[52:55], v[208:211], v[180:183], v[52:55]
    s_add_u32 m0, s45, 122880
    s_nop 0
    buffer_load_dwordx4 v240, s[24:27], s96 offen offset:2048 nt lds
    v_max3_f32 v246, v246, v247, v175
    s_waitcnt lgkmcnt(8)
    v_mfma_f32_16x16x32_bf16 v[56:59], v[212:215], v[176:179], v[56:59]
    v_mfma_f32_16x16x32_bf16 v[60:63], v[212:215], v[180:183], v[60:63]
    v_max3_f32 v248, v248, v249, v250
    v_max_f32 v246, v246, v248
    s_waitcnt lgkmcnt(6)
    v_mfma_f32_16x16x32_bf16 v[64:67], v[184:187], v[176:179], v[64:67]
    v_mfma_f32_16x16x32_bf16 v[68:71], v[184:187], v[180:183], v[68:71]
    s_add_u32 s48, s52, 24576
    v_add_u32 v234, s48, v226
    v_add_u32 v235, s48, v227
    s_waitcnt lgkmcnt(0)
    s_waitcnt vmcnt(12)
    s_barrier
    ds_read_b128 v[200:203], v234 offset:0
    ds_read_b128 v[204:207], v234 offset:6144
    ds_read_b128 v[208:211], v235 offset:0
    s_add_u32 m0, s45, 0
    s_mov_b32 s96, 159744
    buffer_load_dwordx4 v238, s[28:31], s96 offen nt lds
    v_cmp_lt_f32 vcc, s51, v246
    v_mfma_f32_16x16x32_bf16 v[72:75], v[188:191], v[176:179], v[72:75]
    v_mfma_f32_16x16x32_bf16 v[76:79], v[188:191], v[180:183], v[76:79]
    ds_read_b128 v[212:215], v235 offset:6144
    v_mfma_f32_16x16x32_bf16 v[80:83], v[192:195], v[176:179], v[80:83]
    v_mfma_f32_16x16x32_bf16 v[84:87], v[192:195], v[180:183], v[84:87]
    ds_read_b128 v[184:187], v234 offset:128
    v_mfma_f32_16x16x32_bf16 v[88:91], v[196:199], v[176:179], v[88:91]
    v_mfma_f32_16x16x32_bf16 v[92:95], v[196:199], v[180:183], v[92:95]
    ds_read_b128 v[188:191], v234 offset:6272
    s_cbranch_vccnz K1_SLOW11
K1_BACK11:
    s_waitcnt lgkmcnt(5)
    v_mfma_f32_16x16x32_bf16 v[144:147], v[200:203], v[96:99], v[216:219]
    v_mfma_f32_16x16x32_bf16 v[148:151], v[200:203], v[100:103], v[220:223]
    ds_read_b128 v[192:195], v235 offset:128
    v_exp_f32 v160, v160
    v_exp_f32 v161, v161
    v_exp_f32 v162, v162
    v_exp_f32 v163, v163
    s_waitcnt lgkmcnt(5)
    v_mfma_f32_16x16x32_bf16 v[152:155], v[204:207], v[96:99], v[216:219]
    v_mfma_f32_16x16x32_bf16 v[156:159], v[204:207], v[100:103], v[220:223]
    ds_read_b128 v[196:199], v235 offset:6272
    v_exp_f32 v168, v168
    v_exp_f32 v169, v169
    v_exp_f32 v170, v170
    s_waitcnt lgkmcnt(5)
    v_mfma_f32_16x16x32_bf16 v[144:147], v[208:211], v[104:107], v[144:147]
    v_mfma_f32_16x16x32_bf16 v[148:151], v[208:211], v[108:111], v[148:151]
    ds_read_b128 v[200:203], v234 offset:256
    v_exp_f32 v171, v171
    v_add_f32 v251, v160, v161
    v_add_f32 v255, v162, v163
    v_add_f32 v251, v251, v255
    s_waitcnt lgkmcnt(5)
    v_mfma_f32_16x16x32_bf16 v[152:155], v[212:215], v[104:107], v[152:155]
    v_mfma_f32_16x16x32_bf16 v[156:159], v[212:215], v[108:111], v[156:159]
    ds_read_b128 v[204:207], v234 offset:6400
    s_add_u32 m0, s45, 0
    s_nop 0
    buffer_load_dwordx4 v239, s[28:31], s96 offen offset:1024 nt lds
    v_cvt_pk_bf16_f32 v176, v160, v161
    v_cvt_pk_bf16_f32 v177, v162, v163
    v_exp_f32 v164, v164
    s_waitcnt lgkmcnt(5)
    v_mfma_f32_16x16x32_bf16 v[144:147], v[184:187], v[112:115], v[144:147]
    v_mfma_f32_16x16x32_bf16 v[148:151], v[184:187], v[116:119], v[148:151]
    ds_read_b128 v[208:211], v235 offset:256
    v_exp_f32 v165, v165
    v_exp_f32 v166, v166
    v_exp_f32 v167, v167
    v_add_f32 v253, v168, v169
    s_waitcnt lgkmcnt(5)
    v_mfma_f32_16x16x32_bf16 v[152:155], v[188:191], v[112:115], v[152:155]
    v_mfma_f32_16x16x32_bf16 v[156:159], v[188:191], v[116:119], v[156:159]
    ds_read_b128 v[212:215], v235 offset:6400
    v_add_f32 v255, v170, v171
    v_add_f32 v253, v253, v255
    v_add_f32 v251, v251, v253
    s_waitcnt lgkmcnt(5)
    v_mfma_f32_16x16x32_bf16 v[144:147], v[192:195], v[120:123], v[144:147]
    v_mfma_f32_16x16x32_bf16 v[148:151], v[192:195], v[124:127], v[148:151]
    s_add_u32 m0, s45, 0
    s_nop 0
    buffer_load_dwordx4 v240, s[28:31], s96 offen offset:2048 nt lds
    v_add_f32 v224, v224, v251
    v_cvt_pk_bf16_f32 v178, v168, v169
    v_cvt_pk_bf16_f32 v179, v170, v171
    s_waitcnt lgkmcnt(4)
    v_mfma_f32_16x16x32_bf16 v[152:155], v[196:199], v[120:123], v[152:155]
    v_mfma_f32_16x16x32_bf16 v[156:159], v[196:199], v[124:127], v[156:159]
    v_exp_f32 v172, v172
    v_exp_f32 v173, v173
    v_exp_f32 v174, v174
    v_exp_f32 v175, v175
    s_waitcnt lgkmcnt(3)
    v_mfma_f32_16x16x32_bf16 v[144:147], v[200:203], v[128:131], v[144:147]
    v_mfma_f32_16x16x32_bf16 v[148:151], v[200:203], v[132:135], v[148:151]
    s_add_u32 s48, s52, 49152
    v_add_u32 v234, s48, v228
    v_add_u32 v235, s48, v229
    v_add_u32 v236, s48, v230
    v_add_u32 v237, s48, v231
    s_waitcnt lgkmcnt(0)
    s_waitcnt vmcnt(12)
    s_barrier
    ds_read_b64_tr_b16 v[184:185], v234 offset:0
    ds_read_b64_tr_b16 v[186:187], v234 offset:6144
    ds_read_b64_tr_b16 v[188:189], v235 offset:0
    ds_read_b64_tr_b16 v[190:191], v235 offset:6144
    ds_read_b64_tr_b16 v[192:193], v236 offset:0
    ds_read_b64_tr_b16 v[194:195], v236 offset:6144
    s_add_u32 m0, s45, 24576
    s_mov_b32 s96, 184320
    buffer_load_dwordx4 v238, s[24:27], s96 offen nt lds
    v_add_f32 v252, v164, v165
    v_add_f32 v255, v166, v167
    v_add_f32 v252, v252, v255
    v_mfma_f32_16x16x32_bf16 v[152:155], v[204:207], v[128:131], v[152:155]
    v_mfma_f32_16x16x32_bf16 v[156:159], v[204:207], v[132:135], v[156:159]
    ds_read_b64_tr_b16 v[196:197], v237 offset:0
    ds_read_b64_tr_b16 v[198:199], v237 offset:6144
    v_cvt_pk_bf16_f32 v180, v164, v165
    v_cvt_pk_bf16_f32 v181, v166, v167
    v_add_f32 v254, v172, v173
    v_add_f32 v255, v174, v175
    v_mfma_f32_16x16x32_bf16 v[144:147], v[208:211], v[136:139], v[144:147]
    v_mfma_f32_16x16x32_bf16 v[148:151], v[208:211], v[140:143], v[148:151]
    ds_read_b64_tr_b16 v[200:201], v234 offset:128
    ds_read_b64_tr_b16 v[202:203], v234 offset:6272
    v_add_f32 v254, v254, v255
    v_add_f32 v252, v252, v254
    v_add_f32 v225, v225, v252
    v_mfma_f32_16x16x32_bf16 v[152:155], v[212:215], v[136:139], v[152:155]
    v_mfma_f32_16x16x32_bf16 v[156:159], v[212:215], v[140:143], v[156:159]
    ds_read_b64_tr_b16 v[204:205], v235 offset:128
    ds_read_b64_tr_b16 v[206:207], v235 offset:6272
    v_cvt_pk_bf16_f32 v182, v172, v173
    v_cvt_pk_bf16_f32 v183, v174, v175
    s_nop 1
    s_waitcnt lgkmcnt(10)
    v_mfma_f32_16x16x32_bf16 v[0:3], v[184:187], v[176:179], v[0:3]
    v_mfma_f32_16x16x32_bf16 v[4:7], v[184:187], v[180:183], v[4:7]
    ds_read_b64_tr_b16 v[208:209], v236 offset:128
    ds_read_b64_tr_b16 v[210:211], v236 offset:6272
    s_waitcnt lgkmcnt(10)
    v_mfma_f32_16x16x32_bf16 v[8:11], v[188:191], v[176:179], v[8:11]
    v_mfma_f32_16x16x32_bf16 v[12:15], v[188:191], v[180:183], v[12:15]
    ds_read_b64_tr_b16 v[212:213], v237 offset:128
    ds_read_b64_tr_b16 v[214:215], v237 offset:6272
    s_waitcnt lgkmcnt(10)
    v_mfma_f32_16x16x32_bf16 v[16:19], v[192:195], v[176:179], v[16:19]
    v_mfma_f32_16x16x32_bf16 v[20:23], v[192:195], v[180:183], v[20:23]
    ds_read_b64_tr_b16 v[184:185], v234 offset:256
    ds_read_b64_tr_b16 v[186:187], v234 offset:6400
    s_waitcnt lgkmcnt(10)
    v_mfma_f32_16x16x32_bf16 v[24:27], v[196:199], v[176:179], v[24:27]
    v_mfma_f32_16x16x32_bf16 v[28:31], v[196:199], v[180:183], v[28:31]
    ds_read_b64_tr_b16 v[188:189], v235 offset:256
    ds_read_b64_tr_b16 v[190:191], v235 offset:6400
    s_add_u32 m0, s45, 24576
    s_nop 0
    buffer_load_dwordx4 v239, s[24:27], s96 offen offset:1024 nt lds
    v_max3_f32 v246, v144, v145, v146
    v_max3_f32 v247, v147, v152, v153
    s_waitcnt lgkmcnt(10)
    v_mfma_f32_16x16x32_bf16 v[32:35], v[200:203], v[176:179], v[32:35]
    v_mfma_f32_16x16x32_bf16 v[36:39], v[200:203], v[180:183], v[36:39]
    ds_read_b64_tr_b16 v[192:193], v236 offset:256
    ds_read_b64_tr_b16 v[194:195], v236 offset:6400
    v_max3_f32 v248, v154, v155, v148
    s_waitcnt lgkmcnt(10)
    v_mfma_f32_16x16x32_bf16 v[40:43], v[204:207], v[176:179], v[40:43]
    v_mfma_f32_16x16x32_bf16 v[44:47], v[204:207], v[180:183], v[44:47]
    ds_read_b64_tr_b16 v[196:197], v237 offset:256
    ds_read_b64_tr_b16 v[198:199], v237 offset:6400
    v_max3_f32 v249, v149, v150, v151
    v_max3_f32 v250, v156, v157, v158
    s_waitcnt lgkmcnt(10)
    v_mfma_f32_16x16x32_bf16 v[48:51], v[208:211], v[176:179], v[48:51]
    v_mfma_f32_16x16x32_bf16 v[52:55], v[208:211], v[180:183], v[52:55]
    s_add_u32 m0, s45, 24576
    s_nop 0
    buffer_load_dwordx4 v240, s[24:27], s96 offen offset:2048 nt lds
    v_max3_f32 v246, v246, v247, v159
    s_waitcnt lgkmcnt(8)
    v_mfma_f32_16x16x32_bf16 v[56:59], v[212:215], v[176:179], v[56:59]
    v_mfma_f32_16x16x32_bf16 v[60:63], v[212:215], v[180:183], v[60:63]
    v_max3_f32 v248, v248, v249, v250
    v_max_f32 v246, v246, v248
    s_waitcnt lgkmcnt(6)
    v_mfma_f32_16x16x32_bf16 v[64:67], v[184:187], v[176:179], v[64:67]
    v_mfma_f32_16x16x32_bf16 v[68:71], v[184:187], v[180:183], v[68:71]
    s_add_u32 s48, s52, 73728
    v_add_u32 v234, s48, v226
    v_add_u32 v235, s48, v227
    s_waitcnt lgkmcnt(0)
    s_waitcnt vmcnt(12)
    s_barrier
    ds_read_b128 v[200:203], v234 offset:0
    ds_read_b128 v[204:207], v234 offset:6144
    ds_read_b128 v[208:211], v235 offset:0
    s_add_u32 m0, s45, 49152
    s_mov_b32 s96, 172032
    buffer_load_dwordx4 v238, s[28:31], s96 offen nt lds
    v_cmp_lt_f32 vcc, s51, v246
    v_mfma_f32_16x16x32_bf16 v[72:75], v[188:191], v[176:179], v[72:75]
    v_mfma_f32_16x16x32_bf16 v[76:79], v[188:191], v[180:183], v[76:79]
    ds_read_b128 v[212:215], v235 offset:6144
    v_mfma_f32_16x16x32_bf16 v[80:83], v[192:195], v[176:179], v[80:83]
    v_mfma_f32_16x16x32_bf16 v[84:87], v[192:195], v[180:183], v[84:87]
    ds_read_b128 v[184:187], v234 offset:128
    v_mfma_f32_16x16x32_bf16 v[88:91], v[196:199], v[176:179], v[88:91]
    v_mfma_f32_16x16x32_bf16 v[92:95], v[196:199], v[180:183], v[92:95]
    ds_read_b128 v[188:191], v234 offset:6272
    s_cbranch_vccnz K1_SLOW12
K1_BACK12:
    s_waitcnt lgkmcnt(5)
    v_mfma_f32_16x16x32_bf16 v[160:163], v[200:203], v[96:99], v[216:219]
    v_mfma_f32_16x16x32_bf16 v[164:167], v[200:203], v[100:103], v[220:223]
    ds_read_b128 v[192:195], v235 offset:128
    v_exp_f32 v144, v144
    v_exp_f32 v145, v145
    v_exp_f32 v146, v146
    v_exp_f32 v147, v147
    s_waitcnt lgkmcnt(5)
    v_mfma_f32_16x16x32_bf16 v[168:171], v[204:207], v[96:99], v[216:219]
    v_mfma_f32_16x16x32_bf16 v[172:175], v[204:207], v[100:103], v[220:223]
    ds_read_b128 v[196:199], v235 offset:6272
    v_exp_f32 v152, v152
    v_exp_f32 v153, v153
    v_exp_f32 v154, v154
    s_waitcnt lgkmcnt(5)
    v_mfma_f32_16x16x32_bf16 v[160:163], v[208:211], v[104:107], v[160:163]
    v_mfma_f32_16x16x32_bf16 v[164:167], v[208:211], v[108:111], v[164:167]
    ds_read_b128 v[200:203], v234 offset:256
    v_exp_f32 v155, v155
    v_add_f32 v251, v144, v145
    v_add_f32 v255, v146, v147
    v_add_f32 v251, v251, v255
    s_waitcnt lgkmcnt(5)
    v_mfma_f32_16x16x32_bf16 v[168:171], v[212:215], v[104:107], v[168:171]
    v_mfma_f32_16x16x32_bf16 v[172:175], v[212:215], v[108:111], v[172:175]
    ds_read_b128 v[204:207], v234 offset:6400
    s_add_u32 m0, s45, 49152
    s_nop 0
    buffer_load_dwordx4 v239, s[28:31], s96 offen offset:1024 nt lds
    v_cvt_pk_bf16_f32 v176, v144, v145
    v_cvt_pk_bf16_f32 v177, v146, v147
    v_exp_f32 v148, v148
    s_waitcnt lgkmcnt(5)
    v_mfma_f32_16x16x32_bf16 v[160:163], v[184:187], v[112:115], v[160:163]
    v_mfma_f32_16x16x32_bf16 v[164:167], v[184:187], v[116:119], v[164:167]
    ds_read_b128 v[208:211], v235 offset:256
    v_exp_f32 v149, v149
    v_exp_f32 v150, v150
    v_exp_f32 v151, v151
    v_add_f32 v253, v152, v153
    s_waitcnt lgkmcnt(5)
    v_mfma_f32_16x16x32_bf16 v[168:171], v[188:191], v[112:115], v[168:171]
    v_mfma_f32_16x16x32_bf16 v[172:175], v[188:191], v[116:119], v[172:175]
    ds_read_b128 v[212:215], v235 offset:6400
    v_add_f32 v255, v154, v155
    v_add_f32 v253, v253, v255
    v_add_f32 v251, v251, v253
    s_waitcnt lgkmcnt(5)
    v_mfma_f32_16x16x32_bf16 v[160:163], v[192:195], v[120:123], v[160:163]
    v_mfma_f32_16x16x32_bf16 v[164:167], v[192:195], v[124:127], v[164:167]
    s_add_u32 m0, s45, 49152
    s_nop 0
    buffer_load_dwordx4 v240, s[28:31], s96 offen offset:2048 nt lds
    v_add_f32 v224, v224, v251
    v_cvt_pk_bf16_f32 v178, v152, v153
    v_cvt_pk_bf16_f32 v179, v154, v155
    s_waitcnt lgkmcnt(4)
    v_mfma_f32_16x16x32_bf16 v[168:171], v[196:199], v[120:123], v[168:171]
    v_mfma_f32_16x16x32_bf16 v[172:175], v[196:199], v[124:127], v[172:175]
    v_exp_f32 v156, v156
    v_exp_f32 v157, v157
    v_exp_f32 v158, v158
    v_exp_f32 v159, v159
    s_waitcnt lgkmcnt(3)
    v_mfma_f32_16x16x32_bf16 v[160:163], v[200:203], v[128:131], v[160:163]
    v_mfma_f32_16x16x32_bf16 v[164:167], v[200:203], v[132:135], v[164:167]
    s_add_u32 s48, s52, 98304
    v_add_u32 v234, s48, v228
    v_add_u32 v235, s48, v229
    v_add_u32 v236, s48, v230
    v_add_u32 v237, s48, v231
    s_waitcnt lgkmcnt(0)
    s_waitcnt vmcnt(12)
    s_barrier
    ds_read_b64_tr_b16 v[184:185], v234 offset:0
    ds_read_b64_tr_b16 v[186:187], v234 offset:6144
    ds_read_b64_tr_b16 v[188:189], v235 offset:0
    ds_read_b64_tr_b16 v[190:191], v235 offset:6144
    ds_read_b64_tr_b16 v[192:193], v236 offset:0
    ds_read_b64_tr_b16 v[194:195], v236 offset:6144
    s_add_u32 m0, s45, 73728
    s_mov_b32 s96, 184320
    buffer_load_dwordx4 v238, s[28:31], s96 offen nt lds
    v_add_f32 v252, v148, v149
    v_add_f32 v255, v150, v151
    v_add_f32 v252, v252, v255
    v_mfma_f32_16x16x32_bf16 v[168:171], v[204:207], v[128:131], v[168:171]
    v_mfma_f32_16x16x32_bf16 v[172:175], v[204:207], v[132:135], v[172:175]
    ds_read_b64_tr_b16 v[196:197], v237 offset:0
    ds_read_b64_tr_b16 v[198:199], v237 offset:6144
    v_cvt_pk_bf16_f32 v180, v148, v149
    v_cvt_pk_bf16_f32 v181, v150, v151
    v_add_f32 v254, v156, v157
    v_add_f32 v255, v158, v159
    v_mfma_f32_16x16x32_bf16 v[160:163], v[208:211], v[136:139], v[160:163]
    v_mfma_f32_16x16x32_bf16 v[164:167], v[208:211], v[140:143], v[164:167]
    ds_read_b64_tr_b16 v[200:201], v234 offset:128
    ds_read_b64_tr_b16 v[202:203], v234 offset:6272
    v_add_f32 v254, v254, v255
    v_add_f32 v252, v252, v254
    v_add_f32 v225, v225, v252
    v_mfma_f32_16x16x32_bf16 v[168:171], v[212:215], v[136:139], v[168:171]
    v_mfma_f32_16x16x32_bf16 v[172:175], v[212:215], v[140:143], v[172:175]
    ds_read_b64_tr_b16 v[204:205], v235 offset:128
    ds_read_b64_tr_b16 v[206:207], v235 offset:6272
    v_cvt_pk_bf16_f32 v182, v156, v157
    v_cvt_pk_bf16_f32 v183, v158, v159
    s_nop 1
    s_waitcnt lgkmcnt(10)
    v_mfma_f32_16x16x32_bf16 v[0:3], v[184:187], v[176:179], v[0:3]
    v_mfma_f32_16x16x32_bf16 v[4:7], v[184:187], v[180:183], v[4:7]
    ds_read_b64_tr_b16 v[208:209], v236 offset:128
    ds_read_b64_tr_b16 v[210:211], v236 offset:6272
    s_waitcnt lgkmcnt(10)
    v_mfma_f32_16x16x32_bf16 v[8:11], v[188:191], v[176:179], v[8:11]
    v_mfma_f32_16x16x32_bf16 v[12:15], v[188:191], v[180:183], v[12:15]
    ds_read_b64_tr_b16 v[212:213], v237 offset:128
    ds_read_b64_tr_b16 v[214:215], v237 offset:6272
    s_waitcnt lgkmcnt(10)
    v_mfma_f32_16x16x32_bf16 v[16:19], v[192:195], v[176:179], v[16:19]
    v_mfma_f32_16x16x32_bf16 v[20:23], v[192:195], v[180:183], v[20:23]
    ds_read_b64_tr_b16 v[184:185], v234 offset:256
    ds_read_b64_tr_b16 v[186:187], v234 offset:6400
    s_waitcnt lgkmcnt(10)
    v_mfma_f32_16x16x32_bf16 v[24:27], v[196:199], v[176:179], v[24:27]
    v_mfma_f32_16x16x32_bf16 v[28:31], v[196:199], v[180:183], v[28:31]
    ds_read_b64_tr_b16 v[188:189], v235 offset:256
    ds_read_b64_tr_b16 v[190:191], v235 offset:6400
    s_add_u32 m0, s45, 73728
    s_nop 0
    buffer_load_dwordx4 v239, s[28:31], s96 offen offset:1024 nt lds
    v_max3_f32 v246, v160, v161, v162
    v_max3_f32 v247, v163, v168, v169
    s_waitcnt lgkmcnt(10)
    v_mfma_f32_16x16x32_bf16 v[32:35], v[200:203], v[176:179], v[32:35]
    v_mfma_f32_16x16x32_bf16 v[36:39], v[200:203], v[180:183], v[36:39]
    ds_read_b64_tr_b16 v[192:193], v236 offset:256
    ds_read_b64_tr_b16 v[194:195], v236 offset:6400
    v_max3_f32 v248, v170, v171, v164
    s_waitcnt lgkmcnt(10)
    v_mfma_f32_16x16x32_bf16 v[40:43], v[204:207], v[176:179], v[40:43]
    v_mfma_f32_16x16x32_bf16 v[44:47], v[204:207], v[180:183], v[44:47]
    ds_read_b64_tr_b16 v[196:197], v237 offset:256
    ds_read_b64_tr_b16 v[198:199], v237 offset:6400
    v_max3_f32 v249, v165, v166, v167
    v_max3_f32 v250, v172, v173, v174
    s_waitcnt lgkmcnt(10)
    v_mfma_f32_16x16x32_bf16 v[48:51], v[208:211], v[176:179], v[48:51]
    v_mfma_f32_16x16x32_bf16 v[52:55], v[208:211], v[180:183], v[52:55]
    s_add_u32 m0, s45, 73728
    s_nop 0
    buffer_load_dwordx4 v240, s[28:31], s96 offen offset:2048 nt lds
    v_max3_f32 v246, v246, v247, v175
    s_waitcnt lgkmcnt(8)
    v_mfma_f32_16x16x32_bf16 v[56:59], v[212:215], v[176:179], v[56:59]
    v_mfma_f32_16x16x32_bf16 v[60:63], v[212:215], v[180:183], v[60:63]
    v_max3_f32 v248, v248, v249, v250
    v_max_f32 v246, v246, v248
    s_waitcnt lgkmcnt(6)
    v_mfma_f32_16x16x32_bf16 v[64:67], v[184:187], v[176:179], v[64:67]
    v_mfma_f32_16x16x32_bf16 v[68:71], v[184:187], v[180:183], v[68:71]
    s_add_u32 s48, s52, 122880
    v_add_u32 v234, s48, v226
    v_add_u32 v235, s48, v227
    s_waitcnt lgkmcnt(0)
    s_waitcnt vmcnt(12)
    s_barrier
    ds_read_b128 v[200:203], v234 offset:0
    ds_read_b128 v[204:207], v234 offset:6144
    ds_read_b128 v[208:211], v235 offset:0
    v_cmp_lt_f32 vcc, s51, v246
    v_mfma_f32_16x16x32_bf16 v[72:75], v[188:191], v[176:179], v[72:75]
    v_mfma_f32_16x16x32_bf16 v[76:79], v[188:191], v[180:183], v[76:79]
    ds_read_b128 v[212:215], v235 offset:6144
    v_mfma_f32_16x16x32_bf16 v[80:83], v[192:195], v[176:179], v[80:83]
    v_mfma_f32_16x16x32_bf16 v[84:87], v[192:195], v[180:183], v[84:87]
    ds_read_b128 v[184:187], v234 offset:128
    v_mfma_f32_16x16x32_bf16 v[88:91], v[196:199], v[176:179], v[88:91]
    v_mfma_f32_16x16x32_bf16 v[92:95], v[196:199], v[180:183], v[92:95]
    ds_read_b128 v[188:191], v234 offset:6272
    s_cbranch_vccnz K1_SLOW13
K1_BACK13:
    s_waitcnt lgkmcnt(5)
    v_mfma_f32_16x16x32_bf16 v[144:147], v[200:203], v[96:99], v[216:219]
    v_mfma_f32_16x16x32_bf16 v[148:151], v[200:203], v[100:103], v[220:223]
    ds_read_b128 v[192:195], v235 offset:128
    v_exp_f32 v160, v160
    v_exp_f32 v161, v161
    v_exp_f32 v162, v162
    v_exp_f32 v163, v163
    s_waitcnt lgkmcnt(5)
    v_mfma_f32_16x16x32_bf16 v[152:155], v[204:207], v[96:99], v[216:219]
    v_mfma_f32_16x16x32_bf16 v[156:159], v[204:207], v[100:103], v[220:223]
    ds_read_b128 v[196:199], v235 offset:6272
    v_exp_f32 v168, v168
    v_exp_f32 v169, v169
    v_exp_f32 v170, v170
    s_waitcnt lgkmcnt(5)
    v_mfma_f32_16x16x32_bf16 v[144:147], v[208:211], v[104:107], v[144:147]
    v_mfma_f32_16x16x32_bf16 v[148:151], v[208:211], v[108:111], v[148:151]
    ds_read_b128 v[200:203], v234 offset:256
    v_exp_f32 v171, v171
    v_add_f32 v251, v160, v161
    v_add_f32 v255, v162, v163
    v_add_f32 v251, v251, v255
    s_waitcnt lgkmcnt(5)
    v_mfma_f32_16x16x32_bf16 v[152:155], v[212:215], v[104:107], v[152:155]
    v_mfma_f32_16x16x32_bf16 v[156:159], v[212:215], v[108:111], v[156:159]
    ds_read_b128 v[204:207], v234 offset:6400
    v_cvt_pk_bf16_f32 v176, v160, v161
    v_cvt_pk_bf16_f32 v177, v162, v163
    v_exp_f32 v164, v164
    s_waitcnt lgkmcnt(5)
    v_mfma_f32_16x16x32_bf16 v[144:147], v[184:187], v[112:115], v[144:147]
    v_mfma_f32_16x16x32_bf16 v[148:151], v[184:187], v[116:119], v[148:151]
    ds_read_b128 v[208:211], v235 offset:256
    v_exp_f32 v165, v165
    v_exp_f32 v166, v166
    v_exp_f32 v167, v167
    v_add_f32 v253, v168, v169
    s_waitcnt lgkmcnt(5)
    v_mfma_f32_16x16x32_bf16 v[152:155], v[188:191], v[112:115], v[152:155]
    v_mfma_f32_16x16x32_bf16 v[156:159], v[188:191], v[116:119], v[156:159]
    ds_read_b128 v[212:215], v235 offset:6400
    v_add_f32 v255, v170, v171
    v_add_f32 v253, v253, v255
    v_add_f32 v251, v251, v253
    s_waitcnt lgkmcnt(5)
    v_mfma_f32_16x16x32_bf16 v[144:147], v[192:195], v[120:123], v[144:147]
    v_mfma_f32_16x16x32_bf16 v[148:151], v[192:195], v[124:127], v[148:151]
    v_add_f32 v224, v224, v251
    v_cvt_pk_bf16_f32 v178, v168, v169
    v_cvt_pk_bf16_f32 v179, v170, v171
    s_waitcnt lgkmcnt(4)
    v_mfma_f32_16x16x32_bf16 v[152:155], v[196:199], v[120:123], v[152:155]
    v_mfma_f32_16x16x32_bf16 v[156:159], v[196:199], v[124:127], v[156:159]
    v_exp_f32 v172, v172
    v_exp_f32 v173, v173
    v_exp_f32 v174, v174
    v_exp_f32 v175, v175
    s_waitcnt lgkmcnt(3)
    v_mfma_f32_16x16x32_bf16 v[144:147], v[200:203], v[128:131], v[144:147]
    v_mfma_f32_16x16x32_bf16 v[148:151], v[200:203], v[132:135], v[148:151]
    s_add_u32 s48, s52, 0
    v_add_u32 v234, s48, v228
    v_add_u32 v235, s48, v229
    v_add_u32 v236, s48, v230
    v_add_u32 v237, s48, v231
    s_waitcnt lgkmcnt(0)
    s_waitcnt vmcnt(9)
    s_barrier
    ds_read_b64_tr_b16 v[184:185], v234 offset:0
    ds_read_b64_tr_b16 v[186:187], v234 offset:6144
    ds_read_b64_tr_b16 v[188:189], v235 offset:0
    ds_read_b64_tr_b16 v[190:191], v235 offset:6144
    ds_read_b64_tr_b16 v[192:193], v236 offset:0
    ds_read_b64_tr_b16 v[194:195], v236 offset:6144
    s_add_u32 m0, s55, 0
    s_add_u32 s49, s95, 0
    s_sub_u32 s94, s49, 10
    s_cmp_ge_u32 s49, 10
    s_cselect_b32 s49, s94, s49
    s_lshl_b32 s97, s49, 7
    buffer_load_dwordx4 v244, s[36:39], s97 offen lds
    v_add_f32 v252, v164, v165
    v_add_f32 v255, v166, v167
    v_add_f32 v252, v252, v255
    v_mfma_f32_16x16x32_bf16 v[152:155], v[204:207], v[128:131], v[152:155]
    v_mfma_f32_16x16x32_bf16 v[156:159], v[204:207], v[132:135], v[156:159]
    ds_read_b64_tr_b16 v[196:197], v237 offset:0
    ds_read_b64_tr_b16 v[198:199], v237 offset:6144
    v_cvt_pk_bf16_f32 v180, v164, v165
    v_cvt_pk_bf16_f32 v181, v166, v167
    v_add_f32 v254, v172, v173
    v_add_f32 v255, v174, v175
    v_mfma_f32_16x16x32_bf16 v[144:147], v[208:211], v[136:139], v[144:147]
    v_mfma_f32_16x16x32_bf16 v[148:151], v[208:211], v[140:143], v[148:151]
    ds_read_b64_tr_b16 v[200:201], v234 offset:128
    ds_read_b64_tr_b16 v[202:203], v234 offset:6272
    v_add_f32 v254, v254, v255
    v_add_f32 v252, v252, v254
    v_add_f32 v225, v225, v252
    v_mfma_f32_16x16x32_bf16 v[152:155], v[212:215], v[136:139], v[152:155]
    v_mfma_f32_16x16x32_bf16 v[156:159], v[212:215], v[140:143], v[156:159]
    ds_read_b64_tr_b16 v[204:205], v235 offset:128
    ds_read_b64_tr_b16 v[206:207], v235 offset:6272
    v_cvt_pk_bf16_f32 v182, v172, v173
    v_cvt_pk_bf16_f32 v183, v174, v175
    s_nop 1
    s_waitcnt lgkmcnt(10)
    v_mfma_f32_16x16x32_bf16 v[0:3], v[184:187], v[176:179], v[0:3]
    v_mfma_f32_16x16x32_bf16 v[4:7], v[184:187], v[180:183], v[4:7]
    ds_read_b64_tr_b16 v[208:209], v236 offset:128
    ds_read_b64_tr_b16 v[210:211], v236 offset:6272
    s_add_u32 m0, s55, 0
    s_add_u32 s97, s97, 9216
    buffer_load_dwordx4 v244, s[36:39], s97 offen offset:1024 lds
    s_waitcnt lgkmcnt(10)
    v_mfma_f32_16x16x32_bf16 v[8:11], v[188:191], v[176:179], v[8:11]
    v_mfma_f32_16x16x32_bf16 v[12:15], v[188:191], v[180:183], v[12:15]
    ds_read_b64_tr_b16 v[212:213], v237 offset:128
    ds_read_b64_tr_b16 v[214:215], v237 offset:6272
    s_add_u32 m0, s55, 0
    s_add_u32 s97, s97, 9216
    buffer_load_dwordx4 v244, s[36:39], s97 offen offset:2048 lds
    s_waitcnt lgkmcnt(10)
    v_mfma_f32_16x16x32_bf16 v[16:19], v[192:195], v[176:179], v[16:19]
    v_mfma_f32_16x16x32_bf16 v[20:23], v[192:195], v[180:183], v[20:23]
    ds_read_b64_tr_b16 v[184:185], v234 offset:256
    ds_read_b64_tr_b16 v[186:187], v234 offset:6400
    s_add_u32 m0, s55, 0
    s_add_u32 s97, s97, 9216
    buffer_load_dwordx4 v244, s[36:39], s97 offen offset:3072 lds
    s_waitcnt lgkmcnt(10)
    v_mfma_f32_16x16x32_bf16 v[24:27], v[196:199], v[176:179], v[24:27]
    v_mfma_f32_16x16x32_bf16 v[28:31], v[196:199], v[180:183], v[28:31]
    ds_read_b64_tr_b16 v[188:189], v235 offset:256
    ds_read_b64_tr_b16 v[190:191], v235 offset:6400
    v_max3_f32 v246, v144, v145, v146
    v_max3_f32 v247, v147, v152, v153
    s_waitcnt lgkmcnt(10)
    v_mfma_f32_16x16x32_bf16 v[32:35], v[200:203], v[176:179], v[32:35]
    v_mfma_f32_16x16x32_bf16 v[36:39], v[200:203], v[180:183], v[36:39]
    ds_read_b64_tr_b16 v[192:193], v236 offset:256
    ds_read_b64_tr_b16 v[194:195], v236 offset:6400
    s_add_u32 m0, s55, 4096
    s_add_u32 s49, s95, 1
    s_sub_u32 s94, s49, 10
    s_cmp_ge_u32 s49, 10
    s_cselect_b32 s49, s94, s49
    s_lshl_b32 s97, s49, 7
    buffer_load_dwordx4 v244, s[36:39], s97 offen lds
    v_max3_f32 v248, v154, v155, v148
    s_waitcnt lgkmcnt(10)
    v_mfma_f32_16x16x32_bf16 v[40:43], v[204:207], v[176:179], v[40:43]
    v_mfma_f32_16x16x32_bf16 v[44:47], v[204:207], v[180:183], v[44:47]
    ds_read_b64_tr_b16 v[196:197], v237 offset:256
    ds_read_b64_tr_b16 v[198:199], v237 offset:6400
    s_add_u32 m0, s55, 4096
    s_add_u32 s97, s97, 9216
    buffer_load_dwordx4 v244, s[36:39], s97 offen offset:1024 lds
    v_max3_f32 v249, v149, v150, v151
    v_max3_f32 v250, v156, v157, v158
    s_waitcnt lgkmcnt(10)
    v_mfma_f32_16x16x32_bf16 v[48:51], v[208:211], v[176:179], v[48:51]
    v_mfma_f32_16x16x32_bf16 v[52:55], v[208:211], v[180:183], v[52:55]
    s_add_u32 m0, s55, 4096
    s_add_u32 s97, s97, 9216
    buffer_load_dwordx4 v244, s[36:39], s97 offen offset:2048 lds
    v_max3_f32 v246, v246, v247, v159
    s_waitcnt lgkmcnt(8)
    v_mfma_f32_16x16x32_bf16 v[56:59], v[212:215], v[176:179], v[56:59]
    v_mfma_f32_16x16x32_bf16 v[60:63], v[212:215], v[180:183], v[60:63]
    s_add_u32 m0, s55, 4096
    s_add_u32 s97, s97, 9216
    buffer_load_dwordx4 v244, s[36:39], s97 offen offset:3072 lds
    v_max3_f32 v248, v248, v249, v250
    v_max_f32 v246, v246, v248
    s_waitcnt lgkmcnt(6)
    v_mfma_f32_16x16x32_bf16 v[64:67], v[184:187], v[176:179], v[64:67]
    v_mfma_f32_16x16x32_bf16 v[68:71], v[184:187], v[180:183], v[68:71]
    s_add_u32 s48, s52, 24576
    v_add_u32 v234, s48, v226
    v_add_u32 v235, s48, v227
    s_waitcnt lgkmcnt(0)
    s_waitcnt vmcnt(14)
    s_barrier
    ds_read_b128 v[200:203], v234 offset:0
    ds_read_b128 v[204:207], v234 offset:6144
    ds_read_b128 v[208:211], v235 offset:0
    s_add_u32 m0, s45, 0
    s_add_u32 s49, s95, 0
    s_sub_u32 s94, s49, 10
    s_cmp_ge_u32 s49, 10
    s_cselect_b32 s49, s94, s49
    s_mul_i32 s96, s49, 786432
    buffer_load_dwordx4 v241, s[32:35], s96 offen lds
    v_cmp_lt_f32 vcc, s51, v246
    v_mfma_f32_16x16x32_bf16 v[72:75], v[188:191], v[176:179], v[72:75]
    v_mfma_f32_16x16x32_bf16 v[76:79], v[188:191], v[180:183], v[76:79]
    ds_read_b128 v[212:215], v235 offset:6144
    v_mfma_f32_16x16x32_bf16 v[80:83], v[192:195], v[176:179], v[80:83]
    v_mfma_f32_16x16x32_bf16 v[84:87], v[192:195], v[180:183], v[84:87]
    ds_read_b128 v[184:187], v234 offset:128
    v_mfma_f32_16x16x32_bf16 v[88:91], v[196:199], v[176:179], v[88:91]
    v_mfma_f32_16x16x32_bf16 v[92:95], v[196:199], v[180:183], v[92:95]
    ds_read_b128 v[188:191], v234 offset:6272
    s_cbranch_vccnz K1_SLOW14
K1_BACK14:
    s_waitcnt lgkmcnt(5)
    v_mfma_f32_16x16x32_bf16 v[160:163], v[200:203], v[96:99], v[216:219]
    v_mfma_f32_16x16x32_bf16 v[164:167], v[200:203], v[100:103], v[220:223]
    ds_read_b128 v[192:195], v235 offset:128
    v_exp_f32 v144, v144
    v_exp_f32 v145, v145
    v_exp_f32 v146, v146
    v_exp_f32 v147, v147
    s_waitcnt lgkmcnt(5)
    v_mfma_f32_16x16x32_bf16 v[168:171], v[204:207], v[96:99], v[216:219]
    v_mfma_f32_16x16x32_bf16 v[172:175], v[204:207], v[100:103], v[220:223]
    ds_read_b128 v[196:199], v235 offset:6272
    v_exp_f32 v152, v152
    v_exp_f32 v153, v153
    v_exp_f32 v154, v154
    s_waitcnt lgkmcnt(5)
    v_mfma_f32_16x16x32_bf16 v[160:163], v[208:211], v[104:107], v[160:163]
    v_mfma_f32_16x16x32_bf16 v[164:167], v[208:211], v[108:111], v[164:167]
    ds_read_b128 v[200:203], v234 offset:256
    v_exp_f32 v155, v155
    v_add_f32 v251, v144, v145
    v_add_f32 v255, v146, v147
    v_add_f32 v251, v251, v255
    s_waitcnt lgkmcnt(5)
    v_mfma_f32_16x16x32_bf16 v[168:171], v[212:215], v[104:107], v[168:171]
    v_mfma_f32_16x16x32_bf16 v[172:175], v[212:215], v[108:111], v[172:175]
    ds_read_b128 v[204:207], v234 offset:6400
    s_add_u32 m0, s45, 0
    s_nop 0
    buffer_load_dwordx4 v242, s[32:35], s96 offen offset:1024 lds
    v_cvt_pk_bf16_f32 v176, v144, v145
    v_cvt_pk_bf16_f32 v177, v146, v147
    v_exp_f32 v148, v148
    s_waitcnt lgkmcnt(5)
    v_mfma_f32_16x16x32_bf16 v[160:163], v[184:187], v[112:115], v[160:163]
    v_mfma_f32_16x16x32_bf16 v[164:167], v[184:187], v[116:119], v[164:167]
    ds_read_b128 v[208:211], v235 offset:256
    v_exp_f32 v149, v149
    v_exp_f32 v150, v150
    v_exp_f32 v151, v151
    v_add_f32 v253, v152, v153
    s_waitcnt lgkmcnt(5)
    v_mfma_f32_16x16x32_bf16 v[168:171], v[188:191], v[112:115], v[168:171]
    v_mfma_f32_16x16x32_bf16 v[172:175], v[188:191], v[116:119], v[172:175]
    ds_read_b128 v[212:215], v235 offset:6400
    v_add_f32 v255, v154, v155
    v_add_f32 v253, v253, v255
    v_add_f32 v251, v251, v253
    s_waitcnt lgkmcnt(5)
    v_mfma_f32_16x16x32_bf16 v[160:163], v[192:195], v[120:123], v[160:163]
    v_mfma_f32_16x16x32_bf16 v[164:167], v[192:195], v[124:127], v[164:167]
    s_add_u32 m0, s45, 0
    s_nop 0
    buffer_load_dwordx4 v243, s[32:35], s96 offen offset:2048 lds
    v_add_f32 v224, v224, v251
    v_cvt_pk_bf16_f32 v178, v152, v153
    v_cvt_pk_bf16_f32 v179, v154, v155
    s_waitcnt lgkmcnt(4)
    v_mfma_f32_16x16x32_bf16 v[168:171], v[196:199], v[120:123], v[168:171]
    v_mfma_f32_16x16x32_bf16 v[172:175], v[196:199], v[124:127], v[172:175]
    v_exp_f32 v156, v156
    v_exp_f32 v157, v157
    v_exp_f32 v158, v158
    v_exp_f32 v159, v159
    s_waitcnt lgkmcnt(3)
    v_mfma_f32_16x16x32_bf16 v[160:163], v[200:203], v[128:131], v[160:163]
    v_mfma_f32_16x16x32_bf16 v[164:167], v[200:203], v[132:135], v[164:167]
    s_add_u32 s48, s52, 49152
    v_add_u32 v234, s48, v228
    v_add_u32 v235, s48, v229
    v_add_u32 v236, s48, v230
    v_add_u32 v237, s48, v231
    s_waitcnt lgkmcnt(0)
    s_waitcnt vmcnt(14)
    s_barrier
    ds_read_b64_tr_b16 v[184:185], v234 offset:0
    ds_read_b64_tr_b16 v[186:187], v234 offset:6144
    ds_read_b64_tr_b16 v[188:189], v235 offset:0
    ds_read_b64_tr_b16 v[190:191], v235 offset:6144
    ds_read_b64_tr_b16 v[192:193], v236 offset:0
    ds_read_b64_tr_b16 v[194:195], v236 offset:6144
    s_add_u32 m0, s45, 24576
    s_add_u32 s49, s95, 1
    s_sub_u32 s94, s49, 10
    s_cmp_ge_u32 s49, 10
    s_cselect_b32 s49, s94, s49
    s_mul_i32 s96, s49, 786432
    buffer_load_dwordx4 v241, s[32:35], s96 offen lds
    v_add_f32 v252, v148, v149
    v_add_f32 v255, v150, v151
    v_add_f32 v252, v252, v255
    v_mfma_f32_16x16x32_bf16 v[168:171], v[204:207], v[128:131], v[168:171]
    v_mfma_f32_16x16x32_bf16 v[172:175], v[204:207], v[132:135], v[172:175]
    ds_read_b64_tr_b16 v[196:197], v237 offset:0
    ds_read_b64_tr_b16 v[198:199], v237 offset:6144
    v_cvt_pk_bf16_f32 v180, v148, v149
    v_cvt_pk_bf16_f32 v181, v150, v151
    v_add_f32 v254, v156, v157
    v_add_f32 v255, v158, v159
    v_mfma_f32_16x16x32_bf16 v[160:163], v[208:211], v[136:139], v[160:163]
    v_mfma_f32_16x16x32_bf16 v[164:167], v[208:211], v[140:143], v[164:167]
    ds_read_b64_tr_b16 v[200:201], v234 offset:128
    ds_read_b64_tr_b16 v[202:203], v234 offset:6272
    v_add_f32 v254, v254, v255
    v_add_f32 v252, v252, v254
    v_add_f32 v225, v225, v252
    v_mfma_f32_16x16x32_bf16 v[168:171], v[212:215], v[136:139], v[168:171]
    v_mfma_f32_16x16x32_bf16 v[172:175], v[212:215], v[140:143], v[172:175]
    ds_read_b64_tr_b16 v[204:205], v235 offset:128
    ds_read_b64_tr_b16 v[206:207], v235 offset:6272
    v_cvt_pk_bf16_f32 v182, v156, v157
    v_cvt_pk_bf16_f32 v183, v158, v159
    s_nop 1
    s_waitcnt lgkmcnt(10)
    v_mfma_f32_16x16x32_bf16 v[0:3], v[184:187], v[176:179], v[0:3]
    v_mfma_f32_16x16x32_bf16 v[4:7], v[184:187], v[180:183], v[4:7]
    ds_read_b64_tr_b16 v[208:209], v236 offset:128
    ds_read_b64_tr_b16 v[210:211], v236 offset:6272
    s_waitcnt lgkmcnt(10)
    v_mfma_f32_16x16x32_bf16 v[8:11], v[188:191], v[176:179], v[8:11]
    v_mfma_f32_16x16x32_bf16 v[12:15], v[188:191], v[180:183], v[12:15]
    ds_read_b64_tr_b16 v[212:213], v237 offset:128
    ds_read_b64_tr_b16 v[214:215], v237 offset:6272
    s_waitcnt lgkmcnt(10)
    v_mfma_f32_16x16x32_bf16 v[16:19], v[192:195], v[176:179], v[16:19]
    v_mfma_f32_16x16x32_bf16 v[20:23], v[192:195], v[180:183], v[20:23]
    ds_read_b64_tr_b16 v[184:185], v234 offset:256
    ds_read_b64_tr_b16 v[186:187], v234 offset:6400
    s_waitcnt lgkmcnt(10)
    v_mfma_f32_16x16x32_bf16 v[24:27], v[196:199], v[176:179], v[24:27]
    v_mfma_f32_16x16x32_bf16 v[28:31], v[196:199], v[180:183], v[28:31]
    ds_read_b64_tr_b16 v[188:189], v235 offset:256
    ds_read_b64_tr_b16 v[190:191], v235 offset:6400
    s_add_u32 m0, s45, 24576
    s_nop 0
    buffer_load_dwordx4 v242, s[32:35], s96 offen offset:1024 lds
    v_max3_f32 v246, v160, v161, v162
    v_max3_f32 v247, v163, v168, v169
    s_waitcnt lgkmcnt(10)
    v_mfma_f32_16x16x32_bf16 v[32:35], v[200:203], v[176:179], v[32:35]
    v_mfma_f32_16x16x32_bf16 v[36:39], v[200:203], v[180:183], v[36:39]
    ds_read_b64_tr_b16 v[192:193], v236 offset:256
    ds_read_b64_tr_b16 v[194:195], v236 offset:6400
    v_max3_f32 v248, v170, v171, v164
    s_waitcnt lgkmcnt(10)
    v_mfma_f32_16x16x32_bf16 v[40:43], v[204:207], v[176:179], v[40:43]
    v_mfma_f32_16x16x32_bf16 v[44:47], v[204:207], v[180:183], v[44:47]
    ds_read_b64_tr_b16 v[196:197], v237 offset:256
    ds_read_b64_tr_b16 v[198:199], v237 offset:6400
    v_max3_f32 v249, v165, v166, v167
    v_max3_f32 v250, v172, v173, v174
    s_waitcnt lgkmcnt(10)
    v_mfma_f32_16x16x32_bf16 v[48:51], v[208:211], v[176:179], v[48:51]
    v_mfma_f32_16x16x32_bf16 v[52:55], v[208:211], v[180:183], v[52:55]
    s_add_u32 m0, s45, 24576
    s_nop 0
    buffer_load_dwordx4 v243, s[32:35], s96 offen offset:2048 lds
    v_max3_f32 v246, v246, v247, v175
    s_waitcnt lgkmcnt(8)
    v_mfma_f32_16x16x32_bf16 v[56:59], v[212:215], v[176:179], v[56:59]
    v_mfma_f32_16x16x32_bf16 v[60:63], v[212:215], v[180:183], v[60:63]
    v_max3_f32 v248, v248, v249, v250
    v_max_f32 v246, v246, v248
    s_waitcnt lgkmcnt(6)
    v_mfma_f32_16x16x32_bf16 v[64:67], v[184:187], v[176:179], v[64:67]
    v_mfma_f32_16x16x32_bf16 v[68:71], v[184:187], v[180:183], v[68:71]
    s_add_u32 s48, s52, 73728
    v_add_u32 v234, s48, v228
    v_add_u32 v235, s48, v229
    v_add_u32 v236, s48, v230
    v_add_u32 v237, s48, v231
    s_waitcnt lgkmcnt(0)
    s_waitcnt vmcnt(14)
    s_barrier
    ds_read_b64_tr_b16 v[200:201], v234 offset:0
    ds_read_b64_tr_b16 v[202:203], v234 offset:6144
    ds_read_b64_tr_b16 v[204:205], v235 offset:0
    ds_read_b64_tr_b16 v[206:207], v235 offset:6144
    ds_read_b64_tr_b16 v[208:209], v236 offset:0
    ds_read_b64_tr_b16 v[210:211], v236 offset:6144
    s_add_u32 m0, s45, 49152
    s_add_u32 s49, s95, 2
    s_sub_u32 s94, s49, 10
    s_cmp_ge_u32 s49, 10
    s_cselect_b32 s49, s94, s49
    s_mul_i32 s96, s49, 786432
    buffer_load_dwordx4 v241, s[32:35], s96 offen lds
    v_cmp_lt_f32 vcc, s51, v246
    v_mfma_f32_16x16x32_bf16 v[72:75], v[188:191], v[176:179], v[72:75]
    v_mfma_f32_16x16x32_bf16 v[76:79], v[188:191], v[180:183], v[76:79]
    ds_read_b64_tr_b16 v[212:213], v237 offset:0
    ds_read_b64_tr_b16 v[214:215], v237 offset:6144
    v_mfma_f32_16x16x32_bf16 v[80:83], v[192:195], v[176:179], v[80:83]
    v_mfma_f32_16x16x32_bf16 v[84:87], v[192:195], v[180:183], v[84:87]
    ds_read_b64_tr_b16 v[184:185], v234 offset:128
    ds_read_b64_tr_b16 v[186:187], v234 offset:6272
    v_mfma_f32_16x16x32_bf16 v[88:91], v[196:199], v[176:179], v[88:91]
    v_mfma_f32_16x16x32_bf16 v[92:95], v[196:199], v[180:183], v[92:95]
    ds_read_b64_tr_b16 v[188:189], v235 offset:128
    ds_read_b64_tr_b16 v[190:191], v235 offset:6272
    s_cbranch_vccnz K1_SLOW15
K1_BACK15:
    v_exp_f32 v160, v160
    v_exp_f32 v161, v161
    v_exp_f32 v162, v162
    v_exp_f32 v163, v163
    v_exp_f32 v168, v168
    v_exp_f32 v169, v169
    v_exp_f32 v170, v170
    v_exp_f32 v171, v171
    v_add_f32 v251, v160, v161
    v_add_f32 v255, v162, v163
    v_add_f32 v251, v251, v255
    v_cvt_pk_bf16_f32 v176, v160, v161
    v_cvt_pk_bf16_f32 v177, v162, v163
    v_exp_f32 v164, v164
    v_exp_f32 v165, v165
    v_exp_f32 v166, v166
    v_exp_f32 v167, v167
    v_add_f32 v253, v168, v169
    v_add_f32 v255, v170, v171
    v_add_f32 v253, v253, v255
    v_add_f32 v251, v251, v253
    v_add_f32 v224, v224, v251
    v_cvt_pk_bf16_f32 v178, v168, v169
    v_cvt_pk_bf16_f32 v179, v170, v171
    v_exp_f32 v172, v172
    v_exp_f32 v173, v173
    v_exp_f32 v174, v174
    v_exp_f32 v175, v175
    v_add_f32 v252, v164, v165
    v_add_f32 v255, v166, v167
    v_add_f32 v252, v252, v255
    v_cvt_pk_bf16_f32 v180, v164, v165
    v_cvt_pk_bf16_f32 v181, v166, v167
    v_add_f32 v254, v172, v173
    v_add_f32 v255, v174, v175
    v_add_f32 v254, v254, v255
    v_add_f32 v252, v252, v254
    v_add_f32 v225, v225, v252
    v_cvt_pk_bf16_f32 v182, v172, v173
    v_cvt_pk_bf16_f32 v183, v174, v175
    s_nop 1
    s_nop 1
    s_waitcnt lgkmcnt(10)
    v_mfma_f32_16x16x32_bf16 v[0:3], v[200:203], v[176:179], v[0:3]
    v_mfma_f32_16x16x32_bf16 v[4:7], v[200:203], v[180:183], v[4:7]
    ds_read_b64_tr_b16 v[192:193], v236 offset:128
    ds_read_b64_tr_b16 v[194:195], v236 offset:6272
    s_waitcnt lgkmcnt(10)
    v_mfma_f32_16x16x32_bf16 v[8:11], v[204:207], v[176:179], v[8:11]
    v_mfma_f32_16x16x32_bf16 v[12:15], v[204:207], v[180:183], v[12:15]
    ds_read_b64_tr_b16 v[196:197], v237 offset:128
    ds_read_b64_tr_b16 v[198:199], v237 offset:6272
    s_waitcnt lgkmcnt(10)
    v_mfma_f32_16x16x32_bf16 v[16:19], v[208:211], v[176:179], v[16:19]
    v_mfma_f32_16x16x32_bf16 v[20:23], v[208:211], v[180:183], v[20:23]
    ds_read_b64_tr_b16 v[200:201], v234 offset:256
    ds_read_b64_tr_b16 v[202:203], v234 offset:6400
    s_waitcnt lgkmcnt(10)
    v_mfma_f32_16x16x32_bf16 v[24:27], v[212:215], v[176:179], v[24:27]
    v_mfma_f32_16x16x32_bf16 v[28:31], v[212:215], v[180:183], v[28:31]
    ds_read_b64_tr_b16 v[204:205], v235 offset:256
    ds_read_b64_tr_b16 v[206:207], v235 offset:6400
    s_add_u32 m0, s45, 49152
    s_nop 0
    buffer_load_dwordx4 v242, s[32:35], s96 offen offset:1024 lds
    s_waitcnt lgkmcnt(10)
    v_mfma_f32_16x16x32_bf16 v[32:35], v[184:187], v[176:179], v[32:35]
    v_mfma_f32_16x16x32_bf16 v[36:39], v[184:187], v[180:183], v[36:39]
    ds_read_b64_tr_b16 v[208:209], v236 offset:256
    ds_read_b64_tr_b16 v[210:211], v236 offset:6400
    s_waitcnt lgkmcnt(10)
    v_mfma_f32_16x16x32_bf16 v[40:43], v[188:191], v[176:179], v[40:43]
    v_mfma_f32_16x16x32_bf16 v[44:47], v[188:191], v[180:183], v[44:47]
    ds_read_b64_tr_b16 v[212:213], v237 offset:256
    ds_read_b64_tr_b16 v[214:215], v237 offset:6400
    s_waitcnt lgkmcnt(10)
    v_mfma_f32_16x16x32_bf16 v[48:51], v[192:195], v[176:179], v[48:51]
    v_mfma_f32_16x16x32_bf16 v[52:55], v[192:195], v[180:183], v[52:55]
    s_add_u32 m0, s45, 49152
    s_nop 0
    buffer_load_dwordx4 v243, s[32:35], s96 offen offset:2048 lds
    s_waitcnt lgkmcnt(8)
    v_mfma_f32_16x16x32_bf16 v[56:59], v[196:199], v[176:179], v[56:59]
    v_mfma_f32_16x16x32_bf16 v[60:63], v[196:199], v[180:183], v[60:63]
    s_waitcnt lgkmcnt(6)
    v_mfma_f32_16x16x32_bf16 v[64:67], v[200:203], v[176:179], v[64:67]
    v_mfma_f32_16x16x32_bf16 v[68:71], v[200:203], v[180:183], v[68:71]
    s_cmp_lg_u32 s61, 0
    s_cbranch_scc1 K1_FINAL
    s_mov_b32 s61, 1
    s_mov_b32 s42, 49152
    s_add_u32 s24, s18, s64
    s_addc_u32 s25, s19, 0
    s_add_u32 s28, s20, s64
    s_addc_u32 s29, s21, 0
    s_branch K1_LOOP
K1_FINAL:
    s_waitcnt lgkmcnt(0)
    v_mfma_f32_16x16x32_bf16 v[72:75], v[204:207], v[176:179], v[72:75]
    v_mfma_f32_16x16x32_bf16 v[76:79], v[204:207], v[180:183], v[76:79]
    v_mfma_f32_16x16x32_bf16 v[80:83], v[208:211], v[176:179], v[80:83]
    v_mfma_f32_16x16x32_bf16 v[84:87], v[208:211], v[180:183], v[84:87]
    v_mfma_f32_16x16x32_bf16 v[88:91], v[212:215], v[176:179], v[88:91]
    v_mfma_f32_16x16x32_bf16 v[92:95], v[212:215], v[180:183], v[92:95]
    s_nop 7
    v_mov_b32 v246, v224
    v_mov_b32 v247, v225
    s_nop 1
    v_permlane32_swap_b32 v224, v246
    v_permlane32_swap_b32 v225, v247
    s_nop 0
    v_add_f32 v224, v224, v246
    v_mov_b32 v246, v224
    v_add_f32 v225, v225, v247
    v_mov_b32 v247, v225
    s_nop 1
    v_permlane16_swap_b32 v224, v246
    v_permlane16_swap_b32 v225, v247
    s_nop 0
    v_add_f32 v224, v224, v246
    v_add_f32 v225, v225, v247
    v_rcp_f32 v246, v224
    v_rcp_f32 v247, v225
    s_nop 0
    v_mul_f32 v0, v0, v246
    v_mul_f32 v1, v1, v246
    v_mul_f32 v2, v2, v246
    v_mul_f32 v3, v3, v246
    v_mul_f32 v8, v8, v246
    v_mul_f32 v9, v9, v246
    v_mul_f32 v10, v10, v246
    v_mul_f32 v11, v11, v246
    v_cvt_pk_bf16_f32 v96, v0, v1
    v_cvt_pk_bf16_f32 v97, v2, v3
    v_cvt_pk_bf16_f32 v98, v8, v9
    v_cvt_pk_bf16_f32 v99, v10, v11
    buffer_store_dwordx4 v[96:99], v245, s[40:43], 0 offen offset:0
    v_mul_f32 v16, v16, v246
    v_mul_f32 v17, v17, v246
    v_mul_f32 v18, v18, v246
    v_mul_f32 v19, v19, v246
    v_mul_f32 v24, v24, v246
    v_mul_f32 v25, v25, v246
    v_mul_f32 v26, v26, v246
    v_mul_f32 v27, v27, v246
    v_cvt_pk_bf16_f32 v100, v16, v17
    v_cvt_pk_bf16_f32 v101, v18, v19
    v_cvt_pk_bf16_f32 v102, v24, v25
    v_cvt_pk_bf16_f32 v103, v26, v27
    buffer_store_dwordx4 v[100:103], v245, s[40:43], 0 offen offset:1024
    v_mul_f32 v32, v32, v246
    v_mul_f32 v33, v33, v246
    v_mul_f32 v34, v34, v246
    v_mul_f32 v35, v35, v246
    v_mul_f32 v40, v40, v246
    v_mul_f32 v41, v41, v246
    v_mul_f32 v42, v42, v246
    v_mul_f32 v43, v43, v246
    v_cvt_pk_bf16_f32 v104, v32, v33
    v_cvt_pk_bf16_f32 v105, v34, v35
    v_cvt_pk_bf16_f32 v106, v40, v41
    v_cvt_pk_bf16_f32 v107, v42, v43
    buffer_store_dwordx4 v[104:107], v245, s[40:43], 0 offen offset:2048
    v_mul_f32 v48, v48, v246
    v_mul_f32 v49, v49, v246
    v_mul_f32 v50, v50, v246
    v_mul_f32 v51, v51, v246
    v_mul_f32 v56, v56, v246
    v_mul_f32 v57, v57, v246
    v_mul_f32 v58, v58, v246
    v_mul_f32 v59, v59, v246
    v_cvt_pk_bf16_f32 v108, v48, v49
    v_cvt_pk_bf16_f32 v109, v50, v51
    v_cvt_pk_bf16_f32 v110, v56, v57
    v_cvt_pk_bf16_f32 v111, v58, v59
    buffer_store_dwordx4 v[108:111], v245, s[40:43], 0 offen offset:3072
    v_mul_f32 v64, v64, v246
    v_mul_f32 v65, v65, v246
    v_mul_f32 v66, v66, v246
    v_mul_f32 v67, v67, v246
    v_mul_f32 v72, v72, v246
    v_mul_f32 v73, v73, v246
    v_mul_f32 v74, v74, v246
    v_mul_f32 v75, v75, v246
    v_cvt_pk_bf16_f32 v112, v64, v65
    v_cvt_pk_bf16_f32 v113, v66, v67
    v_cvt_pk_bf16_f32 v114, v72, v73
    v_cvt_pk_bf16_f32 v115, v74, v75
    buffer_store_dwordx4 v[112:115], v245, s[40:43], s66 offen offset:0
    v_mul_f32 v80, v80, v246
    v_mul_f32 v81, v81, v246
    v_mul_f32 v82, v82, v246
    v_mul_f32 v83, v83, v246
    v_mul_f32 v88, v88, v246
    v_mul_f32 v89, v89, v246
    v_mul_f32 v90, v90, v246
    v_mul_f32 v91, v91, v246
    v_cvt_pk_bf16_f32 v116, v80, v81
    v_cvt_pk_bf16_f32 v117, v82, v83
    v_cvt_pk_bf16_f32 v118, v88, v89
    v_cvt_pk_bf16_f32 v119, v90, v91
    buffer_store_dwordx4 v[116:119], v245, s[40:43], s66 offen offset:1024
    v_mul_f32 v4, v4, v247
    v_mul_f32 v5, v5, v247
    v_mul_f32 v6, v6, v247
    v_mul_f32 v7, v7, v247
    v_mul_f32 v12, v12, v247
    v_mul_f32 v13, v13, v247
    v_mul_f32 v14, v14, v247
    v_mul_f32 v15, v15, v247
    v_cvt_pk_bf16_f32 v120, v4, v5
    v_cvt_pk_bf16_f32 v121, v6, v7
    v_cvt_pk_bf16_f32 v122, v12, v13
    v_cvt_pk_bf16_f32 v123, v14, v15
    buffer_store_dwordx4 v[120:123], v245, s[40:43], s66 offen offset:2048
    v_mul_f32 v20, v20, v247
    v_mul_f32 v21, v21, v247
    v_mul_f32 v22, v22, v247
    v_mul_f32 v23, v23, v247
    v_mul_f32 v28, v28, v247
    v_mul_f32 v29, v29, v247
    v_mul_f32 v30, v30, v247
    v_mul_f32 v31, v31, v247
    v_cvt_pk_bf16_f32 v124, v20, v21
    v_cvt_pk_bf16_f32 v125, v22, v23
    v_cvt_pk_bf16_f32 v126, v28, v29
    v_cvt_pk_bf16_f32 v127, v30, v31
    buffer_store_dwordx4 v[124:127], v245, s[40:43], s66 offen offset:3072
    v_mul_f32 v36, v36, v247
    v_mul_f32 v37, v37, v247
    v_mul_f32 v38, v38, v247
    v_mul_f32 v39, v39, v247
    v_mul_f32 v44, v44, v247
    v_mul_f32 v45, v45, v247
    v_mul_f32 v46, v46, v247
    v_mul_f32 v47, v47, v247
    v_cvt_pk_bf16_f32 v128, v36, v37
    v_cvt_pk_bf16_f32 v129, v38, v39
    v_cvt_pk_bf16_f32 v130, v44, v45
    v_cvt_pk_bf16_f32 v131, v46, v47
    buffer_store_dwordx4 v[128:131], v245, s[40:43], s67 offen offset:0
    v_mul_f32 v52, v52, v247
    v_mul_f32 v53, v53, v247
    v_mul_f32 v54, v54, v247
    v_mul_f32 v55, v55, v247
    v_mul_f32 v60, v60, v247
    v_mul_f32 v61, v61, v247
    v_mul_f32 v62, v62, v247
    v_mul_f32 v63, v63, v247
    v_cvt_pk_bf16_f32 v132, v52, v53
    v_cvt_pk_bf16_f32 v133, v54, v55
    v_cvt_pk_bf16_f32 v134, v60, v61
    v_cvt_pk_bf16_f32 v135, v62, v63
    buffer_store_dwordx4 v[132:135], v245, s[40:43], s67 offen offset:1024
    v_mul_f32 v68, v68, v247
    v_mul_f32 v69, v69, v247
    v_mul_f32 v70, v70, v247
    v_mul_f32 v71, v71, v247
    v_mul_f32 v76, v76, v247
    v_mul_f32 v77, v77, v247
    v_mul_f32 v78, v78, v247
    v_mul_f32 v79, v79, v247
    v_cvt_pk_bf16_f32 v136, v68, v69
    v_cvt_pk_bf16_f32 v137, v70, v71
    v_cvt_pk_bf16_f32 v138, v76, v77
    v_cvt_pk_bf16_f32 v139, v78, v79
    buffer_store_dwordx4 v[136:139], v245, s[40:43], s67 offen offset:2048
    v_mul_f32 v84, v84, v247
    v_mul_f32 v85, v85, v247
    v_mul_f32 v86, v86, v247
    v_mul_f32 v87, v87, v247
    v_mul_f32 v92, v92, v247
    v_mul_f32 v93, v93, v247
    v_mul_f32 v94, v94, v247
    v_mul_f32 v95, v95, v247
    v_cvt_pk_bf16_f32 v140, v84, v85
    v_cvt_pk_bf16_f32 v141, v86, v87
    v_cvt_pk_bf16_f32 v142, v92, v93
    v_cvt_pk_bf16_f32 v143, v94, v95
    buffer_store_dwordx4 v[140:143], v245, s[40:43], s67 offen offset:3072
    s_nop 1
    s_waitcnt vmcnt(0)
K1_END:
    s_endpgm
K1_SLOW1:
    s_nop 7
    s_nop 3
    v_max3_f32 v246, v160, v161, v162
    v_max3_f32 v247, v163, v168, v169
    v_max3_f32 v246, v246, v170, v171
    v_max_f32 v246, v246, v247
    v_mov_b32 v247, v246
    v_max3_f32 v248, v164, v165, v166
    v_max3_f32 v249, v167, v172, v173
    v_max3_f32 v248, v248, v174, v175
    v_max_f32 v248, v248, v249
    v_mov_b32 v249, v248
    s_nop 1
    v_permlane32_swap_b32 v246, v247
    v_permlane32_swap_b32 v248, v249
    s_nop 0
    v_max_f32 v246, v246, v247
    v_mov_b32 v247, v246
    v_max_f32 v248, v248, v249
    v_mov_b32 v249, v248
    s_nop 1
    v_permlane16_swap_b32 v246, v247
    v_permlane16_swap_b32 v248, v249
    s_nop 0
    v_max_f32 v246, v246, v247
    v_max_f32 v246, 0, v246
    v_sub_f32 v160, v160, v246
    v_sub_f32 v161, v161, v246
    v_sub_f32 v162, v162, v246
    v_sub_f32 v163, v163, v246
    v_sub_f32 v168, v168, v246
    v_sub_f32 v169, v169, v246
    v_sub_f32 v170, v170, v246
    v_sub_f32 v171, v171, v246
    v_sub_f32 v216, v216, v246
    v_mov_b32 v217, v216
    v_mov_b32 v218, v216
    v_mov_b32 v219, v216
    v_sub_f32 v247, 0, v246
    v_exp_f32 v247, v247
    s_nop 0
    v_mul_f32 v224, v224, v247
    v_mul_f32 v0, v0, v247
    v_mul_f32 v1, v1, v247
    v_mul_f32 v2, v2, v247
    v_mul_f32 v3, v3, v247
    v_mul_f32 v8, v8, v247
    v_mul_f32 v9, v9, v247
    v_mul_f32 v10, v10, v247
    v_mul_f32 v11, v11, v247
    v_mul_f32 v16, v16, v247
    v_mul_f32 v17, v17, v247
    v_mul_f32 v18, v18, v247
    v_mul_f32 v19, v19, v247
    v_mul_f32 v24, v24, v247
    v_mul_f32 v25, v25, v247
    v_mul_f32 v26, v26, v247
    v_mul_f32 v27, v27, v247
    v_mul_f32 v32, v32, v247
    v_mul_f32 v33, v33, v247
    v_mul_f32 v34, v34, v247
    v_mul_f32 v35, v35, v247
    v_mul_f32 v40, v40, v247
    v_mul_f32 v41, v41, v247
    v_mul_f32 v42, v42, v247
    v_mul_f32 v43, v43, v247
    v_mul_f32 v48, v48, v247
    v_mul_f32 v49, v49, v247
    v_mul_f32 v50, v50, v247
    v_mul_f32 v51, v51, v247
    v_mul_f32 v56, v56, v247
    v_mul_f32 v57, v57, v247
    v_mul_f32 v58, v58, v247
    v_mul_f32 v59, v59, v247
    v_mul_f32 v64, v64, v247
    v_mul_f32 v65, v65, v247
    v_mul_f32 v66, v66, v247
    v_mul_f32 v67, v67, v247
    v_mul_f32 v72, v72, v247
    v_mul_f32 v73, v73, v247
    v_mul_f32 v74, v74, v247
    v_mul_f32 v75, v75, v247
    v_mul_f32 v80, v80, v247
    v_mul_f32 v81, v81, v247
    v_mul_f32 v82, v82, v247
    v_mul_f32 v83, v83, v247
    v_mul_f32 v88, v88, v247
    v_mul_f32 v89, v89, v247
    v_mul_f32 v90, v90, v247
    v_mul_f32 v91, v91, v247
    v_max_f32 v248, v248, v249
    v_max_f32 v248, 0, v248
    v_sub_f32 v164, v164, v248
    v_sub_f32 v165, v165, v248
    v_sub_f32 v166, v166, v248
    v_sub_f32 v167, v167, v248
    v_sub_f32 v172, v172, v248
    v_sub_f32 v173, v173, v248
    v_sub_f32 v174, v174, v248
    v_sub_f32 v175, v175, v248
    v_sub_f32 v220, v220, v248
    v_mov_b32 v221, v220
    v_mov_b32 v222, v220
    v_mov_b32 v223, v220
    v_sub_f32 v249, 0, v248
    v_exp_f32 v249, v249
    s_nop 0
    v_mul_f32 v225, v225, v249
    v_mul_f32 v4, v4, v249
    v_mul_f32 v5, v5, v249
    v_mul_f32 v6, v6, v249
    v_mul_f32 v7, v7, v249
    v_mul_f32 v12, v12, v249
    v_mul_f32 v13, v13, v249
    v_mul_f32 v14, v14, v249
    v_mul_f32 v15, v15, v249
    v_mul_f32 v20, v20, v249
    v_mul_f32 v21, v21, v249
    v_mul_f32 v22, v22, v249
    v_mul_f32 v23, v23, v249
    v_mul_f32 v28, v28, v249
    v_mul_f32 v29, v29, v249
    v_mul_f32 v30, v30, v249
    v_mul_f32 v31, v31, v249
    v_mul_f32 v36, v36, v249
    v_mul_f32 v37, v37, v249
    v_mul_f32 v38, v38, v249
    v_mul_f32 v39, v39, v249
    v_mul_f32 v44, v44, v249
    v_mul_f32 v45, v45, v249
    v_mul_f32 v46, v46, v249
    v_mul_f32 v47, v47, v249
    v_mul_f32 v52, v52, v249
    v_mul_f32 v53, v53, v249
    v_mul_f32 v54, v54, v249
    v_mul_f32 v55, v55, v249
    v_mul_f32 v60, v60, v249
    v_mul_f32 v61, v61, v249
    v_mul_f32 v62, v62, v249
    v_mul_f32 v63, v63, v249
    v_mul_f32 v68, v68, v249
    v_mul_f32 v69, v69, v249
    v_mul_f32 v70, v70, v249
    v_mul_f32 v71, v71, v249
    v_mul_f32 v76, v76, v249
    v_mul_f32 v77, v77, v249
    v_mul_f32 v78, v78, v249
    v_mul_f32 v79, v79, v249
    v_mul_f32 v84, v84, v249
    v_mul_f32 v85, v85, v249
    v_mul_f32 v86, v86, v249
    v_mul_f32 v87, v87, v249
    v_mul_f32 v92, v92, v249
    v_mul_f32 v93, v93, v249
    v_mul_f32 v94, v94, v249
    v_mul_f32 v95, v95, v249
    s_nop 1
    s_branch K1_BACK1
K1_SLOW2:
    s_nop 7
    s_nop 3
    v_max3_f32 v246, v144, v145, v146
    v_max3_f32 v247, v147, v152, v153
    v_max3_f32 v246, v246, v154, v155
    v_max_f32 v246, v246, v247
    v_mov_b32 v247, v246
    v_max3_f32 v248, v148, v149, v150
    v_max3_f32 v249, v151, v156, v157
    v_max3_f32 v248, v248, v158, v159
    v_max_f32 v248, v248, v249
    v_mov_b32 v249, v248
    s_nop 1
    v_permlane32_swap_b32 v246, v247
    v_permlane32_swap_b32 v248, v249
    s_nop 0
    v_max_f32 v246, v246, v247
    v_mov_b32 v247, v246
    v_max_f32 v248, v248, v249
    v_mov_b32 v249, v248
    s_nop 1
    v_permlane16_swap_b32 v246, v247
    v_permlane16_swap_b32 v248, v249
    s_nop 0
    v_max_f32 v246, v246, v247
    v_max_f32 v246, 0, v246
    v_sub_f32 v144, v144, v246
    v_sub_f32 v145, v145, v246
    v_sub_f32 v146, v146, v246
    v_sub_f32 v147, v147, v246
    v_sub_f32 v152, v152, v246
    v_sub_f32 v153, v153, v246
    v_sub_f32 v154, v154, v246
    v_sub_f32 v155, v155, v246
    v_sub_f32 v216, v216, v246
    v_mov_b32 v217, v216
    v_mov_b32 v218, v216
    v_mov_b32 v219, v216
    v_sub_f32 v247, 0, v246
    v_exp_f32 v247, v247
    s_nop 0
    v_mul_f32 v224, v224, v247
    v_mul_f32 v0, v0, v247
    v_mul_f32 v1, v1, v247
    v_mul_f32 v2, v2, v247
    v_mul_f32 v3, v3, v247
    v_mul_f32 v8, v8, v247
    v_mul_f32 v9, v9, v247
    v_mul_f32 v10, v10, v247
    v_mul_f32 v11, v11, v247
    v_mul_f32 v16, v16, v247
    v_mul_f32 v17, v17, v247
    v_mul_f32 v18, v18, v247
    v_mul_f32 v19, v19, v247
    v_mul_f32 v24, v24, v247
    v_mul_f32 v25, v25, v247
    v_mul_f32 v26, v26, v247
    v_mul_f32 v27, v27, v247
    v_mul_f32 v32, v32, v247
    v_mul_f32 v33, v33, v247
    v_mul_f32 v34, v34, v247
    v_mul_f32 v35, v35, v247
    v_mul_f32 v40, v40, v247
    v_mul_f32 v41, v41, v247
    v_mul_f32 v42, v42, v247
    v_mul_f32 v43, v43, v247
    v_mul_f32 v48, v48, v247
    v_mul_f32 v49, v49, v247
    v_mul_f32 v50, v50, v247
    v_mul_f32 v51, v51, v247
    v_mul_f32 v56, v56, v247
    v_mul_f32 v57, v57, v247
    v_mul_f32 v58, v58, v247
    v_mul_f32 v59, v59, v247
    v_mul_f32 v64, v64, v247
    v_mul_f32 v65, v65, v247
    v_mul_f32 v66, v66, v247
    v_mul_f32 v67, v67, v247
    v_mul_f32 v72, v72, v247
    v_mul_f32 v73, v73, v247
    v_mul_f32 v74, v74, v247
    v_mul_f32 v75, v75, v247
    v_mul_f32 v80, v80, v247
    v_mul_f32 v81, v81, v247
    v_mul_f32 v82, v82, v247
    v_mul_f32 v83, v83, v247
    v_mul_f32 v88, v88, v247
    v_mul_f32 v89, v89, v247
    v_mul_f32 v90, v90, v247
    v_mul_f32 v91, v91, v247
    v_max_f32 v248, v248, v249
    v_max_f32 v248, 0, v248
    v_sub_f32 v148, v148, v248
    v_sub_f32 v149, v149, v248
    v_sub_f32 v150, v150, v248
    v_sub_f32 v151, v151, v248
    v_sub_f32 v156, v156, v248
    v_sub_f32 v157, v157, v248
    v_sub_f32 v158, v158, v248
    v_sub_f32 v159, v159, v248
    v_sub_f32 v220, v220, v248
    v_mov_b32 v221, v220
    v_mov_b32 v222, v220
    v_mov_b32 v223, v220
    v_sub_f32 v249, 0, v248
    v_exp_f32 v249, v249
    s_nop 0
    v_mul_f32 v225, v225, v249
    v_mul_f32 v4, v4, v249
    v_mul_f32 v5, v5, v249
    v_mul_f32 v6, v6, v249
    v_mul_f32 v7, v7, v249
    v_mul_f32 v12, v12, v249
    v_mul_f32 v13, v13, v249
    v_mul_f32 v14, v14, v249
    v_mul_f32 v15, v15, v249
    v_mul_f32 v20, v20, v249
    v_mul_f32 v21, v21, v249
    v_mul_f32 v22, v22, v249
    v_mul_f32 v23, v23, v249
    v_mul_f32 v28, v28, v249
    v_mul_f32 v29, v29, v249
    v_mul_f32 v30, v30, v249
    v_mul_f32 v31, v31, v249
    v_mul_f32 v36, v36, v249
    v_mul_f32 v37, v37, v249
    v_mul_f32 v38, v38, v249
    v_mul_f32 v39, v39, v249
    v_mul_f32 v44, v44, v249
    v_mul_f32 v45, v45, v249
    v_mul_f32 v46, v46, v249
    v_mul_f32 v47, v47, v249
    v_mul_f32 v52, v52, v249
    v_mul_f32 v53, v53, v249
    v_mul_f32 v54, v54, v249
    v_mul_f32 v55, v55, v249
    v_mul_f32 v60, v60, v249
    v_mul_f32 v61, v61, v249
    v_mul_f32 v62, v62, v249
    v_mul_f32 v63, v63, v249
    v_mul_f32 v68, v68, v249
    v_mul_f32 v69, v69, v249
    v_mul_f32 v70, v70, v249
    v_mul_f32 v71, v71, v249
    v_mul_f32 v76, v76, v249
    v_mul_f32 v77, v77, v249
    v_mul_f32 v78, v78, v249
    v_mul_f32 v79, v79, v249
    v_mul_f32 v84, v84, v249
    v_mul_f32 v85, v85, v249
    v_mul_f32 v86, v86, v249
    v_mul_f32 v87, v87, v249
    v_mul_f32 v92, v92, v249
    v_mul_f32 v93, v93, v249
    v_mul_f32 v94, v94, v249
    v_mul_f32 v95, v95, v249
    s_nop 1
    s_branch K1_BACK2
K1_SLOW3:
    s_nop 7
    s_nop 3
    v_max3_f32 v246, v160, v161, v162
    v_max3_f32 v247, v163, v168, v169
    v_max3_f32 v246, v246, v170, v171
    v_max_f32 v246, v246, v247
    v_mov_b32 v247, v246
    v_max3_f32 v248, v164, v165, v166
    v_max3_f32 v249, v167, v172, v173
    v_max3_f32 v248, v248, v174, v175
    v_max_f32 v248, v248, v249
    v_mov_b32 v249, v248
    s_nop 1
    v_permlane32_swap_b32 v246, v247
    v_permlane32_swap_b32 v248, v249
    s_nop 0
    v_max_f32 v246, v246, v247
    v_mov_b32 v247, v246
    v_max_f32 v248, v248, v249
    v_mov_b32 v249, v248
    s_nop 1
    v_permlane16_swap_b32 v246, v247
    v_permlane16_swap_b32 v248, v249
    s_nop 0
    v_max_f32 v246, v246, v247
    v_max_f32 v246, 0, v246
    v_sub_f32 v160, v160, v246
    v_sub_f32 v161, v161, v246
    v_sub_f32 v162, v162, v246
    v_sub_f32 v163, v163, v246
    v_sub_f32 v168, v168, v246
    v_sub_f32 v169, v169, v246
    v_sub_f32 v170, v170, v246
    v_sub_f32 v171, v171, v246
    v_sub_f32 v216, v216, v246
    v_mov_b32 v217, v216
    v_mov_b32 v218, v216
    v_mov_b32 v219, v216
    v_sub_f32 v247, 0, v246
    v_exp_f32 v247, v247
    s_nop 0
    v_mul_f32 v224, v224, v247
    v_mul_f32 v0, v0, v247
    v_mul_f32 v1, v1, v247
    v_mul_f32 v2, v2, v247
    v_mul_f32 v3, v3, v247
    v_mul_f32 v8, v8, v247
    v_mul_f32 v9, v9, v247
    v_mul_f32 v10, v10, v247
    v_mul_f32 v11, v11, v247
    v_mul_f32 v16, v16, v247
    v_mul_f32 v17, v17, v247
    v_mul_f32 v18, v18, v247
    v_mul_f32 v19, v19, v247
    v_mul_f32 v24, v24, v247
    v_mul_f32 v25, v25, v247
    v_mul_f32 v26, v26, v247
    v_mul_f32 v27, v27, v247
    v_mul_f32 v32, v32, v247
    v_mul_f32 v33, v33, v247
    v_mul_f32 v34, v34, v247
    v_mul_f32 v35, v35, v247
    v_mul_f32 v40, v40, v247
    v_mul_f32 v41, v41, v247
    v_mul_f32 v42, v42, v247
    v_mul_f32 v43, v43, v247
    v_mul_f32 v48, v48, v247
    v_mul_f32 v49, v49, v247
    v_mul_f32 v50, v50, v247
    v_mul_f32 v51, v51, v247
    v_mul_f32 v56, v56, v247
    v_mul_f32 v57, v57, v247
    v_mul_f32 v58, v58, v247
    v_mul_f32 v59, v59, v247
    v_mul_f32 v64, v64, v247
    v_mul_f32 v65, v65, v247
    v_mul_f32 v66, v66, v247
    v_mul_f32 v67, v67, v247
    v_mul_f32 v72, v72, v247
    v_mul_f32 v73, v73, v247
    v_mul_f32 v74, v74, v247
    v_mul_f32 v75, v75, v247
    v_mul_f32 v80, v80, v247
    v_mul_f32 v81, v81, v247
    v_mul_f32 v82, v82, v247
    v_mul_f32 v83, v83, v247
    v_mul_f32 v88, v88, v247
    v_mul_f32 v89, v89, v247
    v_mul_f32 v90, v90, v247
    v_mul_f32 v91, v91, v247
    v_max_f32 v248, v248, v249
    v_max_f32 v248, 0, v248
    v_sub_f32 v164, v164, v248
    v_sub_f32 v165, v165, v248
    v_sub_f32 v166, v166, v248
    v_sub_f32 v167, v167, v248
    v_sub_f32 v172, v172, v248
    v_sub_f32 v173, v173, v248
    v_sub_f32 v174, v174, v248
    v_sub_f32 v175, v175, v248
    v_sub_f32 v220, v220, v248
    v_mov_b32 v221, v220
    v_mov_b32 v222, v220
    v_mov_b32 v223, v220
    v_sub_f32 v249, 0, v248
    v_exp_f32 v249, v249
    s_nop 0
    v_mul_f32 v225, v225, v249
    v_mul_f32 v4, v4, v249
    v_mul_f32 v5, v5, v249
    v_mul_f32 v6, v6, v249
    v_mul_f32 v7, v7, v249
    v_mul_f32 v12, v12, v249
    v_mul_f32 v13, v13, v249
    v_mul_f32 v14, v14, v249
    v_mul_f32 v15, v15, v249
    v_mul_f32 v20, v20, v249
    v_mul_f32 v21, v21, v249
    v_mul_f32 v22, v22, v249
    v_mul_f32 v23, v23, v249
    v_mul_f32 v28, v28, v249
    v_mul_f32 v29, v29, v249
    v_mul_f32 v30, v30, v249
    v_mul_f32 v31, v31, v249
    v_mul_f32 v36, v36, v249
    v_mul_f32 v37, v37, v249
    v_mul_f32 v38, v38, v249
    v_mul_f32 v39, v39, v249
    v_mul_f32 v44, v44, v249
    v_mul_f32 v45, v45, v249
    v_mul_f32 v46, v46, v249
    v_mul_f32 v47, v47, v249
    v_mul_f32 v52, v52, v249
    v_mul_f32 v53, v53, v249
    v_mul_f32 v54, v54, v249
    v_mul_f32 v55, v55, v249
    v_mul_f32 v60, v60, v249
    v_mul_f32 v61, v61, v249
    v_mul_f32 v62, v62, v249
    v_mul_f32 v63, v63, v249
    v_mul_f32 v68, v68, v249
    v_mul_f32 v69, v69, v249
    v_mul_f32 v70, v70, v249
    v_mul_f32 v71, v71, v249
    v_mul_f32 v76, v76, v249
    v_mul_f32 v77, v77, v249
    v_mul_f32 v78, v78, v249
    v_mul_f32 v79, v79, v249
    v_mul_f32 v84, v84, v249
    v_mul_f32 v85, v85, v249
    v_mul_f32 v86, v86, v249
    v_mul_f32 v87, v87, v249
    v_mul_f32 v92, v92, v249
    v_mul_f32 v93, v93, v249
    v_mul_f32 v94, v94, v249
    v_mul_f32 v95, v95, v249
    s_nop 1
    s_branch K1_BACK3
K1_SLOW4:
    s_nop 7
    s_nop 3
    v_max3_f32 v246, v144, v145, v146
    v_max3_f32 v247, v147, v152, v153
    v_max3_f32 v246, v246, v154, v155
    v_max_f32 v246, v246, v247
    v_mov_b32 v247, v246
    v_max3_f32 v248, v148, v149, v150
    v_max3_f32 v249, v151, v156, v157
    v_max3_f32 v248, v248, v158, v159
    v_max_f32 v248, v248, v249
    v_mov_b32 v249, v248
    s_nop 1
    v_permlane32_swap_b32 v246, v247
    v_permlane32_swap_b32 v248, v249
    s_nop 0
    v_max_f32 v246, v246, v247
    v_mov_b32 v247, v246
    v_max_f32 v248, v248, v249
    v_mov_b32 v249, v248
    s_nop 1
    v_permlane16_swap_b32 v246, v247
    v_permlane16_swap_b32 v248, v249
    s_nop 0
    v_max_f32 v246, v246, v247
    v_max_f32 v246, 0, v246
    v_sub_f32 v144, v144, v246
    v_sub_f32 v145, v145, v246
    v_sub_f32 v146, v146, v246
    v_sub_f32 v147, v147, v246
    v_sub_f32 v152, v152, v246
    v_sub_f32 v153, v153, v246
    v_sub_f32 v154, v154, v246
    v_sub_f32 v155, v155, v246
    v_sub_f32 v216, v216, v246
    v_mov_b32 v217, v216
    v_mov_b32 v218, v216
    v_mov_b32 v219, v216
    v_sub_f32 v247, 0, v246
    v_exp_f32 v247, v247
    s_nop 0
    v_mul_f32 v224, v224, v247
    v_mul_f32 v0, v0, v247
    v_mul_f32 v1, v1, v247
    v_mul_f32 v2, v2, v247
    v_mul_f32 v3, v3, v247
    v_mul_f32 v8, v8, v247
    v_mul_f32 v9, v9, v247
    v_mul_f32 v10, v10, v247
    v_mul_f32 v11, v11, v247
    v_mul_f32 v16, v16, v247
    v_mul_f32 v17, v17, v247
    v_mul_f32 v18, v18, v247
    v_mul_f32 v19, v19, v247
    v_mul_f32 v24, v24, v247
    v_mul_f32 v25, v25, v247
    v_mul_f32 v26, v26, v247
    v_mul_f32 v27, v27, v247
    v_mul_f32 v32, v32, v247
    v_mul_f32 v33, v33, v247
    v_mul_f32 v34, v34, v247
    v_mul_f32 v35, v35, v247
    v_mul_f32 v40, v40, v247
    v_mul_f32 v41, v41, v247
    v_mul_f32 v42, v42, v247
    v_mul_f32 v43, v43, v247
    v_mul_f32 v48, v48, v247
    v_mul_f32 v49, v49, v247
    v_mul_f32 v50, v50, v247
    v_mul_f32 v51, v51, v247
    v_mul_f32 v56, v56, v247
    v_mul_f32 v57, v57, v247
    v_mul_f32 v58, v58, v247
    v_mul_f32 v59, v59, v247
    v_mul_f32 v64, v64, v247
    v_mul_f32 v65, v65, v247
    v_mul_f32 v66, v66, v247
    v_mul_f32 v67, v67, v247
    v_mul_f32 v72, v72, v247
    v_mul_f32 v73, v73, v247
    v_mul_f32 v74, v74, v247
    v_mul_f32 v75, v75, v247
    v_mul_f32 v80, v80, v247
    v_mul_f32 v81, v81, v247
    v_mul_f32 v82, v82, v247
    v_mul_f32 v83, v83, v247
    v_mul_f32 v88, v88, v247
    v_mul_f32 v89, v89, v247
    v_mul_f32 v90, v90, v247
    v_mul_f32 v91, v91, v247
    v_max_f32 v248, v248, v249
    v_max_f32 v248, 0, v248
    v_sub_f32 v148, v148, v248
    v_sub_f32 v149, v149, v248
    v_sub_f32 v150, v150, v248
    v_sub_f32 v151, v151, v248
    v_sub_f32 v156, v156, v248
    v_sub_f32 v157, v157, v248
    v_sub_f32 v158, v158, v248
    v_sub_f32 v159, v159, v248
    v_sub_f32 v220, v220, v248
    v_mov_b32 v221, v220
    v_mov_b32 v222, v220
    v_mov_b32 v223, v220
    v_sub_f32 v249, 0, v248
    v_exp_f32 v249, v249
    s_nop 0
    v_mul_f32 v225, v225, v249
    v_mul_f32 v4, v4, v249
    v_mul_f32 v5, v5, v249
    v_mul_f32 v6, v6, v249
    v_mul_f32 v7, v7, v249
    v_mul_f32 v12, v12, v249
    v_mul_f32 v13, v13, v249
    v_mul_f32 v14, v14, v249
    v_mul_f32 v15, v15, v249
    v_mul_f32 v20, v20, v249
    v_mul_f32 v21, v21, v249
    v_mul_f32 v22, v22, v249
    v_mul_f32 v23, v23, v249
    v_mul_f32 v28, v28, v249
    v_mul_f32 v29, v29, v249
    v_mul_f32 v30, v30, v249
    v_mul_f32 v31, v31, v249
    v_mul_f32 v36, v36, v249
    v_mul_f32 v37, v37, v249
    v_mul_f32 v38, v38, v249
    v_mul_f32 v39, v39, v249
    v_mul_f32 v44, v44, v249
    v_mul_f32 v45, v45, v249
    v_mul_f32 v46, v46, v249
    v_mul_f32 v47, v47, v249
    v_mul_f32 v52, v52, v249
    v_mul_f32 v53, v53, v249
    v_mul_f32 v54, v54, v249
    v_mul_f32 v55, v55, v249
    v_mul_f32 v60, v60, v249
    v_mul_f32 v61, v61, v249
    v_mul_f32 v62, v62, v249
    v_mul_f32 v63, v63, v249
    v_mul_f32 v68, v68, v249
    v_mul_f32 v69, v69, v249
    v_mul_f32 v70, v70, v249
    v_mul_f32 v71, v71, v249
    v_mul_f32 v76, v76, v249
    v_mul_f32 v77, v77, v249
    v_mul_f32 v78, v78, v249
    v_mul_f32 v79, v79, v249
    v_mul_f32 v84, v84, v249
    v_mul_f32 v85, v85, v249
    v_mul_f32 v86, v86, v249
    v_mul_f32 v87, v87, v249
    v_mul_f32 v92, v92, v249
    v_mul_f32 v93, v93, v249
    v_mul_f32 v94, v94, v249
    v_mul_f32 v95, v95, v249
    s_nop 1
    s_branch K1_BACK4
K1_SLOW5:
    s_nop 7
    s_nop 3
    v_max3_f32 v246, v160, v161, v162
    v_max3_f32 v247, v163, v168, v169
    v_max3_f32 v246, v246, v170, v171
    v_max_f32 v246, v246, v247
    v_mov_b32 v247, v246
    v_max3_f32 v248, v164, v165, v166
    v_max3_f32 v249, v167, v172, v173
    v_max3_f32 v248, v248, v174, v175
    v_max_f32 v248, v248, v249
    v_mov_b32 v249, v248
    s_nop 1
    v_permlane32_swap_b32 v246, v247
    v_permlane32_swap_b32 v248, v249
    s_nop 0
    v_max_f32 v246, v246, v247
    v_mov_b32 v247, v246
    v_max_f32 v248, v248, v249
    v_mov_b32 v249, v248
    s_nop 1
    v_permlane16_swap_b32 v246, v247
    v_permlane16_swap_b32 v248, v249
    s_nop 0
    v_max_f32 v246, v246, v247
    v_max_f32 v246, 0, v246
    v_sub_f32 v160, v160, v246
    v_sub_f32 v161, v161, v246
    v_sub_f32 v162, v162, v246
    v_sub_f32 v163, v163, v246
    v_sub_f32 v168, v168, v246
    v_sub_f32 v169, v169, v246
    v_sub_f32 v170, v170, v246
    v_sub_f32 v171, v171, v246
    v_sub_f32 v216, v216, v246
    v_mov_b32 v217, v216
    v_mov_b32 v218, v216
    v_mov_b32 v219, v216
    v_sub_f32 v247, 0, v246
    v_exp_f32 v247, v247
    s_nop 0
    v_mul_f32 v224, v224, v247
    v_mul_f32 v0, v0, v247
    v_mul_f32 v1, v1, v247
    v_mul_f32 v2, v2, v247
    v_mul_f32 v3, v3, v247
    v_mul_f32 v8, v8, v247
    v_mul_f32 v9, v9, v247
    v_mul_f32 v10, v10, v247
    v_mul_f32 v11, v11, v247
    v_mul_f32 v16, v16, v247
    v_mul_f32 v17, v17, v247
    v_mul_f32 v18, v18, v247
    v_mul_f32 v19, v19, v247
    v_mul_f32 v24, v24, v247
    v_mul_f32 v25, v25, v247
    v_mul_f32 v26, v26, v247
    v_mul_f32 v27, v27, v247
    v_mul_f32 v32, v32, v247
    v_mul_f32 v33, v33, v247
    v_mul_f32 v34, v34, v247
    v_mul_f32 v35, v35, v247
    v_mul_f32 v40, v40, v247
    v_mul_f32 v41, v41, v247
    v_mul_f32 v42, v42, v247
    v_mul_f32 v43, v43, v247
    v_mul_f32 v48, v48, v247
    v_mul_f32 v49, v49, v247
    v_mul_f32 v50, v50, v247
    v_mul_f32 v51, v51, v247
    v_mul_f32 v56, v56, v247
    v_mul_f32 v57, v57, v247
    v_mul_f32 v58, v58, v247
    v_mul_f32 v59, v59, v247
    v_mul_f32 v64, v64, v247
    v_mul_f32 v65, v65, v247
    v_mul_f32 v66, v66, v247
    v_mul_f32 v67, v67, v247
    v_mul_f32 v72, v72, v247
    v_mul_f32 v73, v73, v247
    v_mul_f32 v74, v74, v247
    v_mul_f32 v75, v75, v247
    v_mul_f32 v80, v80, v247
    v_mul_f32 v81, v81, v247
    v_mul_f32 v82, v82, v247
    v_mul_f32 v83, v83, v247
    v_mul_f32 v88, v88, v247
    v_mul_f32 v89, v89, v247
    v_mul_f32 v90, v90, v247
    v_mul_f32 v91, v91, v247
    v_max_f32 v248, v248, v249
    v_max_f32 v248, 0, v248
    v_sub_f32 v164, v164, v248
    v_sub_f32 v165, v165, v248
    v_sub_f32 v166, v166, v248
    v_sub_f32 v167, v167, v248
    v_sub_f32 v172, v172, v248
    v_sub_f32 v173, v173, v248
    v_sub_f32 v174, v174, v248
    v_sub_f32 v175, v175, v248
    v_sub_f32 v220, v220, v248
    v_mov_b32 v221, v220
    v_mov_b32 v222, v220
    v_mov_b32 v223, v220
    v_sub_f32 v249, 0, v248
    v_exp_f32 v249, v249
    s_nop 0
    v_mul_f32 v225, v225, v249
    v_mul_f32 v4, v4, v249
    v_mul_f32 v5, v5, v249
    v_mul_f32 v6, v6, v249
    v_mul_f32 v7, v7, v249
    v_mul_f32 v12, v12, v249
    v_mul_f32 v13, v13, v249
    v_mul_f32 v14, v14, v249
    v_mul_f32 v15, v15, v249
    v_mul_f32 v20, v20, v249
    v_mul_f32 v21, v21, v249
    v_mul_f32 v22, v22, v249
    v_mul_f32 v23, v23, v249
    v_mul_f32 v28, v28, v249
    v_mul_f32 v29, v29, v249
    v_mul_f32 v30, v30, v249
    v_mul_f32 v31, v31, v249
    v_mul_f32 v36, v36, v249
    v_mul_f32 v37, v37, v249
    v_mul_f32 v38, v38, v249
    v_mul_f32 v39, v39, v249
    v_mul_f32 v44, v44, v249
    v_mul_f32 v45, v45, v249
    v_mul_f32 v46, v46, v249
    v_mul_f32 v47, v47, v249
    v_mul_f32 v52, v52, v249
    v_mul_f32 v53, v53, v249
    v_mul_f32 v54, v54, v249
    v_mul_f32 v55, v55, v249
    v_mul_f32 v60, v60, v249
    v_mul_f32 v61, v61, v249
    v_mul_f32 v62, v62, v249
    v_mul_f32 v63, v63, v249
    v_mul_f32 v68, v68, v249
    v_mul_f32 v69, v69, v249
    v_mul_f32 v70, v70, v249
    v_mul_f32 v71, v71, v249
    v_mul_f32 v76, v76, v249
    v_mul_f32 v77, v77, v249
    v_mul_f32 v78, v78, v249
    v_mul_f32 v79, v79, v249
    v_mul_f32 v84, v84, v249
    v_mul_f32 v85, v85, v249
    v_mul_f32 v86, v86, v249
    v_mul_f32 v87, v87, v249
    v_mul_f32 v92, v92, v249
    v_mul_f32 v93, v93, v249
    v_mul_f32 v94, v94, v249
    v_mul_f32 v95, v95, v249
    s_nop 1
    s_branch K1_BACK5
K1_SLOW6:
    s_nop 7
    s_nop 3
    v_max3_f32 v246, v144, v145, v146
    v_max3_f32 v247, v147, v152, v153
    v_max3_f32 v246, v246, v154, v155
    v_max_f32 v246, v246, v247
    v_mov_b32 v247, v246
    v_max3_f32 v248, v148, v149, v150
    v_max3_f32 v249, v151, v156, v157
    v_max3_f32 v248, v248, v158, v159
    v_max_f32 v248, v248, v249
    v_mov_b32 v249, v248
    s_nop 1
    v_permlane32_swap_b32 v246, v247
    v_permlane32_swap_b32 v248, v249
    s_nop 0
    v_max_f32 v246, v246, v247
    v_mov_b32 v247, v246
    v_max_f32 v248, v248, v249
    v_mov_b32 v249, v248
    s_nop 1
    v_permlane16_swap_b32 v246, v247
    v_permlane16_swap_b32 v248, v249
    s_nop 0
    v_max_f32 v246, v246, v247
    v_max_f32 v246, 0, v246
    v_sub_f32 v144, v144, v246
    v_sub_f32 v145, v145, v246
    v_sub_f32 v146, v146, v246
    v_sub_f32 v147, v147, v246
    v_sub_f32 v152, v152, v246
    v_sub_f32 v153, v153, v246
    v_sub_f32 v154, v154, v246
    v_sub_f32 v155, v155, v246
    v_sub_f32 v216, v216, v246
    v_mov_b32 v217, v216
    v_mov_b32 v218, v216
    v_mov_b32 v219, v216
    v_sub_f32 v247, 0, v246
    v_exp_f32 v247, v247
    s_nop 0
    v_mul_f32 v224, v224, v247
    v_mul_f32 v0, v0, v247
    v_mul_f32 v1, v1, v247
    v_mul_f32 v2, v2, v247
    v_mul_f32 v3, v3, v247
    v_mul_f32 v8, v8, v247
    v_mul_f32 v9, v9, v247
    v_mul_f32 v10, v10, v247
    v_mul_f32 v11, v11, v247
    v_mul_f32 v16, v16, v247
    v_mul_f32 v17, v17, v247
    v_mul_f32 v18, v18, v247
    v_mul_f32 v19, v19, v247
    v_mul_f32 v24, v24, v247
    v_mul_f32 v25, v25, v247
    v_mul_f32 v26, v26, v247
    v_mul_f32 v27, v27, v247
    v_mul_f32 v32, v32, v247
    v_mul_f32 v33, v33, v247
    v_mul_f32 v34, v34, v247
    v_mul_f32 v35, v35, v247
    v_mul_f32 v40, v40, v247
    v_mul_f32 v41, v41, v247
    v_mul_f32 v42, v42, v247
    v_mul_f32 v43, v43, v247
    v_mul_f32 v48, v48, v247
    v_mul_f32 v49, v49, v247
    v_mul_f32 v50, v50, v247
    v_mul_f32 v51, v51, v247
    v_mul_f32 v56, v56, v247
    v_mul_f32 v57, v57, v247
    v_mul_f32 v58, v58, v247
    v_mul_f32 v59, v59, v247
    v_mul_f32 v64, v64, v247
    v_mul_f32 v65, v65, v247
    v_mul_f32 v66, v66, v247
    v_mul_f32 v67, v67, v247
    v_mul_f32 v72, v72, v247
    v_mul_f32 v73, v73, v247
    v_mul_f32 v74, v74, v247
    v_mul_f32 v75, v75, v247
    v_mul_f32 v80, v80, v247
    v_mul_f32 v81, v81, v247
    v_mul_f32 v82, v82, v247
    v_mul_f32 v83, v83, v247
    v_mul_f32 v88, v88, v247
    v_mul_f32 v89, v89, v247
    v_mul_f32 v90, v90, v247
    v_mul_f32 v91, v91, v247
    v_max_f32 v248, v248, v249
    v_max_f32 v248, 0, v248
    v_sub_f32 v148, v148, v248
    v_sub_f32 v149, v149, v248
    v_sub_f32 v150, v150, v248
    v_sub_f32 v151, v151, v248
    v_sub_f32 v156, v156, v248
    v_sub_f32 v157, v157, v248
    v_sub_f32 v158, v158, v248
    v_sub_f32 v159, v159, v248
    v_sub_f32 v220, v220, v248
    v_mov_b32 v221, v220
    v_mov_b32 v222, v220
    v_mov_b32 v223, v220
    v_sub_f32 v249, 0, v248
    v_exp_f32 v249, v249
    s_nop 0
    v_mul_f32 v225, v225, v249
    v_mul_f32 v4, v4, v249
    v_mul_f32 v5, v5, v249
    v_mul_f32 v6, v6, v249
    v_mul_f32 v7, v7, v249
    v_mul_f32 v12, v12, v249
    v_mul_f32 v13, v13, v249
    v_mul_f32 v14, v14, v249
    v_mul_f32 v15, v15, v249
    v_mul_f32 v20, v20, v249
    v_mul_f32 v21, v21, v249
    v_mul_f32 v22, v22, v249
    v_mul_f32 v23, v23, v249
    v_mul_f32 v28, v28, v249
    v_mul_f32 v29, v29, v249
    v_mul_f32 v30, v30, v249
    v_mul_f32 v31, v31, v249
    v_mul_f32 v36, v36, v249
    v_mul_f32 v37, v37, v249
    v_mul_f32 v38, v38, v249
    v_mul_f32 v39, v39, v249
    v_mul_f32 v44, v44, v249
    v_mul_f32 v45, v45, v249
    v_mul_f32 v46, v46, v249
    v_mul_f32 v47, v47, v249
    v_mul_f32 v52, v52, v249
    v_mul_f32 v53, v53, v249
    v_mul_f32 v54, v54, v249
    v_mul_f32 v55, v55, v249
    v_mul_f32 v60, v60, v249
    v_mul_f32 v61, v61, v249
    v_mul_f32 v62, v62, v249
    v_mul_f32 v63, v63, v249
    v_mul_f32 v68, v68, v249
    v_mul_f32 v69, v69, v249
    v_mul_f32 v70, v70, v249
    v_mul_f32 v71, v71, v249
    v_mul_f32 v76, v76, v249
    v_mul_f32 v77, v77, v249
    v_mul_f32 v78, v78, v249
    v_mul_f32 v79, v79, v249
    v_mul_f32 v84, v84, v249
    v_mul_f32 v85, v85, v249
    v_mul_f32 v86, v86, v249
    v_mul_f32 v87, v87, v249
    v_mul_f32 v92, v92, v249
    v_mul_f32 v93, v93, v249
    v_mul_f32 v94, v94, v249
    v_mul_f32 v95, v95, v249
    s_nop 1
    s_branch K1_BACK6
K1_SLOW7:
    s_nop 7
    s_nop 3
    v_max3_f32 v246, v160, v161, v162
    v_max3_f32 v247, v163, v168, v169
    v_max3_f32 v246, v246, v170, v171
    v_max_f32 v246, v246, v247
    v_mov_b32 v247, v246
    v_max3_f32 v248, v164, v165, v166
    v_max3_f32 v249, v167, v172, v173
    v_max3_f32 v248, v248, v174, v175
    v_max_f32 v248, v248, v249
    v_mov_b32 v249, v248
    s_nop 1
    v_permlane32_swap_b32 v246, v247
    v_permlane32_swap_b32 v248, v249
    s_nop 0
    v_max_f32 v246, v246, v247
    v_mov_b32 v247, v246
    v_max_f32 v248, v248, v249
    v_mov_b32 v249, v248
    s_nop 1
    v_permlane16_swap_b32 v246, v247
    v_permlane16_swap_b32 v248, v249
    s_nop 0
    v_max_f32 v246, v246, v247
    v_max_f32 v246, 0, v246
    v_sub_f32 v160, v160, v246
    v_sub_f32 v161, v161, v246
    v_sub_f32 v162, v162, v246
    v_sub_f32 v163, v163, v246
    v_sub_f32 v168, v168, v246
    v_sub_f32 v169, v169, v246
    v_sub_f32 v170, v170, v246
    v_sub_f32 v171, v171, v246
    v_sub_f32 v216, v216, v246
    v_mov_b32 v217, v216
    v_mov_b32 v218, v216
    v_mov_b32 v219, v216
    v_sub_f32 v247, 0, v246
    v_exp_f32 v247, v247
    s_nop 0
    v_mul_f32 v224, v224, v247
    v_mul_f32 v0, v0, v247
    v_mul_f32 v1, v1, v247
    v_mul_f32 v2, v2, v247
    v_mul_f32 v3, v3, v247
    v_mul_f32 v8, v8, v247
    v_mul_f32 v9, v9, v247
    v_mul_f32 v10, v10, v247
    v_mul_f32 v11, v11, v247
    v_mul_f32 v16, v16, v247
    v_mul_f32 v17, v17, v247
    v_mul_f32 v18, v18, v247
    v_mul_f32 v19, v19, v247
    v_mul_f32 v24, v24, v247
    v_mul_f32 v25, v25, v247
    v_mul_f32 v26, v26, v247
    v_mul_f32 v27, v27, v247
    v_mul_f32 v32, v32, v247
    v_mul_f32 v33, v33, v247
    v_mul_f32 v34, v34, v247
    v_mul_f32 v35, v35, v247
    v_mul_f32 v40, v40, v247
    v_mul_f32 v41, v41, v247
    v_mul_f32 v42, v42, v247
    v_mul_f32 v43, v43, v247
    v_mul_f32 v48, v48, v247
    v_mul_f32 v49, v49, v247
    v_mul_f32 v50, v50, v247
    v_mul_f32 v51, v51, v247
    v_mul_f32 v56, v56, v247
    v_mul_f32 v57, v57, v247
    v_mul_f32 v58, v58, v247
    v_mul_f32 v59, v59, v247
    v_mul_f32 v64, v64, v247
    v_mul_f32 v65, v65, v247
    v_mul_f32 v66, v66, v247
    v_mul_f32 v67, v67, v247
    v_mul_f32 v72, v72, v247
    v_mul_f32 v73, v73, v247
    v_mul_f32 v74, v74, v247
    v_mul_f32 v75, v75, v247
    v_mul_f32 v80, v80, v247
    v_mul_f32 v81, v81, v247
    v_mul_f32 v82, v82, v247
    v_mul_f32 v83, v83, v247
    v_mul_f32 v88, v88, v247
    v_mul_f32 v89, v89, v247
    v_mul_f32 v90, v90, v247
    v_mul_f32 v91, v91, v247
    v_max_f32 v248, v248, v249
    v_max_f32 v248, 0, v248
    v_sub_f32 v164, v164, v248
    v_sub_f32 v165, v165, v248
    v_sub_f32 v166, v166, v248
    v_sub_f32 v167, v167, v248
    v_sub_f32 v172, v172, v248
    v_sub_f32 v173, v173, v248
    v_sub_f32 v174, v174, v248
    v_sub_f32 v175, v175, v248
    v_sub_f32 v220, v220, v248
    v_mov_b32 v221, v220
    v_mov_b32 v222, v220
    v_mov_b32 v223, v220
    v_sub_f32 v249, 0, v248
    v_exp_f32 v249, v249
    s_nop 0
    v_mul_f32 v225, v225, v249
    v_mul_f32 v4, v4, v249
    v_mul_f32 v5, v5, v249
    v_mul_f32 v6, v6, v249
    v_mul_f32 v7, v7, v249
    v_mul_f32 v12, v12, v249
    v_mul_f32 v13, v13, v249
    v_mul_f32 v14, v14, v249
    v_mul_f32 v15, v15, v249
    v_mul_f32 v20, v20, v249
    v_mul_f32 v21, v21, v249
    v_mul_f32 v22, v22, v249
    v_mul_f32 v23, v23, v249
    v_mul_f32 v28, v28, v249
    v_mul_f32 v29, v29, v249
    v_mul_f32 v30, v30, v249
    v_mul_f32 v31, v31, v249
    v_mul_f32 v36, v36, v249
    v_mul_f32 v37, v37, v249
    v_mul_f32 v38, v38, v249
    v_mul_f32 v39, v39, v249
    v_mul_f32 v44, v44, v249
    v_mul_f32 v45, v45, v249
    v_mul_f32 v46, v46, v249
    v_mul_f32 v47, v47, v249
    v_mul_f32 v52, v52, v249
    v_mul_f32 v53, v53, v249
    v_mul_f32 v54, v54, v249
    v_mul_f32 v55, v55, v249
    v_mul_f32 v60, v60, v249
    v_mul_f32 v61, v61, v249
    v_mul_f32 v62, v62, v249
    v_mul_f32 v63, v63, v249
    v_mul_f32 v68, v68, v249
    v_mul_f32 v69, v69, v249
    v_mul_f32 v70, v70, v249
    v_mul_f32 v71, v71, v249
    v_mul_f32 v76, v76, v249
    v_mul_f32 v77, v77, v249
    v_mul_f32 v78, v78, v249
    v_mul_f32 v79, v79, v249
    v_mul_f32 v84, v84, v249
    v_mul_f32 v85, v85, v249
    v_mul_f32 v86, v86, v249
    v_mul_f32 v87, v87, v249
    v_mul_f32 v92, v92, v249
    v_mul_f32 v93, v93, v249
    v_mul_f32 v94, v94, v249
    v_mul_f32 v95, v95, v249
    s_nop 1
    s_branch K1_BACK7
K1_SLOW8:
    s_nop 7
    s_nop 3
    v_max3_f32 v246, v144, v145, v146
    v_max3_f32 v247, v147, v152, v153
    v_max3_f32 v246, v246, v154, v155
    v_max_f32 v246, v246, v247
    v_mov_b32 v247, v246
    v_max3_f32 v248, v148, v149, v150
    v_max3_f32 v249, v151, v156, v157
    v_max3_f32 v248, v248, v158, v159
    v_max_f32 v248, v248, v249
    v_mov_b32 v249, v248
    s_nop 1
    v_permlane32_swap_b32 v246, v247
    v_permlane32_swap_b32 v248, v249
    s_nop 0
    v_max_f32 v246, v246, v247
    v_mov_b32 v247, v246
    v_max_f32 v248, v248, v249
    v_mov_b32 v249, v248
    s_nop 1
    v_permlane16_swap_b32 v246, v247
    v_permlane16_swap_b32 v248, v249
    s_nop 0
    v_max_f32 v246, v246, v247
    v_max_f32 v246, 0, v246
    v_sub_f32 v144, v144, v246
    v_sub_f32 v145, v145, v246
    v_sub_f32 v146, v146, v246
    v_sub_f32 v147, v147, v246
    v_sub_f32 v152, v152, v246
    v_sub_f32 v153, v153, v246
    v_sub_f32 v154, v154, v246
    v_sub_f32 v155, v155, v246
    v_sub_f32 v216, v216, v246
    v_mov_b32 v217, v216
    v_mov_b32 v218, v216
    v_mov_b32 v219, v216
    v_sub_f32 v247, 0, v246
    v_exp_f32 v247, v247
    s_nop 0
    v_mul_f32 v224, v224, v247
    v_mul_f32 v0, v0, v247
    v_mul_f32 v1, v1, v247
    v_mul_f32 v2, v2, v247
    v_mul_f32 v3, v3, v247
    v_mul_f32 v8, v8, v247
    v_mul_f32 v9, v9, v247
    v_mul_f32 v10, v10, v247
    v_mul_f32 v11, v11, v247
    v_mul_f32 v16, v16, v247
    v_mul_f32 v17, v17, v247
    v_mul_f32 v18, v18, v247
    v_mul_f32 v19, v19, v247
    v_mul_f32 v24, v24, v247
    v_mul_f32 v25, v25, v247
    v_mul_f32 v26, v26, v247
    v_mul_f32 v27, v27, v247
    v_mul_f32 v32, v32, v247
    v_mul_f32 v33, v33, v247
    v_mul_f32 v34, v34, v247
    v_mul_f32 v35, v35, v247
    v_mul_f32 v40, v40, v247
    v_mul_f32 v41, v41, v247
    v_mul_f32 v42, v42, v247
    v_mul_f32 v43, v43, v247
    v_mul_f32 v48, v48, v247
    v_mul_f32 v49, v49, v247
    v_mul_f32 v50, v50, v247
    v_mul_f32 v51, v51, v247
    v_mul_f32 v56, v56, v247
    v_mul_f32 v57, v57, v247
    v_mul_f32 v58, v58, v247
    v_mul_f32 v59, v59, v247
    v_mul_f32 v64, v64, v247
    v_mul_f32 v65, v65, v247
    v_mul_f32 v66, v66, v247
    v_mul_f32 v67, v67, v247
    v_mul_f32 v72, v72, v247
    v_mul_f32 v73, v73, v247
    v_mul_f32 v74, v74, v247
    v_mul_f32 v75, v75, v247
    v_mul_f32 v80, v80, v247
    v_mul_f32 v81, v81, v247
    v_mul_f32 v82, v82, v247
    v_mul_f32 v83, v83, v247
    v_mul_f32 v88, v88, v247
    v_mul_f32 v89, v89, v247
    v_mul_f32 v90, v90, v247
    v_mul_f32 v91, v91, v247
    v_max_f32 v248, v248, v249
    v_max_f32 v248, 0, v248
    v_sub_f32 v148, v148, v248
    v_sub_f32 v149, v149, v248
    v_sub_f32 v150, v150, v248
    v_sub_f32 v151, v151, v248
    v_sub_f32 v156, v156, v248
    v_sub_f32 v157, v157, v248
    v_sub_f32 v158, v158, v248
    v_sub_f32 v159, v159, v248
    v_sub_f32 v220, v220, v248
    v_mov_b32 v221, v220
    v_mov_b32 v222, v220
    v_mov_b32 v223, v220
    v_sub_f32 v249, 0, v248
    v_exp_f32 v249, v249
    s_nop 0
    v_mul_f32 v225, v225, v249
    v_mul_f32 v4, v4, v249
    v_mul_f32 v5, v5, v249
    v_mul_f32 v6, v6, v249
    v_mul_f32 v7, v7, v249
    v_mul_f32 v12, v12, v249
    v_mul_f32 v13, v13, v249
    v_mul_f32 v14, v14, v249
    v_mul_f32 v15, v15, v249
    v_mul_f32 v20, v20, v249
    v_mul_f32 v21, v21, v249
    v_mul_f32 v22, v22, v249
    v_mul_f32 v23, v23, v249
    v_mul_f32 v28, v28, v249
    v_mul_f32 v29, v29, v249
    v_mul_f32 v30, v30, v249
    v_mul_f32 v31, v31, v249
    v_mul_f32 v36, v36, v249
    v_mul_f32 v37, v37, v249
    v_mul_f32 v38, v38, v249
    v_mul_f32 v39, v39, v249
    v_mul_f32 v44, v44, v249
    v_mul_f32 v45, v45, v249
    v_mul_f32 v46, v46, v249
    v_mul_f32 v47, v47, v249
    v_mul_f32 v52, v52, v249
    v_mul_f32 v53, v53, v249
    v_mul_f32 v54, v54, v249
    v_mul_f32 v55, v55, v249
    v_mul_f32 v60, v60, v249
    v_mul_f32 v61, v61, v249
    v_mul_f32 v62, v62, v249
    v_mul_f32 v63, v63, v249
    v_mul_f32 v68, v68, v249
    v_mul_f32 v69, v69, v249
    v_mul_f32 v70, v70, v249
    v_mul_f32 v71, v71, v249
    v_mul_f32 v76, v76, v249
    v_mul_f32 v77, v77, v249
    v_mul_f32 v78, v78, v249
    v_mul_f32 v79, v79, v249
    v_mul_f32 v84, v84, v249
    v_mul_f32 v85, v85, v249
    v_mul_f32 v86, v86, v249
    v_mul_f32 v87, v87, v249
    v_mul_f32 v92, v92, v249
    v_mul_f32 v93, v93, v249
    v_mul_f32 v94, v94, v249
    v_mul_f32 v95, v95, v249
    s_nop 1
    s_branch K1_BACK8
K1_SLOW9:
    s_nop 7
    s_nop 3
    v_max3_f32 v246, v160, v161, v162
    v_max3_f32 v247, v163, v168, v169
    v_max3_f32 v246, v246, v170, v171
    v_max_f32 v246, v246, v247
    v_mov_b32 v247, v246
    v_max3_f32 v248, v164, v165, v166
    v_max3_f32 v249, v167, v172, v173
    v_max3_f32 v248, v248, v174, v175
    v_max_f32 v248, v248, v249
    v_mov_b32 v249, v248
    s_nop 1
    v_permlane32_swap_b32 v246, v247
    v_permlane32_swap_b32 v248, v249
    s_nop 0
    v_max_f32 v246, v246, v247
    v_mov_b32 v247, v246
    v_max_f32 v248, v248, v249
    v_mov_b32 v249, v248
    s_nop 1
    v_permlane16_swap_b32 v246, v247
    v_permlane16_swap_b32 v248, v249
    s_nop 0
    v_max_f32 v246, v246, v247
    v_max_f32 v246, 0, v246
    v_sub_f32 v160, v160, v246
    v_sub_f32 v161, v161, v246
    v_sub_f32 v162, v162, v246
    v_sub_f32 v163, v163, v246
    v_sub_f32 v168, v168, v246
    v_sub_f32 v169, v169, v246
    v_sub_f32 v170, v170, v246
    v_sub_f32 v171, v171, v246
    v_sub_f32 v216, v216, v246
    v_mov_b32 v217, v216
    v_mov_b32 v218, v216
    v_mov_b32 v219, v216
    v_sub_f32 v247, 0, v246
    v_exp_f32 v247, v247
    s_nop 0
    v_mul_f32 v224, v224, v247
    v_mul_f32 v0, v0, v247
    v_mul_f32 v1, v1, v247
    v_mul_f32 v2, v2, v247
    v_mul_f32 v3, v3, v247
    v_mul_f32 v8, v8, v247
    v_mul_f32 v9, v9, v247
    v_mul_f32 v10, v10, v247
    v_mul_f32 v11, v11, v247
    v_mul_f32 v16, v16, v247
    v_mul_f32 v17, v17, v247
    v_mul_f32 v18, v18, v247
    v_mul_f32 v19, v19, v247
    v_mul_f32 v24, v24, v247
    v_mul_f32 v25, v25, v247
    v_mul_f32 v26, v26, v247
    v_mul_f32 v27, v27, v247
    v_mul_f32 v32, v32, v247
    v_mul_f32 v33, v33, v247
    v_mul_f32 v34, v34, v247
    v_mul_f32 v35, v35, v247
    v_mul_f32 v40, v40, v247
    v_mul_f32 v41, v41, v247
    v_mul_f32 v42, v42, v247
    v_mul_f32 v43, v43, v247
    v_mul_f32 v48, v48, v247
    v_mul_f32 v49, v49, v247
    v_mul_f32 v50, v50, v247
    v_mul_f32 v51, v51, v247
    v_mul_f32 v56, v56, v247
    v_mul_f32 v57, v57, v247
    v_mul_f32 v58, v58, v247
    v_mul_f32 v59, v59, v247
    v_mul_f32 v64, v64, v247
    v_mul_f32 v65, v65, v247
    v_mul_f32 v66, v66, v247
    v_mul_f32 v67, v67, v247
    v_mul_f32 v72, v72, v247
    v_mul_f32 v73, v73, v247
    v_mul_f32 v74, v74, v247
    v_mul_f32 v75, v75, v247
    v_mul_f32 v80, v80, v247
    v_mul_f32 v81, v81, v247
    v_mul_f32 v82, v82, v247
    v_mul_f32 v83, v83, v247
    v_mul_f32 v88, v88, v247
    v_mul_f32 v89, v89, v247
    v_mul_f32 v90, v90, v247
    v_mul_f32 v91, v91, v247
    v_max_f32 v248, v248, v249
    v_max_f32 v248, 0, v248
    v_sub_f32 v164, v164, v248
    v_sub_f32 v165, v165, v248
    v_sub_f32 v166, v166, v248
    v_sub_f32 v167, v167, v248
    v_sub_f32 v172, v172, v248
    v_sub_f32 v173, v173, v248
    v_sub_f32 v174, v174, v248
    v_sub_f32 v175, v175, v248
    v_sub_f32 v220, v220, v248
    v_mov_b32 v221, v220
    v_mov_b32 v222, v220
    v_mov_b32 v223, v220
    v_sub_f32 v249, 0, v248
    v_exp_f32 v249, v249
    s_nop 0
    v_mul_f32 v225, v225, v249
    v_mul_f32 v4, v4, v249
    v_mul_f32 v5, v5, v249
    v_mul_f32 v6, v6, v249
    v_mul_f32 v7, v7, v249
    v_mul_f32 v12, v12, v249
    v_mul_f32 v13, v13, v249
    v_mul_f32 v14, v14, v249
    v_mul_f32 v15, v15, v249
    v_mul_f32 v20, v20, v249
    v_mul_f32 v21, v21, v249
    v_mul_f32 v22, v22, v249
    v_mul_f32 v23, v23, v249
    v_mul_f32 v28, v28, v249
    v_mul_f32 v29, v29, v249
    v_mul_f32 v30, v30, v249
    v_mul_f32 v31, v31, v249
    v_mul_f32 v36, v36, v249
    v_mul_f32 v37, v37, v249
    v_mul_f32 v38, v38, v249
    v_mul_f32 v39, v39, v249
    v_mul_f32 v44, v44, v249
    v_mul_f32 v45, v45, v249
    v_mul_f32 v46, v46, v249
    v_mul_f32 v47, v47, v249
    v_mul_f32 v52, v52, v249
    v_mul_f32 v53, v53, v249
    v_mul_f32 v54, v54, v249
    v_mul_f32 v55, v55, v249
    v_mul_f32 v60, v60, v249
    v_mul_f32 v61, v61, v249
    v_mul_f32 v62, v62, v249
    v_mul_f32 v63, v63, v249
    v_mul_f32 v68, v68, v249
    v_mul_f32 v69, v69, v249
    v_mul_f32 v70, v70, v249
    v_mul_f32 v71, v71, v249
    v_mul_f32 v76, v76, v249
    v_mul_f32 v77, v77, v249
    v_mul_f32 v78, v78, v249
    v_mul_f32 v79, v79, v249
    v_mul_f32 v84, v84, v249
    v_mul_f32 v85, v85, v249
    v_mul_f32 v86, v86, v249
    v_mul_f32 v87, v87, v249
    v_mul_f32 v92, v92, v249
    v_mul_f32 v93, v93, v249
    v_mul_f32 v94, v94, v249
    v_mul_f32 v95, v95, v249
    s_nop 1
    s_branch K1_BACK9
K1_SLOW10:
    s_nop 7
    s_nop 3
    v_max3_f32 v246, v144, v145, v146
    v_max3_f32 v247, v147, v152, v153
    v_max3_f32 v246, v246, v154, v155
    v_max_f32 v246, v246, v247
    v_mov_b32 v247, v246
    v_max3_f32 v248, v148, v149, v150
    v_max3_f32 v249, v151, v156, v157
    v_max3_f32 v248, v248, v158, v159
    v_max_f32 v248, v248, v249
    v_mov_b32 v249, v248
    s_nop 1
    v_permlane32_swap_b32 v246, v247
    v_permlane32_swap_b32 v248, v249
    s_nop 0
    v_max_f32 v246, v246, v247
    v_mov_b32 v247, v246
    v_max_f32 v248, v248, v249
    v_mov_b32 v249, v248
    s_nop 1
    v_permlane16_swap_b32 v246, v247
    v_permlane16_swap_b32 v248, v249
    s_nop 0
    v_max_f32 v246, v246, v247
    v_max_f32 v246, 0, v246
    v_sub_f32 v144, v144, v246
    v_sub_f32 v145, v145, v246
    v_sub_f32 v146, v146, v246
    v_sub_f32 v147, v147, v246
    v_sub_f32 v152, v152, v246
    v_sub_f32 v153, v153, v246
    v_sub_f32 v154, v154, v246
    v_sub_f32 v155, v155, v246
    v_sub_f32 v216, v216, v246
    v_mov_b32 v217, v216
    v_mov_b32 v218, v216
    v_mov_b32 v219, v216
    v_sub_f32 v247, 0, v246
    v_exp_f32 v247, v247
    s_nop 0
    v_mul_f32 v224, v224, v247
    v_mul_f32 v0, v0, v247
    v_mul_f32 v1, v1, v247
    v_mul_f32 v2, v2, v247
    v_mul_f32 v3, v3, v247
    v_mul_f32 v8, v8, v247
    v_mul_f32 v9, v9, v247
    v_mul_f32 v10, v10, v247
    v_mul_f32 v11, v11, v247
    v_mul_f32 v16, v16, v247
    v_mul_f32 v17, v17, v247
    v_mul_f32 v18, v18, v247
    v_mul_f32 v19, v19, v247
    v_mul_f32 v24, v24, v247
    v_mul_f32 v25, v25, v247
    v_mul_f32 v26, v26, v247
    v_mul_f32 v27, v27, v247
    v_mul_f32 v32, v32, v247
    v_mul_f32 v33, v33, v247
    v_mul_f32 v34, v34, v247
    v_mul_f32 v35, v35, v247
    v_mul_f32 v40, v40, v247
    v_mul_f32 v41, v41, v247
    v_mul_f32 v42, v42, v247
    v_mul_f32 v43, v43, v247
    v_mul_f32 v48, v48, v247
    v_mul_f32 v49, v49, v247
    v_mul_f32 v50, v50, v247
    v_mul_f32 v51, v51, v247
    v_mul_f32 v56, v56, v247
    v_mul_f32 v57, v57, v247
    v_mul_f32 v58, v58, v247
    v_mul_f32 v59, v59, v247
    v_mul_f32 v64, v64, v247
    v_mul_f32 v65, v65, v247
    v_mul_f32 v66, v66, v247
    v_mul_f32 v67, v67, v247
    v_mul_f32 v72, v72, v247
    v_mul_f32 v73, v73, v247
    v_mul_f32 v74, v74, v247
    v_mul_f32 v75, v75, v247
    v_mul_f32 v80, v80, v247
    v_mul_f32 v81, v81, v247
    v_mul_f32 v82, v82, v247
    v_mul_f32 v83, v83, v247
    v_mul_f32 v88, v88, v247
    v_mul_f32 v89, v89, v247
    v_mul_f32 v90, v90, v247
    v_mul_f32 v91, v91, v247
    v_max_f32 v248, v248, v249
    v_max_f32 v248, 0, v248
    v_sub_f32 v148, v148, v248
    v_sub_f32 v149, v149, v248
    v_sub_f32 v150, v150, v248
    v_sub_f32 v151, v151, v248
    v_sub_f32 v156, v156, v248
    v_sub_f32 v157, v157, v248
    v_sub_f32 v158, v158, v248
    v_sub_f32 v159, v159, v248
    v_sub_f32 v220, v220, v248
    v_mov_b32 v221, v220
    v_mov_b32 v222, v220
    v_mov_b32 v223, v220
    v_sub_f32 v249, 0, v248
    v_exp_f32 v249, v249
    s_nop 0
    v_mul_f32 v225, v225, v249
    v_mul_f32 v4, v4, v249
    v_mul_f32 v5, v5, v249
    v_mul_f32 v6, v6, v249
    v_mul_f32 v7, v7, v249
    v_mul_f32 v12, v12, v249
    v_mul_f32 v13, v13, v249
    v_mul_f32 v14, v14, v249
    v_mul_f32 v15, v15, v249
    v_mul_f32 v20, v20, v249
    v_mul_f32 v21, v21, v249
    v_mul_f32 v22, v22, v249
    v_mul_f32 v23, v23, v249
    v_mul_f32 v28, v28, v249
    v_mul_f32 v29, v29, v249
    v_mul_f32 v30, v30, v249
    v_mul_f32 v31, v31, v249
    v_mul_f32 v36, v36, v249
    v_mul_f32 v37, v37, v249
    v_mul_f32 v38, v38, v249
    v_mul_f32 v39, v39, v249
    v_mul_f32 v44, v44, v249
    v_mul_f32 v45, v45, v249
    v_mul_f32 v46, v46, v249
    v_mul_f32 v47, v47, v249
    v_mul_f32 v52, v52, v249
    v_mul_f32 v53, v53, v249
    v_mul_f32 v54, v54, v249
    v_mul_f32 v55, v55, v249
    v_mul_f32 v60, v60, v249
    v_mul_f32 v61, v61, v249
    v_mul_f32 v62, v62, v249
    v_mul_f32 v63, v63, v249
    v_mul_f32 v68, v68, v249
    v_mul_f32 v69, v69, v249
    v_mul_f32 v70, v70, v249
    v_mul_f32 v71, v71, v249
    v_mul_f32 v76, v76, v249
    v_mul_f32 v77, v77, v249
    v_mul_f32 v78, v78, v249
    v_mul_f32 v79, v79, v249
    v_mul_f32 v84, v84, v249
    v_mul_f32 v85, v85, v249
    v_mul_f32 v86, v86, v249
    v_mul_f32 v87, v87, v249
    v_mul_f32 v92, v92, v249
    v_mul_f32 v93, v93, v249
    v_mul_f32 v94, v94, v249
    v_mul_f32 v95, v95, v249
    s_nop 1
    s_branch K1_BACK10
K1_SLOW11:
    s_nop 7
    s_nop 3
    v_max3_f32 v246, v160, v161, v162
    v_max3_f32 v247, v163, v168, v169
    v_max3_f32 v246, v246, v170, v171
    v_max_f32 v246, v246, v247
    v_mov_b32 v247, v246
    v_max3_f32 v248, v164, v165, v166
    v_max3_f32 v249, v167, v172, v173
    v_max3_f32 v248, v248, v174, v175
    v_max_f32 v248, v248, v249
    v_mov_b32 v249, v248
    s_nop 1
    v_permlane32_swap_b32 v246, v247
    v_permlane32_swap_b32 v248, v249
    s_nop 0
    v_max_f32 v246, v246, v247
    v_mov_b32 v247, v246
    v_max_f32 v248, v248, v249
    v_mov_b32 v249, v248
    s_nop 1
    v_permlane16_swap_b32 v246, v247
    v_permlane16_swap_b32 v248, v249
    s_nop 0
    v_max_f32 v246, v246, v247
    v_max_f32 v246, 0, v246
    v_sub_f32 v160, v160, v246
    v_sub_f32 v161, v161, v246
    v_sub_f32 v162, v162, v246
    v_sub_f32 v163, v163, v246
    v_sub_f32 v168, v168, v246
    v_sub_f32 v169, v169, v246
    v_sub_f32 v170, v170, v246
    v_sub_f32 v171, v171, v246
    v_sub_f32 v216, v216, v246
    v_mov_b32 v217, v216
    v_mov_b32 v218, v216
    v_mov_b32 v219, v216
    v_sub_f32 v247, 0, v246
    v_exp_f32 v247, v247
    s_nop 0
    v_mul_f32 v224, v224, v247
    v_mul_f32 v0, v0, v247
    v_mul_f32 v1, v1, v247
    v_mul_f32 v2, v2, v247
    v_mul_f32 v3, v3, v247
    v_mul_f32 v8, v8, v247
    v_mul_f32 v9, v9, v247
    v_mul_f32 v10, v10, v247
    v_mul_f32 v11, v11, v247
    v_mul_f32 v16, v16, v247
    v_mul_f32 v17, v17, v247
    v_mul_f32 v18, v18, v247
    v_mul_f32 v19, v19, v247
    v_mul_f32 v24, v24, v247
    v_mul_f32 v25, v25, v247
    v_mul_f32 v26, v26, v247
    v_mul_f32 v27, v27, v247
    v_mul_f32 v32, v32, v247
    v_mul_f32 v33, v33, v247
    v_mul_f32 v34, v34, v247
    v_mul_f32 v35, v35, v247
    v_mul_f32 v40, v40, v247
    v_mul_f32 v41, v41, v247
    v_mul_f32 v42, v42, v247
    v_mul_f32 v43, v43, v247
    v_mul_f32 v48, v48, v247
    v_mul_f32 v49, v49, v247
    v_mul_f32 v50, v50, v247
    v_mul_f32 v51, v51, v247
    v_mul_f32 v56, v56, v247
    v_mul_f32 v57, v57, v247
    v_mul_f32 v58, v58, v247
    v_mul_f32 v59, v59, v247
    v_mul_f32 v64, v64, v247
    v_mul_f32 v65, v65, v247
    v_mul_f32 v66, v66, v247
    v_mul_f32 v67, v67, v247
    v_mul_f32 v72, v72, v247
    v_mul_f32 v73, v73, v247
    v_mul_f32 v74, v74, v247
    v_mul_f32 v75, v75, v247
    v_mul_f32 v80, v80, v247
    v_mul_f32 v81, v81, v247
    v_mul_f32 v82, v82, v247
    v_mul_f32 v83, v83, v247
    v_mul_f32 v88, v88, v247
    v_mul_f32 v89, v89, v247
    v_mul_f32 v90, v90, v247
    v_mul_f32 v91, v91, v247
    v_max_f32 v248, v248, v249
    v_max_f32 v248, 0, v248
    v_sub_f32 v164, v164, v248
    v_sub_f32 v165, v165, v248
    v_sub_f32 v166, v166, v248
    v_sub_f32 v167, v167, v248
    v_sub_f32 v172, v172, v248
    v_sub_f32 v173, v173, v248
    v_sub_f32 v174, v174, v248
    v_sub_f32 v175, v175, v248
    v_sub_f32 v220, v220, v248
    v_mov_b32 v221, v220
    v_mov_b32 v222, v220
    v_mov_b32 v223, v220
    v_sub_f32 v249, 0, v248
    v_exp_f32 v249, v249
    s_nop 0
    v_mul_f32 v225, v225, v249
    v_mul_f32 v4, v4, v249
    v_mul_f32 v5, v5, v249
    v_mul_f32 v6, v6, v249
    v_mul_f32 v7, v7, v249
    v_mul_f32 v12, v12, v249
    v_mul_f32 v13, v13, v249
    v_mul_f32 v14, v14, v249
    v_mul_f32 v15, v15, v249
    v_mul_f32 v20, v20, v249
    v_mul_f32 v21, v21, v249
    v_mul_f32 v22, v22, v249
    v_mul_f32 v23, v23, v249
    v_mul_f32 v28, v28, v249
    v_mul_f32 v29, v29, v249
    v_mul_f32 v30, v30, v249
    v_mul_f32 v31, v31, v249
    v_mul_f32 v36, v36, v249
    v_mul_f32 v37, v37, v249
    v_mul_f32 v38, v38, v249
    v_mul_f32 v39, v39, v249
    v_mul_f32 v44, v44, v249
    v_mul_f32 v45, v45, v249
    v_mul_f32 v46, v46, v249
    v_mul_f32 v47, v47, v249
    v_mul_f32 v52, v52, v249
    v_mul_f32 v53, v53, v249
    v_mul_f32 v54, v54, v249
    v_mul_f32 v55, v55, v249
    v_mul_f32 v60, v60, v249
    v_mul_f32 v61, v61, v249
    v_mul_f32 v62, v62, v249
    v_mul_f32 v63, v63, v249
    v_mul_f32 v68, v68, v249
    v_mul_f32 v69, v69, v249
    v_mul_f32 v70, v70, v249
    v_mul_f32 v71, v71, v249
    v_mul_f32 v76, v76, v249
    v_mul_f32 v77, v77, v249
    v_mul_f32 v78, v78, v249
    v_mul_f32 v79, v79, v249
    v_mul_f32 v84, v84, v249
    v_mul_f32 v85, v85, v249
    v_mul_f32 v86, v86, v249
    v_mul_f32 v87, v87, v249
    v_mul_f32 v92, v92, v249
    v_mul_f32 v93, v93, v249
    v_mul_f32 v94, v94, v249
    v_mul_f32 v95, v95, v249
    s_nop 1
    s_branch K1_BACK11
K1_SLOW12:
    s_nop 7
    s_nop 3
    v_max3_f32 v246, v144, v145, v146
    v_max3_f32 v247, v147, v152, v153
    v_max3_f32 v246, v246, v154, v155
    v_max_f32 v246, v246, v247
    v_mov_b32 v247, v246
    v_max3_f32 v248, v148, v149, v150
    v_max3_f32 v249, v151, v156, v157
    v_max3_f32 v248, v248, v158, v159
    v_max_f32 v248, v248, v249
    v_mov_b32 v249, v248
    s_nop 1
    v_permlane32_swap_b32 v246, v247
    v_permlane32_swap_b32 v248, v249
    s_nop 0
    v_max_f32 v246, v246, v247
    v_mov_b32 v247, v246
    v_max_f32 v248, v248, v249
    v_mov_b32 v249, v248
    s_nop 1
    v_permlane16_swap_b32 v246, v247
    v_permlane16_swap_b32 v248, v249
    s_nop 0
    v_max_f32 v246, v246, v247
    v_max_f32 v246, 0, v246
    v_sub_f32 v144, v144, v246
    v_sub_f32 v145, v145, v246
    v_sub_f32 v146, v146, v246
    v_sub_f32 v147, v147, v246
    v_sub_f32 v152, v152, v246
    v_sub_f32 v153, v153, v246
    v_sub_f32 v154, v154, v246
    v_sub_f32 v155, v155, v246
    v_sub_f32 v216, v216, v246
    v_mov_b32 v217, v216
    v_mov_b32 v218, v216
    v_mov_b32 v219, v216
    v_sub_f32 v247, 0, v246
    v_exp_f32 v247, v247
    s_nop 0
    v_mul_f32 v224, v224, v247
    v_mul_f32 v0, v0, v247
    v_mul_f32 v1, v1, v247
    v_mul_f32 v2, v2, v247
    v_mul_f32 v3, v3, v247
    v_mul_f32 v8, v8, v247
    v_mul_f32 v9, v9, v247
    v_mul_f32 v10, v10, v247
    v_mul_f32 v11, v11, v247
    v_mul_f32 v16, v16, v247
    v_mul_f32 v17, v17, v247
    v_mul_f32 v18, v18, v247
    v_mul_f32 v19, v19, v247
    v_mul_f32 v24, v24, v247
    v_mul_f32 v25, v25, v247
    v_mul_f32 v26, v26, v247
    v_mul_f32 v27, v27, v247
    v_mul_f32 v32, v32, v247
    v_mul_f32 v33, v33, v247
    v_mul_f32 v34, v34, v247
    v_mul_f32 v35, v35, v247
    v_mul_f32 v40, v40, v247
    v_mul_f32 v41, v41, v247
    v_mul_f32 v42, v42, v247
    v_mul_f32 v43, v43, v247
    v_mul_f32 v48, v48, v247
    v_mul_f32 v49, v49, v247
    v_mul_f32 v50, v50, v247
    v_mul_f32 v51, v51, v247
    v_mul_f32 v56, v56, v247
    v_mul_f32 v57, v57, v247
    v_mul_f32 v58, v58, v247
    v_mul_f32 v59, v59, v247
    v_mul_f32 v64, v64, v247
    v_mul_f32 v65, v65, v247
    v_mul_f32 v66, v66, v247
    v_mul_f32 v67, v67, v247
    v_mul_f32 v72, v72, v247
    v_mul_f32 v73, v73, v247
    v_mul_f32 v74, v74, v247
    v_mul_f32 v75, v75, v247
    v_mul_f32 v80, v80, v247
    v_mul_f32 v81, v81, v247
    v_mul_f32 v82, v82, v247
    v_mul_f32 v83, v83, v247
    v_mul_f32 v88, v88, v247
    v_mul_f32 v89, v89, v247
    v_mul_f32 v90, v90, v247
    v_mul_f32 v91, v91, v247
    v_max_f32 v248, v248, v249
    v_max_f32 v248, 0, v248
    v_sub_f32 v148, v148, v248
    v_sub_f32 v149, v149, v248
    v_sub_f32 v150, v150, v248
    v_sub_f32 v151, v151, v248
    v_sub_f32 v156, v156, v248
    v_sub_f32 v157, v157, v248
    v_sub_f32 v158, v158, v248
    v_sub_f32 v159, v159, v248
    v_sub_f32 v220, v220, v248
    v_mov_b32 v221, v220
    v_mov_b32 v222, v220
    v_mov_b32 v223, v220
    v_sub_f32 v249, 0, v248
    v_exp_f32 v249, v249
    s_nop 0
    v_mul_f32 v225, v225, v249
    v_mul_f32 v4, v4, v249
    v_mul_f32 v5, v5, v249
    v_mul_f32 v6, v6, v249
    v_mul_f32 v7, v7, v249
    v_mul_f32 v12, v12, v249
    v_mul_f32 v13, v13, v249
    v_mul_f32 v14, v14, v249
    v_mul_f32 v15, v15, v249
    v_mul_f32 v20, v20, v249
    v_mul_f32 v21, v21, v249
    v_mul_f32 v22, v22, v249
    v_mul_f32 v23, v23, v249
    v_mul_f32 v28, v28, v249
    v_mul_f32 v29, v29, v249
    v_mul_f32 v30, v30, v249
    v_mul_f32 v31, v31, v249
    v_mul_f32 v36, v36, v249
    v_mul_f32 v37, v37, v249
    v_mul_f32 v38, v38, v249
    v_mul_f32 v39, v39, v249
    v_mul_f32 v44, v44, v249
    v_mul_f32 v45, v45, v249
    v_mul_f32 v46, v46, v249
    v_mul_f32 v47, v47, v249
    v_mul_f32 v52, v52, v249
    v_mul_f32 v53, v53, v249
    v_mul_f32 v54, v54, v249
    v_mul_f32 v55, v55, v249
    v_mul_f32 v60, v60, v249
    v_mul_f32 v61, v61, v249
    v_mul_f32 v62, v62, v249
    v_mul_f32 v63, v63, v249
    v_mul_f32 v68, v68, v249
    v_mul_f32 v69, v69, v249
    v_mul_f32 v70, v70, v249
    v_mul_f32 v71, v71, v249
    v_mul_f32 v76, v76, v249
    v_mul_f32 v77, v77, v249
    v_mul_f32 v78, v78, v249
    v_mul_f32 v79, v79, v249
    v_mul_f32 v84, v84, v249
    v_mul_f32 v85, v85, v249
    v_mul_f32 v86, v86, v249
    v_mul_f32 v87, v87, v249
    v_mul_f32 v92, v92, v249
    v_mul_f32 v93, v93, v249
    v_mul_f32 v94, v94, v249
    v_mul_f32 v95, v95, v249
    s_nop 1
    s_branch K1_BACK12
K1_SLOW13:
    s_nop 7
    s_nop 3
    v_max3_f32 v246, v160, v161, v162
    v_max3_f32 v247, v163, v168, v169
    v_max3_f32 v246, v246, v170, v171
    v_max_f32 v246, v246, v247
    v_mov_b32 v247, v246
    v_max3_f32 v248, v164, v165, v166
    v_max3_f32 v249, v167, v172, v173
    v_max3_f32 v248, v248, v174, v175
    v_max_f32 v248, v248, v249
    v_mov_b32 v249, v248
    s_nop 1
    v_permlane32_swap_b32 v246, v247
    v_permlane32_swap_b32 v248, v249
    s_nop 0
    v_max_f32 v246, v246, v247
    v_mov_b32 v247, v246
    v_max_f32 v248, v248, v249
    v_mov_b32 v249, v248
    s_nop 1
    v_permlane16_swap_b32 v246, v247
    v_permlane16_swap_b32 v248, v249
    s_nop 0
    v_max_f32 v246, v246, v247
    v_max_f32 v246, 0, v246
    v_sub_f32 v160, v160, v246
    v_sub_f32 v161, v161, v246
    v_sub_f32 v162, v162, v246
    v_sub_f32 v163, v163, v246
    v_sub_f32 v168, v168, v246
    v_sub_f32 v169, v169, v246
    v_sub_f32 v170, v170, v246
    v_sub_f32 v171, v171, v246
    v_sub_f32 v216, v216, v246
    v_mov_b32 v217, v216
    v_mov_b32 v218, v216
    v_mov_b32 v219, v216
    v_sub_f32 v247, 0, v246
    v_exp_f32 v247, v247
    s_nop 0
    v_mul_f32 v224, v224, v247
    v_mul_f32 v0, v0, v247
    v_mul_f32 v1, v1, v247
    v_mul_f32 v2, v2, v247
    v_mul_f32 v3, v3, v247
    v_mul_f32 v8, v8, v247
    v_mul_f32 v9, v9, v247
    v_mul_f32 v10, v10, v247
    v_mul_f32 v11, v11, v247
    v_mul_f32 v16, v16, v247
    v_mul_f32 v17, v17, v247
    v_mul_f32 v18, v18, v247
    v_mul_f32 v19, v19, v247
    v_mul_f32 v24, v24, v247
    v_mul_f32 v25, v25, v247
    v_mul_f32 v26, v26, v247
    v_mul_f32 v27, v27, v247
    v_mul_f32 v32, v32, v247
    v_mul_f32 v33, v33, v247
    v_mul_f32 v34, v34, v247
    v_mul_f32 v35, v35, v247
    v_mul_f32 v40, v40, v247
    v_mul_f32 v41, v41, v247
    v_mul_f32 v42, v42, v247
    v_mul_f32 v43, v43, v247
    v_mul_f32 v48, v48, v247
    v_mul_f32 v49, v49, v247
    v_mul_f32 v50, v50, v247
    v_mul_f32 v51, v51, v247
    v_mul_f32 v56, v56, v247
    v_mul_f32 v57, v57, v247
    v_mul_f32 v58, v58, v247
    v_mul_f32 v59, v59, v247
    v_mul_f32 v64, v64, v247
    v_mul_f32 v65, v65, v247
    v_mul_f32 v66, v66, v247
    v_mul_f32 v67, v67, v247
    v_mul_f32 v72, v72, v247
    v_mul_f32 v73, v73, v247
    v_mul_f32 v74, v74, v247
    v_mul_f32 v75, v75, v247
    v_mul_f32 v80, v80, v247
    v_mul_f32 v81, v81, v247
    v_mul_f32 v82, v82, v247
    v_mul_f32 v83, v83, v247
    v_mul_f32 v88, v88, v247
    v_mul_f32 v89, v89, v247
    v_mul_f32 v90, v90, v247
    v_mul_f32 v91, v91, v247
    v_max_f32 v248, v248, v249
    v_max_f32 v248, 0, v248
    v_sub_f32 v164, v164, v248
    v_sub_f32 v165, v165, v248
    v_sub_f32 v166, v166, v248
    v_sub_f32 v167, v167, v248
    v_sub_f32 v172, v172, v248
    v_sub_f32 v173, v173, v248
    v_sub_f32 v174, v174, v248
    v_sub_f32 v175, v175, v248
    v_sub_f32 v220, v220, v248
    v_mov_b32 v221, v220
    v_mov_b32 v222, v220
    v_mov_b32 v223, v220
    v_sub_f32 v249, 0, v248
    v_exp_f32 v249, v249
    s_nop 0
    v_mul_f32 v225, v225, v249
    v_mul_f32 v4, v4, v249
    v_mul_f32 v5, v5, v249
    v_mul_f32 v6, v6, v249
    v_mul_f32 v7, v7, v249
    v_mul_f32 v12, v12, v249
    v_mul_f32 v13, v13, v249
    v_mul_f32 v14, v14, v249
    v_mul_f32 v15, v15, v249
    v_mul_f32 v20, v20, v249
    v_mul_f32 v21, v21, v249
    v_mul_f32 v22, v22, v249
    v_mul_f32 v23, v23, v249
    v_mul_f32 v28, v28, v249
    v_mul_f32 v29, v29, v249
    v_mul_f32 v30, v30, v249
    v_mul_f32 v31, v31, v249
    v_mul_f32 v36, v36, v249
    v_mul_f32 v37, v37, v249
    v_mul_f32 v38, v38, v249
    v_mul_f32 v39, v39, v249
    v_mul_f32 v44, v44, v249
    v_mul_f32 v45, v45, v249
    v_mul_f32 v46, v46, v249
    v_mul_f32 v47, v47, v249
    v_mul_f32 v52, v52, v249
    v_mul_f32 v53, v53, v249
    v_mul_f32 v54, v54, v249
    v_mul_f32 v55, v55, v249
    v_mul_f32 v60, v60, v249
    v_mul_f32 v61, v61, v249
    v_mul_f32 v62, v62, v249
    v_mul_f32 v63, v63, v249
    v_mul_f32 v68, v68, v249
    v_mul_f32 v69, v69, v249
    v_mul_f32 v70, v70, v249
    v_mul_f32 v71, v71, v249
    v_mul_f32 v76, v76, v249
    v_mul_f32 v77, v77, v249
    v_mul_f32 v78, v78, v249
    v_mul_f32 v79, v79, v249
    v_mul_f32 v84, v84, v249
    v_mul_f32 v85, v85, v249
    v_mul_f32 v86, v86, v249
    v_mul_f32 v87, v87, v249
    v_mul_f32 v92, v92, v249
    v_mul_f32 v93, v93, v249
    v_mul_f32 v94, v94, v249
    v_mul_f32 v95, v95, v249
    s_nop 1
    s_branch K1_BACK13
K1_SLOW14:
    s_nop 7
    s_nop 3
    v_max3_f32 v246, v144, v145, v146
    v_max3_f32 v247, v147, v152, v153
    v_max3_f32 v246, v246, v154, v155
    v_max_f32 v246, v246, v247
    v_mov_b32 v247, v246
    v_max3_f32 v248, v148, v149, v150
    v_max3_f32 v249, v151, v156, v157
    v_max3_f32 v248, v248, v158, v159
    v_max_f32 v248, v248, v249
    v_mov_b32 v249, v248
    s_nop 1
    v_permlane32_swap_b32 v246, v247
    v_permlane32_swap_b32 v248, v249
    s_nop 0
    v_max_f32 v246, v246, v247
    v_mov_b32 v247, v246
    v_max_f32 v248, v248, v249
    v_mov_b32 v249, v248
    s_nop 1
    v_permlane16_swap_b32 v246, v247
    v_permlane16_swap_b32 v248, v249
    s_nop 0
    v_max_f32 v246, v246, v247
    v_max_f32 v246, 0, v246
    v_sub_f32 v144, v144, v246
    v_sub_f32 v145, v145, v246
    v_sub_f32 v146, v146, v246
    v_sub_f32 v147, v147, v246
    v_sub_f32 v152, v152, v246
    v_sub_f32 v153, v153, v246
    v_sub_f32 v154, v154, v246
    v_sub_f32 v155, v155, v246
    v_sub_f32 v216, v216, v246
    v_mov_b32 v217, v216
    v_mov_b32 v218, v216
    v_mov_b32 v219, v216
    v_sub_f32 v247, 0, v246
    v_exp_f32 v247, v247
    s_nop 0
    v_mul_f32 v224, v224, v247
    v_mul_f32 v0, v0, v247
    v_mul_f32 v1, v1, v247
    v_mul_f32 v2, v2, v247
    v_mul_f32 v3, v3, v247
    v_mul_f32 v8, v8, v247
    v_mul_f32 v9, v9, v247
    v_mul_f32 v10, v10, v247
    v_mul_f32 v11, v11, v247
    v_mul_f32 v16, v16, v247
    v_mul_f32 v17, v17, v247
    v_mul_f32 v18, v18, v247
    v_mul_f32 v19, v19, v247
    v_mul_f32 v24, v24, v247
    v_mul_f32 v25, v25, v247
    v_mul_f32 v26, v26, v247
    v_mul_f32 v27, v27, v247
    v_mul_f32 v32, v32, v247
    v_mul_f32 v33, v33, v247
    v_mul_f32 v34, v34, v247
    v_mul_f32 v35, v35, v247
    v_mul_f32 v40, v40, v247
    v_mul_f32 v41, v41, v247
    v_mul_f32 v42, v42, v247
    v_mul_f32 v43, v43, v247
    v_mul_f32 v48, v48, v247
    v_mul_f32 v49, v49, v247
    v_mul_f32 v50, v50, v247
    v_mul_f32 v51, v51, v247
    v_mul_f32 v56, v56, v247
    v_mul_f32 v57, v57, v247
    v_mul_f32 v58, v58, v247
    v_mul_f32 v59, v59, v247
    v_mul_f32 v64, v64, v247
    v_mul_f32 v65, v65, v247
    v_mul_f32 v66, v66, v247
    v_mul_f32 v67, v67, v247
    v_mul_f32 v72, v72, v247
    v_mul_f32 v73, v73, v247
    v_mul_f32 v74, v74, v247
    v_mul_f32 v75, v75, v247
    v_mul_f32 v80, v80, v247
    v_mul_f32 v81, v81, v247
    v_mul_f32 v82, v82, v247
    v_mul_f32 v83, v83, v247
    v_mul_f32 v88, v88, v247
    v_mul_f32 v89, v89, v247
    v_mul_f32 v90, v90, v247
    v_mul_f32 v91, v91, v247
    v_max_f32 v248, v248, v249
    v_max_f32 v248, 0, v248
    v_sub_f32 v148, v148, v248
    v_sub_f32 v149, v149, v248
    v_sub_f32 v150, v150, v248
    v_sub_f32 v151, v151, v248
    v_sub_f32 v156, v156, v248
    v_sub_f32 v157, v157, v248
    v_sub_f32 v158, v158, v248
    v_sub_f32 v159, v159, v248
    v_sub_f32 v220, v220, v248
    v_mov_b32 v221, v220
    v_mov_b32 v222, v220
    v_mov_b32 v223, v220
    v_sub_f32 v249, 0, v248
    v_exp_f32 v249, v249
    s_nop 0
    v_mul_f32 v225, v225, v249
    v_mul_f32 v4, v4, v249
    v_mul_f32 v5, v5, v249
    v_mul_f32 v6, v6, v249
    v_mul_f32 v7, v7, v249
    v_mul_f32 v12, v12, v249
    v_mul_f32 v13, v13, v249
    v_mul_f32 v14, v14, v249
    v_mul_f32 v15, v15, v249
    v_mul_f32 v20, v20, v249
    v_mul_f32 v21, v21, v249
    v_mul_f32 v22, v22, v249
    v_mul_f32 v23, v23, v249
    v_mul_f32 v28, v28, v249
    v_mul_f32 v29, v29, v249
    v_mul_f32 v30, v30, v249
    v_mul_f32 v31, v31, v249
    v_mul_f32 v36, v36, v249
    v_mul_f32 v37, v37, v249
    v_mul_f32 v38, v38, v249
    v_mul_f32 v39, v39, v249
    v_mul_f32 v44, v44, v249
    v_mul_f32 v45, v45, v249
    v_mul_f32 v46, v46, v249
    v_mul_f32 v47, v47, v249
    v_mul_f32 v52, v52, v249
    v_mul_f32 v53, v53, v249
    v_mul_f32 v54, v54, v249
    v_mul_f32 v55, v55, v249
    v_mul_f32 v60, v60, v249
    v_mul_f32 v61, v61, v249
    v_mul_f32 v62, v62, v249
    v_mul_f32 v63, v63, v249
    v_mul_f32 v68, v68, v249
    v_mul_f32 v69, v69, v249
    v_mul_f32 v70, v70, v249
    v_mul_f32 v71, v71, v249
    v_mul_f32 v76, v76, v249
    v_mul_f32 v77, v77, v249
    v_mul_f32 v78, v78, v249
    v_mul_f32 v79, v79, v249
    v_mul_f32 v84, v84, v249
    v_mul_f32 v85, v85, v249
    v_mul_f32 v86, v86, v249
    v_mul_f32 v87, v87, v249
    v_mul_f32 v92, v92, v249
    v_mul_f32 v93, v93, v249
    v_mul_f32 v94, v94, v249
    v_mul_f32 v95, v95, v249
    s_nop 1
    s_branch K1_BACK14
K1_SLOW15:
    s_nop 7
    s_nop 3
    v_max3_f32 v246, v160, v161, v162
    v_max3_f32 v247, v163, v168, v169
    v_max3_f32 v246, v246, v170, v171
    v_max_f32 v246, v246, v247
    v_mov_b32 v247, v246
    v_max3_f32 v248, v164, v165, v166
    v_max3_f32 v249, v167, v172, v173
    v_max3_f32 v248, v248, v174, v175
    v_max_f32 v248, v248, v249
    v_mov_b32 v249, v248
    s_nop 1
    v_permlane32_swap_b32 v246, v247
    v_permlane32_swap_b32 v248, v249
    s_nop 0
    v_max_f32 v246, v246, v247
    v_mov_b32 v247, v246
    v_max_f32 v248, v248, v249
    v_mov_b32 v249, v248
    s_nop 1
    v_permlane16_swap_b32 v246, v247
    v_permlane16_swap_b32 v248, v249
    s_nop 0
    v_max_f32 v246, v246, v247
    v_max_f32 v246, 0, v246
    v_sub_f32 v160, v160, v246
    v_sub_f32 v161, v161, v246
    v_sub_f32 v162, v162, v246
    v_sub_f32 v163, v163, v246
    v_sub_f32 v168, v168, v246
    v_sub_f32 v169, v169, v246
    v_sub_f32 v170, v170, v246
    v_sub_f32 v171, v171, v246
    v_sub_f32 v216, v216, v246
    v_mov_b32 v217, v216
    v_mov_b32 v218, v216
    v_mov_b32 v219, v216
    v_sub_f32 v247, 0, v246
    v_exp_f32 v247, v247
    s_nop 0
    v_mul_f32 v224, v224, v247
    v_mul_f32 v0, v0, v247
    v_mul_f32 v1, v1, v247
    v_mul_f32 v2, v2, v247
    v_mul_f32 v3, v3, v247
    v_mul_f32 v8, v8, v247
    v_mul_f32 v9, v9, v247
    v_mul_f32 v10, v10, v247
    v_mul_f32 v11, v11, v247
    v_mul_f32 v16, v16, v247
    v_mul_f32 v17, v17, v247
    v_mul_f32 v18, v18, v247
    v_mul_f32 v19, v19, v247
    v_mul_f32 v24, v24, v247
    v_mul_f32 v25, v25, v247
    v_mul_f32 v26, v26, v247
    v_mul_f32 v27, v27, v247
    v_mul_f32 v32, v32, v247
    v_mul_f32 v33, v33, v247
    v_mul_f32 v34, v34, v247
    v_mul_f32 v35, v35, v247
    v_mul_f32 v40, v40, v247
    v_mul_f32 v41, v41, v247
    v_mul_f32 v42, v42, v247
    v_mul_f32 v43, v43, v247
    v_mul_f32 v48, v48, v247
    v_mul_f32 v49, v49, v247
    v_mul_f32 v50, v50, v247
    v_mul_f32 v51, v51, v247
    v_mul_f32 v56, v56, v247
    v_mul_f32 v57, v57, v247
    v_mul_f32 v58, v58, v247
    v_mul_f32 v59, v59, v247
    v_mul_f32 v64, v64, v247
    v_mul_f32 v65, v65, v247
    v_mul_f32 v66, v66, v247
    v_mul_f32 v67, v67, v247
    v_mul_f32 v72, v72, v247
    v_mul_f32 v73, v73, v247
    v_mul_f32 v74, v74, v247
    v_mul_f32 v75, v75, v247
    v_mul_f32 v80, v80, v247
    v_mul_f32 v81, v81, v247
    v_mul_f32 v82, v82, v247
    v_mul_f32 v83, v83, v247
    v_mul_f32 v88, v88, v247
    v_mul_f32 v89, v89, v247
    v_mul_f32 v90, v90, v247
    v_mul_f32 v91, v91, v247
    v_max_f32 v248, v248, v249
    v_max_f32 v248, 0, v248
    v_sub_f32 v164, v164, v248
    v_sub_f32 v165, v165, v248
    v_sub_f32 v166, v166, v248
    v_sub_f32 v167, v167, v248
    v_sub_f32 v172, v172, v248
    v_sub_f32 v173, v173, v248
    v_sub_f32 v174, v174, v248
    v_sub_f32 v175, v175, v248
    v_sub_f32 v220, v220, v248
    v_mov_b32 v221, v220
    v_mov_b32 v222, v220
    v_mov_b32 v223, v220
    v_sub_f32 v249, 0, v248
    v_exp_f32 v249, v249
    s_nop 0
    v_mul_f32 v225, v225, v249
    v_mul_f32 v4, v4, v249
    v_mul_f32 v5, v5, v249
    v_mul_f32 v6, v6, v249
    v_mul_f32 v7, v7, v249
    v_mul_f32 v12, v12, v249
    v_mul_f32 v13, v13, v249
    v_mul_f32 v14, v14, v249
    v_mul_f32 v15, v15, v249
    v_mul_f32 v20, v20, v249
    v_mul_f32 v21, v21, v249
    v_mul_f32 v22, v22, v249
    v_mul_f32 v23, v23, v249
    v_mul_f32 v28, v28, v249
    v_mul_f32 v29, v29, v249
    v_mul_f32 v30, v30, v249
    v_mul_f32 v31, v31, v249
    v_mul_f32 v36, v36, v249
    v_mul_f32 v37, v37, v249
    v_mul_f32 v38, v38, v249
    v_mul_f32 v39, v39, v249
    v_mul_f32 v44, v44, v249
    v_mul_f32 v45, v45, v249
    v_mul_f32 v46, v46, v249
    v_mul_f32 v47, v47, v249
    v_mul_f32 v52, v52, v249
    v_mul_f32 v53, v53, v249
    v_mul_f32 v54, v54, v249
    v_mul_f32 v55, v55, v249
    v_mul_f32 v60, v60, v249
    v_mul_f32 v61, v61, v249
    v_mul_f32 v62, v62, v249
    v_mul_f32 v63, v63, v249
    v_mul_f32 v68, v68, v249
    v_mul_f32 v69, v69, v249
    v_mul_f32 v70, v70, v249
    v_mul_f32 v71, v71, v249
    v_mul_f32 v76, v76, v249
    v_mul_f32 v77, v77, v249
    v_mul_f32 v78, v78, v249
    v_mul_f32 v79, v79, v249
    v_mul_f32 v84, v84, v249
    v_mul_f32 v85, v85, v249
    v_mul_f32 v86, v86, v249
    v_mul_f32 v87, v87, v249
    v_mul_f32 v92, v92, v249
    v_mul_f32 v93, v93, v249
    v_mul_f32 v94, v94, v249
    v_mul_f32 v95, v95, v249
    s_nop 1
    s_branch K1_BACK15
.globl concat_heads__gqa_block_cached__gqa_block_cached__near_ridge_k2_kernel
.p2align 8
.type concat_heads__gqa_block_cached__gqa_block_cached__near_ridge_k2_kernel,@function
concat_heads__gqa_block_cached__gqa_block_cached__near_ridge_k2_kernel:
    s_cmp_ge_u32 s2, 256
    s_cbranch_scc1 K2_END
    s_load_dwordx2 s[8:9], s[0:1], 32
    s_load_dwordx2 s[10:11], s[0:1], 72
    s_load_dwordx2 s[12:13], s[0:1], 80
    s_load_dwordx2 s[4:5], s[0:1], 96
    v_lshrrev_b32 v1, 6, v0
    v_and_b32 v2, 63, v0
    s_nop 0
    v_readfirstlane_b32 s44, v1
    s_and_b32 s48, s2, 3
    s_bfe_u32 s7, s2, 0x10002
    s_lshr_b32 s3, s2, 5
    s_bfe_u32 s6, s2, 0x20003
    s_lshr_b32 s50, s44, 2
    s_and_b32 s51, s44, 3
    s_lshl_b32 s3, s3, 1
    s_add_u32 s3, s3, s50
    s_waitcnt lgkmcnt(0)
    s_cmp_eq_u32 s7, 0
    s_cselect_b32 s8, s8, s10
    s_cselect_b32 s9, s9, s11
    s_mul_i32 s47, s6, 320
    s_mul_i32 s52, s48, 1966080
    s_add_u32 s47, s47, s52
    s_add_u32 s24, s8, s47
    s_addc_u32 s25, s9, 0
    s_sub_u32 s26, 7864320, s47
    s_mov_b32 s27, 0x00020000
    s_lshl_b32 s47, s7, 4
    s_add_u32 s47, s47, s3
    s_lshl_b32 s47, s47, 2
    s_add_u32 s47, s47, s48
    s_mul_i32 s47, s47, 393216
    s_add_u32 s28, s4, s47
    s_addc_u32 s29, s5, 0
    s_mov_b32 s30, 393216
    s_mov_b32 s31, 0x00020000
    s_mul_i32 s47, s3, 327680
    s_mul_i32 s52, s7, 1280
    s_add_u32 s47, s47, s52
    s_mul_i32 s52, s6, 320
    s_add_u32 s47, s47, s52
    s_add_u32 s32, s12, s47
    s_addc_u32 s33, s13, 0
    s_sub_u32 s34, 5242880, s47
    s_mov_b32 s35, 0x00020000
    s_add_u32 s36, s4, 134217728
    s_addc_u32 s37, s5, 0
    s_mov_b32 s38, 41943040
    s_mov_b32 s39, 0x00020000
    s_add_u32 s40, s4, 100663296
    s_addc_u32 s41, s5, 0
    s_mov_b32 s42, 65536
    s_mov_b32 s43, 0x00020000
    s_mul_i32 s45, s44, 2560
    s_mul_i32 s47, s44, 160
    s_add_u32 s52, s47, 0
    v_add_u32 v3, s52, v2
    v_mul_u32_u24 v4, 3277, v3
    v_lshrrev_b32 v4, 16, v4
    v_mul_u32_u24 v5, 20, v4
    v_sub_u32 v5, v3, v5
    v_bfe_u32 v7, v4, 2, 1
    v_lshlrev_b32 v7, 1, v7
    v_xor_b32 v5, v5, v7
    v_mul_u32_u24 v6, 1280, v4
    v_lshl_add_u32 v6, v5, 4, v6
    v_mov_b32 v208, v6
    s_add_u32 s52, s47, 64
    v_add_u32 v3, s52, v2
    v_mul_u32_u24 v4, 3277, v3
    v_lshrrev_b32 v4, 16, v4
    v_mul_u32_u24 v5, 20, v4
    v_sub_u32 v5, v3, v5
    v_bfe_u32 v7, v4, 2, 1
    v_lshlrev_b32 v7, 1, v7
    v_xor_b32 v5, v5, v7
    v_mul_u32_u24 v6, 1280, v4
    v_lshl_add_u32 v6, v5, 4, v6
    v_subrev_u32 v209, 1024, v6
    s_add_u32 s52, s47, 128
    v_add_u32 v3, s52, v2
    v_mul_u32_u24 v4, 3277, v3
    v_lshrrev_b32 v4, 16, v4
    v_mul_u32_u24 v5, 20, v4
    v_sub_u32 v5, v3, v5
    v_bfe_u32 v7, v4, 2, 1
    v_lshlrev_b32 v7, 1, v7
    v_xor_b32 v5, v5, v7
    v_mul_u32_u24 v6, 1280, v4
    v_lshl_add_u32 v6, v5, 4, v6
    v_subrev_u32 v210, 2048, v6
    s_mul_i32 s47, s51, 12288
    v_lshlrev_b32 v8, 4, v2
    v_add_u32 v217, s47, v8
    v_add_u32 v218, 6144, v217
    s_lshr_b32 s66, s3, 1
    s_add_u32 s63, s6, s66
    s_and_b32 s63, s63, 3
    s_mov_b32 s61, 0
    s_mov_b32 s62, 0
    s_mov_b32 s64, 0
    s_mov_b32 s65, 0
    s_add_u32 s66, s64, s63
    s_and_b32 s66, s66, 3
    s_andn2_b32 s67, s64, 3
    s_or_b32 s66, s66, s67
    s_add_u32 s64, s64, 1
    s_mul_i32 s61, s66, 81920
    s_add_u32 s66, s65, s63
    s_and_b32 s66, s66, 3
    s_andn2_b32 s67, s65, 3
    s_or_b32 s66, s66, s67
    s_add_u32 s65, s65, 1
    s_mul_i32 s67, s66, 43
    s_lshr_b32 s67, s67, 7
    s_mul_i32 s67, s67, 43008
    s_lshl_b32 s66, s66, 11
    s_add_u32 s62, s66, s67
    s_mov_b32 s56, -1
    s_mov_b32 s57, 0
    s_add_u32 m0, s45, 0
    s_nop 0
    buffer_load_dwordx4 v208, s[24:27], s61 offen lds
    buffer_load_dwordx4 v[112:115], v217, s[28:31], s62 offen
    buffer_load_dwordx4 v209, s[24:27], s61 offen offset:1024 lds
    buffer_load_dwordx4 v[120:123], v217, s[28:31], s62 offen offset:1024
    s_mov_b64 exec, s[56:57]
    buffer_load_dwordx4 v210, s[24:27], s61 offen offset:2048 lds
    s_mov_b64 exec, -1
    s_add_u32 s66, s64, s63
    s_and_b32 s66, s66, 3
    s_andn2_b32 s67, s64, 3
    s_or_b32 s66, s66, s67
    s_add_u32 s64, s64, 1
    s_mul_i32 s61, s66, 81920
    buffer_load_dwordx4 v[116:119], v218, s[28:31], s62 offen
    buffer_load_dwordx4 v[124:127], v218, s[28:31], s62 offen offset:1024
    s_add_u32 s66, s65, s63
    s_and_b32 s66, s66, 3
    s_andn2_b32 s67, s65, 3
    s_or_b32 s66, s66, s67
    s_add_u32 s65, s65, 1
    s_mul_i32 s67, s66, 43
    s_lshr_b32 s67, s67, 7
    s_mul_i32 s67, s67, 43008
    s_lshl_b32 s66, s66, 11
    s_add_u32 s62, s66, s67
    s_add_u32 m0, s45, 20480
    s_nop 0
    buffer_load_dwordx4 v208, s[24:27], s61 offen lds
    buffer_load_dwordx4 v[128:131], v217, s[28:31], s62 offen
    buffer_load_dwordx4 v209, s[24:27], s61 offen offset:1024 lds
    buffer_load_dwordx4 v[136:139], v217, s[28:31], s62 offen offset:1024
    s_mov_b64 exec, s[56:57]
    buffer_load_dwordx4 v210, s[24:27], s61 offen offset:2048 lds
    s_mov_b64 exec, -1
    s_add_u32 s66, s64, s63
    s_and_b32 s66, s66, 3
    s_andn2_b32 s67, s64, 3
    s_or_b32 s66, s66, s67
    s_add_u32 s64, s64, 1
    s_mul_i32 s61, s66, 81920
    buffer_load_dwordx4 v[132:135], v218, s[28:31], s62 offen
    buffer_load_dwordx4 v[140:143], v218, s[28:31], s62 offen offset:1024
    s_add_u32 s66, s65, s63
    s_and_b32 s66, s66, 3
    s_andn2_b32 s67, s65, 3
    s_or_b32 s66, s66, s67
    s_add_u32 s65, s65, 1
    s_mul_i32 s67, s66, 43
    s_lshr_b32 s67, s67, 7
    s_mul_i32 s67, s67, 43008
    s_lshl_b32 s66, s66, 11
    s_add_u32 s62, s66, s67
    s_add_u32 m0, s45, 40960
    s_nop 0
    buffer_load_dwordx4 v208, s[24:27], s61 offen lds
    buffer_load_dwordx4 v[144:147], v217, s[28:31], s62 offen
    buffer_load_dwordx4 v209, s[24:27], s61 offen offset:1024 lds
    buffer_load_dwordx4 v[152:155], v217, s[28:31], s62 offen offset:1024
    s_mov_b64 exec, s[56:57]
    buffer_load_dwordx4 v210, s[24:27], s61 offen offset:2048 lds
    s_mov_b64 exec, -1
    s_add_u32 s66, s64, s63
    s_and_b32 s66, s66, 3
    s_andn2_b32 s67, s64, 3
    s_or_b32 s66, s66, s67
    s_add_u32 s64, s64, 1
    s_mul_i32 s61, s66, 81920
    buffer_load_dwordx4 v[148:151], v218, s[28:31], s62 offen
    buffer_load_dwordx4 v[156:159], v218, s[28:31], s62 offen offset:1024
    s_add_u32 s66, s65, s63
    s_and_b32 s66, s66, 3
    s_andn2_b32 s67, s65, 3
    s_or_b32 s66, s66, s67
    s_add_u32 s65, s65, 1
    s_mul_i32 s67, s66, 43
    s_lshr_b32 s67, s67, 7
    s_mul_i32 s67, s67, 43008
    s_lshl_b32 s66, s66, 11
    s_add_u32 s62, s66, s67
    s_add_u32 m0, s45, 61440
    s_nop 0
    buffer_load_dwordx4 v208, s[24:27], s61 offen lds
    buffer_load_dwordx4 v[160:163], v217, s[28:31], s62 offen
    buffer_load_dwordx4 v209, s[24:27], s61 offen offset:1024 lds
    buffer_load_dwordx4 v[168:171], v217, s[28:31], s62 offen offset:1024
    s_mov_b64 exec, s[56:57]
    buffer_load_dwordx4 v210, s[24:27], s61 offen offset:2048 lds
    s_mov_b64 exec, -1
    s_add_u32 s66, s64, s63
    s_and_b32 s66, s66, 3
    s_andn2_b32 s67, s64, 3
    s_or_b32 s66, s66, s67
    s_add_u32 s64, s64, 1
    s_mul_i32 s61, s66, 81920
    buffer_load_dwordx4 v[164:167], v218, s[28:31], s62 offen
    buffer_load_dwordx4 v[172:175], v218, s[28:31], s62 offen offset:1024
    s_add_u32 s66, s65, s63
    s_and_b32 s66, s66, 3
    s_andn2_b32 s67, s65, 3
    s_or_b32 s66, s66, s67
    s_add_u32 s65, s65, 1
    s_mul_i32 s67, s66, 43
    s_lshr_b32 s67, s67, 7
    s_mul_i32 s67, s67, 43008
    s_lshl_b32 s66, s66, 11
    s_add_u32 s62, s66, s67
    s_add_u32 m0, s45, 81920
    s_nop 0
    buffer_load_dwordx4 v208, s[24:27], s61 offen lds
    buffer_load_dwordx4 v[176:179], v217, s[28:31], s62 offen
    v_lshrrev_b32 v4, 2, v2
    v_mul_u32_u24 v4, 320, v4
    v_and_b32 v5, 3, v2
    v_lshl_add_u32 v4, v5, 3, v4
    v_bfe_u32 v5, v2, 4, 1
    v_lshlrev_b32 v5, 5, v5
    v_add_u32 v213, v4, v5
    v_sub_u32 v214, v4, v5
    v_add_u32 v214, 32, v214
    v_add_u32 v215, 61440, v213
    v_add_u32 v216, 61440, v214
    v_lshlrev_b32 v220, 4, v2
    v_and_b32 v3, 15, v2
    s_lshl_b32 s47, s51, 5
    v_add_u32 v8, s47, v3
    v_mul_u32_u24 v8, 2560, v8
    v_lshrrev_b32 v4, 4, v2
    v_lshl_add_u32 v219, v4, 4, v8
    v_mov_b32 v0, 0
    v_mov_b32 v1, 0
    v_mov_b32 v2, 0
    v_mov_b32 v3, 0
    v_mov_b32 v4, 0
    v_mov_b32 v5, 0
    v_mov_b32 v6, 0
    v_mov_b32 v7, 0
    v_mov_b32 v8, 0
    v_mov_b32 v9, 0
    v_mov_b32 v10, 0
    v_mov_b32 v11, 0
    v_mov_b32 v12, 0
    v_mov_b32 v13, 0
    v_mov_b32 v14, 0
    v_mov_b32 v15, 0
    v_mov_b32 v16, 0
    v_mov_b32 v17, 0
    v_mov_b32 v18, 0
    v_mov_b32 v19, 0
    v_mov_b32 v20, 0
    v_mov_b32 v21, 0
    v_mov_b32 v22, 0
    v_mov_b32 v23, 0
    v_mov_b32 v24, 0
    v_mov_b32 v25, 0
    v_mov_b32 v26, 0
    v_mov_b32 v27, 0
    v_mov_b32 v28, 0
    v_mov_b32 v29, 0
    v_mov_b32 v30, 0
    v_mov_b32 v31, 0
    v_mov_b32 v32, 0
    v_mov_b32 v33, 0
    v_mov_b32 v34, 0
    v_mov_b32 v35, 0
    v_mov_b32 v36, 0
    v_mov_b32 v37, 0
    v_mov_b32 v38, 0
    v_mov_b32 v39, 0
    v_mov_b32 v40, 0
    v_mov_b32 v41, 0
    v_mov_b32 v42, 0
    v_mov_b32 v43, 0
    v_mov_b32 v44, 0
    v_mov_b32 v45, 0
    v_mov_b32 v46, 0
    v_mov_b32 v47, 0
    v_mov_b32 v48, 0
    v_mov_b32 v49, 0
    v_mov_b32 v50, 0
    v_mov_b32 v51, 0
    v_mov_b32 v52, 0
    v_mov_b32 v53, 0
    v_mov_b32 v54, 0
    v_mov_b32 v55, 0
    v_mov_b32 v56, 0
    v_mov_b32 v57, 0
    v_mov_b32 v58, 0
    v_mov_b32 v59, 0
    v_mov_b32 v60, 0
    v_mov_b32 v61, 0
    v_mov_b32 v62, 0
    v_mov_b32 v63, 0
    v_mov_b32 v64, 0
    v_mov_b32 v65, 0
    v_mov_b32 v66, 0
    v_mov_b32 v67, 0
    v_mov_b32 v68, 0
    v_mov_b32 v69, 0
    v_mov_b32 v70, 0
    v_mov_b32 v71, 0
    v_mov_b32 v72, 0
    v_mov_b32 v73, 0
    v_mov_b32 v74, 0
    v_mov_b32 v75, 0
    v_mov_b32 v76, 0
    v_mov_b32 v77, 0
    v_mov_b32 v78, 0
    v_mov_b32 v79, 0
    s_waitcnt vmcnt(25)
    s_barrier
    ds_read_b64_tr_b16 v[80:81], v213 offset:0
    ds_read_b64_tr_b16 v[82:83], v213 offset:5120
    ds_read_b64_tr_b16 v[84:85], v214 offset:0
    ds_read_b64_tr_b16 v[86:87], v214 offset:5120
    ds_read_b64_tr_b16 v[88:89], v213 offset:64
    ds_read_b64_tr_b16 v[90:91], v213 offset:5184
    ds_read_b64_tr_b16 v[92:93], v214 offset:64
    ds_read_b64_tr_b16 v[94:95], v214 offset:5184
    ds_read_b64_tr_b16 v[96:97], v213 offset:128
    ds_read_b64_tr_b16 v[98:99], v213 offset:5248
    ds_read_b64_tr_b16 v[100:101], v214 offset:128
    ds_read_b64_tr_b16 v[102:103], v214 offset:5248
    s_mov_b32 s60, 0
K2_LOOP:
    s_waitcnt vmcnt(23)
    s_waitcnt lgkmcnt(10)
    v_mfma_f32_16x16x32_bf16 v[0:3], v[80:83], v[112:115], v[0:3]
    v_mfma_f32_16x16x32_bf16 v[4:7], v[80:83], v[116:119], v[4:7]
    ds_read_b64_tr_b16 v[104:105], v213 offset:192
    ds_read_b64_tr_b16 v[106:107], v213 offset:5312
    buffer_load_dwordx4 v209, s[24:27], s61 offen offset:1024 lds
    s_waitcnt lgkmcnt(10)
    v_mfma_f32_16x16x32_bf16 v[8:11], v[84:87], v[112:115], v[8:11]
    v_mfma_f32_16x16x32_bf16 v[12:15], v[84:87], v[116:119], v[12:15]
    ds_read_b64_tr_b16 v[108:109], v214 offset:192
    ds_read_b64_tr_b16 v[110:111], v214 offset:5312
    s_waitcnt lgkmcnt(10)
    v_mfma_f32_16x16x32_bf16 v[16:19], v[88:91], v[112:115], v[16:19]
    v_mfma_f32_16x16x32_bf16 v[20:23], v[88:91], v[116:119], v[20:23]
    ds_read_b64_tr_b16 v[80:81], v213 offset:256
    ds_read_b64_tr_b16 v[82:83], v213 offset:5376
    s_waitcnt lgkmcnt(10)
    v_mfma_f32_16x16x32_bf16 v[24:27], v[92:95], v[112:115], v[24:27]
    v_mfma_f32_16x16x32_bf16 v[28:31], v[92:95], v[116:119], v[28:31]
    ds_read_b64_tr_b16 v[84:85], v214 offset:256
    ds_read_b64_tr_b16 v[86:87], v214 offset:5376
    buffer_load_dwordx4 v[184:187], v217, s[28:31], s62 offen offset:1024
    s_waitcnt lgkmcnt(10)
    v_mfma_f32_16x16x32_bf16 v[32:35], v[96:99], v[112:115], v[32:35]
    v_mfma_f32_16x16x32_bf16 v[36:39], v[96:99], v[116:119], v[36:39]
    ds_read_b64_tr_b16 v[88:89], v213 offset:10240
    ds_read_b64_tr_b16 v[90:91], v213 offset:15360
    s_waitcnt lgkmcnt(10)
    v_mfma_f32_16x16x32_bf16 v[40:43], v[100:103], v[112:115], v[40:43]
    v_mfma_f32_16x16x32_bf16 v[44:47], v[100:103], v[116:119], v[44:47]
    ds_read_b64_tr_b16 v[92:93], v214 offset:10240
    ds_read_b64_tr_b16 v[94:95], v214 offset:15360
    s_waitcnt lgkmcnt(10)
    v_mfma_f32_16x16x32_bf16 v[48:51], v[104:107], v[112:115], v[48:51]
    v_mfma_f32_16x16x32_bf16 v[52:55], v[104:107], v[116:119], v[52:55]
    ds_read_b64_tr_b16 v[96:97], v213 offset:10304
    ds_read_b64_tr_b16 v[98:99], v213 offset:15424
    s_mov_b64 exec, s[56:57]
    buffer_load_dwordx4 v210, s[24:27], s61 offen offset:2048 lds
    s_mov_b64 exec, -1
    s_add_u32 s66, s64, s63
    s_and_b32 s66, s66, 3
    s_andn2_b32 s67, s64, 3
    s_or_b32 s66, s66, s67
    s_add_u32 s64, s64, 1
    s_mul_i32 s61, s66, 81920
    s_waitcnt lgkmcnt(10)
    v_mfma_f32_16x16x32_bf16 v[56:59], v[108:111], v[112:115], v[56:59]
    v_mfma_f32_16x16x32_bf16 v[60:63], v[108:111], v[116:119], v[60:63]
    ds_read_b64_tr_b16 v[100:101], v214 offset:10304
    ds_read_b64_tr_b16 v[102:103], v214 offset:15424
    s_waitcnt lgkmcnt(10)
    v_mfma_f32_16x16x32_bf16 v[64:67], v[80:83], v[112:115], v[64:67]
    v_mfma_f32_16x16x32_bf16 v[68:71], v[80:83], v[116:119], v[68:71]
    ds_read_b64_tr_b16 v[104:105], v213 offset:10368
    ds_read_b64_tr_b16 v[106:107], v213 offset:15488
    s_waitcnt lgkmcnt(10)
    v_mfma_f32_16x16x32_bf16 v[72:75], v[84:87], v[112:115], v[72:75]
    v_mfma_f32_16x16x32_bf16 v[76:79], v[84:87], v[116:119], v[76:79]
    ds_read_b64_tr_b16 v[108:109], v214 offset:10368
    ds_read_b64_tr_b16 v[110:111], v214 offset:15488
    buffer_load_dwordx4 v[180:183], v218, s[28:31], s62 offen
    s_waitcnt lgkmcnt(10)
    v_mfma_f32_16x16x32_bf16 v[0:3], v[88:91], v[120:123], v[0:3]
    v_mfma_f32_16x16x32_bf16 v[4:7], v[88:91], v[124:127], v[4:7]
    ds_read_b64_tr_b16 v[80:81], v213 offset:10432
    ds_read_b64_tr_b16 v[82:83], v213 offset:15552
    s_waitcnt lgkmcnt(10)
    v_mfma_f32_16x16x32_bf16 v[8:11], v[92:95], v[120:123], v[8:11]
    v_mfma_f32_16x16x32_bf16 v[12:15], v[92:95], v[124:127], v[12:15]
    ds_read_b64_tr_b16 v[84:85], v214 offset:10432
    ds_read_b64_tr_b16 v[86:87], v214 offset:15552
    s_waitcnt lgkmcnt(10)
    v_mfma_f32_16x16x32_bf16 v[16:19], v[96:99], v[120:123], v[16:19]
    v_mfma_f32_16x16x32_bf16 v[20:23], v[96:99], v[124:127], v[20:23]
    ds_read_b64_tr_b16 v[88:89], v213 offset:10496
    ds_read_b64_tr_b16 v[90:91], v213 offset:15616
    buffer_load_dwordx4 v[188:191], v218, s[28:31], s62 offen offset:1024
    s_add_u32 s66, s65, s63
    s_and_b32 s66, s66, 3
    s_andn2_b32 s67, s65, 3
    s_or_b32 s66, s66, s67
    s_add_u32 s65, s65, 1
    s_mul_i32 s67, s66, 43
    s_lshr_b32 s67, s67, 7
    s_mul_i32 s67, s67, 43008
    s_lshl_b32 s66, s66, 11
    s_add_u32 s62, s66, s67
    s_waitcnt lgkmcnt(10)
    v_mfma_f32_16x16x32_bf16 v[24:27], v[100:103], v[120:123], v[24:27]
    v_mfma_f32_16x16x32_bf16 v[28:31], v[100:103], v[124:127], v[28:31]
    ds_read_b64_tr_b16 v[92:93], v214 offset:10496
    ds_read_b64_tr_b16 v[94:95], v214 offset:15616
    s_waitcnt lgkmcnt(10)
    v_mfma_f32_16x16x32_bf16 v[32:35], v[104:107], v[120:123], v[32:35]
    v_mfma_f32_16x16x32_bf16 v[36:39], v[104:107], v[124:127], v[36:39]
    s_waitcnt vmcnt(23)
    s_barrier
    ds_read_b64_tr_b16 v[96:97], v213 offset:20480
    ds_read_b64_tr_b16 v[98:99], v213 offset:25600
    s_add_u32 m0, s45, 102400
    s_nop 0
    buffer_load_dwordx4 v208, s[24:27], s61 offen lds
    s_waitcnt lgkmcnt(10)
    v_mfma_f32_16x16x32_bf16 v[40:43], v[108:111], v[120:123], v[40:43]
    v_mfma_f32_16x16x32_bf16 v[44:47], v[108:111], v[124:127], v[44:47]
    ds_read_b64_tr_b16 v[100:101], v214 offset:20480
    ds_read_b64_tr_b16 v[102:103], v214 offset:25600
    s_waitcnt lgkmcnt(10)
    v_mfma_f32_16x16x32_bf16 v[48:51], v[80:83], v[120:123], v[48:51]
    v_mfma_f32_16x16x32_bf16 v[52:55], v[80:83], v[124:127], v[52:55]
    ds_read_b64_tr_b16 v[104:105], v213 offset:20544
    ds_read_b64_tr_b16 v[106:107], v213 offset:25664
    s_waitcnt lgkmcnt(10)
    v_mfma_f32_16x16x32_bf16 v[56:59], v[84:87], v[120:123], v[56:59]
    v_mfma_f32_16x16x32_bf16 v[60:63], v[84:87], v[124:127], v[60:63]
    ds_read_b64_tr_b16 v[108:109], v214 offset:20544
    ds_read_b64_tr_b16 v[110:111], v214 offset:25664
    buffer_load_dwordx4 v[192:195], v217, s[28:31], s62 offen
    s_waitcnt lgkmcnt(10)
    v_mfma_f32_16x16x32_bf16 v[64:67], v[88:91], v[120:123], v[64:67]
    v_mfma_f32_16x16x32_bf16 v[68:71], v[88:91], v[124:127], v[68:71]
    ds_read_b64_tr_b16 v[80:81], v213 offset:20608
    ds_read_b64_tr_b16 v[82:83], v213 offset:25728
    s_waitcnt lgkmcnt(10)
    v_mfma_f32_16x16x32_bf16 v[72:75], v[92:95], v[120:123], v[72:75]
    v_mfma_f32_16x16x32_bf16 v[76:79], v[92:95], v[124:127], v[76:79]
    ds_read_b64_tr_b16 v[84:85], v214 offset:20608
    ds_read_b64_tr_b16 v[86:87], v214 offset:25728
    s_waitcnt vmcnt(23)
    s_waitcnt lgkmcnt(10)
    v_mfma_f32_16x16x32_bf16 v[0:3], v[96:99], v[128:131], v[0:3]
    v_mfma_f32_16x16x32_bf16 v[4:7], v[96:99], v[132:135], v[4:7]
    ds_read_b64_tr_b16 v[88:89], v213 offset:20672
    ds_read_b64_tr_b16 v[90:91], v213 offset:25792
    buffer_load_dwordx4 v209, s[24:27], s61 offen offset:1024 lds
    s_waitcnt lgkmcnt(10)
    v_mfma_f32_16x16x32_bf16 v[8:11], v[100:103], v[128:131], v[8:11]
    v_mfma_f32_16x16x32_bf16 v[12:15], v[100:103], v[132:135], v[12:15]
    ds_read_b64_tr_b16 v[92:93], v214 offset:20672
    ds_read_b64_tr_b16 v[94:95], v214 offset:25792
    s_waitcnt lgkmcnt(10)
    v_mfma_f32_16x16x32_bf16 v[16:19], v[104:107], v[128:131], v[16:19]
    v_mfma_f32_16x16x32_bf16 v[20:23], v[104:107], v[132:135], v[20:23]
    ds_read_b64_tr_b16 v[96:97], v213 offset:20736
    ds_read_b64_tr_b16 v[98:99], v213 offset:25856
    s_waitcnt lgkmcnt(10)
    v_mfma_f32_16x16x32_bf16 v[24:27], v[108:111], v[128:131], v[24:27]
    v_mfma_f32_16x16x32_bf16 v[28:31], v[108:111], v[132:135], v[28:31]
    ds_read_b64_tr_b16 v[100:101], v214 offset:20736
    ds_read_b64_tr_b16 v[102:103], v214 offset:25856
    buffer_load_dwordx4 v[200:203], v217, s[28:31], s62 offen offset:1024
    s_waitcnt lgkmcnt(10)
    v_mfma_f32_16x16x32_bf16 v[32:35], v[80:83], v[128:131], v[32:35]
    v_mfma_f32_16x16x32_bf16 v[36:39], v[80:83], v[132:135], v[36:39]
    ds_read_b64_tr_b16 v[104:105], v213 offset:30720
    ds_read_b64_tr_b16 v[106:107], v213 offset:35840
    s_waitcnt lgkmcnt(10)
    v_mfma_f32_16x16x32_bf16 v[40:43], v[84:87], v[128:131], v[40:43]
    v_mfma_f32_16x16x32_bf16 v[44:47], v[84:87], v[132:135], v[44:47]
    ds_read_b64_tr_b16 v[108:109], v214 offset:30720
    ds_read_b64_tr_b16 v[110:111], v214 offset:35840
    s_waitcnt lgkmcnt(10)
    v_mfma_f32_16x16x32_bf16 v[48:51], v[88:91], v[128:131], v[48:51]
    v_mfma_f32_16x16x32_bf16 v[52:55], v[88:91], v[132:135], v[52:55]
    ds_read_b64_tr_b16 v[80:81], v213 offset:30784
    ds_read_b64_tr_b16 v[82:83], v213 offset:35904
    s_mov_b64 exec, s[56:57]
    buffer_load_dwordx4 v210, s[24:27], s61 offen offset:2048 lds
    s_mov_b64 exec, -1
    s_add_u32 s66, s64, s63
    s_and_b32 s66, s66, 3
    s_andn2_b32 s67, s64, 3
    s_or_b32 s66, s66, s67
    s_add_u32 s64, s64, 1
    s_mul_i32 s61, s66, 81920
    s_waitcnt lgkmcnt(10)
    v_mfma_f32_16x16x32_bf16 v[56:59], v[92:95], v[128:131], v[56:59]
    v_mfma_f32_16x16x32_bf16 v[60:63], v[92:95], v[132:135], v[60:63]
    ds_read_b64_tr_b16 v[84:85], v214 offset:30784
    ds_read_b64_tr_b16 v[86:87], v214 offset:35904
    s_waitcnt lgkmcnt(10)
    v_mfma_f32_16x16x32_bf16 v[64:67], v[96:99], v[128:131], v[64:67]
    v_mfma_f32_16x16x32_bf16 v[68:71], v[96:99], v[132:135], v[68:71]
    ds_read_b64_tr_b16 v[88:89], v213 offset:30848
    ds_read_b64_tr_b16 v[90:91], v213 offset:35968
    s_waitcnt lgkmcnt(10)
    v_mfma_f32_16x16x32_bf16 v[72:75], v[100:103], v[128:131], v[72:75]
    v_mfma_f32_16x16x32_bf16 v[76:79], v[100:103], v[132:135], v[76:79]
    ds_read_b64_tr_b16 v[92:93], v214 offset:30848
    ds_read_b64_tr_b16 v[94:95], v214 offset:35968
    buffer_load_dwordx4 v[196:199], v218, s[28:31], s62 offen
    s_waitcnt lgkmcnt(10)
    v_mfma_f32_16x16x32_bf16 v[0:3], v[104:107], v[136:139], v[0:3]
    v_mfma_f32_16x16x32_bf16 v[4:7], v[104:107], v[140:143], v[4:7]
    ds_read_b64_tr_b16 v[96:97], v213 offset:30912
    ds_read_b64_tr_b16 v[98:99], v213 offset:36032
    s_waitcnt lgkmcnt(10)
    v_mfma_f32_16x16x32_bf16 v[8:11], v[108:111], v[136:139], v[8:11]
    v_mfma_f32_16x16x32_bf16 v[12:15], v[108:111], v[140:143], v[12:15]
    ds_read_b64_tr_b16 v[100:101], v214 offset:30912
    ds_read_b64_tr_b16 v[102:103], v214 offset:36032
    s_waitcnt lgkmcnt(10)
    v_mfma_f32_16x16x32_bf16 v[16:19], v[80:83], v[136:139], v[16:19]
    v_mfma_f32_16x16x32_bf16 v[20:23], v[80:83], v[140:143], v[20:23]
    ds_read_b64_tr_b16 v[104:105], v213 offset:30976
    ds_read_b64_tr_b16 v[106:107], v213 offset:36096
    buffer_load_dwordx4 v[204:207], v218, s[28:31], s62 offen offset:1024
    s_add_u32 s66, s65, s63
    s_and_b32 s66, s66, 3
    s_andn2_b32 s67, s65, 3
    s_or_b32 s66, s66, s67
    s_add_u32 s65, s65, 1
    s_mul_i32 s67, s66, 43
    s_lshr_b32 s67, s67, 7
    s_mul_i32 s67, s67, 43008
    s_lshl_b32 s66, s66, 11
    s_add_u32 s62, s66, s67
    s_waitcnt lgkmcnt(10)
    v_mfma_f32_16x16x32_bf16 v[24:27], v[84:87], v[136:139], v[24:27]
    v_mfma_f32_16x16x32_bf16 v[28:31], v[84:87], v[140:143], v[28:31]
    ds_read_b64_tr_b16 v[108:109], v214 offset:30976
    ds_read_b64_tr_b16 v[110:111], v214 offset:36096
    s_waitcnt lgkmcnt(10)
    v_mfma_f32_16x16x32_bf16 v[32:35], v[88:91], v[136:139], v[32:35]
    v_mfma_f32_16x16x32_bf16 v[36:39], v[88:91], v[140:143], v[36:39]
    s_waitcnt vmcnt(23)
    s_barrier
    ds_read_b64_tr_b16 v[80:81], v213 offset:40960
    ds_read_b64_tr_b16 v[82:83], v213 offset:46080
    s_add_u32 m0, s45, 0
    s_nop 0
    buffer_load_dwordx4 v208, s[24:27], s61 offen lds
    s_waitcnt lgkmcnt(10)
    v_mfma_f32_16x16x32_bf16 v[40:43], v[92:95], v[136:139], v[40:43]
    v_mfma_f32_16x16x32_bf16 v[44:47], v[92:95], v[140:143], v[44:47]
    ds_read_b64_tr_b16 v[84:85], v214 offset:40960
    ds_read_b64_tr_b16 v[86:87], v214 offset:46080
    s_waitcnt lgkmcnt(10)
    v_mfma_f32_16x16x32_bf16 v[48:51], v[96:99], v[136:139], v[48:51]
    v_mfma_f32_16x16x32_bf16 v[52:55], v[96:99], v[140:143], v[52:55]
    ds_read_b64_tr_b16 v[88:89], v213 offset:41024
    ds_read_b64_tr_b16 v[90:91], v213 offset:46144
    s_waitcnt lgkmcnt(10)
    v_mfma_f32_16x16x32_bf16 v[56:59], v[100:103], v[136:139], v[56:59]
    v_mfma_f32_16x16x32_bf16 v[60:63], v[100:103], v[140:143], v[60:63]
    ds_read_b64_tr_b16 v[92:93], v214 offset:41024
    ds_read_b64_tr_b16 v[94:95], v214 offset:46144
    buffer_load_dwordx4 v[112:115], v217, s[28:31], s62 offen
    s_waitcnt lgkmcnt(10)
    v_mfma_f32_16x16x32_bf16 v[64:67], v[104:107], v[136:139], v[64:67]
    v_mfma_f32_16x16x32_bf16 v[68:71], v[104:107], v[140:143], v[68:71]
    ds_read_b64_tr_b16 v[96:97], v213 offset:41088
    ds_read_b64_tr_b16 v[98:99], v213 offset:46208
    s_waitcnt lgkmcnt(10)
    v_mfma_f32_16x16x32_bf16 v[72:75], v[108:111], v[136:139], v[72:75]
    v_mfma_f32_16x16x32_bf16 v[76:79], v[108:111], v[140:143], v[76:79]
    ds_read_b64_tr_b16 v[100:101], v214 offset:41088
    ds_read_b64_tr_b16 v[102:103], v214 offset:46208
    s_waitcnt vmcnt(23)
    s_waitcnt lgkmcnt(10)
    v_mfma_f32_16x16x32_bf16 v[0:3], v[80:83], v[144:147], v[0:3]
    v_mfma_f32_16x16x32_bf16 v[4:7], v[80:83], v[148:151], v[4:7]
    ds_read_b64_tr_b16 v[104:105], v213 offset:41152
    ds_read_b64_tr_b16 v[106:107], v213 offset:46272
    buffer_load_dwordx4 v209, s[24:27], s61 offen offset:1024 lds
    s_waitcnt lgkmcnt(10)
    v_mfma_f32_16x16x32_bf16 v[8:11], v[84:87], v[144:147], v[8:11]
    v_mfma_f32_16x16x32_bf16 v[12:15], v[84:87], v[148:151], v[12:15]
    ds_read_b64_tr_b16 v[108:109], v214 offset:41152
    ds_read_b64_tr_b16 v[110:111], v214 offset:46272
    s_waitcnt lgkmcnt(10)
    v_mfma_f32_16x16x32_bf16 v[16:19], v[88:91], v[144:147], v[16:19]
    v_mfma_f32_16x16x32_bf16 v[20:23], v[88:91], v[148:151], v[20:23]
    ds_read_b64_tr_b16 v[80:81], v213 offset:41216
    ds_read_b64_tr_b16 v[82:83], v213 offset:46336
    s_waitcnt lgkmcnt(10)
    v_mfma_f32_16x16x32_bf16 v[24:27], v[92:95], v[144:147], v[24:27]
    v_mfma_f32_16x16x32_bf16 v[28:31], v[92:95], v[148:151], v[28:31]
    ds_read_b64_tr_b16 v[84:85], v214 offset:41216
    ds_read_b64_tr_b16 v[86:87], v214 offset:46336
    buffer_load_dwordx4 v[120:123], v217, s[28:31], s62 offen offset:1024
    s_waitcnt lgkmcnt(10)
    v_mfma_f32_16x16x32_bf16 v[32:35], v[96:99], v[144:147], v[32:35]
    v_mfma_f32_16x16x32_bf16 v[36:39], v[96:99], v[148:151], v[36:39]
    ds_read_b64_tr_b16 v[88:89], v213 offset:51200
    ds_read_b64_tr_b16 v[90:91], v213 offset:56320
    s_waitcnt lgkmcnt(10)
    v_mfma_f32_16x16x32_bf16 v[40:43], v[100:103], v[144:147], v[40:43]
    v_mfma_f32_16x16x32_bf16 v[44:47], v[100:103], v[148:151], v[44:47]
    ds_read_b64_tr_b16 v[92:93], v214 offset:51200
    ds_read_b64_tr_b16 v[94:95], v214 offset:56320
    s_waitcnt lgkmcnt(10)
    v_mfma_f32_16x16x32_bf16 v[48:51], v[104:107], v[144:147], v[48:51]
    v_mfma_f32_16x16x32_bf16 v[52:55], v[104:107], v[148:151], v[52:55]
    ds_read_b64_tr_b16 v[96:97], v213 offset:51264
    ds_read_b64_tr_b16 v[98:99], v213 offset:56384
    s_mov_b64 exec, s[56:57]
    buffer_load_dwordx4 v210, s[24:27], s61 offen offset:2048 lds
    s_mov_b64 exec, -1
    s_add_u32 s66, s64, s63
    s_and_b32 s66, s66, 3
    s_andn2_b32 s67, s64, 3
    s_or_b32 s66, s66, s67
    s_add_u32 s64, s64, 1
    s_mul_i32 s61, s66, 81920
    s_waitcnt lgkmcnt(10)
    v_mfma_f32_16x16x32_bf16 v[56:59], v[108:111], v[144:147], v[56:59]
    v_mfma_f32_16x16x32_bf16 v[60:63], v[108:111], v[148:151], v[60:63]
    ds_read_b64_tr_b16 v[100:101], v214 offset:51264
    ds_read_b64_tr_b16 v[102:103], v214 offset:56384
    s_waitcnt lgkmcnt(10)
    v_mfma_f32_16x16x32_bf16 v[64:67], v[80:83], v[144:147], v[64:67]
    v_mfma_f32_16x16x32_bf16 v[68:71], v[80:83], v[148:151], v[68:71]
    ds_read_b64_tr_b16 v[104:105], v213 offset:51328
    ds_read_b64_tr_b16 v[106:107], v213 offset:56448
    s_waitcnt lgkmcnt(10)
    v_mfma_f32_16x16x32_bf16 v[72:75], v[84:87], v[144:147], v[72:75]
    v_mfma_f32_16x16x32_bf16 v[76:79], v[84:87], v[148:151], v[76:79]
    ds_read_b64_tr_b16 v[108:109], v214 offset:51328
    ds_read_b64_tr_b16 v[110:111], v214 offset:56448
    buffer_load_dwordx4 v[116:119], v218, s[28:31], s62 offen
    s_waitcnt lgkmcnt(10)
    v_mfma_f32_16x16x32_bf16 v[0:3], v[88:91], v[152:155], v[0:3]
    v_mfma_f32_16x16x32_bf16 v[4:7], v[88:91], v[156:159], v[4:7]
    ds_read_b64_tr_b16 v[80:81], v213 offset:51392
    ds_read_b64_tr_b16 v[82:83], v213 offset:56512
    s_waitcnt lgkmcnt(10)
    v_mfma_f32_16x16x32_bf16 v[8:11], v[92:95], v[152:155], v[8:11]
    v_mfma_f32_16x16x32_bf16 v[12:15], v[92:95], v[156:159], v[12:15]
    ds_read_b64_tr_b16 v[84:85], v214 offset:51392
    ds_read_b64_tr_b16 v[86:87], v214 offset:56512
    s_waitcnt lgkmcnt(10)
    v_mfma_f32_16x16x32_bf16 v[16:19], v[96:99], v[152:155], v[16:19]
    v_mfma_f32_16x16x32_bf16 v[20:23], v[96:99], v[156:159], v[20:23]
    ds_read_b64_tr_b16 v[88:89], v213 offset:51456
    ds_read_b64_tr_b16 v[90:91], v213 offset:56576
    buffer_load_dwordx4 v[124:127], v218, s[28:31], s62 offen offset:1024
    s_add_u32 s66, s65, s63
    s_and_b32 s66, s66, 3
    s_andn2_b32 s67, s65, 3
    s_or_b32 s66, s66, s67
    s_add_u32 s65, s65, 1
    s_mul_i32 s67, s66, 43
    s_lshr_b32 s67, s67, 7
    s_mul_i32 s67, s67, 43008
    s_lshl_b32 s66, s66, 11
    s_add_u32 s62, s66, s67
    s_waitcnt lgkmcnt(10)
    v_mfma_f32_16x16x32_bf16 v[24:27], v[100:103], v[152:155], v[24:27]
    v_mfma_f32_16x16x32_bf16 v[28:31], v[100:103], v[156:159], v[28:31]
    ds_read_b64_tr_b16 v[92:93], v214 offset:51456
    ds_read_b64_tr_b16 v[94:95], v214 offset:56576
    s_waitcnt lgkmcnt(10)
    v_mfma_f32_16x16x32_bf16 v[32:35], v[104:107], v[152:155], v[32:35]
    v_mfma_f32_16x16x32_bf16 v[36:39], v[104:107], v[156:159], v[36:39]
    s_waitcnt vmcnt(23)
    s_barrier
    ds_read_b64_tr_b16 v[96:97], v215 offset:0
    ds_read_b64_tr_b16 v[98:99], v215 offset:5120
    s_add_u32 m0, s45, 20480
    s_nop 0
    buffer_load_dwordx4 v208, s[24:27], s61 offen lds
    s_waitcnt lgkmcnt(10)
    v_mfma_f32_16x16x32_bf16 v[40:43], v[108:111], v[152:155], v[40:43]
    v_mfma_f32_16x16x32_bf16 v[44:47], v[108:111], v[156:159], v[44:47]
    ds_read_b64_tr_b16 v[100:101], v216 offset:0
    ds_read_b64_tr_b16 v[102:103], v216 offset:5120
    s_waitcnt lgkmcnt(10)
    v_mfma_f32_16x16x32_bf16 v[48:51], v[80:83], v[152:155], v[48:51]
    v_mfma_f32_16x16x32_bf16 v[52:55], v[80:83], v[156:159], v[52:55]
    ds_read_b64_tr_b16 v[104:105], v215 offset:64
    ds_read_b64_tr_b16 v[106:107], v215 offset:5184
    s_waitcnt lgkmcnt(10)
    v_mfma_f32_16x16x32_bf16 v[56:59], v[84:87], v[152:155], v[56:59]
    v_mfma_f32_16x16x32_bf16 v[60:63], v[84:87], v[156:159], v[60:63]
    ds_read_b64_tr_b16 v[108:109], v216 offset:64
    ds_read_b64_tr_b16 v[110:111], v216 offset:5184
    buffer_load_dwordx4 v[128:131], v217, s[28:31], s62 offen
    s_waitcnt lgkmcnt(10)
    v_mfma_f32_16x16x32_bf16 v[64:67], v[88:91], v[152:155], v[64:67]
    v_mfma_f32_16x16x32_bf16 v[68:71], v[88:91], v[156:159], v[68:71]
    ds_read_b64_tr_b16 v[80:81], v215 offset:128
    ds_read_b64_tr_b16 v[82:83], v215 offset:5248
    s_waitcnt lgkmcnt(10)
    v_mfma_f32_16x16x32_bf16 v[72:75], v[92:95], v[152:155], v[72:75]
    v_mfma_f32_16x16x32_bf16 v[76:79], v[92:95], v[156:159], v[76:79]
    ds_read_b64_tr_b16 v[84:85], v216 offset:128
    ds_read_b64_tr_b16 v[86:87], v216 offset:5248
    s_waitcnt vmcnt(23)
    s_waitcnt lgkmcnt(10)
    v_mfma_f32_16x16x32_bf16 v[0:3], v[96:99], v[160:163], v[0:3]
    v_mfma_f32_16x16x32_bf16 v[4:7], v[96:99], v[164:167], v[4:7]
    ds_read_b64_tr_b16 v[88:89], v215 offset:192
    ds_read_b64_tr_b16 v[90:91], v215 offset:5312
    buffer_load_dwordx4 v209, s[24:27], s61 offen offset:1024 lds
    s_waitcnt lgkmcnt(10)
    v_mfma_f32_16x16x32_bf16 v[8:11], v[100:103], v[160:163], v[8:11]
    v_mfma_f32_16x16x32_bf16 v[12:15], v[100:103], v[164:167], v[12:15]
    ds_read_b64_tr_b16 v[92:93], v216 offset:192
    ds_read_b64_tr_b16 v[94:95], v216 offset:5312
    s_waitcnt lgkmcnt(10)
    v_mfma_f32_16x16x32_bf16 v[16:19], v[104:107], v[160:163], v[16:19]
    v_mfma_f32_16x16x32_bf16 v[20:23], v[104:107], v[164:167], v[20:23]
    ds_read_b64_tr_b16 v[96:97], v215 offset:256
    ds_read_b64_tr_b16 v[98:99], v215 offset:5376
    s_waitcnt lgkmcnt(10)
    v_mfma_f32_16x16x32_bf16 v[24:27], v[108:111], v[160:163], v[24:27]
    v_mfma_f32_16x16x32_bf16 v[28:31], v[108:111], v[164:167], v[28:31]
    ds_read_b64_tr_b16 v[100:101], v216 offset:256
    ds_read_b64_tr_b16 v[102:103], v216 offset:5376
    buffer_load_dwordx4 v[136:139], v217, s[28:31], s62 offen offset:1024
    s_waitcnt lgkmcnt(10)
    v_mfma_f32_16x16x32_bf16 v[32:35], v[80:83], v[160:163], v[32:35]
    v_mfma_f32_16x16x32_bf16 v[36:39], v[80:83], v[164:167], v[36:39]
    ds_read_b64_tr_b16 v[104:105], v215 offset:10240
    ds_read_b64_tr_b16 v[106:107], v215 offset:15360
    s_waitcnt lgkmcnt(10)
    v_mfma_f32_16x16x32_bf16 v[40:43], v[84:87], v[160:163], v[40:43]
    v_mfma_f32_16x16x32_bf16 v[44:47], v[84:87], v[164:167], v[44:47]
    ds_read_b64_tr_b16 v[108:109], v216 offset:10240
    ds_read_b64_tr_b16 v[110:111], v216 offset:15360
    s_waitcnt lgkmcnt(10)
    v_mfma_f32_16x16x32_bf16 v[48:51], v[88:91], v[160:163], v[48:51]
    v_mfma_f32_16x16x32_bf16 v[52:55], v[88:91], v[164:167], v[52:55]
    ds_read_b64_tr_b16 v[80:81], v215 offset:10304
    ds_read_b64_tr_b16 v[82:83], v215 offset:15424
    s_mov_b64 exec, s[56:57]
    buffer_load_dwordx4 v210, s[24:27], s61 offen offset:2048 lds
    s_mov_b64 exec, -1
    s_add_u32 s66, s64, s63
    s_and_b32 s66, s66, 3
    s_andn2_b32 s67, s64, 3
    s_or_b32 s66, s66, s67
    s_add_u32 s64, s64, 1
    s_mul_i32 s61, s66, 81920
    s_waitcnt lgkmcnt(10)
    v_mfma_f32_16x16x32_bf16 v[56:59], v[92:95], v[160:163], v[56:59]
    v_mfma_f32_16x16x32_bf16 v[60:63], v[92:95], v[164:167], v[60:63]
    ds_read_b64_tr_b16 v[84:85], v216 offset:10304
    ds_read_b64_tr_b16 v[86:87], v216 offset:15424
    s_waitcnt lgkmcnt(10)
    v_mfma_f32_16x16x32_bf16 v[64:67], v[96:99], v[160:163], v[64:67]
    v_mfma_f32_16x16x32_bf16 v[68:71], v[96:99], v[164:167], v[68:71]
    ds_read_b64_tr_b16 v[88:89], v215 offset:10368
    ds_read_b64_tr_b16 v[90:91], v215 offset:15488
    s_waitcnt lgkmcnt(10)
    v_mfma_f32_16x16x32_bf16 v[72:75], v[100:103], v[160:163], v[72:75]
    v_mfma_f32_16x16x32_bf16 v[76:79], v[100:103], v[164:167], v[76:79]
    ds_read_b64_tr_b16 v[92:93], v216 offset:10368
    ds_read_b64_tr_b16 v[94:95], v216 offset:15488
    buffer_load_dwordx4 v[132:135], v218, s[28:31], s62 offen
    s_waitcnt lgkmcnt(10)
    v_mfma_f32_16x16x32_bf16 v[0:3], v[104:107], v[168:171], v[0:3]
    v_mfma_f32_16x16x32_bf16 v[4:7], v[104:107], v[172:175], v[4:7]
    ds_read_b64_tr_b16 v[96:97], v215 offset:10432
    ds_read_b64_tr_b16 v[98:99], v215 offset:15552
    s_waitcnt lgkmcnt(10)
    v_mfma_f32_16x16x32_bf16 v[8:11], v[108:111], v[168:171], v[8:11]
    v_mfma_f32_16x16x32_bf16 v[12:15], v[108:111], v[172:175], v[12:15]
    ds_read_b64_tr_b16 v[100:101], v216 offset:10432
    ds_read_b64_tr_b16 v[102:103], v216 offset:15552
    s_waitcnt lgkmcnt(10)
    v_mfma_f32_16x16x32_bf16 v[16:19], v[80:83], v[168:171], v[16:19]
    v_mfma_f32_16x16x32_bf16 v[20:23], v[80:83], v[172:175], v[20:23]
    ds_read_b64_tr_b16 v[104:105], v215 offset:10496
    ds_read_b64_tr_b16 v[106:107], v215 offset:15616
    buffer_load_dwordx4 v[140:143], v218, s[28:31], s62 offen offset:1024
    s_add_u32 s66, s65, s63
    s_and_b32 s66, s66, 3
    s_andn2_b32 s67, s65, 3
    s_or_b32 s66, s66, s67
    s_add_u32 s65, s65, 1
    s_mul_i32 s67, s66, 43
    s_lshr_b32 s67, s67, 7
    s_mul_i32 s67, s67, 43008
    s_lshl_b32 s66, s66, 11
    s_add_u32 s62, s66, s67
    s_waitcnt lgkmcnt(10)
    v_mfma_f32_16x16x32_bf16 v[24:27], v[84:87], v[168:171], v[24:27]
    v_mfma_f32_16x16x32_bf16 v[28:31], v[84:87], v[172:175], v[28:31]
    ds_read_b64_tr_b16 v[108:109], v216 offset:10496
    ds_read_b64_tr_b16 v[110:111], v216 offset:15616
    s_waitcnt lgkmcnt(10)
    v_mfma_f32_16x16x32_bf16 v[32:35], v[88:91], v[168:171], v[32:35]
    v_mfma_f32_16x16x32_bf16 v[36:39], v[88:91], v[172:175], v[36:39]
    s_waitcnt vmcnt(23)
    s_barrier
    ds_read_b64_tr_b16 v[80:81], v215 offset:20480
    ds_read_b64_tr_b16 v[82:83], v215 offset:25600
    s_add_u32 m0, s45, 40960
    s_nop 0
    buffer_load_dwordx4 v208, s[24:27], s61 offen lds
    s_waitcnt lgkmcnt(10)
    v_mfma_f32_16x16x32_bf16 v[40:43], v[92:95], v[168:171], v[40:43]
    v_mfma_f32_16x16x32_bf16 v[44:47], v[92:95], v[172:175], v[44:47]
    ds_read_b64_tr_b16 v[84:85], v216 offset:20480
    ds_read_b64_tr_b16 v[86:87], v216 offset:25600
    s_waitcnt lgkmcnt(10)
    v_mfma_f32_16x16x32_bf16 v[48:51], v[96:99], v[168:171], v[48:51]
    v_mfma_f32_16x16x32_bf16 v[52:55], v[96:99], v[172:175], v[52:55]
    ds_read_b64_tr_b16 v[88:89], v215 offset:20544
    ds_read_b64_tr_b16 v[90:91], v215 offset:25664
    s_waitcnt lgkmcnt(10)
    v_mfma_f32_16x16x32_bf16 v[56:59], v[100:103], v[168:171], v[56:59]
    v_mfma_f32_16x16x32_bf16 v[60:63], v[100:103], v[172:175], v[60:63]
    ds_read_b64_tr_b16 v[92:93], v216 offset:20544
    ds_read_b64_tr_b16 v[94:95], v216 offset:25664
    buffer_load_dwordx4 v[144:147], v217, s[28:31], s62 offen
    s_waitcnt lgkmcnt(10)
    v_mfma_f32_16x16x32_bf16 v[64:67], v[104:107], v[168:171], v[64:67]
    v_mfma_f32_16x16x32_bf16 v[68:71], v[104:107], v[172:175], v[68:71]
    ds_read_b64_tr_b16 v[96:97], v215 offset:20608
    ds_read_b64_tr_b16 v[98:99], v215 offset:25728
    s_waitcnt lgkmcnt(10)
    v_mfma_f32_16x16x32_bf16 v[72:75], v[108:111], v[168:171], v[72:75]
    v_mfma_f32_16x16x32_bf16 v[76:79], v[108:111], v[172:175], v[76:79]
    ds_read_b64_tr_b16 v[100:101], v216 offset:20608
    ds_read_b64_tr_b16 v[102:103], v216 offset:25728
    s_waitcnt vmcnt(23)
    s_waitcnt lgkmcnt(10)
    v_mfma_f32_16x16x32_bf16 v[0:3], v[80:83], v[176:179], v[0:3]
    v_mfma_f32_16x16x32_bf16 v[4:7], v[80:83], v[180:183], v[4:7]
    ds_read_b64_tr_b16 v[104:105], v215 offset:20672
    ds_read_b64_tr_b16 v[106:107], v215 offset:25792
    buffer_load_dwordx4 v209, s[24:27], s61 offen offset:1024 lds
    s_waitcnt lgkmcnt(10)
    v_mfma_f32_16x16x32_bf16 v[8:11], v[84:87], v[176:179], v[8:11]
    v_mfma_f32_16x16x32_bf16 v[12:15], v[84:87], v[180:183], v[12:15]
    ds_read_b64_tr_b16 v[108:109], v216 offset:20672
    ds_read_b64_tr_b16 v[110:111], v216 offset:25792
    s_waitcnt lgkmcnt(10)
    v_mfma_f32_16x16x32_bf16 v[16:19], v[88:91], v[176:179], v[16:19]
    v_mfma_f32_16x16x32_bf16 v[20:23], v[88:91], v[180:183], v[20:23]
    ds_read_b64_tr_b16 v[80:81], v215 offset:20736
    ds_read_b64_tr_b16 v[82:83], v215 offset:25856
    s_waitcnt lgkmcnt(10)
    v_mfma_f32_16x16x32_bf16 v[24:27], v[92:95], v[176:179], v[24:27]
    v_mfma_f32_16x16x32_bf16 v[28:31], v[92:95], v[180:183], v[28:31]
    ds_read_b64_tr_b16 v[84:85], v216 offset:20736
    ds_read_b64_tr_b16 v[86:87], v216 offset:25856
    buffer_load_dwordx4 v[152:155], v217, s[28:31], s62 offen offset:1024
    s_waitcnt lgkmcnt(10)
    v_mfma_f32_16x16x32_bf16 v[32:35], v[96:99], v[176:179], v[32:35]
    v_mfma_f32_16x16x32_bf16 v[36:39], v[96:99], v[180:183], v[36:39]
    ds_read_b64_tr_b16 v[88:89], v215 offset:30720
    ds_read_b64_tr_b16 v[90:91], v215 offset:35840
    s_waitcnt lgkmcnt(10)
    v_mfma_f32_16x16x32_bf16 v[40:43], v[100:103], v[176:179], v[40:43]
    v_mfma_f32_16x16x32_bf16 v[44:47], v[100:103], v[180:183], v[44:47]
    ds_read_b64_tr_b16 v[92:93], v216 offset:30720
    ds_read_b64_tr_b16 v[94:95], v216 offset:35840
    s_waitcnt lgkmcnt(10)
    v_mfma_f32_16x16x32_bf16 v[48:51], v[104:107], v[176:179], v[48:51]
    v_mfma_f32_16x16x32_bf16 v[52:55], v[104:107], v[180:183], v[52:55]
    ds_read_b64_tr_b16 v[96:97], v215 offset:30784
    ds_read_b64_tr_b16 v[98:99], v215 offset:35904
    s_mov_b64 exec, s[56:57]
    buffer_load_dwordx4 v210, s[24:27], s61 offen offset:2048 lds
    s_mov_b64 exec, -1
    s_add_u32 s66, s64, s63
    s_and_b32 s66, s66, 3
    s_andn2_b32 s67, s64, 3
    s_or_b32 s66, s66, s67
    s_add_u32 s64, s64, 1
    s_mul_i32 s61, s66, 81920
    s_waitcnt lgkmcnt(10)
    v_mfma_f32_16x16x32_bf16 v[56:59], v[108:111], v[176:179], v[56:59]
    v_mfma_f32_16x16x32_bf16 v[60:63], v[108:111], v[180:183], v[60:63]
    ds_read_b64_tr_b16 v[100:101], v216 offset:30784
    ds_read_b64_tr_b16 v[102:103], v216 offset:35904
    s_waitcnt lgkmcnt(10)
    v_mfma_f32_16x16x32_bf16 v[64:67], v[80:83], v[176:179], v[64:67]
    v_mfma_f32_16x16x32_bf16 v[68:71], v[80:83], v[180:183], v[68:71]
    ds_read_b64_tr_b16 v[104:105], v215 offset:30848
    ds_read_b64_tr_b16 v[106:107], v215 offset:35968
    s_waitcnt lgkmcnt(10)
    v_mfma_f32_16x16x32_bf16 v[72:75], v[84:87], v[176:179], v[72:75]
    v_mfma_f32_16x16x32_bf16 v[76:79], v[84:87], v[180:183], v[76:79]
    ds_read_b64_tr_b16 v[108:109], v216 offset:30848
    ds_read_b64_tr_b16 v[110:111], v216 offset:35968
    buffer_load_dwordx4 v[148:151], v218, s[28:31], s62 offen
    s_waitcnt lgkmcnt(10)
    v_mfma_f32_16x16x32_bf16 v[0:3], v[88:91], v[184:187], v[0:3]
    v_mfma_f32_16x16x32_bf16 v[4:7], v[88:91], v[188:191], v[4:7]
    ds_read_b64_tr_b16 v[80:81], v215 offset:30912
    ds_read_b64_tr_b16 v[82:83], v215 offset:36032
    s_waitcnt lgkmcnt(10)
    v_mfma_f32_16x16x32_bf16 v[8:11], v[92:95], v[184:187], v[8:11]
    v_mfma_f32_16x16x32_bf16 v[12:15], v[92:95], v[188:191], v[12:15]
    ds_read_b64_tr_b16 v[84:85], v216 offset:30912
    ds_read_b64_tr_b16 v[86:87], v216 offset:36032
    s_waitcnt lgkmcnt(10)
    v_mfma_f32_16x16x32_bf16 v[16:19], v[96:99], v[184:187], v[16:19]
    v_mfma_f32_16x16x32_bf16 v[20:23], v[96:99], v[188:191], v[20:23]
    ds_read_b64_tr_b16 v[88:89], v215 offset:30976
    ds_read_b64_tr_b16 v[90:91], v215 offset:36096
    buffer_load_dwordx4 v[156:159], v218, s[28:31], s62 offen offset:1024
    s_add_u32 s66, s65, s63
    s_and_b32 s66, s66, 3
    s_andn2_b32 s67, s65, 3
    s_or_b32 s66, s66, s67
    s_add_u32 s65, s65, 1
    s_mul_i32 s67, s66, 43
    s_lshr_b32 s67, s67, 7
    s_mul_i32 s67, s67, 43008
    s_lshl_b32 s66, s66, 11
    s_add_u32 s62, s66, s67
    s_waitcnt lgkmcnt(10)
    v_mfma_f32_16x16x32_bf16 v[24:27], v[100:103], v[184:187], v[24:27]
    v_mfma_f32_16x16x32_bf16 v[28:31], v[100:103], v[188:191], v[28:31]
    ds_read_b64_tr_b16 v[92:93], v216 offset:30976
    ds_read_b64_tr_b16 v[94:95], v216 offset:36096
    s_waitcnt lgkmcnt(10)
    v_mfma_f32_16x16x32_bf16 v[32:35], v[104:107], v[184:187], v[32:35]
    v_mfma_f32_16x16x32_bf16 v[36:39], v[104:107], v[188:191], v[36:39]
    s_waitcnt vmcnt(23)
    s_barrier
    ds_read_b64_tr_b16 v[96:97], v215 offset:40960
    ds_read_b64_tr_b16 v[98:99], v215 offset:46080
    s_add_u32 m0, s45, 61440
    s_nop 0
    buffer_load_dwordx4 v208, s[24:27], s61 offen lds
    s_waitcnt lgkmcnt(10)
    v_mfma_f32_16x16x32_bf16 v[40:43], v[108:111], v[184:187], v[40:43]
    v_mfma_f32_16x16x32_bf16 v[44:47], v[108:111], v[188:191], v[44:47]
    ds_read_b64_tr_b16 v[100:101], v216 offset:40960
    ds_read_b64_tr_b16 v[102:103], v216 offset:46080
    s_waitcnt lgkmcnt(10)
    v_mfma_f32_16x16x32_bf16 v[48:51], v[80:83], v[184:187], v[48:51]
    v_mfma_f32_16x16x32_bf16 v[52:55], v[80:83], v[188:191], v[52:55]
    ds_read_b64_tr_b16 v[104:105], v215 offset:41024
    ds_read_b64_tr_b16 v[106:107], v215 offset:46144
    s_waitcnt lgkmcnt(10)
    v_mfma_f32_16x16x32_bf16 v[56:59], v[84:87], v[184:187], v[56:59]
    v_mfma_f32_16x16x32_bf16 v[60:63], v[84:87], v[188:191], v[60:63]
    ds_read_b64_tr_b16 v[108:109], v216 offset:41024
    ds_read_b64_tr_b16 v[110:111], v216 offset:46144
    buffer_load_dwordx4 v[160:163], v217, s[28:31], s62 offen
    s_waitcnt lgkmcnt(10)
    v_mfma_f32_16x16x32_bf16 v[64:67], v[88:91], v[184:187], v[64:67]
    v_mfma_f32_16x16x32_bf16 v[68:71], v[88:91], v[188:191], v[68:71]
    ds_read_b64_tr_b16 v[80:81], v215 offset:41088
    ds_read_b64_tr_b16 v[82:83], v215 offset:46208
    s_waitcnt lgkmcnt(10)
    v_mfma_f32_16x16x32_bf16 v[72:75], v[92:95], v[184:187], v[72:75]
    v_mfma_f32_16x16x32_bf16 v[76:79], v[92:95], v[188:191], v[76:79]
    ds_read_b64_tr_b16 v[84:85], v216 offset:41088
    ds_read_b64_tr_b16 v[86:87], v216 offset:46208
    s_waitcnt vmcnt(23)
    s_waitcnt lgkmcnt(10)
    v_mfma_f32_16x16x32_bf16 v[0:3], v[96:99], v[192:195], v[0:3]
    v_mfma_f32_16x16x32_bf16 v[4:7], v[96:99], v[196:199], v[4:7]
    ds_read_b64_tr_b16 v[88:89], v215 offset:41152
    ds_read_b64_tr_b16 v[90:91], v215 offset:46272
    buffer_load_dwordx4 v209, s[24:27], s61 offen offset:1024 lds
    s_waitcnt lgkmcnt(10)
    v_mfma_f32_16x16x32_bf16 v[8:11], v[100:103], v[192:195], v[8:11]
    v_mfma_f32_16x16x32_bf16 v[12:15], v[100:103], v[196:199], v[12:15]
    ds_read_b64_tr_b16 v[92:93], v216 offset:41152
    ds_read_b64_tr_b16 v[94:95], v216 offset:46272
    s_waitcnt lgkmcnt(10)
    v_mfma_f32_16x16x32_bf16 v[16:19], v[104:107], v[192:195], v[16:19]
    v_mfma_f32_16x16x32_bf16 v[20:23], v[104:107], v[196:199], v[20:23]
    ds_read_b64_tr_b16 v[96:97], v215 offset:41216
    ds_read_b64_tr_b16 v[98:99], v215 offset:46336
    s_waitcnt lgkmcnt(10)
    v_mfma_f32_16x16x32_bf16 v[24:27], v[108:111], v[192:195], v[24:27]
    v_mfma_f32_16x16x32_bf16 v[28:31], v[108:111], v[196:199], v[28:31]
    ds_read_b64_tr_b16 v[100:101], v216 offset:41216
    ds_read_b64_tr_b16 v[102:103], v216 offset:46336
    buffer_load_dwordx4 v[168:171], v217, s[28:31], s62 offen offset:1024
    s_waitcnt lgkmcnt(10)
    v_mfma_f32_16x16x32_bf16 v[32:35], v[80:83], v[192:195], v[32:35]
    v_mfma_f32_16x16x32_bf16 v[36:39], v[80:83], v[196:199], v[36:39]
    ds_read_b64_tr_b16 v[104:105], v215 offset:51200
    ds_read_b64_tr_b16 v[106:107], v215 offset:56320
    s_waitcnt lgkmcnt(10)
    v_mfma_f32_16x16x32_bf16 v[40:43], v[84:87], v[192:195], v[40:43]
    v_mfma_f32_16x16x32_bf16 v[44:47], v[84:87], v[196:199], v[44:47]
    ds_read_b64_tr_b16 v[108:109], v216 offset:51200
    ds_read_b64_tr_b16 v[110:111], v216 offset:56320
    s_waitcnt lgkmcnt(10)
    v_mfma_f32_16x16x32_bf16 v[48:51], v[88:91], v[192:195], v[48:51]
    v_mfma_f32_16x16x32_bf16 v[52:55], v[88:91], v[196:199], v[52:55]
    ds_read_b64_tr_b16 v[80:81], v215 offset:51264
    ds_read_b64_tr_b16 v[82:83], v215 offset:56384
    s_mov_b64 exec, s[56:57]
    buffer_load_dwordx4 v210, s[24:27], s61 offen offset:2048 lds
    s_mov_b64 exec, -1
    s_add_u32 s66, s64, s63
    s_and_b32 s66, s66, 3
    s_andn2_b32 s67, s64, 3
    s_or_b32 s66, s66, s67
    s_add_u32 s64, s64, 1
    s_mul_i32 s61, s66, 81920
    s_waitcnt lgkmcnt(10)
    v_mfma_f32_16x16x32_bf16 v[56:59], v[92:95], v[192:195], v[56:59]
    v_mfma_f32_16x16x32_bf16 v[60:63], v[92:95], v[196:199], v[60:63]
    ds_read_b64_tr_b16 v[84:85], v216 offset:51264
    ds_read_b64_tr_b16 v[86:87], v216 offset:56384
    s_waitcnt lgkmcnt(10)
    v_mfma_f32_16x16x32_bf16 v[64:67], v[96:99], v[192:195], v[64:67]
    v_mfma_f32_16x16x32_bf16 v[68:71], v[96:99], v[196:199], v[68:71]
    ds_read_b64_tr_b16 v[88:89], v215 offset:51328
    ds_read_b64_tr_b16 v[90:91], v215 offset:56448
    s_waitcnt lgkmcnt(10)
    v_mfma_f32_16x16x32_bf16 v[72:75], v[100:103], v[192:195], v[72:75]
    v_mfma_f32_16x16x32_bf16 v[76:79], v[100:103], v[196:199], v[76:79]
    ds_read_b64_tr_b16 v[92:93], v216 offset:51328
    ds_read_b64_tr_b16 v[94:95], v216 offset:56448
    buffer_load_dwordx4 v[164:167], v218, s[28:31], s62 offen
    s_waitcnt lgkmcnt(10)
    v_mfma_f32_16x16x32_bf16 v[0:3], v[104:107], v[200:203], v[0:3]
    v_mfma_f32_16x16x32_bf16 v[4:7], v[104:107], v[204:207], v[4:7]
    ds_read_b64_tr_b16 v[96:97], v215 offset:51392
    ds_read_b64_tr_b16 v[98:99], v215 offset:56512
    s_waitcnt lgkmcnt(10)
    v_mfma_f32_16x16x32_bf16 v[8:11], v[108:111], v[200:203], v[8:11]
    v_mfma_f32_16x16x32_bf16 v[12:15], v[108:111], v[204:207], v[12:15]
    ds_read_b64_tr_b16 v[100:101], v216 offset:51392
    ds_read_b64_tr_b16 v[102:103], v216 offset:56512
    s_waitcnt lgkmcnt(10)
    v_mfma_f32_16x16x32_bf16 v[16:19], v[80:83], v[200:203], v[16:19]
    v_mfma_f32_16x16x32_bf16 v[20:23], v[80:83], v[204:207], v[20:23]
    ds_read_b64_tr_b16 v[104:105], v215 offset:51456
    ds_read_b64_tr_b16 v[106:107], v215 offset:56576
    buffer_load_dwordx4 v[172:175], v218, s[28:31], s62 offen offset:1024
    s_add_u32 s66, s65, s63
    s_and_b32 s66, s66, 3
    s_andn2_b32 s67, s65, 3
    s_or_b32 s66, s66, s67
    s_add_u32 s65, s65, 1
    s_mul_i32 s67, s66, 43
    s_lshr_b32 s67, s67, 7
    s_mul_i32 s67, s67, 43008
    s_lshl_b32 s66, s66, 11
    s_add_u32 s62, s66, s67
    s_waitcnt lgkmcnt(10)
    v_mfma_f32_16x16x32_bf16 v[24:27], v[84:87], v[200:203], v[24:27]
    v_mfma_f32_16x16x32_bf16 v[28:31], v[84:87], v[204:207], v[28:31]
    ds_read_b64_tr_b16 v[108:109], v216 offset:51456
    ds_read_b64_tr_b16 v[110:111], v216 offset:56576
    s_waitcnt lgkmcnt(10)
    v_mfma_f32_16x16x32_bf16 v[32:35], v[88:91], v[200:203], v[32:35]
    v_mfma_f32_16x16x32_bf16 v[36:39], v[88:91], v[204:207], v[36:39]
    s_waitcnt vmcnt(23)
    s_barrier
    ds_read_b64_tr_b16 v[80:81], v213 offset:0
    ds_read_b64_tr_b16 v[82:83], v213 offset:5120
    s_add_u32 m0, s45, 81920
    s_nop 0
    buffer_load_dwordx4 v208, s[24:27], s61 offen lds
    s_waitcnt lgkmcnt(10)
    v_mfma_f32_16x16x32_bf16 v[40:43], v[92:95], v[200:203], v[40:43]
    v_mfma_f32_16x16x32_bf16 v[44:47], v[92:95], v[204:207], v[44:47]
    ds_read_b64_tr_b16 v[84:85], v214 offset:0
    ds_read_b64_tr_b16 v[86:87], v214 offset:5120
    s_waitcnt lgkmcnt(10)
    v_mfma_f32_16x16x32_bf16 v[48:51], v[96:99], v[200:203], v[48:51]
    v_mfma_f32_16x16x32_bf16 v[52:55], v[96:99], v[204:207], v[52:55]
    ds_read_b64_tr_b16 v[88:89], v213 offset:64
    ds_read_b64_tr_b16 v[90:91], v213 offset:5184
    s_waitcnt lgkmcnt(10)
    v_mfma_f32_16x16x32_bf16 v[56:59], v[100:103], v[200:203], v[56:59]
    v_mfma_f32_16x16x32_bf16 v[60:63], v[100:103], v[204:207], v[60:63]
    ds_read_b64_tr_b16 v[92:93], v214 offset:64
    ds_read_b64_tr_b16 v[94:95], v214 offset:5184
    buffer_load_dwordx4 v[176:179], v217, s[28:31], s62 offen
    s_waitcnt lgkmcnt(10)
    v_mfma_f32_16x16x32_bf16 v[64:67], v[104:107], v[200:203], v[64:67]
    v_mfma_f32_16x16x32_bf16 v[68:71], v[104:107], v[204:207], v[68:71]
    ds_read_b64_tr_b16 v[96:97], v213 offset:128
    ds_read_b64_tr_b16 v[98:99], v213 offset:5248
    s_waitcnt lgkmcnt(10)
    v_mfma_f32_16x16x32_bf16 v[72:75], v[108:111], v[200:203], v[72:75]
    v_mfma_f32_16x16x32_bf16 v[76:79], v[108:111], v[204:207], v[76:79]
    ds_read_b64_tr_b16 v[100:101], v214 offset:128
    ds_read_b64_tr_b16 v[102:103], v214 offset:5248
    s_add_u32 s60, s60, 1
    s_cmp_lt_u32 s60, 3
    s_cbranch_scc1 K2_LOOP
    s_waitcnt vmcnt(23)
    s_waitcnt lgkmcnt(10)
    v_mfma_f32_16x16x32_bf16 v[0:3], v[80:83], v[112:115], v[0:3]
    v_mfma_f32_16x16x32_bf16 v[4:7], v[80:83], v[116:119], v[4:7]
    ds_read_b64_tr_b16 v[104:105], v213 offset:192
    ds_read_b64_tr_b16 v[106:107], v213 offset:5312
    buffer_load_dwordx4 v209, s[24:27], s61 offen offset:1024 lds
    s_waitcnt lgkmcnt(10)
    v_mfma_f32_16x16x32_bf16 v[8:11], v[84:87], v[112:115], v[8:11]
    v_mfma_f32_16x16x32_bf16 v[12:15], v[84:87], v[116:119], v[12:15]
    ds_read_b64_tr_b16 v[108:109], v214 offset:192
    ds_read_b64_tr_b16 v[110:111], v214 offset:5312
    s_waitcnt lgkmcnt(10)
    v_mfma_f32_16x16x32_bf16 v[16:19], v[88:91], v[112:115], v[16:19]
    v_mfma_f32_16x16x32_bf16 v[20:23], v[88:91], v[116:119], v[20:23]
    ds_read_b64_tr_b16 v[80:81], v213 offset:256
    ds_read_b64_tr_b16 v[82:83], v213 offset:5376
    s_waitcnt lgkmcnt(10)
    v_mfma_f32_16x16x32_bf16 v[24:27], v[92:95], v[112:115], v[24:27]
    v_mfma_f32_16x16x32_bf16 v[28:31], v[92:95], v[116:119], v[28:31]
    ds_read_b64_tr_b16 v[84:85], v214 offset:256
    ds_read_b64_tr_b16 v[86:87], v214 offset:5376
    buffer_load_dwordx4 v[184:187], v217, s[28:31], s62 offen offset:1024
    s_waitcnt lgkmcnt(10)
    v_mfma_f32_16x16x32_bf16 v[32:35], v[96:99], v[112:115], v[32:35]
    v_mfma_f32_16x16x32_bf16 v[36:39], v[96:99], v[116:119], v[36:39]
    ds_read_b64_tr_b16 v[88:89], v213 offset:10240
    ds_read_b64_tr_b16 v[90:91], v213 offset:15360
    s_waitcnt lgkmcnt(10)
    v_mfma_f32_16x16x32_bf16 v[40:43], v[100:103], v[112:115], v[40:43]
    v_mfma_f32_16x16x32_bf16 v[44:47], v[100:103], v[116:119], v[44:47]
    ds_read_b64_tr_b16 v[92:93], v214 offset:10240
    ds_read_b64_tr_b16 v[94:95], v214 offset:15360
    s_waitcnt lgkmcnt(10)
    v_mfma_f32_16x16x32_bf16 v[48:51], v[104:107], v[112:115], v[48:51]
    v_mfma_f32_16x16x32_bf16 v[52:55], v[104:107], v[116:119], v[52:55]
    ds_read_b64_tr_b16 v[96:97], v213 offset:10304
    ds_read_b64_tr_b16 v[98:99], v213 offset:15424
    s_mov_b64 exec, s[56:57]
    buffer_load_dwordx4 v210, s[24:27], s61 offen offset:2048 lds
    s_mov_b64 exec, -1
    s_add_u32 s66, s64, s63
    s_and_b32 s66, s66, 3
    s_andn2_b32 s67, s64, 3
    s_or_b32 s66, s66, s67
    s_add_u32 s64, s64, 1
    s_mul_i32 s61, s66, 81920
    s_waitcnt lgkmcnt(10)
    v_mfma_f32_16x16x32_bf16 v[56:59], v[108:111], v[112:115], v[56:59]
    v_mfma_f32_16x16x32_bf16 v[60:63], v[108:111], v[116:119], v[60:63]
    ds_read_b64_tr_b16 v[100:101], v214 offset:10304
    ds_read_b64_tr_b16 v[102:103], v214 offset:15424
    s_waitcnt lgkmcnt(10)
    v_mfma_f32_16x16x32_bf16 v[64:67], v[80:83], v[112:115], v[64:67]
    v_mfma_f32_16x16x32_bf16 v[68:71], v[80:83], v[116:119], v[68:71]
    ds_read_b64_tr_b16 v[104:105], v213 offset:10368
    ds_read_b64_tr_b16 v[106:107], v213 offset:15488
    s_waitcnt lgkmcnt(10)
    v_mfma_f32_16x16x32_bf16 v[72:75], v[84:87], v[112:115], v[72:75]
    v_mfma_f32_16x16x32_bf16 v[76:79], v[84:87], v[116:119], v[76:79]
    ds_read_b64_tr_b16 v[108:109], v214 offset:10368
    ds_read_b64_tr_b16 v[110:111], v214 offset:15488
    buffer_load_dwordx4 v[180:183], v218, s[28:31], s62 offen
    s_waitcnt lgkmcnt(10)
    v_mfma_f32_16x16x32_bf16 v[0:3], v[88:91], v[120:123], v[0:3]
    v_mfma_f32_16x16x32_bf16 v[4:7], v[88:91], v[124:127], v[4:7]
    ds_read_b64_tr_b16 v[80:81], v213 offset:10432
    ds_read_b64_tr_b16 v[82:83], v213 offset:15552
    s_waitcnt lgkmcnt(10)
    v_mfma_f32_16x16x32_bf16 v[8:11], v[92:95], v[120:123], v[8:11]
    v_mfma_f32_16x16x32_bf16 v[12:15], v[92:95], v[124:127], v[12:15]
    ds_read_b64_tr_b16 v[84:85], v214 offset:10432
    ds_read_b64_tr_b16 v[86:87], v214 offset:15552
    s_waitcnt lgkmcnt(10)
    v_mfma_f32_16x16x32_bf16 v[16:19], v[96:99], v[120:123], v[16:19]
    v_mfma_f32_16x16x32_bf16 v[20:23], v[96:99], v[124:127], v[20:23]
    ds_read_b64_tr_b16 v[88:89], v213 offset:10496
    ds_read_b64_tr_b16 v[90:91], v213 offset:15616
    buffer_load_dwordx4 v[188:191], v218, s[28:31], s62 offen offset:1024
    s_add_u32 s66, s65, s63
    s_and_b32 s66, s66, 3
    s_andn2_b32 s67, s65, 3
    s_or_b32 s66, s66, s67
    s_add_u32 s65, s65, 1
    s_mul_i32 s67, s66, 43
    s_lshr_b32 s67, s67, 7
    s_mul_i32 s67, s67, 43008
    s_lshl_b32 s66, s66, 11
    s_add_u32 s62, s66, s67
    s_waitcnt lgkmcnt(10)
    v_mfma_f32_16x16x32_bf16 v[24:27], v[100:103], v[120:123], v[24:27]
    v_mfma_f32_16x16x32_bf16 v[28:31], v[100:103], v[124:127], v[28:31]
    ds_read_b64_tr_b16 v[92:93], v214 offset:10496
    ds_read_b64_tr_b16 v[94:95], v214 offset:15616
    s_waitcnt lgkmcnt(10)
    v_mfma_f32_16x16x32_bf16 v[32:35], v[104:107], v[120:123], v[32:35]
    v_mfma_f32_16x16x32_bf16 v[36:39], v[104:107], v[124:127], v[36:39]
    s_waitcnt vmcnt(23)
    s_barrier
    ds_read_b64_tr_b16 v[96:97], v213 offset:20480
    ds_read_b64_tr_b16 v[98:99], v213 offset:25600
    s_add_u32 m0, s45, 102400
    s_nop 0
    buffer_load_dwordx4 v208, s[24:27], s61 offen lds
    s_waitcnt lgkmcnt(10)
    v_mfma_f32_16x16x32_bf16 v[40:43], v[108:111], v[120:123], v[40:43]
    v_mfma_f32_16x16x32_bf16 v[44:47], v[108:111], v[124:127], v[44:47]
    ds_read_b64_tr_b16 v[100:101], v214 offset:20480
    ds_read_b64_tr_b16 v[102:103], v214 offset:25600
    buffer_load_dwordx4 v[192:195], v217, s[28:31], s62 offen
    s_waitcnt lgkmcnt(10)
    v_mfma_f32_16x16x32_bf16 v[48:51], v[80:83], v[120:123], v[48:51]
    v_mfma_f32_16x16x32_bf16 v[52:55], v[80:83], v[124:127], v[52:55]
    ds_read_b64_tr_b16 v[104:105], v213 offset:20544
    ds_read_b64_tr_b16 v[106:107], v213 offset:25664
    buffer_load_dwordx4 v209, s[24:27], s61 offen offset:1024 lds
    s_waitcnt lgkmcnt(10)
    v_mfma_f32_16x16x32_bf16 v[56:59], v[84:87], v[120:123], v[56:59]
    v_mfma_f32_16x16x32_bf16 v[60:63], v[84:87], v[124:127], v[60:63]
    ds_read_b64_tr_b16 v[108:109], v214 offset:20544
    ds_read_b64_tr_b16 v[110:111], v214 offset:25664
    buffer_load_dwordx4 v[200:203], v217, s[28:31], s62 offen offset:1024
    s_waitcnt lgkmcnt(10)
    v_mfma_f32_16x16x32_bf16 v[64:67], v[88:91], v[120:123], v[64:67]
    v_mfma_f32_16x16x32_bf16 v[68:71], v[88:91], v[124:127], v[68:71]
    ds_read_b64_tr_b16 v[80:81], v213 offset:20608
    ds_read_b64_tr_b16 v[82:83], v213 offset:25728
    s_mov_b64 exec, s[56:57]
    buffer_load_dwordx4 v210, s[24:27], s61 offen offset:2048 lds
    s_mov_b64 exec, -1
    s_add_u32 s66, s64, s63
    s_and_b32 s66, s66, 3
    s_andn2_b32 s67, s64, 3
    s_or_b32 s66, s66, s67
    s_add_u32 s64, s64, 1
    s_mul_i32 s61, s66, 81920
    s_waitcnt lgkmcnt(10)
    v_mfma_f32_16x16x32_bf16 v[72:75], v[92:95], v[120:123], v[72:75]
    v_mfma_f32_16x16x32_bf16 v[76:79], v[92:95], v[124:127], v[76:79]
    ds_read_b64_tr_b16 v[84:85], v214 offset:20608
    ds_read_b64_tr_b16 v[86:87], v214 offset:25728
    buffer_load_dwordx4 v[196:199], v218, s[28:31], s62 offen
    s_waitcnt vmcnt(27)
    s_waitcnt lgkmcnt(10)
    v_mfma_f32_16x16x32_bf16 v[0:3], v[96:99], v[128:131], v[0:3]
    v_mfma_f32_16x16x32_bf16 v[4:7], v[96:99], v[132:135], v[4:7]
    ds_read_b64_tr_b16 v[88:89], v213 offset:20672
    ds_read_b64_tr_b16 v[90:91], v213 offset:25792
    buffer_load_dwordx4 v[204:207], v218, s[28:31], s62 offen offset:1024
    s_add_u32 s66, s65, s63
    s_and_b32 s66, s66, 3
    s_andn2_b32 s67, s65, 3
    s_or_b32 s66, s66, s67
    s_add_u32 s65, s65, 1
    s_mul_i32 s67, s66, 43
    s_lshr_b32 s67, s67, 7
    s_mul_i32 s67, s67, 43008
    s_lshl_b32 s66, s66, 11
    s_add_u32 s62, s66, s67
    s_waitcnt lgkmcnt(10)
    v_mfma_f32_16x16x32_bf16 v[8:11], v[100:103], v[128:131], v[8:11]
    v_mfma_f32_16x16x32_bf16 v[12:15], v[100:103], v[132:135], v[12:15]
    ds_read_b64_tr_b16 v[92:93], v214 offset:20672
    ds_read_b64_tr_b16 v[94:95], v214 offset:25792
    s_waitcnt lgkmcnt(10)
    v_mfma_f32_16x16x32_bf16 v[16:19], v[104:107], v[128:131], v[16:19]
    v_mfma_f32_16x16x32_bf16 v[20:23], v[104:107], v[132:135], v[20:23]
    ds_read_b64_tr_b16 v[96:97], v213 offset:20736
    ds_read_b64_tr_b16 v[98:99], v213 offset:25856
    s_waitcnt lgkmcnt(10)
    v_mfma_f32_16x16x32_bf16 v[24:27], v[108:111], v[128:131], v[24:27]
    v_mfma_f32_16x16x32_bf16 v[28:31], v[108:111], v[132:135], v[28:31]
    ds_read_b64_tr_b16 v[100:101], v214 offset:20736
    ds_read_b64_tr_b16 v[102:103], v214 offset:25856
    s_waitcnt lgkmcnt(10)
    v_mfma_f32_16x16x32_bf16 v[32:35], v[80:83], v[128:131], v[32:35]
    v_mfma_f32_16x16x32_bf16 v[36:39], v[80:83], v[132:135], v[36:39]
    ds_read_b64_tr_b16 v[104:105], v213 offset:30720
    ds_read_b64_tr_b16 v[106:107], v213 offset:35840
    s_waitcnt lgkmcnt(10)
    v_mfma_f32_16x16x32_bf16 v[40:43], v[84:87], v[128:131], v[40:43]
    v_mfma_f32_16x16x32_bf16 v[44:47], v[84:87], v[132:135], v[44:47]
    ds_read_b64_tr_b16 v[108:109], v214 offset:30720
    ds_read_b64_tr_b16 v[110:111], v214 offset:35840
    s_waitcnt lgkmcnt(10)
    v_mfma_f32_16x16x32_bf16 v[48:51], v[88:91], v[128:131], v[48:51]
    v_mfma_f32_16x16x32_bf16 v[52:55], v[88:91], v[132:135], v[52:55]
    ds_read_b64_tr_b16 v[80:81], v213 offset:30784
    ds_read_b64_tr_b16 v[82:83], v213 offset:35904
    s_waitcnt lgkmcnt(10)
    v_mfma_f32_16x16x32_bf16 v[56:59], v[92:95], v[128:131], v[56:59]
    v_mfma_f32_16x16x32_bf16 v[60:63], v[92:95], v[132:135], v[60:63]
    ds_read_b64_tr_b16 v[84:85], v214 offset:30784
    ds_read_b64_tr_b16 v[86:87], v214 offset:35904
    s_waitcnt lgkmcnt(10)
    v_mfma_f32_16x16x32_bf16 v[64:67], v[96:99], v[128:131], v[64:67]
    v_mfma_f32_16x16x32_bf16 v[68:71], v[96:99], v[132:135], v[68:71]
    ds_read_b64_tr_b16 v[88:89], v213 offset:30848
    ds_read_b64_tr_b16 v[90:91], v213 offset:35968
    s_waitcnt lgkmcnt(10)
    v_mfma_f32_16x16x32_bf16 v[72:75], v[100:103], v[128:131], v[72:75]
    v_mfma_f32_16x16x32_bf16 v[76:79], v[100:103], v[132:135], v[76:79]
    ds_read_b64_tr_b16 v[92:93], v214 offset:30848
    ds_read_b64_tr_b16 v[94:95], v214 offset:35968
    s_waitcnt lgkmcnt(10)
    v_mfma_f32_16x16x32_bf16 v[0:3], v[104:107], v[136:139], v[0:3]
    v_mfma_f32_16x16x32_bf16 v[4:7], v[104:107], v[140:143], v[4:7]
    ds_read_b64_tr_b16 v[96:97], v213 offset:30912
    ds_read_b64_tr_b16 v[98:99], v213 offset:36032
    s_waitcnt lgkmcnt(10)
    v_mfma_f32_16x16x32_bf16 v[8:11], v[108:111], v[136:139], v[8:11]
    v_mfma_f32_16x16x32_bf16 v[12:15], v[108:111], v[140:143], v[12:15]
    ds_read_b64_tr_b16 v[100:101], v214 offset:30912
    ds_read_b64_tr_b16 v[102:103], v214 offset:36032
    s_waitcnt lgkmcnt(10)
    v_mfma_f32_16x16x32_bf16 v[16:19], v[80:83], v[136:139], v[16:19]
    v_mfma_f32_16x16x32_bf16 v[20:23], v[80:83], v[140:143], v[20:23]
    ds_read_b64_tr_b16 v[104:105], v213 offset:30976
    ds_read_b64_tr_b16 v[106:107], v213 offset:36096
    s_waitcnt lgkmcnt(10)
    v_mfma_f32_16x16x32_bf16 v[24:27], v[84:87], v[136:139], v[24:27]
    v_mfma_f32_16x16x32_bf16 v[28:31], v[84:87], v[140:143], v[28:31]
    ds_read_b64_tr_b16 v[108:109], v214 offset:30976
    ds_read_b64_tr_b16 v[110:111], v214 offset:36096
    s_waitcnt lgkmcnt(10)
    v_mfma_f32_16x16x32_bf16 v[32:35], v[88:91], v[136:139], v[32:35]
    v_mfma_f32_16x16x32_bf16 v[36:39], v[88:91], v[140:143], v[36:39]
    s_waitcnt vmcnt(0)
    s_barrier
    s_waitcnt lgkmcnt(8)
    v_mfma_f32_16x16x32_bf16 v[40:43], v[92:95], v[136:139], v[40:43]
    v_mfma_f32_16x16x32_bf16 v[44:47], v[92:95], v[140:143], v[44:47]
    s_waitcnt lgkmcnt(6)
    v_mfma_f32_16x16x32_bf16 v[48:51], v[96:99], v[136:139], v[48:51]
    v_mfma_f32_16x16x32_bf16 v[52:55], v[96:99], v[140:143], v[52:55]
    s_waitcnt lgkmcnt(4)
    v_mfma_f32_16x16x32_bf16 v[56:59], v[100:103], v[136:139], v[56:59]
    v_mfma_f32_16x16x32_bf16 v[60:63], v[100:103], v[140:143], v[60:63]
    s_waitcnt lgkmcnt(2)
    v_mfma_f32_16x16x32_bf16 v[64:67], v[104:107], v[136:139], v[64:67]
    v_mfma_f32_16x16x32_bf16 v[68:71], v[104:107], v[140:143], v[68:71]
    s_waitcnt lgkmcnt(0)
    v_mfma_f32_16x16x32_bf16 v[72:75], v[108:111], v[136:139], v[72:75]
    v_mfma_f32_16x16x32_bf16 v[76:79], v[108:111], v[140:143], v[76:79]
    s_waitcnt lgkmcnt(0)
    s_lshl_b32 s52, s2, 3
    s_add_u32 s52, s52, s44
    s_mul_i32 s59, s52, 20480
    s_mov_b32 s55, 40960
    v_mov_b32 v223, 0
    v_mbcnt_lo_u32_b32 v224, -1, 0
    v_and_b32 v224, 3, v224
    v_lshlrev_b32 v224, 3, v224
    v_xor_b32 v224, s52, v224
    v_lshlrev_b32 v224, 5, v224
    s_cmp_lg_u32 s48, 0
    s_cbranch_scc1 K2_V1
    ds_read_b64_tr_b16 v[80:81], v213 offset:41024
    ds_read_b64_tr_b16 v[82:83], v213 offset:46144
    ds_read_b64_tr_b16 v[84:85], v214 offset:41024
    ds_read_b64_tr_b16 v[86:87], v214 offset:46144
    ds_read_b64_tr_b16 v[88:89], v213 offset:51264
    ds_read_b64_tr_b16 v[90:91], v213 offset:56384
    ds_read_b64_tr_b16 v[92:93], v214 offset:51264
    ds_read_b64_tr_b16 v[94:95], v214 offset:56384
    ds_read_b64_tr_b16 v[96:97], v215 offset:64
    ds_read_b64_tr_b16 v[98:99], v215 offset:5184
    ds_read_b64_tr_b16 v[100:101], v216 offset:64
    ds_read_b64_tr_b16 v[102:103], v216 offset:5184
    s_waitcnt lgkmcnt(10)
    v_mfma_f32_16x16x32_bf16 v[16:19], v[80:83], v[144:147], v[16:19]
    v_mfma_f32_16x16x32_bf16 v[20:23], v[80:83], v[148:151], v[20:23]
    ds_read_b64_tr_b16 v[104:105], v215 offset:10304
    ds_read_b64_tr_b16 v[106:107], v215 offset:15424
    s_waitcnt lgkmcnt(10)
    v_mfma_f32_16x16x32_bf16 v[24:27], v[84:87], v[144:147], v[24:27]
    v_mfma_f32_16x16x32_bf16 v[28:31], v[84:87], v[148:151], v[28:31]
    ds_read_b64_tr_b16 v[108:109], v216 offset:10304
    ds_read_b64_tr_b16 v[110:111], v216 offset:15424
    s_waitcnt lgkmcnt(10)
    v_mfma_f32_16x16x32_bf16 v[16:19], v[88:91], v[152:155], v[16:19]
    v_mfma_f32_16x16x32_bf16 v[20:23], v[88:91], v[156:159], v[20:23]
    ds_read_b64_tr_b16 v[80:81], v215 offset:20544
    ds_read_b64_tr_b16 v[82:83], v215 offset:25664
    s_waitcnt lgkmcnt(10)
    v_mfma_f32_16x16x32_bf16 v[24:27], v[92:95], v[152:155], v[24:27]
    v_mfma_f32_16x16x32_bf16 v[28:31], v[92:95], v[156:159], v[28:31]
    ds_read_b64_tr_b16 v[84:85], v216 offset:20544
    ds_read_b64_tr_b16 v[86:87], v216 offset:25664
    s_waitcnt lgkmcnt(10)
    v_mfma_f32_16x16x32_bf16 v[16:19], v[96:99], v[160:163], v[16:19]
    v_mfma_f32_16x16x32_bf16 v[20:23], v[96:99], v[164:167], v[20:23]
    ds_read_b64_tr_b16 v[88:89], v215 offset:30784
    ds_read_b64_tr_b16 v[90:91], v215 offset:35904
    s_waitcnt lgkmcnt(10)
    v_mfma_f32_16x16x32_bf16 v[24:27], v[100:103], v[160:163], v[24:27]
    v_mfma_f32_16x16x32_bf16 v[28:31], v[100:103], v[164:167], v[28:31]
    ds_read_b64_tr_b16 v[92:93], v216 offset:30784
    ds_read_b64_tr_b16 v[94:95], v216 offset:35904
    s_waitcnt lgkmcnt(10)
    v_mfma_f32_16x16x32_bf16 v[16:19], v[104:107], v[168:171], v[16:19]
    v_mfma_f32_16x16x32_bf16 v[20:23], v[104:107], v[172:175], v[20:23]
    ds_read_b64_tr_b16 v[96:97], v215 offset:41024
    ds_read_b64_tr_b16 v[98:99], v215 offset:46144
    s_waitcnt lgkmcnt(10)
    v_mfma_f32_16x16x32_bf16 v[24:27], v[108:111], v[168:171], v[24:27]
    v_mfma_f32_16x16x32_bf16 v[28:31], v[108:111], v[172:175], v[28:31]
    ds_read_b64_tr_b16 v[100:101], v216 offset:41024
    ds_read_b64_tr_b16 v[102:103], v216 offset:46144
    s_waitcnt lgkmcnt(10)
    v_mfma_f32_16x16x32_bf16 v[16:19], v[80:83], v[176:179], v[16:19]
    v_mfma_f32_16x16x32_bf16 v[20:23], v[80:83], v[180:183], v[20:23]
    ds_read_b64_tr_b16 v[104:105], v215 offset:51264
    ds_read_b64_tr_b16 v[106:107], v215 offset:56384
    s_waitcnt lgkmcnt(10)
    v_mfma_f32_16x16x32_bf16 v[24:27], v[84:87], v[176:179], v[24:27]
    v_mfma_f32_16x16x32_bf16 v[28:31], v[84:87], v[180:183], v[28:31]
    ds_read_b64_tr_b16 v[108:109], v216 offset:51264
    ds_read_b64_tr_b16 v[110:111], v216 offset:56384
    s_waitcnt lgkmcnt(10)
    v_mfma_f32_16x16x32_bf16 v[16:19], v[88:91], v[184:187], v[16:19]
    v_mfma_f32_16x16x32_bf16 v[20:23], v[88:91], v[188:191], v[20:23]
    ds_read_b64_tr_b16 v[80:81], v213 offset:41088
    ds_read_b64_tr_b16 v[82:83], v213 offset:46208
    s_waitcnt lgkmcnt(10)
    v_mfma_f32_16x16x32_bf16 v[24:27], v[92:95], v[184:187], v[24:27]
    v_mfma_f32_16x16x32_bf16 v[28:31], v[92:95], v[188:191], v[28:31]
    ds_read_b64_tr_b16 v[84:85], v214 offset:41088
    ds_read_b64_tr_b16 v[86:87], v214 offset:46208
    s_waitcnt lgkmcnt(10)
    v_mfma_f32_16x16x32_bf16 v[16:19], v[96:99], v[192:195], v[16:19]
    v_mfma_f32_16x16x32_bf16 v[20:23], v[96:99], v[196:199], v[20:23]
    ds_read_b64_tr_b16 v[88:89], v213 offset:51328
    ds_read_b64_tr_b16 v[90:91], v213 offset:56448
    s_waitcnt lgkmcnt(10)
    v_mfma_f32_16x16x32_bf16 v[24:27], v[100:103], v[192:195], v[24:27]
    v_mfma_f32_16x16x32_bf16 v[28:31], v[100:103], v[196:199], v[28:31]
    ds_read_b64_tr_b16 v[92:93], v214 offset:51328
    ds_read_b64_tr_b16 v[94:95], v214 offset:56448
    s_waitcnt lgkmcnt(10)
    v_mfma_f32_16x16x32_bf16 v[16:19], v[104:107], v[200:203], v[16:19]
    v_mfma_f32_16x16x32_bf16 v[20:23], v[104:107], v[204:207], v[20:23]
    ds_read_b64_tr_b16 v[96:97], v215 offset:128
    ds_read_b64_tr_b16 v[98:99], v215 offset:5248
    s_waitcnt lgkmcnt(10)
    v_mfma_f32_16x16x32_bf16 v[24:27], v[108:111], v[200:203], v[24:27]
    v_mfma_f32_16x16x32_bf16 v[28:31], v[108:111], v[204:207], v[28:31]
    ds_read_b64_tr_b16 v[100:101], v216 offset:128
    ds_read_b64_tr_b16 v[102:103], v216 offset:5248
    s_waitcnt lgkmcnt(10)
    v_mfma_f32_16x16x32_bf16 v[32:35], v[80:83], v[144:147], v[32:35]
    v_mfma_f32_16x16x32_bf16 v[36:39], v[80:83], v[148:151], v[36:39]
    ds_read_b64_tr_b16 v[104:105], v215 offset:10368
    ds_read_b64_tr_b16 v[106:107], v215 offset:15488
    s_waitcnt lgkmcnt(10)
    v_mfma_f32_16x16x32_bf16 v[40:43], v[84:87], v[144:147], v[40:43]
    v_mfma_f32_16x16x32_bf16 v[44:47], v[84:87], v[148:151], v[44:47]
    ds_read_b64_tr_b16 v[108:109], v216 offset:10368
    ds_read_b64_tr_b16 v[110:111], v216 offset:15488
    s_waitcnt lgkmcnt(10)
    v_mfma_f32_16x16x32_bf16 v[32:35], v[88:91], v[152:155], v[32:35]
    v_mfma_f32_16x16x32_bf16 v[36:39], v[88:91], v[156:159], v[36:39]
    ds_read_b64_tr_b16 v[80:81], v215 offset:20608
    ds_read_b64_tr_b16 v[82:83], v215 offset:25728
    s_waitcnt lgkmcnt(10)
    v_mfma_f32_16x16x32_bf16 v[40:43], v[92:95], v[152:155], v[40:43]
    v_mfma_f32_16x16x32_bf16 v[44:47], v[92:95], v[156:159], v[44:47]
    ds_read_b64_tr_b16 v[84:85], v216 offset:20608
    ds_read_b64_tr_b16 v[86:87], v216 offset:25728
    s_waitcnt lgkmcnt(10)
    v_mfma_f32_16x16x32_bf16 v[32:35], v[96:99], v[160:163], v[32:35]
    v_mfma_f32_16x16x32_bf16 v[36:39], v[96:99], v[164:167], v[36:39]
    ds_read_b64_tr_b16 v[88:89], v215 offset:30848
    ds_read_b64_tr_b16 v[90:91], v215 offset:35968
    s_waitcnt lgkmcnt(10)
    v_mfma_f32_16x16x32_bf16 v[40:43], v[100:103], v[160:163], v[40:43]
    v_mfma_f32_16x16x32_bf16 v[44:47], v[100:103], v[164:167], v[44:47]
    ds_read_b64_tr_b16 v[92:93], v216 offset:30848
    ds_read_b64_tr_b16 v[94:95], v216 offset:35968
    s_add_u32 s53, s59, 0
    buffer_store_dwordx4 v[16:19], v220, s[36:39], s53 offen offset:2048 sc1
    s_add_u32 s53, s59, 0
    buffer_store_dwordx4 v[24:27], v220, s[36:39], s53 offen offset:3072 sc1
    s_add_u32 s53, s59, 12288
    buffer_store_dwordx4 v[20:23], v220, s[36:39], s53 offen offset:0 sc1
    s_add_u32 s53, s59, 12288
    buffer_store_dwordx4 v[28:31], v220, s[36:39], s53 offen offset:1024 sc1
    s_waitcnt lgkmcnt(10)
    v_mfma_f32_16x16x32_bf16 v[32:35], v[104:107], v[168:171], v[32:35]
    v_mfma_f32_16x16x32_bf16 v[36:39], v[104:107], v[172:175], v[36:39]
    ds_read_b64_tr_b16 v[96:97], v215 offset:41088
    ds_read_b64_tr_b16 v[98:99], v215 offset:46208
    s_waitcnt lgkmcnt(10)
    v_mfma_f32_16x16x32_bf16 v[40:43], v[108:111], v[168:171], v[40:43]
    v_mfma_f32_16x16x32_bf16 v[44:47], v[108:111], v[172:175], v[44:47]
    ds_read_b64_tr_b16 v[100:101], v216 offset:41088
    ds_read_b64_tr_b16 v[102:103], v216 offset:46208
    s_waitcnt lgkmcnt(10)
    v_mfma_f32_16x16x32_bf16 v[32:35], v[80:83], v[176:179], v[32:35]
    v_mfma_f32_16x16x32_bf16 v[36:39], v[80:83], v[180:183], v[36:39]
    ds_read_b64_tr_b16 v[104:105], v215 offset:51328
    ds_read_b64_tr_b16 v[106:107], v215 offset:56448
    s_waitcnt lgkmcnt(10)
    v_mfma_f32_16x16x32_bf16 v[40:43], v[84:87], v[176:179], v[40:43]
    v_mfma_f32_16x16x32_bf16 v[44:47], v[84:87], v[180:183], v[44:47]
    ds_read_b64_tr_b16 v[108:109], v216 offset:51328
    ds_read_b64_tr_b16 v[110:111], v216 offset:56448
    s_waitcnt lgkmcnt(10)
    v_mfma_f32_16x16x32_bf16 v[32:35], v[88:91], v[184:187], v[32:35]
    v_mfma_f32_16x16x32_bf16 v[36:39], v[88:91], v[188:191], v[36:39]
    ds_read_b64_tr_b16 v[80:81], v213 offset:41152
    ds_read_b64_tr_b16 v[82:83], v213 offset:46272
    s_waitcnt lgkmcnt(10)
    v_mfma_f32_16x16x32_bf16 v[40:43], v[92:95], v[184:187], v[40:43]
    v_mfma_f32_16x16x32_bf16 v[44:47], v[92:95], v[188:191], v[44:47]
    ds_read_b64_tr_b16 v[84:85], v214 offset:41152
    ds_read_b64_tr_b16 v[86:87], v214 offset:46272
    s_waitcnt lgkmcnt(10)
    v_mfma_f32_16x16x32_bf16 v[32:35], v[96:99], v[192:195], v[32:35]
    v_mfma_f32_16x16x32_bf16 v[36:39], v[96:99], v[196:199], v[36:39]
    ds_read_b64_tr_b16 v[88:89], v213 offset:51392
    ds_read_b64_tr_b16 v[90:91], v213 offset:56512
    s_waitcnt lgkmcnt(10)
    v_mfma_f32_16x16x32_bf16 v[40:43], v[100:103], v[192:195], v[40:43]
    v_mfma_f32_16x16x32_bf16 v[44:47], v[100:103], v[196:199], v[44:47]
    ds_read_b64_tr_b16 v[92:93], v214 offset:51392
    ds_read_b64_tr_b16 v[94:95], v214 offset:56512
    s_waitcnt lgkmcnt(10)
    v_mfma_f32_16x16x32_bf16 v[32:35], v[104:107], v[200:203], v[32:35]
    v_mfma_f32_16x16x32_bf16 v[36:39], v[104:107], v[204:207], v[36:39]
    ds_read_b64_tr_b16 v[96:97], v215 offset:192
    ds_read_b64_tr_b16 v[98:99], v215 offset:5312
    s_waitcnt lgkmcnt(10)
    v_mfma_f32_16x16x32_bf16 v[40:43], v[108:111], v[200:203], v[40:43]
    v_mfma_f32_16x16x32_bf16 v[44:47], v[108:111], v[204:207], v[44:47]
    ds_read_b64_tr_b16 v[100:101], v216 offset:192
    ds_read_b64_tr_b16 v[102:103], v216 offset:5312
    s_waitcnt lgkmcnt(10)
    v_mfma_f32_16x16x32_bf16 v[48:51], v[80:83], v[144:147], v[48:51]
    v_mfma_f32_16x16x32_bf16 v[52:55], v[80:83], v[148:151], v[52:55]
    ds_read_b64_tr_b16 v[104:105], v215 offset:10432
    ds_read_b64_tr_b16 v[106:107], v215 offset:15552
    s_waitcnt lgkmcnt(10)
    v_mfma_f32_16x16x32_bf16 v[56:59], v[84:87], v[144:147], v[56:59]
    v_mfma_f32_16x16x32_bf16 v[60:63], v[84:87], v[148:151], v[60:63]
    ds_read_b64_tr_b16 v[108:109], v216 offset:10432
    ds_read_b64_tr_b16 v[110:111], v216 offset:15552
    s_waitcnt lgkmcnt(10)
    v_mfma_f32_16x16x32_bf16 v[48:51], v[88:91], v[152:155], v[48:51]
    v_mfma_f32_16x16x32_bf16 v[52:55], v[88:91], v[156:159], v[52:55]
    ds_read_b64_tr_b16 v[80:81], v215 offset:20672
    ds_read_b64_tr_b16 v[82:83], v215 offset:25792
    s_waitcnt lgkmcnt(10)
    v_mfma_f32_16x16x32_bf16 v[56:59], v[92:95], v[152:155], v[56:59]
    v_mfma_f32_16x16x32_bf16 v[60:63], v[92:95], v[156:159], v[60:63]
    ds_read_b64_tr_b16 v[84:85], v216 offset:20672
    ds_read_b64_tr_b16 v[86:87], v216 offset:25792
    s_waitcnt lgkmcnt(10)
    v_mfma_f32_16x16x32_bf16 v[48:51], v[96:99], v[160:163], v[48:51]
    v_mfma_f32_16x16x32_bf16 v[52:55], v[96:99], v[164:167], v[52:55]
    ds_read_b64_tr_b16 v[88:89], v215 offset:30912
    ds_read_b64_tr_b16 v[90:91], v215 offset:36032
    s_waitcnt lgkmcnt(10)
    v_mfma_f32_16x16x32_bf16 v[56:59], v[100:103], v[160:163], v[56:59]
    v_mfma_f32_16x16x32_bf16 v[60:63], v[100:103], v[164:167], v[60:63]
    ds_read_b64_tr_b16 v[92:93], v216 offset:30912
    ds_read_b64_tr_b16 v[94:95], v216 offset:36032
    s_add_u32 s53, s59, 4096
    buffer_store_dwordx4 v[32:35], v220, s[36:39], s53 offen offset:0 sc1
    s_add_u32 s53, s59, 4096
    buffer_store_dwordx4 v[40:43], v220, s[36:39], s53 offen offset:1024 sc1
    s_add_u32 s53, s59, 12288
    buffer_store_dwordx4 v[36:39], v220, s[36:39], s53 offen offset:2048 sc1
    s_add_u32 s53, s59, 12288
    buffer_store_dwordx4 v[44:47], v220, s[36:39], s53 offen offset:3072 sc1
    s_waitcnt lgkmcnt(10)
    v_mfma_f32_16x16x32_bf16 v[48:51], v[104:107], v[168:171], v[48:51]
    v_mfma_f32_16x16x32_bf16 v[52:55], v[104:107], v[172:175], v[52:55]
    ds_read_b64_tr_b16 v[96:97], v215 offset:41152
    ds_read_b64_tr_b16 v[98:99], v215 offset:46272
    s_waitcnt lgkmcnt(10)
    v_mfma_f32_16x16x32_bf16 v[56:59], v[108:111], v[168:171], v[56:59]
    v_mfma_f32_16x16x32_bf16 v[60:63], v[108:111], v[172:175], v[60:63]
    ds_read_b64_tr_b16 v[100:101], v216 offset:41152
    ds_read_b64_tr_b16 v[102:103], v216 offset:46272
    s_waitcnt lgkmcnt(10)
    v_mfma_f32_16x16x32_bf16 v[48:51], v[80:83], v[176:179], v[48:51]
    v_mfma_f32_16x16x32_bf16 v[52:55], v[80:83], v[180:183], v[52:55]
    ds_read_b64_tr_b16 v[104:105], v215 offset:51392
    ds_read_b64_tr_b16 v[106:107], v215 offset:56512
    s_waitcnt lgkmcnt(10)
    v_mfma_f32_16x16x32_bf16 v[56:59], v[84:87], v[176:179], v[56:59]
    v_mfma_f32_16x16x32_bf16 v[60:63], v[84:87], v[180:183], v[60:63]
    ds_read_b64_tr_b16 v[108:109], v216 offset:51392
    ds_read_b64_tr_b16 v[110:111], v216 offset:56512
    s_waitcnt lgkmcnt(10)
    v_mfma_f32_16x16x32_bf16 v[48:51], v[88:91], v[184:187], v[48:51]
    v_mfma_f32_16x16x32_bf16 v[52:55], v[88:91], v[188:191], v[52:55]
    ds_read_b64_tr_b16 v[80:81], v213 offset:41216
    ds_read_b64_tr_b16 v[82:83], v213 offset:46336
    s_waitcnt lgkmcnt(10)
    v_mfma_f32_16x16x32_bf16 v[56:59], v[92:95], v[184:187], v[56:59]
    v_mfma_f32_16x16x32_bf16 v[60:63], v[92:95], v[188:191], v[60:63]
    ds_read_b64_tr_b16 v[84:85], v214 offset:41216
    ds_read_b64_tr_b16 v[86:87], v214 offset:46336
    s_waitcnt lgkmcnt(10)
    v_mfma_f32_16x16x32_bf16 v[48:51], v[96:99], v[192:195], v[48:51]
    v_mfma_f32_16x16x32_bf16 v[52:55], v[96:99], v[196:199], v[52:55]
    ds_read_b64_tr_b16 v[88:89], v213 offset:51456
    ds_read_b64_tr_b16 v[90:91], v213 offset:56576
    s_waitcnt lgkmcnt(10)
    v_mfma_f32_16x16x32_bf16 v[56:59], v[100:103], v[192:195], v[56:59]
    v_mfma_f32_16x16x32_bf16 v[60:63], v[100:103], v[196:199], v[60:63]
    ds_read_b64_tr_b16 v[92:93], v214 offset:51456
    ds_read_b64_tr_b16 v[94:95], v214 offset:56576
    s_waitcnt lgkmcnt(10)
    v_mfma_f32_16x16x32_bf16 v[48:51], v[104:107], v[200:203], v[48:51]
    v_mfma_f32_16x16x32_bf16 v[52:55], v[104:107], v[204:207], v[52:55]
    ds_read_b64_tr_b16 v[96:97], v215 offset:256
    ds_read_b64_tr_b16 v[98:99], v215 offset:5376
    s_waitcnt lgkmcnt(10)
    v_mfma_f32_16x16x32_bf16 v[56:59], v[108:111], v[200:203], v[56:59]
    v_mfma_f32_16x16x32_bf16 v[60:63], v[108:111], v[204:207], v[60:63]
    ds_read_b64_tr_b16 v[100:101], v216 offset:256
    ds_read_b64_tr_b16 v[102:103], v216 offset:5376
    s_waitcnt lgkmcnt(10)
    v_mfma_f32_16x16x32_bf16 v[64:67], v[80:83], v[144:147], v[64:67]
    v_mfma_f32_16x16x32_bf16 v[68:71], v[80:83], v[148:151], v[68:71]
    ds_read_b64_tr_b16 v[104:105], v215 offset:10496
    ds_read_b64_tr_b16 v[106:107], v215 offset:15616
    s_waitcnt lgkmcnt(10)
    v_mfma_f32_16x16x32_bf16 v[72:75], v[84:87], v[144:147], v[72:75]
    v_mfma_f32_16x16x32_bf16 v[76:79], v[84:87], v[148:151], v[76:79]
    ds_read_b64_tr_b16 v[108:109], v216 offset:10496
    ds_read_b64_tr_b16 v[110:111], v216 offset:15616
    s_waitcnt lgkmcnt(10)
    v_mfma_f32_16x16x32_bf16 v[64:67], v[88:91], v[152:155], v[64:67]
    v_mfma_f32_16x16x32_bf16 v[68:71], v[88:91], v[156:159], v[68:71]
    ds_read_b64_tr_b16 v[80:81], v215 offset:20736
    ds_read_b64_tr_b16 v[82:83], v215 offset:25856
    s_waitcnt lgkmcnt(10)
    v_mfma_f32_16x16x32_bf16 v[72:75], v[92:95], v[152:155], v[72:75]
    v_mfma_f32_16x16x32_bf16 v[76:79], v[92:95], v[156:159], v[76:79]
    ds_read_b64_tr_b16 v[84:85], v216 offset:20736
    ds_read_b64_tr_b16 v[86:87], v216 offset:25856
    s_waitcnt lgkmcnt(10)
    v_mfma_f32_16x16x32_bf16 v[64:67], v[96:99], v[160:163], v[64:67]
    v_mfma_f32_16x16x32_bf16 v[68:71], v[96:99], v[164:167], v[68:71]
    ds_read_b64_tr_b16 v[88:89], v215 offset:30976
    ds_read_b64_tr_b16 v[90:91], v215 offset:36096
    s_waitcnt lgkmcnt(10)
    v_mfma_f32_16x16x32_bf16 v[72:75], v[100:103], v[160:163], v[72:75]
    v_mfma_f32_16x16x32_bf16 v[76:79], v[100:103], v[164:167], v[76:79]
    ds_read_b64_tr_b16 v[92:93], v216 offset:30976
    ds_read_b64_tr_b16 v[94:95], v216 offset:36096
    s_add_u32 s53, s59, 4096
    buffer_store_dwordx4 v[48:51], v220, s[36:39], s53 offen offset:2048 sc1
    s_add_u32 s53, s59, 4096
    buffer_store_dwordx4 v[56:59], v220, s[36:39], s53 offen offset:3072 sc1
    s_add_u32 s53, s59, 16384
    buffer_store_dwordx4 v[52:55], v220, s[36:39], s53 offen offset:0 sc1
    s_add_u32 s53, s59, 16384
    buffer_store_dwordx4 v[60:63], v220, s[36:39], s53 offen offset:1024 sc1
    s_waitcnt lgkmcnt(10)
    v_mfma_f32_16x16x32_bf16 v[64:67], v[104:107], v[168:171], v[64:67]
    v_mfma_f32_16x16x32_bf16 v[68:71], v[104:107], v[172:175], v[68:71]
    ds_read_b64_tr_b16 v[96:97], v215 offset:41216
    ds_read_b64_tr_b16 v[98:99], v215 offset:46336
    s_waitcnt lgkmcnt(10)
    v_mfma_f32_16x16x32_bf16 v[72:75], v[108:111], v[168:171], v[72:75]
    v_mfma_f32_16x16x32_bf16 v[76:79], v[108:111], v[172:175], v[76:79]
    ds_read_b64_tr_b16 v[100:101], v216 offset:41216
    ds_read_b64_tr_b16 v[102:103], v216 offset:46336
    s_waitcnt lgkmcnt(10)
    v_mfma_f32_16x16x32_bf16 v[64:67], v[80:83], v[176:179], v[64:67]
    v_mfma_f32_16x16x32_bf16 v[68:71], v[80:83], v[180:183], v[68:71]
    ds_read_b64_tr_b16 v[104:105], v215 offset:51456
    ds_read_b64_tr_b16 v[106:107], v215 offset:56576
    s_waitcnt lgkmcnt(10)
    v_mfma_f32_16x16x32_bf16 v[72:75], v[84:87], v[176:179], v[72:75]
    v_mfma_f32_16x16x32_bf16 v[76:79], v[84:87], v[180:183], v[76:79]
    ds_read_b64_tr_b16 v[108:109], v216 offset:51456
    ds_read_b64_tr_b16 v[110:111], v216 offset:56576
    s_waitcnt lgkmcnt(10)
    v_mfma_f32_16x16x32_bf16 v[64:67], v[88:91], v[184:187], v[64:67]
    v_mfma_f32_16x16x32_bf16 v[68:71], v[88:91], v[188:191], v[68:71]
    ds_read_b64_tr_b16 v[80:81], v213 offset:40960
    ds_read_b64_tr_b16 v[82:83], v213 offset:46080
    s_waitcnt lgkmcnt(10)
    v_mfma_f32_16x16x32_bf16 v[72:75], v[92:95], v[184:187], v[72:75]
    v_mfma_f32_16x16x32_bf16 v[76:79], v[92:95], v[188:191], v[76:79]
    ds_read_b64_tr_b16 v[84:85], v214 offset:40960
    ds_read_b64_tr_b16 v[86:87], v214 offset:46080
    s_waitcnt lgkmcnt(10)
    v_mfma_f32_16x16x32_bf16 v[64:67], v[96:99], v[192:195], v[64:67]
    v_mfma_f32_16x16x32_bf16 v[68:71], v[96:99], v[196:199], v[68:71]
    ds_read_b64_tr_b16 v[88:89], v213 offset:51200
    ds_read_b64_tr_b16 v[90:91], v213 offset:56320
    s_waitcnt lgkmcnt(10)
    v_mfma_f32_16x16x32_bf16 v[72:75], v[100:103], v[192:195], v[72:75]
    v_mfma_f32_16x16x32_bf16 v[76:79], v[100:103], v[196:199], v[76:79]
    ds_read_b64_tr_b16 v[92:93], v214 offset:51200
    ds_read_b64_tr_b16 v[94:95], v214 offset:56320
    s_waitcnt lgkmcnt(10)
    v_mfma_f32_16x16x32_bf16 v[64:67], v[104:107], v[200:203], v[64:67]
    v_mfma_f32_16x16x32_bf16 v[68:71], v[104:107], v[204:207], v[68:71]
    ds_read_b64_tr_b16 v[96:97], v215 offset:0
    ds_read_b64_tr_b16 v[98:99], v215 offset:5120
    s_waitcnt lgkmcnt(10)
    v_mfma_f32_16x16x32_bf16 v[72:75], v[108:111], v[200:203], v[72:75]
    v_mfma_f32_16x16x32_bf16 v[76:79], v[108:111], v[204:207], v[76:79]
    ds_read_b64_tr_b16 v[100:101], v216 offset:0
    ds_read_b64_tr_b16 v[102:103], v216 offset:5120
    s_waitcnt lgkmcnt(10)
    v_mfma_f32_16x16x32_bf16 v[0:3], v[80:83], v[144:147], v[0:3]
    v_mfma_f32_16x16x32_bf16 v[4:7], v[80:83], v[148:151], v[4:7]
    ds_read_b64_tr_b16 v[104:105], v215 offset:10240
    ds_read_b64_tr_b16 v[106:107], v215 offset:15360
    s_waitcnt lgkmcnt(10)
    v_mfma_f32_16x16x32_bf16 v[8:11], v[84:87], v[144:147], v[8:11]
    v_mfma_f32_16x16x32_bf16 v[12:15], v[84:87], v[148:151], v[12:15]
    ds_read_b64_tr_b16 v[108:109], v216 offset:10240
    ds_read_b64_tr_b16 v[110:111], v216 offset:15360
    s_waitcnt lgkmcnt(10)
    v_mfma_f32_16x16x32_bf16 v[0:3], v[88:91], v[152:155], v[0:3]
    v_mfma_f32_16x16x32_bf16 v[4:7], v[88:91], v[156:159], v[4:7]
    ds_read_b64_tr_b16 v[80:81], v215 offset:20480
    ds_read_b64_tr_b16 v[82:83], v215 offset:25600
    s_waitcnt lgkmcnt(10)
    v_mfma_f32_16x16x32_bf16 v[8:11], v[92:95], v[152:155], v[8:11]
    v_mfma_f32_16x16x32_bf16 v[12:15], v[92:95], v[156:159], v[12:15]
    ds_read_b64_tr_b16 v[84:85], v216 offset:20480
    ds_read_b64_tr_b16 v[86:87], v216 offset:25600
    s_waitcnt lgkmcnt(10)
    v_mfma_f32_16x16x32_bf16 v[0:3], v[96:99], v[160:163], v[0:3]
    v_mfma_f32_16x16x32_bf16 v[4:7], v[96:99], v[164:167], v[4:7]
    ds_read_b64_tr_b16 v[88:89], v215 offset:30720
    ds_read_b64_tr_b16 v[90:91], v215 offset:35840
    s_waitcnt lgkmcnt(10)
    v_mfma_f32_16x16x32_bf16 v[8:11], v[100:103], v[160:163], v[8:11]
    v_mfma_f32_16x16x32_bf16 v[12:15], v[100:103], v[164:167], v[12:15]
    ds_read_b64_tr_b16 v[92:93], v216 offset:30720
    ds_read_b64_tr_b16 v[94:95], v216 offset:35840
    s_add_u32 s53, s59, 16384
    buffer_store_dwordx4 v[68:71], v220, s[36:39], s53 offen offset:2048 sc1
    s_add_u32 s53, s59, 16384
    buffer_store_dwordx4 v[76:79], v220, s[36:39], s53 offen offset:3072 sc1
    s_waitcnt lgkmcnt(10)
    v_mfma_f32_16x16x32_bf16 v[0:3], v[104:107], v[168:171], v[0:3]
    v_mfma_f32_16x16x32_bf16 v[4:7], v[104:107], v[172:175], v[4:7]
    ds_read_b64_tr_b16 v[96:97], v215 offset:40960
    ds_read_b64_tr_b16 v[98:99], v215 offset:46080
    s_waitcnt lgkmcnt(10)
    v_mfma_f32_16x16x32_bf16 v[8:11], v[108:111], v[168:171], v[8:11]
    v_mfma_f32_16x16x32_bf16 v[12:15], v[108:111], v[172:175], v[12:15]
    ds_read_b64_tr_b16 v[100:101], v216 offset:40960
    ds_read_b64_tr_b16 v[102:103], v216 offset:46080
    s_waitcnt lgkmcnt(10)
    v_mfma_f32_16x16x32_bf16 v[0:3], v[80:83], v[176:179], v[0:3]
    v_mfma_f32_16x16x32_bf16 v[4:7], v[80:83], v[180:183], v[4:7]
    ds_read_b64_tr_b16 v[104:105], v215 offset:51200
    ds_read_b64_tr_b16 v[106:107], v215 offset:56320
    s_waitcnt lgkmcnt(10)
    v_mfma_f32_16x16x32_bf16 v[8:11], v[84:87], v[176:179], v[8:11]
    v_mfma_f32_16x16x32_bf16 v[12:15], v[84:87], v[180:183], v[12:15]
    ds_read_b64_tr_b16 v[108:109], v216 offset:51200
    ds_read_b64_tr_b16 v[110:111], v216 offset:56320
    s_waitcnt lgkmcnt(10)
    v_mfma_f32_16x16x32_bf16 v[0:3], v[88:91], v[184:187], v[0:3]
    v_mfma_f32_16x16x32_bf16 v[4:7], v[88:91], v[188:191], v[4:7]
    s_waitcnt vmcnt(0)
    s_lshl_b32 s54, s52, 5
    v_mov_b32 v222, 1
    s_mov_b64 exec, 1
    buffer_store_dword v222, v223, s[40:43], s54 offen sc1
    s_mov_b64 exec, -1
    s_waitcnt lgkmcnt(8)
    v_mfma_f32_16x16x32_bf16 v[8:11], v[92:95], v[184:187], v[8:11]
    v_mfma_f32_16x16x32_bf16 v[12:15], v[92:95], v[188:191], v[12:15]
    s_waitcnt lgkmcnt(6)
    v_mfma_f32_16x16x32_bf16 v[0:3], v[96:99], v[192:195], v[0:3]
    v_mfma_f32_16x16x32_bf16 v[4:7], v[96:99], v[196:199], v[4:7]
    s_waitcnt lgkmcnt(4)
    v_mfma_f32_16x16x32_bf16 v[8:11], v[100:103], v[192:195], v[8:11]
    v_mfma_f32_16x16x32_bf16 v[12:15], v[100:103], v[196:199], v[12:15]
    s_waitcnt lgkmcnt(2)
    v_mfma_f32_16x16x32_bf16 v[0:3], v[104:107], v[200:203], v[0:3]
    v_mfma_f32_16x16x32_bf16 v[4:7], v[104:107], v[204:207], v[4:7]
    s_waitcnt lgkmcnt(0)
    v_mfma_f32_16x16x32_bf16 v[8:11], v[108:111], v[200:203], v[8:11]
    v_mfma_f32_16x16x32_bf16 v[12:15], v[108:111], v[204:207], v[12:15]
    s_mov_b64 exec, 15
K2_POLL0:
    buffer_load_dword v222, v224, s[40:43], 0 offen sc1
    s_waitcnt vmcnt(0)
    v_cmp_ne_u32 vcc, 1, v222
    s_cbranch_vccz K2_GOT0
    s_sleep 1
    s_branch K2_POLL0
K2_GOT0:
    s_mov_b64 exec, -1
    s_xor_b32 s58, s52, 8
    s_mul_i32 s58, s58, 20480
    s_add_u32 s53, s58, 0
    buffer_load_dwordx4 v[112:115], v220, s[36:39], s53 offen offset:0 sc1
    s_add_u32 s53, s58, 0
    buffer_load_dwordx4 v[116:119], v220, s[36:39], s53 offen offset:1024 sc1
    s_add_u32 s53, s58, 8192
    buffer_load_dwordx4 v[120:123], v220, s[36:39], s53 offen offset:2048 sc1
    s_add_u32 s53, s58, 8192
    buffer_load_dwordx4 v[124:127], v220, s[36:39], s53 offen offset:3072 sc1
    s_add_u32 s53, s58, 8192
    buffer_load_dwordx4 v[128:131], v220, s[36:39], s53 offen offset:0 sc1
    s_add_u32 s53, s58, 8192
    buffer_load_dwordx4 v[132:135], v220, s[36:39], s53 offen offset:1024 sc1
    s_xor_b32 s58, s52, 16
    s_mul_i32 s58, s58, 20480
    s_add_u32 s53, s58, 0
    buffer_load_dwordx4 v[136:139], v220, s[36:39], s53 offen offset:0 sc1
    s_add_u32 s53, s58, 0
    buffer_load_dwordx4 v[140:143], v220, s[36:39], s53 offen offset:1024 sc1
    s_add_u32 s53, s58, 8192
    buffer_load_dwordx4 v[144:147], v220, s[36:39], s53 offen offset:2048 sc1
    s_add_u32 s53, s58, 8192
    buffer_load_dwordx4 v[148:151], v220, s[36:39], s53 offen offset:3072 sc1
    s_add_u32 s53, s58, 8192
    buffer_load_dwordx4 v[152:155], v220, s[36:39], s53 offen offset:0 sc1
    s_add_u32 s53, s58, 8192
    buffer_load_dwordx4 v[156:159], v220, s[36:39], s53 offen offset:1024 sc1
    s_xor_b32 s58, s52, 24
    s_mul_i32 s58, s58, 20480
    s_add_u32 s53, s58, 0
    buffer_load_dwordx4 v[160:163], v220, s[36:39], s53 offen offset:0 sc1
    s_add_u32 s53, s58, 0
    buffer_load_dwordx4 v[164:167], v220, s[36:39], s53 offen offset:1024 sc1
    s_add_u32 s53, s58, 8192
    buffer_load_dwordx4 v[168:171], v220, s[36:39], s53 offen offset:2048 sc1
    s_add_u32 s53, s58, 8192
    buffer_load_dwordx4 v[172:175], v220, s[36:39], s53 offen offset:3072 sc1
    s_add_u32 s53, s58, 8192
    buffer_load_dwordx4 v[176:179], v220, s[36:39], s53 offen offset:0 sc1
    s_add_u32 s53, s58, 8192
    buffer_load_dwordx4 v[180:183], v220, s[36:39], s53 offen offset:1024 sc1
    s_waitcnt vmcnt(17)
    v_add_f32 v0, v0, v112
    v_add_f32 v1, v1, v113
    v_add_f32 v2, v2, v114
    v_add_f32 v3, v3, v115
    s_waitcnt vmcnt(16)
    v_add_f32 v8, v8, v116
    v_add_f32 v9, v9, v117
    v_add_f32 v10, v10, v118
    v_add_f32 v11, v11, v119
    s_waitcnt vmcnt(15)
    v_add_f32 v4, v4, v120
    v_add_f32 v5, v5, v121
    v_add_f32 v6, v6, v122
    v_add_f32 v7, v7, v123
    s_waitcnt vmcnt(14)
    v_add_f32 v12, v12, v124
    v_add_f32 v13, v13, v125
    v_add_f32 v14, v14, v126
    v_add_f32 v15, v15, v127
    s_waitcnt vmcnt(13)
    v_add_f32 v64, v64, v128
    v_add_f32 v65, v65, v129
    v_add_f32 v66, v66, v130
    v_add_f32 v67, v67, v131
    s_waitcnt vmcnt(12)
    v_add_f32 v72, v72, v132
    v_add_f32 v73, v73, v133
    v_add_f32 v74, v74, v134
    v_add_f32 v75, v75, v135
    s_waitcnt vmcnt(11)
    v_add_f32 v0, v0, v136
    v_add_f32 v1, v1, v137
    v_add_f32 v2, v2, v138
    v_add_f32 v3, v3, v139
    s_waitcnt vmcnt(10)
    v_add_f32 v8, v8, v140
    v_add_f32 v9, v9, v141
    v_add_f32 v10, v10, v142
    v_add_f32 v11, v11, v143
    s_waitcnt vmcnt(9)
    v_add_f32 v4, v4, v144
    v_add_f32 v5, v5, v145
    v_add_f32 v6, v6, v146
    v_add_f32 v7, v7, v147
    s_waitcnt vmcnt(8)
    v_add_f32 v12, v12, v148
    v_add_f32 v13, v13, v149
    v_add_f32 v14, v14, v150
    v_add_f32 v15, v15, v151
    s_waitcnt vmcnt(7)
    v_add_f32 v64, v64, v152
    v_add_f32 v65, v65, v153
    v_add_f32 v66, v66, v154
    v_add_f32 v67, v67, v155
    s_waitcnt vmcnt(6)
    v_add_f32 v72, v72, v156
    v_add_f32 v73, v73, v157
    v_add_f32 v74, v74, v158
    v_add_f32 v75, v75, v159
    s_waitcnt vmcnt(5)
    v_add_f32 v0, v0, v160
    v_add_f32 v1, v1, v161
    v_add_f32 v2, v2, v162
    v_add_f32 v3, v3, v163
    s_waitcnt vmcnt(4)
    v_add_f32 v8, v8, v164
    v_add_f32 v9, v9, v165
    v_add_f32 v10, v10, v166
    v_add_f32 v11, v11, v167
    s_waitcnt vmcnt(3)
    v_add_f32 v4, v4, v168
    v_add_f32 v5, v5, v169
    v_add_f32 v6, v6, v170
    v_add_f32 v7, v7, v171
    s_waitcnt vmcnt(2)
    v_add_f32 v12, v12, v172
    v_add_f32 v13, v13, v173
    v_add_f32 v14, v14, v174
    v_add_f32 v15, v15, v175
    s_waitcnt vmcnt(1)
    v_add_f32 v64, v64, v176
    v_add_f32 v65, v65, v177
    v_add_f32 v66, v66, v178
    v_add_f32 v67, v67, v179
    s_waitcnt vmcnt(0)
    v_add_f32 v72, v72, v180
    v_add_f32 v73, v73, v181
    v_add_f32 v74, v74, v182
    v_add_f32 v75, v75, v183
    v_cvt_pk_bf16_f32 v80, v0, v1
    v_cvt_pk_bf16_f32 v81, v2, v3
    v_cvt_pk_bf16_f32 v82, v8, v9
    v_cvt_pk_bf16_f32 v83, v10, v11
    v_cvt_pk_bf16_f32 v84, v4, v5
    v_cvt_pk_bf16_f32 v85, v6, v7
    v_cvt_pk_bf16_f32 v86, v12, v13
    v_cvt_pk_bf16_f32 v87, v14, v15
    v_cvt_pk_bf16_f32 v88, v64, v65
    v_cvt_pk_bf16_f32 v89, v66, v67
    v_cvt_pk_bf16_f32 v90, v72, v73
    v_cvt_pk_bf16_f32 v91, v74, v75
    s_nop 0
    v_permlane32_swap_b32 v80, v82
    v_permlane32_swap_b32 v81, v83
    v_permlane32_swap_b32 v84, v86
    v_permlane32_swap_b32 v85, v87
    v_permlane32_swap_b32 v88, v90
    v_permlane32_swap_b32 v89, v91
    s_nop 0
    v_permlane16_swap_b32 v80, v82
    v_permlane16_swap_b32 v81, v83
    v_permlane16_swap_b32 v84, v86
    v_permlane16_swap_b32 v85, v87
    v_permlane16_swap_b32 v88, v90
    v_permlane16_swap_b32 v89, v91
    s_nop 0
    buffer_store_dwordx4 v[80:83], v219, s[32:35], 0 offen offset:0
    buffer_store_dwordx4 v[84:87], v219, s[32:35], s55 offen offset:0
    buffer_store_dwordx4 v[88:91], v219, s[32:35], 0 offen offset:256
    s_branch K2_FIN
K2_V1:
    s_cmp_lg_u32 s48, 1
    s_cbranch_scc1 K2_V2
    ds_read_b64_tr_b16 v[80:81], v213 offset:40960
    ds_read_b64_tr_b16 v[82:83], v213 offset:46080
    ds_read_b64_tr_b16 v[84:85], v214 offset:40960
    ds_read_b64_tr_b16 v[86:87], v214 offset:46080
    ds_read_b64_tr_b16 v[88:89], v213 offset:51200
    ds_read_b64_tr_b16 v[90:91], v213 offset:56320
    ds_read_b64_tr_b16 v[92:93], v214 offset:51200
    ds_read_b64_tr_b16 v[94:95], v214 offset:56320
    ds_read_b64_tr_b16 v[96:97], v215 offset:0
    ds_read_b64_tr_b16 v[98:99], v215 offset:5120
    ds_read_b64_tr_b16 v[100:101], v216 offset:0
    ds_read_b64_tr_b16 v[102:103], v216 offset:5120
    s_waitcnt lgkmcnt(10)
    v_mfma_f32_16x16x32_bf16 v[0:3], v[80:83], v[144:147], v[0:3]
    v_mfma_f32_16x16x32_bf16 v[4:7], v[80:83], v[148:151], v[4:7]
    ds_read_b64_tr_b16 v[104:105], v215 offset:10240
    ds_read_b64_tr_b16 v[106:107], v215 offset:15360
    s_waitcnt lgkmcnt(10)
    v_mfma_f32_16x16x32_bf16 v[8:11], v[84:87], v[144:147], v[8:11]
    v_mfma_f32_16x16x32_bf16 v[12:15], v[84:87], v[148:151], v[12:15]
    ds_read_b64_tr_b16 v[108:109], v216 offset:10240
    ds_read_b64_tr_b16 v[110:111], v216 offset:15360
    s_waitcnt lgkmcnt(10)
    v_mfma_f32_16x16x32_bf16 v[0:3], v[88:91], v[152:155], v[0:3]
    v_mfma_f32_16x16x32_bf16 v[4:7], v[88:91], v[156:159], v[4:7]
    ds_read_b64_tr_b16 v[80:81], v215 offset:20480
    ds_read_b64_tr_b16 v[82:83], v215 offset:25600
    s_waitcnt lgkmcnt(10)
    v_mfma_f32_16x16x32_bf16 v[8:11], v[92:95], v[152:155], v[8:11]
    v_mfma_f32_16x16x32_bf16 v[12:15], v[92:95], v[156:159], v[12:15]
    ds_read_b64_tr_b16 v[84:85], v216 offset:20480
    ds_read_b64_tr_b16 v[86:87], v216 offset:25600
    s_waitcnt lgkmcnt(10)
    v_mfma_f32_16x16x32_bf16 v[0:3], v[96:99], v[160:163], v[0:3]
    v_mfma_f32_16x16x32_bf16 v[4:7], v[96:99], v[164:167], v[4:7]
    ds_read_b64_tr_b16 v[88:89], v215 offset:30720
    ds_read_b64_tr_b16 v[90:91], v215 offset:35840
    s_waitcnt lgkmcnt(10)
    v_mfma_f32_16x16x32_bf16 v[8:11], v[100:103], v[160:163], v[8:11]
    v_mfma_f32_16x16x32_bf16 v[12:15], v[100:103], v[164:167], v[12:15]
    ds_read_b64_tr_b16 v[92:93], v216 offset:30720
    ds_read_b64_tr_b16 v[94:95], v216 offset:35840
    s_waitcnt lgkmcnt(10)
    v_mfma_f32_16x16x32_bf16 v[0:3], v[104:107], v[168:171], v[0:3]
    v_mfma_f32_16x16x32_bf16 v[4:7], v[104:107], v[172:175], v[4:7]
    ds_read_b64_tr_b16 v[96:97], v215 offset:40960
    ds_read_b64_tr_b16 v[98:99], v215 offset:46080
    s_waitcnt lgkmcnt(10)
    v_mfma_f32_16x16x32_bf16 v[8:11], v[108:111], v[168:171], v[8:11]
    v_mfma_f32_16x16x32_bf16 v[12:15], v[108:111], v[172:175], v[12:15]
    ds_read_b64_tr_b16 v[100:101], v216 offset:40960
    ds_read_b64_tr_b16 v[102:103], v216 offset:46080
    s_waitcnt lgkmcnt(10)
    v_mfma_f32_16x16x32_bf16 v[0:3], v[80:83], v[176:179], v[0:3]
    v_mfma_f32_16x16x32_bf16 v[4:7], v[80:83], v[180:183], v[4:7]
    ds_read_b64_tr_b16 v[104:105], v215 offset:51200
    ds_read_b64_tr_b16 v[106:107], v215 offset:56320
    s_waitcnt lgkmcnt(10)
    v_mfma_f32_16x16x32_bf16 v[8:11], v[84:87], v[176:179], v[8:11]
    v_mfma_f32_16x16x32_bf16 v[12:15], v[84:87], v[180:183], v[12:15]
    ds_read_b64_tr_b16 v[108:109], v216 offset:51200
    ds_read_b64_tr_b16 v[110:111], v216 offset:56320
    s_waitcnt lgkmcnt(10)
    v_mfma_f32_16x16x32_bf16 v[0:3], v[88:91], v[184:187], v[0:3]
    v_mfma_f32_16x16x32_bf16 v[4:7], v[88:91], v[188:191], v[4:7]
    ds_read_b64_tr_b16 v[80:81], v213 offset:41088
    ds_read_b64_tr_b16 v[82:83], v213 offset:46208
    s_waitcnt lgkmcnt(10)
    v_mfma_f32_16x16x32_bf16 v[8:11], v[92:95], v[184:187], v[8:11]
    v_mfma_f32_16x16x32_bf16 v[12:15], v[92:95], v[188:191], v[12:15]
    ds_read_b64_tr_b16 v[84:85], v214 offset:41088
    ds_read_b64_tr_b16 v[86:87], v214 offset:46208
    s_waitcnt lgkmcnt(10)
    v_mfma_f32_16x16x32_bf16 v[0:3], v[96:99], v[192:195], v[0:3]
    v_mfma_f32_16x16x32_bf16 v[4:7], v[96:99], v[196:199], v[4:7]
    ds_read_b64_tr_b16 v[88:89], v213 offset:51328
    ds_read_b64_tr_b16 v[90:91], v213 offset:56448
    s_waitcnt lgkmcnt(10)
    v_mfma_f32_16x16x32_bf16 v[8:11], v[100:103], v[192:195], v[8:11]
    v_mfma_f32_16x16x32_bf16 v[12:15], v[100:103], v[196:199], v[12:15]
    ds_read_b64_tr_b16 v[92:93], v214 offset:51328
    ds_read_b64_tr_b16 v[94:95], v214 offset:56448
    s_waitcnt lgkmcnt(10)
    v_mfma_f32_16x16x32_bf16 v[0:3], v[104:107], v[200:203], v[0:3]
    v_mfma_f32_16x16x32_bf16 v[4:7], v[104:107], v[204:207], v[4:7]
    ds_read_b64_tr_b16 v[96:97], v215 offset:128
    ds_read_b64_tr_b16 v[98:99], v215 offset:5248
    s_waitcnt lgkmcnt(10)
    v_mfma_f32_16x16x32_bf16 v[8:11], v[108:111], v[200:203], v[8:11]
    v_mfma_f32_16x16x32_bf16 v[12:15], v[108:111], v[204:207], v[12:15]
    ds_read_b64_tr_b16 v[100:101], v216 offset:128
    ds_read_b64_tr_b16 v[102:103], v216 offset:5248
    s_waitcnt lgkmcnt(10)
    v_mfma_f32_16x16x32_bf16 v[32:35], v[80:83], v[144:147], v[32:35]
    v_mfma_f32_16x16x32_bf16 v[36:39], v[80:83], v[148:151], v[36:39]
    ds_read_b64_tr_b16 v[104:105], v215 offset:10368
    ds_read_b64_tr_b16 v[106:107], v215 offset:15488
    s_waitcnt lgkmcnt(10)
    v_mfma_f32_16x16x32_bf16 v[40:43], v[84:87], v[144:147], v[40:43]
    v_mfma_f32_16x16x32_bf16 v[44:47], v[84:87], v[148:151], v[44:47]
    ds_read_b64_tr_b16 v[108:109], v216 offset:10368
    ds_read_b64_tr_b16 v[110:111], v216 offset:15488
    s_waitcnt lgkmcnt(10)
    v_mfma_f32_16x16x32_bf16 v[32:35], v[88:91], v[152:155], v[32:35]
    v_mfma_f32_16x16x32_bf16 v[36:39], v[88:91], v[156:159], v[36:39]
    ds_read_b64_tr_b16 v[80:81], v215 offset:20608
    ds_read_b64_tr_b16 v[82:83], v215 offset:25728
    s_waitcnt lgkmcnt(10)
    v_mfma_f32_16x16x32_bf16 v[40:43], v[92:95], v[152:155], v[40:43]
    v_mfma_f32_16x16x32_bf16 v[44:47], v[92:95], v[156:159], v[44:47]
    ds_read_b64_tr_b16 v[84:85], v216 offset:20608
    ds_read_b64_tr_b16 v[86:87], v216 offset:25728
    s_waitcnt lgkmcnt(10)
    v_mfma_f32_16x16x32_bf16 v[32:35], v[96:99], v[160:163], v[32:35]
    v_mfma_f32_16x16x32_bf16 v[36:39], v[96:99], v[164:167], v[36:39]
    ds_read_b64_tr_b16 v[88:89], v215 offset:30848
    ds_read_b64_tr_b16 v[90:91], v215 offset:35968
    s_waitcnt lgkmcnt(10)
    v_mfma_f32_16x16x32_bf16 v[40:43], v[100:103], v[160:163], v[40:43]
    v_mfma_f32_16x16x32_bf16 v[44:47], v[100:103], v[164:167], v[44:47]
    ds_read_b64_tr_b16 v[92:93], v216 offset:30848
    ds_read_b64_tr_b16 v[94:95], v216 offset:35968
    s_add_u32 s53, s59, 0
    buffer_store_dwordx4 v[0:3], v220, s[36:39], s53 offen offset:0 sc1
    s_add_u32 s53, s59, 0
    buffer_store_dwordx4 v[8:11], v220, s[36:39], s53 offen offset:1024 sc1
    s_add_u32 s53, s59, 8192
    buffer_store_dwordx4 v[4:7], v220, s[36:39], s53 offen offset:2048 sc1
    s_add_u32 s53, s59, 8192
    buffer_store_dwordx4 v[12:15], v220, s[36:39], s53 offen offset:3072 sc1
    s_waitcnt lgkmcnt(10)
    v_mfma_f32_16x16x32_bf16 v[32:35], v[104:107], v[168:171], v[32:35]
    v_mfma_f32_16x16x32_bf16 v[36:39], v[104:107], v[172:175], v[36:39]
    ds_read_b64_tr_b16 v[96:97], v215 offset:41088
    ds_read_b64_tr_b16 v[98:99], v215 offset:46208
    s_waitcnt lgkmcnt(10)
    v_mfma_f32_16x16x32_bf16 v[40:43], v[108:111], v[168:171], v[40:43]
    v_mfma_f32_16x16x32_bf16 v[44:47], v[108:111], v[172:175], v[44:47]
    ds_read_b64_tr_b16 v[100:101], v216 offset:41088
    ds_read_b64_tr_b16 v[102:103], v216 offset:46208
    s_waitcnt lgkmcnt(10)
    v_mfma_f32_16x16x32_bf16 v[32:35], v[80:83], v[176:179], v[32:35]
    v_mfma_f32_16x16x32_bf16 v[36:39], v[80:83], v[180:183], v[36:39]
    ds_read_b64_tr_b16 v[104:105], v215 offset:51328
    ds_read_b64_tr_b16 v[106:107], v215 offset:56448
    s_waitcnt lgkmcnt(10)
    v_mfma_f32_16x16x32_bf16 v[40:43], v[84:87], v[176:179], v[40:43]
    v_mfma_f32_16x16x32_bf16 v[44:47], v[84:87], v[180:183], v[44:47]
    ds_read_b64_tr_b16 v[108:109], v216 offset:51328
    ds_read_b64_tr_b16 v[110:111], v216 offset:56448
    s_waitcnt lgkmcnt(10)
    v_mfma_f32_16x16x32_bf16 v[32:35], v[88:91], v[184:187], v[32:35]
    v_mfma_f32_16x16x32_bf16 v[36:39], v[88:91], v[188:191], v[36:39]
    ds_read_b64_tr_b16 v[80:81], v213 offset:41152
    ds_read_b64_tr_b16 v[82:83], v213 offset:46272
    s_waitcnt lgkmcnt(10)
    v_mfma_f32_16x16x32_bf16 v[40:43], v[92:95], v[184:187], v[40:43]
    v_mfma_f32_16x16x32_bf16 v[44:47], v[92:95], v[188:191], v[44:47]
    ds_read_b64_tr_b16 v[84:85], v214 offset:41152
    ds_read_b64_tr_b16 v[86:87], v214 offset:46272
    s_waitcnt lgkmcnt(10)
    v_mfma_f32_16x16x32_bf16 v[32:35], v[96:99], v[192:195], v[32:35]
    v_mfma_f32_16x16x32_bf16 v[36:39], v[96:99], v[196:199], v[36:39]
    ds_read_b64_tr_b16 v[88:89], v213 offset:51392
    ds_read_b64_tr_b16 v[90:91], v213 offset:56512
    s_waitcnt lgkmcnt(10)
    v_mfma_f32_16x16x32_bf16 v[40:43], v[100:103], v[192:195], v[40:43]
    v_mfma_f32_16x16x32_bf16 v[44:47], v[100:103], v[196:199], v[44:47]
    ds_read_b64_tr_b16 v[92:93], v214 offset:51392
    ds_read_b64_tr_b16 v[94:95], v214 offset:56512
    s_waitcnt lgkmcnt(10)
    v_mfma_f32_16x16x32_bf16 v[32:35], v[104:107], v[200:203], v[32:35]
    v_mfma_f32_16x16x32_bf16 v[36:39], v[104:107], v[204:207], v[36:39]
    ds_read_b64_tr_b16 v[96:97], v215 offset:192
    ds_read_b64_tr_b16 v[98:99], v215 offset:5312
    s_waitcnt lgkmcnt(10)
    v_mfma_f32_16x16x32_bf16 v[40:43], v[108:111], v[200:203], v[40:43]
    v_mfma_f32_16x16x32_bf16 v[44:47], v[108:111], v[204:207], v[44:47]
    ds_read_b64_tr_b16 v[100:101], v216 offset:192
    ds_read_b64_tr_b16 v[102:103], v216 offset:5312
    s_waitcnt lgkmcnt(10)
    v_mfma_f32_16x16x32_bf16 v[48:51], v[80:83], v[144:147], v[48:51]
    v_mfma_f32_16x16x32_bf16 v[52:55], v[80:83], v[148:151], v[52:55]
    ds_read_b64_tr_b16 v[104:105], v215 offset:10432
    ds_read_b64_tr_b16 v[106:107], v215 offset:15552
    s_waitcnt lgkmcnt(10)
    v_mfma_f32_16x16x32_bf16 v[56:59], v[84:87], v[144:147], v[56:59]
    v_mfma_f32_16x16x32_bf16 v[60:63], v[84:87], v[148:151], v[60:63]
    ds_read_b64_tr_b16 v[108:109], v216 offset:10432
    ds_read_b64_tr_b16 v[110:111], v216 offset:15552
    s_waitcnt lgkmcnt(10)
    v_mfma_f32_16x16x32_bf16 v[48:51], v[88:91], v[152:155], v[48:51]
    v_mfma_f32_16x16x32_bf16 v[52:55], v[88:91], v[156:159], v[52:55]
    ds_read_b64_tr_b16 v[80:81], v215 offset:20672
    ds_read_b64_tr_b16 v[82:83], v215 offset:25792
    s_waitcnt lgkmcnt(10)
    v_mfma_f32_16x16x32_bf16 v[56:59], v[92:95], v[152:155], v[56:59]
    v_mfma_f32_16x16x32_bf16 v[60:63], v[92:95], v[156:159], v[60:63]
    ds_read_b64_tr_b16 v[84:85], v216 offset:20672
    ds_read_b64_tr_b16 v[86:87], v216 offset:25792
    s_waitcnt lgkmcnt(10)
    v_mfma_f32_16x16x32_bf16 v[48:51], v[96:99], v[160:163], v[48:51]
    v_mfma_f32_16x16x32_bf16 v[52:55], v[96:99], v[164:167], v[52:55]
    ds_read_b64_tr_b16 v[88:89], v215 offset:30912
    ds_read_b64_tr_b16 v[90:91], v215 offset:36032
    s_waitcnt lgkmcnt(10)
    v_mfma_f32_16x16x32_bf16 v[56:59], v[100:103], v[160:163], v[56:59]
    v_mfma_f32_16x16x32_bf16 v[60:63], v[100:103], v[164:167], v[60:63]
    ds_read_b64_tr_b16 v[92:93], v216 offset:30912
    ds_read_b64_tr_b16 v[94:95], v216 offset:36032
    s_add_u32 s53, s59, 4096
    buffer_store_dwordx4 v[32:35], v220, s[36:39], s53 offen offset:0 sc1
    s_add_u32 s53, s59, 4096
    buffer_store_dwordx4 v[40:43], v220, s[36:39], s53 offen offset:1024 sc1
    s_add_u32 s53, s59, 12288
    buffer_store_dwordx4 v[36:39], v220, s[36:39], s53 offen offset:2048 sc1
    s_add_u32 s53, s59, 12288
    buffer_store_dwordx4 v[44:47], v220, s[36:39], s53 offen offset:3072 sc1
    s_waitcnt lgkmcnt(10)
    v_mfma_f32_16x16x32_bf16 v[48:51], v[104:107], v[168:171], v[48:51]
    v_mfma_f32_16x16x32_bf16 v[52:55], v[104:107], v[172:175], v[52:55]
    ds_read_b64_tr_b16 v[96:97], v215 offset:41152
    ds_read_b64_tr_b16 v[98:99], v215 offset:46272
    s_waitcnt lgkmcnt(10)
    v_mfma_f32_16x16x32_bf16 v[56:59], v[108:111], v[168:171], v[56:59]
    v_mfma_f32_16x16x32_bf16 v[60:63], v[108:111], v[172:175], v[60:63]
    ds_read_b64_tr_b16 v[100:101], v216 offset:41152
    ds_read_b64_tr_b16 v[102:103], v216 offset:46272
    s_waitcnt lgkmcnt(10)
    v_mfma_f32_16x16x32_bf16 v[48:51], v[80:83], v[176:179], v[48:51]
    v_mfma_f32_16x16x32_bf16 v[52:55], v[80:83], v[180:183], v[52:55]
    ds_read_b64_tr_b16 v[104:105], v215 offset:51392
    ds_read_b64_tr_b16 v[106:107], v215 offset:56512
    s_waitcnt lgkmcnt(10)
    v_mfma_f32_16x16x32_bf16 v[56:59], v[84:87], v[176:179], v[56:59]
    v_mfma_f32_16x16x32_bf16 v[60:63], v[84:87], v[180:183], v[60:63]
    ds_read_b64_tr_b16 v[108:109], v216 offset:51392
    ds_read_b64_tr_b16 v[110:111], v216 offset:56512
    s_waitcnt lgkmcnt(10)
    v_mfma_f32_16x16x32_bf16 v[48:51], v[88:91], v[184:187], v[48:51]
    v_mfma_f32_16x16x32_bf16 v[52:55], v[88:91], v[188:191], v[52:55]
    ds_read_b64_tr_b16 v[80:81], v213 offset:41216
    ds_read_b64_tr_b16 v[82:83], v213 offset:46336
    s_waitcnt lgkmcnt(10)
    v_mfma_f32_16x16x32_bf16 v[56:59], v[92:95], v[184:187], v[56:59]
    v_mfma_f32_16x16x32_bf16 v[60:63], v[92:95], v[188:191], v[60:63]
    ds_read_b64_tr_b16 v[84:85], v214 offset:41216
    ds_read_b64_tr_b16 v[86:87], v214 offset:46336
    s_waitcnt lgkmcnt(10)
    v_mfma_f32_16x16x32_bf16 v[48:51], v[96:99], v[192:195], v[48:51]
    v_mfma_f32_16x16x32_bf16 v[52:55], v[96:99], v[196:199], v[52:55]
    ds_read_b64_tr_b16 v[88:89], v213 offset:51456
    ds_read_b64_tr_b16 v[90:91], v213 offset:56576
    s_waitcnt lgkmcnt(10)
    v_mfma_f32_16x16x32_bf16 v[56:59], v[100:103], v[192:195], v[56:59]
    v_mfma_f32_16x16x32_bf16 v[60:63], v[100:103], v[196:199], v[60:63]
    ds_read_b64_tr_b16 v[92:93], v214 offset:51456
    ds_read_b64_tr_b16 v[94:95], v214 offset:56576
    s_waitcnt lgkmcnt(10)
    v_mfma_f32_16x16x32_bf16 v[48:51], v[104:107], v[200:203], v[48:51]
    v_mfma_f32_16x16x32_bf16 v[52:55], v[104:107], v[204:207], v[52:55]
    ds_read_b64_tr_b16 v[96:97], v215 offset:256
    ds_read_b64_tr_b16 v[98:99], v215 offset:5376
    s_waitcnt lgkmcnt(10)
    v_mfma_f32_16x16x32_bf16 v[56:59], v[108:111], v[200:203], v[56:59]
    v_mfma_f32_16x16x32_bf16 v[60:63], v[108:111], v[204:207], v[60:63]
    ds_read_b64_tr_b16 v[100:101], v216 offset:256
    ds_read_b64_tr_b16 v[102:103], v216 offset:5376
    s_waitcnt lgkmcnt(10)
    v_mfma_f32_16x16x32_bf16 v[64:67], v[80:83], v[144:147], v[64:67]
    v_mfma_f32_16x16x32_bf16 v[68:71], v[80:83], v[148:151], v[68:71]
    ds_read_b64_tr_b16 v[104:105], v215 offset:10496
    ds_read_b64_tr_b16 v[106:107], v215 offset:15616
    s_waitcnt lgkmcnt(10)
    v_mfma_f32_16x16x32_bf16 v[72:75], v[84:87], v[144:147], v[72:75]
    v_mfma_f32_16x16x32_bf16 v[76:79], v[84:87], v[148:151], v[76:79]
    ds_read_b64_tr_b16 v[108:109], v216 offset:10496
    ds_read_b64_tr_b16 v[110:111], v216 offset:15616
    s_waitcnt lgkmcnt(10)
    v_mfma_f32_16x16x32_bf16 v[64:67], v[88:91], v[152:155], v[64:67]
    v_mfma_f32_16x16x32_bf16 v[68:71], v[88:91], v[156:159], v[68:71]
    ds_read_b64_tr_b16 v[80:81], v215 offset:20736
    ds_read_b64_tr_b16 v[82:83], v215 offset:25856
    s_waitcnt lgkmcnt(10)
    v_mfma_f32_16x16x32_bf16 v[72:75], v[92:95], v[152:155], v[72:75]
    v_mfma_f32_16x16x32_bf16 v[76:79], v[92:95], v[156:159], v[76:79]
    ds_read_b64_tr_b16 v[84:85], v216 offset:20736
    ds_read_b64_tr_b16 v[86:87], v216 offset:25856
    s_waitcnt lgkmcnt(10)
    v_mfma_f32_16x16x32_bf16 v[64:67], v[96:99], v[160:163], v[64:67]
    v_mfma_f32_16x16x32_bf16 v[68:71], v[96:99], v[164:167], v[68:71]
    ds_read_b64_tr_b16 v[88:89], v215 offset:30976
    ds_read_b64_tr_b16 v[90:91], v215 offset:36096
    s_waitcnt lgkmcnt(10)
    v_mfma_f32_16x16x32_bf16 v[72:75], v[100:103], v[160:163], v[72:75]
    v_mfma_f32_16x16x32_bf16 v[76:79], v[100:103], v[164:167], v[76:79]
    ds_read_b64_tr_b16 v[92:93], v216 offset:30976
    ds_read_b64_tr_b16 v[94:95], v216 offset:36096
    s_add_u32 s53, s59, 4096
    buffer_store_dwordx4 v[48:51], v220, s[36:39], s53 offen offset:2048 sc1
    s_add_u32 s53, s59, 4096
    buffer_store_dwordx4 v[56:59], v220, s[36:39], s53 offen offset:3072 sc1
    s_add_u32 s53, s59, 16384
    buffer_store_dwordx4 v[52:55], v220, s[36:39], s53 offen offset:0 sc1
    s_add_u32 s53, s59, 16384
    buffer_store_dwordx4 v[60:63], v220, s[36:39], s53 offen offset:1024 sc1
    s_waitcnt lgkmcnt(10)
    v_mfma_f32_16x16x32_bf16 v[64:67], v[104:107], v[168:171], v[64:67]
    v_mfma_f32_16x16x32_bf16 v[68:71], v[104:107], v[172:175], v[68:71]
    ds_read_b64_tr_b16 v[96:97], v215 offset:41216
    ds_read_b64_tr_b16 v[98:99], v215 offset:46336
    s_waitcnt lgkmcnt(10)
    v_mfma_f32_16x16x32_bf16 v[72:75], v[108:111], v[168:171], v[72:75]
    v_mfma_f32_16x16x32_bf16 v[76:79], v[108:111], v[172:175], v[76:79]
    ds_read_b64_tr_b16 v[100:101], v216 offset:41216
    ds_read_b64_tr_b16 v[102:103], v216 offset:46336
    s_waitcnt lgkmcnt(10)
    v_mfma_f32_16x16x32_bf16 v[64:67], v[80:83], v[176:179], v[64:67]
    v_mfma_f32_16x16x32_bf16 v[68:71], v[80:83], v[180:183], v[68:71]
    ds_read_b64_tr_b16 v[104:105], v215 offset:51456
    ds_read_b64_tr_b16 v[106:107], v215 offset:56576
    s_waitcnt lgkmcnt(10)
    v_mfma_f32_16x16x32_bf16 v[72:75], v[84:87], v[176:179], v[72:75]
    v_mfma_f32_16x16x32_bf16 v[76:79], v[84:87], v[180:183], v[76:79]
    ds_read_b64_tr_b16 v[108:109], v216 offset:51456
    ds_read_b64_tr_b16 v[110:111], v216 offset:56576
    s_waitcnt lgkmcnt(10)
    v_mfma_f32_16x16x32_bf16 v[64:67], v[88:91], v[184:187], v[64:67]
    v_mfma_f32_16x16x32_bf16 v[68:71], v[88:91], v[188:191], v[68:71]
    ds_read_b64_tr_b16 v[80:81], v213 offset:41024
    ds_read_b64_tr_b16 v[82:83], v213 offset:46144
    s_waitcnt lgkmcnt(10)
    v_mfma_f32_16x16x32_bf16 v[72:75], v[92:95], v[184:187], v[72:75]
    v_mfma_f32_16x16x32_bf16 v[76:79], v[92:95], v[188:191], v[76:79]
    ds_read_b64_tr_b16 v[84:85], v214 offset:41024
    ds_read_b64_tr_b16 v[86:87], v214 offset:46144
    s_waitcnt lgkmcnt(10)
    v_mfma_f32_16x16x32_bf16 v[64:67], v[96:99], v[192:195], v[64:67]
    v_mfma_f32_16x16x32_bf16 v[68:71], v[96:99], v[196:199], v[68:71]
    ds_read_b64_tr_b16 v[88:89], v213 offset:51264
    ds_read_b64_tr_b16 v[90:91], v213 offset:56384
    s_waitcnt lgkmcnt(10)
    v_mfma_f32_16x16x32_bf16 v[72:75], v[100:103], v[192:195], v[72:75]
    v_mfma_f32_16x16x32_bf16 v[76:79], v[100:103], v[196:199], v[76:79]
    ds_read_b64_tr_b16 v[92:93], v214 offset:51264
    ds_read_b64_tr_b16 v[94:95], v214 offset:56384
    s_waitcnt lgkmcnt(10)
    v_mfma_f32_16x16x32_bf16 v[64:67], v[104:107], v[200:203], v[64:67]
    v_mfma_f32_16x16x32_bf16 v[68:71], v[104:107], v[204:207], v[68:71]
    ds_read_b64_tr_b16 v[96:97], v215 offset:64
    ds_read_b64_tr_b16 v[98:99], v215 offset:5184
    s_waitcnt lgkmcnt(10)
    v_mfma_f32_16x16x32_bf16 v[72:75], v[108:111], v[200:203], v[72:75]
    v_mfma_f32_16x16x32_bf16 v[76:79], v[108:111], v[204:207], v[76:79]
    ds_read_b64_tr_b16 v[100:101], v216 offset:64
    ds_read_b64_tr_b16 v[102:103], v216 offset:5184
    s_waitcnt lgkmcnt(10)
    v_mfma_f32_16x16x32_bf16 v[16:19], v[80:83], v[144:147], v[16:19]
    v_mfma_f32_16x16x32_bf16 v[20:23], v[80:83], v[148:151], v[20:23]
    ds_read_b64_tr_b16 v[104:105], v215 offset:10304
    ds_read_b64_tr_b16 v[106:107], v215 offset:15424
    s_waitcnt lgkmcnt(10)
    v_mfma_f32_16x16x32_bf16 v[24:27], v[84:87], v[144:147], v[24:27]
    v_mfma_f32_16x16x32_bf16 v[28:31], v[84:87], v[148:151], v[28:31]
    ds_read_b64_tr_b16 v[108:109], v216 offset:10304
    ds_read_b64_tr_b16 v[110:111], v216 offset:15424
    s_waitcnt lgkmcnt(10)
    v_mfma_f32_16x16x32_bf16 v[16:19], v[88:91], v[152:155], v[16:19]
    v_mfma_f32_16x16x32_bf16 v[20:23], v[88:91], v[156:159], v[20:23]
    ds_read_b64_tr_b16 v[80:81], v215 offset:20544
    ds_read_b64_tr_b16 v[82:83], v215 offset:25664
    s_waitcnt lgkmcnt(10)
    v_mfma_f32_16x16x32_bf16 v[24:27], v[92:95], v[152:155], v[24:27]
    v_mfma_f32_16x16x32_bf16 v[28:31], v[92:95], v[156:159], v[28:31]
    ds_read_b64_tr_b16 v[84:85], v216 offset:20544
    ds_read_b64_tr_b16 v[86:87], v216 offset:25664
    s_waitcnt lgkmcnt(10)
    v_mfma_f32_16x16x32_bf16 v[16:19], v[96:99], v[160:163], v[16:19]
    v_mfma_f32_16x16x32_bf16 v[20:23], v[96:99], v[164:167], v[20:23]
    ds_read_b64_tr_b16 v[88:89], v215 offset:30784
    ds_read_b64_tr_b16 v[90:91], v215 offset:35904
    s_waitcnt lgkmcnt(10)
    v_mfma_f32_16x16x32_bf16 v[24:27], v[100:103], v[160:163], v[24:27]
    v_mfma_f32_16x16x32_bf16 v[28:31], v[100:103], v[164:167], v[28:31]
    ds_read_b64_tr_b16 v[92:93], v216 offset:30784
    ds_read_b64_tr_b16 v[94:95], v216 offset:35904
    s_add_u32 s53, s59, 8192
    buffer_store_dwordx4 v[64:67], v220, s[36:39], s53 offen offset:0 sc1
    s_add_u32 s53, s59, 8192
    buffer_store_dwordx4 v[72:75], v220, s[36:39], s53 offen offset:1024 sc1
    s_waitcnt lgkmcnt(10)
    v_mfma_f32_16x16x32_bf16 v[16:19], v[104:107], v[168:171], v[16:19]
    v_mfma_f32_16x16x32_bf16 v[20:23], v[104:107], v[172:175], v[20:23]
    ds_read_b64_tr_b16 v[96:97], v215 offset:41024
    ds_read_b64_tr_b16 v[98:99], v215 offset:46144
    s_waitcnt lgkmcnt(10)
    v_mfma_f32_16x16x32_bf16 v[24:27], v[108:111], v[168:171], v[24:27]
    v_mfma_f32_16x16x32_bf16 v[28:31], v[108:111], v[172:175], v[28:31]
    ds_read_b64_tr_b16 v[100:101], v216 offset:41024
    ds_read_b64_tr_b16 v[102:103], v216 offset:46144
    s_waitcnt lgkmcnt(10)
    v_mfma_f32_16x16x32_bf16 v[16:19], v[80:83], v[176:179], v[16:19]
    v_mfma_f32_16x16x32_bf16 v[20:23], v[80:83], v[180:183], v[20:23]
    ds_read_b64_tr_b16 v[104:105], v215 offset:51264
    ds_read_b64_tr_b16 v[106:107], v215 offset:56384
    s_waitcnt lgkmcnt(10)
    v_mfma_f32_16x16x32_bf16 v[24:27], v[84:87], v[176:179], v[24:27]
    v_mfma_f32_16x16x32_bf16 v[28:31], v[84:87], v[180:183], v[28:31]
    ds_read_b64_tr_b16 v[108:109], v216 offset:51264
    ds_read_b64_tr_b16 v[110:111], v216 offset:56384
    s_waitcnt lgkmcnt(10)
    v_mfma_f32_16x16x32_bf16 v[16:19], v[88:91], v[184:187], v[16:19]
    v_mfma_f32_16x16x32_bf16 v[20:23], v[88:91], v[188:191], v[20:23]
    s_waitcnt vmcnt(0)
    s_lshl_b32 s54, s52, 5
    v_mov_b32 v222, 1
    s_mov_b64 exec, 1
    buffer_store_dword v222, v223, s[40:43], s54 offen sc1
    s_mov_b64 exec, -1
    s_waitcnt lgkmcnt(8)
    v_mfma_f32_16x16x32_bf16 v[24:27], v[92:95], v[184:187], v[24:27]
    v_mfma_f32_16x16x32_bf16 v[28:31], v[92:95], v[188:191], v[28:31]
    s_waitcnt lgkmcnt(6)
    v_mfma_f32_16x16x32_bf16 v[16:19], v[96:99], v[192:195], v[16:19]
    v_mfma_f32_16x16x32_bf16 v[20:23], v[96:99], v[196:199], v[20:23]
    s_waitcnt lgkmcnt(4)
    v_mfma_f32_16x16x32_bf16 v[24:27], v[100:103], v[192:195], v[24:27]
    v_mfma_f32_16x16x32_bf16 v[28:31], v[100:103], v[196:199], v[28:31]
    s_waitcnt lgkmcnt(2)
    v_mfma_f32_16x16x32_bf16 v[16:19], v[104:107], v[200:203], v[16:19]
    v_mfma_f32_16x16x32_bf16 v[20:23], v[104:107], v[204:207], v[20:23]
    s_waitcnt lgkmcnt(0)
    v_mfma_f32_16x16x32_bf16 v[24:27], v[108:111], v[200:203], v[24:27]
    v_mfma_f32_16x16x32_bf16 v[28:31], v[108:111], v[204:207], v[28:31]
    s_mov_b64 exec, 15
K2_POLL1:
    buffer_load_dword v222, v224, s[40:43], 0 offen sc1
    s_waitcnt vmcnt(0)
    v_cmp_ne_u32 vcc, 1, v222
    s_cbranch_vccz K2_GOT1
    s_sleep 1
    s_branch K2_POLL1
K2_GOT1:
    s_mov_b64 exec, -1
    s_xor_b32 s58, s52, 8
    s_mul_i32 s58, s58, 20480
    s_add_u32 s53, s58, 0
    buffer_load_dwordx4 v[112:115], v220, s[36:39], s53 offen offset:2048 sc1
    s_add_u32 s53, s58, 0
    buffer_load_dwordx4 v[116:119], v220, s[36:39], s53 offen offset:3072 sc1
    s_add_u32 s53, s58, 12288
    buffer_load_dwordx4 v[120:123], v220, s[36:39], s53 offen offset:0 sc1
    s_add_u32 s53, s58, 12288
    buffer_load_dwordx4 v[124:127], v220, s[36:39], s53 offen offset:1024 sc1
    s_add_u32 s53, s58, 16384
    buffer_load_dwordx4 v[128:131], v220, s[36:39], s53 offen offset:2048 sc1
    s_add_u32 s53, s58, 16384
    buffer_load_dwordx4 v[132:135], v220, s[36:39], s53 offen offset:3072 sc1
    s_xor_b32 s58, s52, 16
    s_mul_i32 s58, s58, 20480
    s_add_u32 s53, s58, 0
    buffer_load_dwordx4 v[136:139], v220, s[36:39], s53 offen offset:2048 sc1
    s_add_u32 s53, s58, 0
    buffer_load_dwordx4 v[140:143], v220, s[36:39], s53 offen offset:3072 sc1
    s_add_u32 s53, s58, 12288
    buffer_load_dwordx4 v[144:147], v220, s[36:39], s53 offen offset:0 sc1
    s_add_u32 s53, s58, 12288
    buffer_load_dwordx4 v[148:151], v220, s[36:39], s53 offen offset:1024 sc1
    s_add_u32 s53, s58, 16384
    buffer_load_dwordx4 v[152:155], v220, s[36:39], s53 offen offset:2048 sc1
    s_add_u32 s53, s58, 16384
    buffer_load_dwordx4 v[156:159], v220, s[36:39], s53 offen offset:3072 sc1
    s_xor_b32 s58, s52, 24
    s_mul_i32 s58, s58, 20480
    s_add_u32 s53, s58, 0
    buffer_load_dwordx4 v[160:163], v220, s[36:39], s53 offen offset:2048 sc1
    s_add_u32 s53, s58, 0
    buffer_load_dwordx4 v[164:167], v220, s[36:39], s53 offen offset:3072 sc1
    s_add_u32 s53, s58, 12288
    buffer_load_dwordx4 v[168:171], v220, s[36:39], s53 offen offset:0 sc1
    s_add_u32 s53, s58, 12288
    buffer_load_dwordx4 v[172:175], v220, s[36:39], s53 offen offset:1024 sc1
    s_add_u32 s53, s58, 16384
    buffer_load_dwordx4 v[176:179], v220, s[36:39], s53 offen offset:2048 sc1
    s_add_u32 s53, s58, 16384
    buffer_load_dwordx4 v[180:183], v220, s[36:39], s53 offen offset:3072 sc1
    s_waitcnt vmcnt(17)
    v_add_f32 v16, v16, v112
    v_add_f32 v17, v17, v113
    v_add_f32 v18, v18, v114
    v_add_f32 v19, v19, v115
    s_waitcnt vmcnt(16)
    v_add_f32 v24, v24, v116
    v_add_f32 v25, v25, v117
    v_add_f32 v26, v26, v118
    v_add_f32 v27, v27, v119
    s_waitcnt vmcnt(15)
    v_add_f32 v20, v20, v120
    v_add_f32 v21, v21, v121
    v_add_f32 v22, v22, v122
    v_add_f32 v23, v23, v123
    s_waitcnt vmcnt(14)
    v_add_f32 v28, v28, v124
    v_add_f32 v29, v29, v125
    v_add_f32 v30, v30, v126
    v_add_f32 v31, v31, v127
    s_waitcnt vmcnt(13)
    v_add_f32 v68, v68, v128
    v_add_f32 v69, v69, v129
    v_add_f32 v70, v70, v130
    v_add_f32 v71, v71, v131
    s_waitcnt vmcnt(12)
    v_add_f32 v76, v76, v132
    v_add_f32 v77, v77, v133
    v_add_f32 v78, v78, v134
    v_add_f32 v79, v79, v135
    s_waitcnt vmcnt(11)
    v_add_f32 v16, v16, v136
    v_add_f32 v17, v17, v137
    v_add_f32 v18, v18, v138
    v_add_f32 v19, v19, v139
    s_waitcnt vmcnt(10)
    v_add_f32 v24, v24, v140
    v_add_f32 v25, v25, v141
    v_add_f32 v26, v26, v142
    v_add_f32 v27, v27, v143
    s_waitcnt vmcnt(9)
    v_add_f32 v20, v20, v144
    v_add_f32 v21, v21, v145
    v_add_f32 v22, v22, v146
    v_add_f32 v23, v23, v147
    s_waitcnt vmcnt(8)
    v_add_f32 v28, v28, v148
    v_add_f32 v29, v29, v149
    v_add_f32 v30, v30, v150
    v_add_f32 v31, v31, v151
    s_waitcnt vmcnt(7)
    v_add_f32 v68, v68, v152
    v_add_f32 v69, v69, v153
    v_add_f32 v70, v70, v154
    v_add_f32 v71, v71, v155
    s_waitcnt vmcnt(6)
    v_add_f32 v76, v76, v156
    v_add_f32 v77, v77, v157
    v_add_f32 v78, v78, v158
    v_add_f32 v79, v79, v159
    s_waitcnt vmcnt(5)
    v_add_f32 v16, v16, v160
    v_add_f32 v17, v17, v161
    v_add_f32 v18, v18, v162
    v_add_f32 v19, v19, v163
    s_waitcnt vmcnt(4)
    v_add_f32 v24, v24, v164
    v_add_f32 v25, v25, v165
    v_add_f32 v26, v26, v166
    v_add_f32 v27, v27, v167
    s_waitcnt vmcnt(3)
    v_add_f32 v20, v20, v168
    v_add_f32 v21, v21, v169
    v_add_f32 v22, v22, v170
    v_add_f32 v23, v23, v171
    s_waitcnt vmcnt(2)
    v_add_f32 v28, v28, v172
    v_add_f32 v29, v29, v173
    v_add_f32 v30, v30, v174
    v_add_f32 v31, v31, v175
    s_waitcnt vmcnt(1)
    v_add_f32 v68, v68, v176
    v_add_f32 v69, v69, v177
    v_add_f32 v70, v70, v178
    v_add_f32 v71, v71, v179
    s_waitcnt vmcnt(0)
    v_add_f32 v76, v76, v180
    v_add_f32 v77, v77, v181
    v_add_f32 v78, v78, v182
    v_add_f32 v79, v79, v183
    v_cvt_pk_bf16_f32 v80, v16, v17
    v_cvt_pk_bf16_f32 v81, v18, v19
    v_cvt_pk_bf16_f32 v82, v24, v25
    v_cvt_pk_bf16_f32 v83, v26, v27
    v_cvt_pk_bf16_f32 v84, v20, v21
    v_cvt_pk_bf16_f32 v85, v22, v23
    v_cvt_pk_bf16_f32 v86, v28, v29
    v_cvt_pk_bf16_f32 v87, v30, v31
    v_cvt_pk_bf16_f32 v88, v68, v69
    v_cvt_pk_bf16_f32 v89, v70, v71
    v_cvt_pk_bf16_f32 v90, v76, v77
    v_cvt_pk_bf16_f32 v91, v78, v79
    s_nop 0
    v_permlane32_swap_b32 v80, v82
    v_permlane32_swap_b32 v81, v83
    v_permlane32_swap_b32 v84, v86
    v_permlane32_swap_b32 v85, v87
    v_permlane32_swap_b32 v88, v90
    v_permlane32_swap_b32 v89, v91
    s_nop 0
    v_permlane16_swap_b32 v80, v82
    v_permlane16_swap_b32 v81, v83
    v_permlane16_swap_b32 v84, v86
    v_permlane16_swap_b32 v85, v87
    v_permlane16_swap_b32 v88, v90
    v_permlane16_swap_b32 v89, v91
    s_nop 0
    buffer_store_dwordx4 v[80:83], v219, s[32:35], 0 offen offset:64
    buffer_store_dwordx4 v[84:87], v219, s[32:35], s55 offen offset:64
    buffer_store_dwordx4 v[88:91], v219, s[32:35], s55 offen offset:256
    s_branch K2_FIN
K2_V2:
    s_cmp_lg_u32 s48, 2
    s_cbranch_scc1 K2_V3
    ds_read_b64_tr_b16 v[80:81], v213 offset:40960
    ds_read_b64_tr_b16 v[82:83], v213 offset:46080
    ds_read_b64_tr_b16 v[84:85], v214 offset:40960
    ds_read_b64_tr_b16 v[86:87], v214 offset:46080
    ds_read_b64_tr_b16 v[88:89], v213 offset:51200
    ds_read_b64_tr_b16 v[90:91], v213 offset:56320
    ds_read_b64_tr_b16 v[92:93], v214 offset:51200
    ds_read_b64_tr_b16 v[94:95], v214 offset:56320
    ds_read_b64_tr_b16 v[96:97], v215 offset:0
    ds_read_b64_tr_b16 v[98:99], v215 offset:5120
    ds_read_b64_tr_b16 v[100:101], v216 offset:0
    ds_read_b64_tr_b16 v[102:103], v216 offset:5120
    s_waitcnt lgkmcnt(10)
    v_mfma_f32_16x16x32_bf16 v[0:3], v[80:83], v[144:147], v[0:3]
    v_mfma_f32_16x16x32_bf16 v[4:7], v[80:83], v[148:151], v[4:7]
    ds_read_b64_tr_b16 v[104:105], v215 offset:10240
    ds_read_b64_tr_b16 v[106:107], v215 offset:15360
    s_waitcnt lgkmcnt(10)
    v_mfma_f32_16x16x32_bf16 v[8:11], v[84:87], v[144:147], v[8:11]
    v_mfma_f32_16x16x32_bf16 v[12:15], v[84:87], v[148:151], v[12:15]
    ds_read_b64_tr_b16 v[108:109], v216 offset:10240
    ds_read_b64_tr_b16 v[110:111], v216 offset:15360
    s_waitcnt lgkmcnt(10)
    v_mfma_f32_16x16x32_bf16 v[0:3], v[88:91], v[152:155], v[0:3]
    v_mfma_f32_16x16x32_bf16 v[4:7], v[88:91], v[156:159], v[4:7]
    ds_read_b64_tr_b16 v[80:81], v215 offset:20480
    ds_read_b64_tr_b16 v[82:83], v215 offset:25600
    s_waitcnt lgkmcnt(10)
    v_mfma_f32_16x16x32_bf16 v[8:11], v[92:95], v[152:155], v[8:11]
    v_mfma_f32_16x16x32_bf16 v[12:15], v[92:95], v[156:159], v[12:15]
    ds_read_b64_tr_b16 v[84:85], v216 offset:20480
    ds_read_b64_tr_b16 v[86:87], v216 offset:25600
    s_waitcnt lgkmcnt(10)
    v_mfma_f32_16x16x32_bf16 v[0:3], v[96:99], v[160:163], v[0:3]
    v_mfma_f32_16x16x32_bf16 v[4:7], v[96:99], v[164:167], v[4:7]
    ds_read_b64_tr_b16 v[88:89], v215 offset:30720
    ds_read_b64_tr_b16 v[90:91], v215 offset:35840
    s_waitcnt lgkmcnt(10)
    v_mfma_f32_16x16x32_bf16 v[8:11], v[100:103], v[160:163], v[8:11]
    v_mfma_f32_16x16x32_bf16 v[12:15], v[100:103], v[164:167], v[12:15]
    ds_read_b64_tr_b16 v[92:93], v216 offset:30720
    ds_read_b64_tr_b16 v[94:95], v216 offset:35840
    s_waitcnt lgkmcnt(10)
    v_mfma_f32_16x16x32_bf16 v[0:3], v[104:107], v[168:171], v[0:3]
    v_mfma_f32_16x16x32_bf16 v[4:7], v[104:107], v[172:175], v[4:7]
    ds_read_b64_tr_b16 v[96:97], v215 offset:40960
    ds_read_b64_tr_b16 v[98:99], v215 offset:46080
    s_waitcnt lgkmcnt(10)
    v_mfma_f32_16x16x32_bf16 v[8:11], v[108:111], v[168:171], v[8:11]
    v_mfma_f32_16x16x32_bf16 v[12:15], v[108:111], v[172:175], v[12:15]
    ds_read_b64_tr_b16 v[100:101], v216 offset:40960
    ds_read_b64_tr_b16 v[102:103], v216 offset:46080
    s_waitcnt lgkmcnt(10)
    v_mfma_f32_16x16x32_bf16 v[0:3], v[80:83], v[176:179], v[0:3]
    v_mfma_f32_16x16x32_bf16 v[4:7], v[80:83], v[180:183], v[4:7]
    ds_read_b64_tr_b16 v[104:105], v215 offset:51200
    ds_read_b64_tr_b16 v[106:107], v215 offset:56320
    s_waitcnt lgkmcnt(10)
    v_mfma_f32_16x16x32_bf16 v[8:11], v[84:87], v[176:179], v[8:11]
    v_mfma_f32_16x16x32_bf16 v[12:15], v[84:87], v[180:183], v[12:15]
    ds_read_b64_tr_b16 v[108:109], v216 offset:51200
    ds_read_b64_tr_b16 v[110:111], v216 offset:56320
    s_waitcnt lgkmcnt(10)
    v_mfma_f32_16x16x32_bf16 v[0:3], v[88:91], v[184:187], v[0:3]
    v_mfma_f32_16x16x32_bf16 v[4:7], v[88:91], v[188:191], v[4:7]
    ds_read_b64_tr_b16 v[80:81], v213 offset:41024
    ds_read_b64_tr_b16 v[82:83], v213 offset:46144
    s_waitcnt lgkmcnt(10)
    v_mfma_f32_16x16x32_bf16 v[8:11], v[92:95], v[184:187], v[8:11]
    v_mfma_f32_16x16x32_bf16 v[12:15], v[92:95], v[188:191], v[12:15]
    ds_read_b64_tr_b16 v[84:85], v214 offset:41024
    ds_read_b64_tr_b16 v[86:87], v214 offset:46144
    s_waitcnt lgkmcnt(10)
    v_mfma_f32_16x16x32_bf16 v[0:3], v[96:99], v[192:195], v[0:3]
    v_mfma_f32_16x16x32_bf16 v[4:7], v[96:99], v[196:199], v[4:7]
    ds_read_b64_tr_b16 v[88:89], v213 offset:51264
    ds_read_b64_tr_b16 v[90:91], v213 offset:56384
    s_waitcnt lgkmcnt(10)
    v_mfma_f32_16x16x32_bf16 v[8:11], v[100:103], v[192:195], v[8:11]
    v_mfma_f32_16x16x32_bf16 v[12:15], v[100:103], v[196:199], v[12:15]
    ds_read_b64_tr_b16 v[92:93], v214 offset:51264
    ds_read_b64_tr_b16 v[94:95], v214 offset:56384
    s_waitcnt lgkmcnt(10)
    v_mfma_f32_16x16x32_bf16 v[0:3], v[104:107], v[200:203], v[0:3]
    v_mfma_f32_16x16x32_bf16 v[4:7], v[104:107], v[204:207], v[4:7]
    ds_read_b64_tr_b16 v[96:97], v215 offset:64
    ds_read_b64_tr_b16 v[98:99], v215 offset:5184
    s_waitcnt lgkmcnt(10)
    v_mfma_f32_16x16x32_bf16 v[8:11], v[108:111], v[200:203], v[8:11]
    v_mfma_f32_16x16x32_bf16 v[12:15], v[108:111], v[204:207], v[12:15]
    ds_read_b64_tr_b16 v[100:101], v216 offset:64
    ds_read_b64_tr_b16 v[102:103], v216 offset:5184
    s_waitcnt lgkmcnt(10)
    v_mfma_f32_16x16x32_bf16 v[16:19], v[80:83], v[144:147], v[16:19]
    v_mfma_f32_16x16x32_bf16 v[20:23], v[80:83], v[148:151], v[20:23]
    ds_read_b64_tr_b16 v[104:105], v215 offset:10304
    ds_read_b64_tr_b16 v[106:107], v215 offset:15424
    s_waitcnt lgkmcnt(10)
    v_mfma_f32_16x16x32_bf16 v[24:27], v[84:87], v[144:147], v[24:27]
    v_mfma_f32_16x16x32_bf16 v[28:31], v[84:87], v[148:151], v[28:31]
    ds_read_b64_tr_b16 v[108:109], v216 offset:10304
    ds_read_b64_tr_b16 v[110:111], v216 offset:15424
    s_waitcnt lgkmcnt(10)
    v_mfma_f32_16x16x32_bf16 v[16:19], v[88:91], v[152:155], v[16:19]
    v_mfma_f32_16x16x32_bf16 v[20:23], v[88:91], v[156:159], v[20:23]
    ds_read_b64_tr_b16 v[80:81], v215 offset:20544
    ds_read_b64_tr_b16 v[82:83], v215 offset:25664
    s_waitcnt lgkmcnt(10)
    v_mfma_f32_16x16x32_bf16 v[24:27], v[92:95], v[152:155], v[24:27]
    v_mfma_f32_16x16x32_bf16 v[28:31], v[92:95], v[156:159], v[28:31]
    ds_read_b64_tr_b16 v[84:85], v216 offset:20544
    ds_read_b64_tr_b16 v[86:87], v216 offset:25664
    s_waitcnt lgkmcnt(10)
    v_mfma_f32_16x16x32_bf16 v[16:19], v[96:99], v[160:163], v[16:19]
    v_mfma_f32_16x16x32_bf16 v[20:23], v[96:99], v[164:167], v[20:23]
    ds_read_b64_tr_b16 v[88:89], v215 offset:30784
    ds_read_b64_tr_b16 v[90:91], v215 offset:35904
    s_waitcnt lgkmcnt(10)
    v_mfma_f32_16x16x32_bf16 v[24:27], v[100:103], v[160:163], v[24:27]
    v_mfma_f32_16x16x32_bf16 v[28:31], v[100:103], v[164:167], v[28:31]
    ds_read_b64_tr_b16 v[92:93], v216 offset:30784
    ds_read_b64_tr_b16 v[94:95], v216 offset:35904
    s_add_u32 s53, s59, 0
    buffer_store_dwordx4 v[0:3], v220, s[36:39], s53 offen offset:0 sc1
    s_add_u32 s53, s59, 0
    buffer_store_dwordx4 v[8:11], v220, s[36:39], s53 offen offset:1024 sc1
    s_add_u32 s53, s59, 8192
    buffer_store_dwordx4 v[4:7], v220, s[36:39], s53 offen offset:2048 sc1
    s_add_u32 s53, s59, 8192
    buffer_store_dwordx4 v[12:15], v220, s[36:39], s53 offen offset:3072 sc1
    s_waitcnt lgkmcnt(10)
    v_mfma_f32_16x16x32_bf16 v[16:19], v[104:107], v[168:171], v[16:19]
    v_mfma_f32_16x16x32_bf16 v[20:23], v[104:107], v[172:175], v[20:23]
    ds_read_b64_tr_b16 v[96:97], v215 offset:41024
    ds_read_b64_tr_b16 v[98:99], v215 offset:46144
    s_waitcnt lgkmcnt(10)
    v_mfma_f32_16x16x32_bf16 v[24:27], v[108:111], v[168:171], v[24:27]
    v_mfma_f32_16x16x32_bf16 v[28:31], v[108:111], v[172:175], v[28:31]
    ds_read_b64_tr_b16 v[100:101], v216 offset:41024
    ds_read_b64_tr_b16 v[102:103], v216 offset:46144
    s_waitcnt lgkmcnt(10)
    v_mfma_f32_16x16x32_bf16 v[16:19], v[80:83], v[176:179], v[16:19]
    v_mfma_f32_16x16x32_bf16 v[20:23], v[80:83], v[180:183], v[20:23]
    ds_read_b64_tr_b16 v[104:105], v215 offset:51264
    ds_read_b64_tr_b16 v[106:107], v215 offset:56384
    s_waitcnt lgkmcnt(10)
    v_mfma_f32_16x16x32_bf16 v[24:27], v[84:87], v[176:179], v[24:27]
    v_mfma_f32_16x16x32_bf16 v[28:31], v[84:87], v[180:183], v[28:31]
    ds_read_b64_tr_b16 v[108:109], v216 offset:51264
    ds_read_b64_tr_b16 v[110:111], v216 offset:56384
    s_waitcnt lgkmcnt(10)
    v_mfma_f32_16x16x32_bf16 v[16:19], v[88:91], v[184:187], v[16:19]
    v_mfma_f32_16x16x32_bf16 v[20:23], v[88:91], v[188:191], v[20:23]
    ds_read_b64_tr_b16 v[80:81], v213 offset:41152
    ds_read_b64_tr_b16 v[82:83], v213 offset:46272
    s_waitcnt lgkmcnt(10)
    v_mfma_f32_16x16x32_bf16 v[24:27], v[92:95], v[184:187], v[24:27]
    v_mfma_f32_16x16x32_bf16 v[28:31], v[92:95], v[188:191], v[28:31]
    ds_read_b64_tr_b16 v[84:85], v214 offset:41152
    ds_read_b64_tr_b16 v[86:87], v214 offset:46272
    s_waitcnt lgkmcnt(10)
    v_mfma_f32_16x16x32_bf16 v[16:19], v[96:99], v[192:195], v[16:19]
    v_mfma_f32_16x16x32_bf16 v[20:23], v[96:99], v[196:199], v[20:23]
    ds_read_b64_tr_b16 v[88:89], v213 offset:51392
    ds_read_b64_tr_b16 v[90:91], v213 offset:56512
    s_waitcnt lgkmcnt(10)
    v_mfma_f32_16x16x32_bf16 v[24:27], v[100:103], v[192:195], v[24:27]
    v_mfma_f32_16x16x32_bf16 v[28:31], v[100:103], v[196:199], v[28:31]
    ds_read_b64_tr_b16 v[92:93], v214 offset:51392
    ds_read_b64_tr_b16 v[94:95], v214 offset:56512
    s_waitcnt lgkmcnt(10)
    v_mfma_f32_16x16x32_bf16 v[16:19], v[104:107], v[200:203], v[16:19]
    v_mfma_f32_16x16x32_bf16 v[20:23], v[104:107], v[204:207], v[20:23]
    ds_read_b64_tr_b16 v[96:97], v215 offset:192
    ds_read_b64_tr_b16 v[98:99], v215 offset:5312
    s_waitcnt lgkmcnt(10)
    v_mfma_f32_16x16x32_bf16 v[24:27], v[108:111], v[200:203], v[24:27]
    v_mfma_f32_16x16x32_bf16 v[28:31], v[108:111], v[204:207], v[28:31]
    ds_read_b64_tr_b16 v[100:101], v216 offset:192
    ds_read_b64_tr_b16 v[102:103], v216 offset:5312
    s_waitcnt lgkmcnt(10)
    v_mfma_f32_16x16x32_bf16 v[48:51], v[80:83], v[144:147], v[48:51]
    v_mfma_f32_16x16x32_bf16 v[52:55], v[80:83], v[148:151], v[52:55]
    ds_read_b64_tr_b16 v[104:105], v215 offset:10432
    ds_read_b64_tr_b16 v[106:107], v215 offset:15552
    s_waitcnt lgkmcnt(10)
    v_mfma_f32_16x16x32_bf16 v[56:59], v[84:87], v[144:147], v[56:59]
    v_mfma_f32_16x16x32_bf16 v[60:63], v[84:87], v[148:151], v[60:63]
    ds_read_b64_tr_b16 v[108:109], v216 offset:10432
    ds_read_b64_tr_b16 v[110:111], v216 offset:15552
    s_waitcnt lgkmcnt(10)
    v_mfma_f32_16x16x32_bf16 v[48:51], v[88:91], v[152:155], v[48:51]
    v_mfma_f32_16x16x32_bf16 v[52:55], v[88:91], v[156:159], v[52:55]
    ds_read_b64_tr_b16 v[80:81], v215 offset:20672
    ds_read_b64_tr_b16 v[82:83], v215 offset:25792
    s_waitcnt lgkmcnt(10)
    v_mfma_f32_16x16x32_bf16 v[56:59], v[92:95], v[152:155], v[56:59]
    v_mfma_f32_16x16x32_bf16 v[60:63], v[92:95], v[156:159], v[60:63]
    ds_read_b64_tr_b16 v[84:85], v216 offset:20672
    ds_read_b64_tr_b16 v[86:87], v216 offset:25792
    s_waitcnt lgkmcnt(10)
    v_mfma_f32_16x16x32_bf16 v[48:51], v[96:99], v[160:163], v[48:51]
    v_mfma_f32_16x16x32_bf16 v[52:55], v[96:99], v[164:167], v[52:55]
    ds_read_b64_tr_b16 v[88:89], v215 offset:30912
    ds_read_b64_tr_b16 v[90:91], v215 offset:36032
    s_waitcnt lgkmcnt(10)
    v_mfma_f32_16x16x32_bf16 v[56:59], v[100:103], v[160:163], v[56:59]
    v_mfma_f32_16x16x32_bf16 v[60:63], v[100:103], v[164:167], v[60:63]
    ds_read_b64_tr_b16 v[92:93], v216 offset:30912
    ds_read_b64_tr_b16 v[94:95], v216 offset:36032
    s_add_u32 s53, s59, 0
    buffer_store_dwordx4 v[16:19], v220, s[36:39], s53 offen offset:2048 sc1
    s_add_u32 s53, s59, 0
    buffer_store_dwordx4 v[24:27], v220, s[36:39], s53 offen offset:3072 sc1
    s_add_u32 s53, s59, 12288
    buffer_store_dwordx4 v[20:23], v220, s[36:39], s53 offen offset:0 sc1
    s_add_u32 s53, s59, 12288
    buffer_store_dwordx4 v[28:31], v220, s[36:39], s53 offen offset:1024 sc1
    s_waitcnt lgkmcnt(10)
    v_mfma_f32_16x16x32_bf16 v[48:51], v[104:107], v[168:171], v[48:51]
    v_mfma_f32_16x16x32_bf16 v[52:55], v[104:107], v[172:175], v[52:55]
    ds_read_b64_tr_b16 v[96:97], v215 offset:41152
    ds_read_b64_tr_b16 v[98:99], v215 offset:46272
    s_waitcnt lgkmcnt(10)
    v_mfma_f32_16x16x32_bf16 v[56:59], v[108:111], v[168:171], v[56:59]
    v_mfma_f32_16x16x32_bf16 v[60:63], v[108:111], v[172:175], v[60:63]
    ds_read_b64_tr_b16 v[100:101], v216 offset:41152
    ds_read_b64_tr_b16 v[102:103], v216 offset:46272
    s_waitcnt lgkmcnt(10)
    v_mfma_f32_16x16x32_bf16 v[48:51], v[80:83], v[176:179], v[48:51]
    v_mfma_f32_16x16x32_bf16 v[52:55], v[80:83], v[180:183], v[52:55]
    ds_read_b64_tr_b16 v[104:105], v215 offset:51392
    ds_read_b64_tr_b16 v[106:107], v215 offset:56512
    s_waitcnt lgkmcnt(10)
    v_mfma_f32_16x16x32_bf16 v[56:59], v[84:87], v[176:179], v[56:59]
    v_mfma_f32_16x16x32_bf16 v[60:63], v[84:87], v[180:183], v[60:63]
    ds_read_b64_tr_b16 v[108:109], v216 offset:51392
    ds_read_b64_tr_b16 v[110:111], v216 offset:56512
    s_waitcnt lgkmcnt(10)
    v_mfma_f32_16x16x32_bf16 v[48:51], v[88:91], v[184:187], v[48:51]
    v_mfma_f32_16x16x32_bf16 v[52:55], v[88:91], v[188:191], v[52:55]
    ds_read_b64_tr_b16 v[80:81], v213 offset:41216
    ds_read_b64_tr_b16 v[82:83], v213 offset:46336
    s_waitcnt lgkmcnt(10)
    v_mfma_f32_16x16x32_bf16 v[56:59], v[92:95], v[184:187], v[56:59]
    v_mfma_f32_16x16x32_bf16 v[60:63], v[92:95], v[188:191], v[60:63]
    ds_read_b64_tr_b16 v[84:85], v214 offset:41216
    ds_read_b64_tr_b16 v[86:87], v214 offset:46336
    s_waitcnt lgkmcnt(10)
    v_mfma_f32_16x16x32_bf16 v[48:51], v[96:99], v[192:195], v[48:51]
    v_mfma_f32_16x16x32_bf16 v[52:55], v[96:99], v[196:199], v[52:55]
    ds_read_b64_tr_b16 v[88:89], v213 offset:51456
    ds_read_b64_tr_b16 v[90:91], v213 offset:56576
    s_waitcnt lgkmcnt(10)
    v_mfma_f32_16x16x32_bf16 v[56:59], v[100:103], v[192:195], v[56:59]
    v_mfma_f32_16x16x32_bf16 v[60:63], v[100:103], v[196:199], v[60:63]
    ds_read_b64_tr_b16 v[92:93], v214 offset:51456
    ds_read_b64_tr_b16 v[94:95], v214 offset:56576
    s_waitcnt lgkmcnt(10)
    v_mfma_f32_16x16x32_bf16 v[48:51], v[104:107], v[200:203], v[48:51]
    v_mfma_f32_16x16x32_bf16 v[52:55], v[104:107], v[204:207], v[52:55]
    ds_read_b64_tr_b16 v[96:97], v215 offset:256
    ds_read_b64_tr_b16 v[98:99], v215 offset:5376
    s_waitcnt lgkmcnt(10)
    v_mfma_f32_16x16x32_bf16 v[56:59], v[108:111], v[200:203], v[56:59]
    v_mfma_f32_16x16x32_bf16 v[60:63], v[108:111], v[204:207], v[60:63]
    ds_read_b64_tr_b16 v[100:101], v216 offset:256
    ds_read_b64_tr_b16 v[102:103], v216 offset:5376
    s_waitcnt lgkmcnt(10)
    v_mfma_f32_16x16x32_bf16 v[64:67], v[80:83], v[144:147], v[64:67]
    v_mfma_f32_16x16x32_bf16 v[68:71], v[80:83], v[148:151], v[68:71]
    ds_read_b64_tr_b16 v[104:105], v215 offset:10496
    ds_read_b64_tr_b16 v[106:107], v215 offset:15616
    s_waitcnt lgkmcnt(10)
    v_mfma_f32_16x16x32_bf16 v[72:75], v[84:87], v[144:147], v[72:75]
    v_mfma_f32_16x16x32_bf16 v[76:79], v[84:87], v[148:151], v[76:79]
    ds_read_b64_tr_b16 v[108:109], v216 offset:10496
    ds_read_b64_tr_b16 v[110:111], v216 offset:15616
    s_waitcnt lgkmcnt(10)
    v_mfma_f32_16x16x32_bf16 v[64:67], v[88:91], v[152:155], v[64:67]
    v_mfma_f32_16x16x32_bf16 v[68:71], v[88:91], v[156:159], v[68:71]
    ds_read_b64_tr_b16 v[80:81], v215 offset:20736
    ds_read_b64_tr_b16 v[82:83], v215 offset:25856
    s_waitcnt lgkmcnt(10)
    v_mfma_f32_16x16x32_bf16 v[72:75], v[92:95], v[152:155], v[72:75]
    v_mfma_f32_16x16x32_bf16 v[76:79], v[92:95], v[156:159], v[76:79]
    ds_read_b64_tr_b16 v[84:85], v216 offset:20736
    ds_read_b64_tr_b16 v[86:87], v216 offset:25856
    s_waitcnt lgkmcnt(10)
    v_mfma_f32_16x16x32_bf16 v[64:67], v[96:99], v[160:163], v[64:67]
    v_mfma_f32_16x16x32_bf16 v[68:71], v[96:99], v[164:167], v[68:71]
    ds_read_b64_tr_b16 v[88:89], v215 offset:30976
    ds_read_b64_tr_b16 v[90:91], v215 offset:36096
    s_waitcnt lgkmcnt(10)
    v_mfma_f32_16x16x32_bf16 v[72:75], v[100:103], v[160:163], v[72:75]
    v_mfma_f32_16x16x32_bf16 v[76:79], v[100:103], v[164:167], v[76:79]
    ds_read_b64_tr_b16 v[92:93], v216 offset:30976
    ds_read_b64_tr_b16 v[94:95], v216 offset:36096
    s_add_u32 s53, s59, 4096
    buffer_store_dwordx4 v[48:51], v220, s[36:39], s53 offen offset:2048 sc1
    s_add_u32 s53, s59, 4096
    buffer_store_dwordx4 v[56:59], v220, s[36:39], s53 offen offset:3072 sc1
    s_add_u32 s53, s59, 16384
    buffer_store_dwordx4 v[52:55], v220, s[36:39], s53 offen offset:0 sc1
    s_add_u32 s53, s59, 16384
    buffer_store_dwordx4 v[60:63], v220, s[36:39], s53 offen offset:1024 sc1
    s_waitcnt lgkmcnt(10)
    v_mfma_f32_16x16x32_bf16 v[64:67], v[104:107], v[168:171], v[64:67]
    v_mfma_f32_16x16x32_bf16 v[68:71], v[104:107], v[172:175], v[68:71]
    ds_read_b64_tr_b16 v[96:97], v215 offset:41216
    ds_read_b64_tr_b16 v[98:99], v215 offset:46336
    s_waitcnt lgkmcnt(10)
    v_mfma_f32_16x16x32_bf16 v[72:75], v[108:111], v[168:171], v[72:75]
    v_mfma_f32_16x16x32_bf16 v[76:79], v[108:111], v[172:175], v[76:79]
    ds_read_b64_tr_b16 v[100:101], v216 offset:41216
    ds_read_b64_tr_b16 v[102:103], v216 offset:46336
    s_waitcnt lgkmcnt(10)
    v_mfma_f32_16x16x32_bf16 v[64:67], v[80:83], v[176:179], v[64:67]
    v_mfma_f32_16x16x32_bf16 v[68:71], v[80:83], v[180:183], v[68:71]
    ds_read_b64_tr_b16 v[104:105], v215 offset:51456
    ds_read_b64_tr_b16 v[106:107], v215 offset:56576
    s_waitcnt lgkmcnt(10)
    v_mfma_f32_16x16x32_bf16 v[72:75], v[84:87], v[176:179], v[72:75]
    v_mfma_f32_16x16x32_bf16 v[76:79], v[84:87], v[180:183], v[76:79]
    ds_read_b64_tr_b16 v[108:109], v216 offset:51456
    ds_read_b64_tr_b16 v[110:111], v216 offset:56576
    s_waitcnt lgkmcnt(10)
    v_mfma_f32_16x16x32_bf16 v[64:67], v[88:91], v[184:187], v[64:67]
    v_mfma_f32_16x16x32_bf16 v[68:71], v[88:91], v[188:191], v[68:71]
    ds_read_b64_tr_b16 v[80:81], v213 offset:41088
    ds_read_b64_tr_b16 v[82:83], v213 offset:46208
    s_waitcnt lgkmcnt(10)
    v_mfma_f32_16x16x32_bf16 v[72:75], v[92:95], v[184:187], v[72:75]
    v_mfma_f32_16x16x32_bf16 v[76:79], v[92:95], v[188:191], v[76:79]
    ds_read_b64_tr_b16 v[84:85], v214 offset:41088
    ds_read_b64_tr_b16 v[86:87], v214 offset:46208
    s_waitcnt lgkmcnt(10)
    v_mfma_f32_16x16x32_bf16 v[64:67], v[96:99], v[192:195], v[64:67]
    v_mfma_f32_16x16x32_bf16 v[68:71], v[96:99], v[196:199], v[68:71]
    ds_read_b64_tr_b16 v[88:89], v213 offset:51328
    ds_read_b64_tr_b16 v[90:91], v213 offset:56448
    s_waitcnt lgkmcnt(10)
    v_mfma_f32_16x16x32_bf16 v[72:75], v[100:103], v[192:195], v[72:75]
    v_mfma_f32_16x16x32_bf16 v[76:79], v[100:103], v[196:199], v[76:79]
    ds_read_b64_tr_b16 v[92:93], v214 offset:51328
    ds_read_b64_tr_b16 v[94:95], v214 offset:56448
    s_waitcnt lgkmcnt(10)
    v_mfma_f32_16x16x32_bf16 v[64:67], v[104:107], v[200:203], v[64:67]
    v_mfma_f32_16x16x32_bf16 v[68:71], v[104:107], v[204:207], v[68:71]
    ds_read_b64_tr_b16 v[96:97], v215 offset:128
    ds_read_b64_tr_b16 v[98:99], v215 offset:5248
    s_waitcnt lgkmcnt(10)
    v_mfma_f32_16x16x32_bf16 v[72:75], v[108:111], v[200:203], v[72:75]
    v_mfma_f32_16x16x32_bf16 v[76:79], v[108:111], v[204:207], v[76:79]
    ds_read_b64_tr_b16 v[100:101], v216 offset:128
    ds_read_b64_tr_b16 v[102:103], v216 offset:5248
    s_waitcnt lgkmcnt(10)
    v_mfma_f32_16x16x32_bf16 v[32:35], v[80:83], v[144:147], v[32:35]
    v_mfma_f32_16x16x32_bf16 v[36:39], v[80:83], v[148:151], v[36:39]
    ds_read_b64_tr_b16 v[104:105], v215 offset:10368
    ds_read_b64_tr_b16 v[106:107], v215 offset:15488
    s_waitcnt lgkmcnt(10)
    v_mfma_f32_16x16x32_bf16 v[40:43], v[84:87], v[144:147], v[40:43]
    v_mfma_f32_16x16x32_bf16 v[44:47], v[84:87], v[148:151], v[44:47]
    ds_read_b64_tr_b16 v[108:109], v216 offset:10368
    ds_read_b64_tr_b16 v[110:111], v216 offset:15488
    s_waitcnt lgkmcnt(10)
    v_mfma_f32_16x16x32_bf16 v[32:35], v[88:91], v[152:155], v[32:35]
    v_mfma_f32_16x16x32_bf16 v[36:39], v[88:91], v[156:159], v[36:39]
    ds_read_b64_tr_b16 v[80:81], v215 offset:20608
    ds_read_b64_tr_b16 v[82:83], v215 offset:25728
    s_waitcnt lgkmcnt(10)
    v_mfma_f32_16x16x32_bf16 v[40:43], v[92:95], v[152:155], v[40:43]
    v_mfma_f32_16x16x32_bf16 v[44:47], v[92:95], v[156:159], v[44:47]
    ds_read_b64_tr_b16 v[84:85], v216 offset:20608
    ds_read_b64_tr_b16 v[86:87], v216 offset:25728
    s_waitcnt lgkmcnt(10)
    v_mfma_f32_16x16x32_bf16 v[32:35], v[96:99], v[160:163], v[32:35]
    v_mfma_f32_16x16x32_bf16 v[36:39], v[96:99], v[164:167], v[36:39]
    ds_read_b64_tr_b16 v[88:89], v215 offset:30848
    ds_read_b64_tr_b16 v[90:91], v215 offset:35968
    s_waitcnt lgkmcnt(10)
    v_mfma_f32_16x16x32_bf16 v[40:43], v[100:103], v[160:163], v[40:43]
    v_mfma_f32_16x16x32_bf16 v[44:47], v[100:103], v[164:167], v[44:47]
    ds_read_b64_tr_b16 v[92:93], v216 offset:30848
    ds_read_b64_tr_b16 v[94:95], v216 offset:35968
    s_add_u32 s53, s59, 8192
    buffer_store_dwordx4 v[64:67], v220, s[36:39], s53 offen offset:0 sc1
    s_add_u32 s53, s59, 8192
    buffer_store_dwordx4 v[72:75], v220, s[36:39], s53 offen offset:1024 sc1
    s_add_u32 s53, s59, 16384
    buffer_store_dwordx4 v[68:71], v220, s[36:39], s53 offen offset:2048 sc1
    s_add_u32 s53, s59, 16384
    buffer_store_dwordx4 v[76:79], v220, s[36:39], s53 offen offset:3072 sc1
    s_waitcnt lgkmcnt(10)
    v_mfma_f32_16x16x32_bf16 v[32:35], v[104:107], v[168:171], v[32:35]
    v_mfma_f32_16x16x32_bf16 v[36:39], v[104:107], v[172:175], v[36:39]
    ds_read_b64_tr_b16 v[96:97], v215 offset:41088
    ds_read_b64_tr_b16 v[98:99], v215 offset:46208
    s_waitcnt lgkmcnt(10)
    v_mfma_f32_16x16x32_bf16 v[40:43], v[108:111], v[168:171], v[40:43]
    v_mfma_f32_16x16x32_bf16 v[44:47], v[108:111], v[172:175], v[44:47]
    ds_read_b64_tr_b16 v[100:101], v216 offset:41088
    ds_read_b64_tr_b16 v[102:103], v216 offset:46208
    s_waitcnt lgkmcnt(10)
    v_mfma_f32_16x16x32_bf16 v[32:35], v[80:83], v[176:179], v[32:35]
    v_mfma_f32_16x16x32_bf16 v[36:39], v[80:83], v[180:183], v[36:39]
    ds_read_b64_tr_b16 v[104:105], v215 offset:51328
    ds_read_b64_tr_b16 v[106:107], v215 offset:56448
    s_waitcnt lgkmcnt(10)
    v_mfma_f32_16x16x32_bf16 v[40:43], v[84:87], v[176:179], v[40:43]
    v_mfma_f32_16x16x32_bf16 v[44:47], v[84:87], v[180:183], v[44:47]
    ds_read_b64_tr_b16 v[108:109], v216 offset:51328
    ds_read_b64_tr_b16 v[110:111], v216 offset:56448
    s_waitcnt lgkmcnt(10)
    v_mfma_f32_16x16x32_bf16 v[32:35], v[88:91], v[184:187], v[32:35]
    v_mfma_f32_16x16x32_bf16 v[36:39], v[88:91], v[188:191], v[36:39]
    s_waitcnt vmcnt(0)
    s_lshl_b32 s54, s52, 5
    v_mov_b32 v222, 1
    s_mov_b64 exec, 1
    buffer_store_dword v222, v223, s[40:43], s54 offen sc1
    s_mov_b64 exec, -1
    s_waitcnt lgkmcnt(8)
    v_mfma_f32_16x16x32_bf16 v[40:43], v[92:95], v[184:187], v[40:43]
    v_mfma_f32_16x16x32_bf16 v[44:47], v[92:95], v[188:191], v[44:47]
    s_waitcnt lgkmcnt(6)
    v_mfma_f32_16x16x32_bf16 v[32:35], v[96:99], v[192:195], v[32:35]
    v_mfma_f32_16x16x32_bf16 v[36:39], v[96:99], v[196:199], v[36:39]
    s_waitcnt lgkmcnt(4)
    v_mfma_f32_16x16x32_bf16 v[40:43], v[100:103], v[192:195], v[40:43]
    v_mfma_f32_16x16x32_bf16 v[44:47], v[100:103], v[196:199], v[44:47]
    s_waitcnt lgkmcnt(2)
    v_mfma_f32_16x16x32_bf16 v[32:35], v[104:107], v[200:203], v[32:35]
    v_mfma_f32_16x16x32_bf16 v[36:39], v[104:107], v[204:207], v[36:39]
    s_waitcnt lgkmcnt(0)
    v_mfma_f32_16x16x32_bf16 v[40:43], v[108:111], v[200:203], v[40:43]
    v_mfma_f32_16x16x32_bf16 v[44:47], v[108:111], v[204:207], v[44:47]
    s_mov_b64 exec, 15
K2_POLL2:
    buffer_load_dword v222, v224, s[40:43], 0 offen sc1
    s_waitcnt vmcnt(0)
    v_cmp_ne_u32 vcc, 1, v222
    s_cbranch_vccz K2_GOT2
    s_sleep 1
    s_branch K2_POLL2
K2_GOT2:
    s_mov_b64 exec, -1
    s_xor_b32 s58, s52, 8
    s_mul_i32 s58, s58, 20480
    s_add_u32 s53, s58, 4096
    buffer_load_dwordx4 v[112:115], v220, s[36:39], s53 offen offset:0 sc1
    s_add_u32 s53, s58, 4096
    buffer_load_dwordx4 v[116:119], v220, s[36:39], s53 offen offset:1024 sc1
    s_add_u32 s53, s58, 12288
    buffer_load_dwordx4 v[120:123], v220, s[36:39], s53 offen offset:2048 sc1
    s_add_u32 s53, s58, 12288
    buffer_load_dwordx4 v[124:127], v220, s[36:39], s53 offen offset:3072 sc1
    s_xor_b32 s58, s52, 16
    s_mul_i32 s58, s58, 20480
    s_add_u32 s53, s58, 4096
    buffer_load_dwordx4 v[128:131], v220, s[36:39], s53 offen offset:0 sc1
    s_add_u32 s53, s58, 4096
    buffer_load_dwordx4 v[132:135], v220, s[36:39], s53 offen offset:1024 sc1
    s_add_u32 s53, s58, 12288
    buffer_load_dwordx4 v[136:139], v220, s[36:39], s53 offen offset:2048 sc1
    s_add_u32 s53, s58, 12288
    buffer_load_dwordx4 v[140:143], v220, s[36:39], s53 offen offset:3072 sc1
    s_xor_b32 s58, s52, 24
    s_mul_i32 s58, s58, 20480
    s_add_u32 s53, s58, 4096
    buffer_load_dwordx4 v[144:147], v220, s[36:39], s53 offen offset:0 sc1
    s_add_u32 s53, s58, 4096
    buffer_load_dwordx4 v[148:151], v220, s[36:39], s53 offen offset:1024 sc1
    s_add_u32 s53, s58, 12288
    buffer_load_dwordx4 v[152:155], v220, s[36:39], s53 offen offset:2048 sc1
    s_add_u32 s53, s58, 12288
    buffer_load_dwordx4 v[156:159], v220, s[36:39], s53 offen offset:3072 sc1
    s_waitcnt vmcnt(11)
    v_add_f32 v32, v32, v112
    v_add_f32 v33, v33, v113
    v_add_f32 v34, v34, v114
    v_add_f32 v35, v35, v115
    s_waitcnt vmcnt(10)
    v_add_f32 v40, v40, v116
    v_add_f32 v41, v41, v117
    v_add_f32 v42, v42, v118
    v_add_f32 v43, v43, v119
    s_waitcnt vmcnt(9)
    v_add_f32 v36, v36, v120
    v_add_f32 v37, v37, v121
    v_add_f32 v38, v38, v122
    v_add_f32 v39, v39, v123
    s_waitcnt vmcnt(8)
    v_add_f32 v44, v44, v124
    v_add_f32 v45, v45, v125
    v_add_f32 v46, v46, v126
    v_add_f32 v47, v47, v127
    s_waitcnt vmcnt(7)
    v_add_f32 v32, v32, v128
    v_add_f32 v33, v33, v129
    v_add_f32 v34, v34, v130
    v_add_f32 v35, v35, v131
    s_waitcnt vmcnt(6)
    v_add_f32 v40, v40, v132
    v_add_f32 v41, v41, v133
    v_add_f32 v42, v42, v134
    v_add_f32 v43, v43, v135
    s_waitcnt vmcnt(5)
    v_add_f32 v36, v36, v136
    v_add_f32 v37, v37, v137
    v_add_f32 v38, v38, v138
    v_add_f32 v39, v39, v139
    s_waitcnt vmcnt(4)
    v_add_f32 v44, v44, v140
    v_add_f32 v45, v45, v141
    v_add_f32 v46, v46, v142
    v_add_f32 v47, v47, v143
    s_waitcnt vmcnt(3)
    v_add_f32 v32, v32, v144
    v_add_f32 v33, v33, v145
    v_add_f32 v34, v34, v146
    v_add_f32 v35, v35, v147
    s_waitcnt vmcnt(2)
    v_add_f32 v40, v40, v148
    v_add_f32 v41, v41, v149
    v_add_f32 v42, v42, v150
    v_add_f32 v43, v43, v151
    s_waitcnt vmcnt(1)
    v_add_f32 v36, v36, v152
    v_add_f32 v37, v37, v153
    v_add_f32 v38, v38, v154
    v_add_f32 v39, v39, v155
    s_waitcnt vmcnt(0)
    v_add_f32 v44, v44, v156
    v_add_f32 v45, v45, v157
    v_add_f32 v46, v46, v158
    v_add_f32 v47, v47, v159
    v_cvt_pk_bf16_f32 v80, v32, v33
    v_cvt_pk_bf16_f32 v81, v34, v35
    v_cvt_pk_bf16_f32 v82, v40, v41
    v_cvt_pk_bf16_f32 v83, v42, v43
    v_cvt_pk_bf16_f32 v84, v36, v37
    v_cvt_pk_bf16_f32 v85, v38, v39
    v_cvt_pk_bf16_f32 v86, v44, v45
    v_cvt_pk_bf16_f32 v87, v46, v47
    s_nop 0
    v_permlane32_swap_b32 v80, v82
    v_permlane32_swap_b32 v81, v83
    v_permlane32_swap_b32 v84, v86
    v_permlane32_swap_b32 v85, v87
    s_nop 0
    v_permlane16_swap_b32 v80, v82
    v_permlane16_swap_b32 v81, v83
    v_permlane16_swap_b32 v84, v86
    v_permlane16_swap_b32 v85, v87
    s_nop 0
    buffer_store_dwordx4 v[80:83], v219, s[32:35], 0 offen offset:128
    buffer_store_dwordx4 v[84:87], v219, s[32:35], s55 offen offset:128
    s_branch K2_FIN
K2_V3:
    ds_read_b64_tr_b16 v[80:81], v213 offset:40960
    ds_read_b64_tr_b16 v[82:83], v213 offset:46080
    ds_read_b64_tr_b16 v[84:85], v214 offset:40960
    ds_read_b64_tr_b16 v[86:87], v214 offset:46080
    ds_read_b64_tr_b16 v[88:89], v213 offset:51200
    ds_read_b64_tr_b16 v[90:91], v213 offset:56320
    ds_read_b64_tr_b16 v[92:93], v214 offset:51200
    ds_read_b64_tr_b16 v[94:95], v214 offset:56320
    ds_read_b64_tr_b16 v[96:97], v215 offset:0
    ds_read_b64_tr_b16 v[98:99], v215 offset:5120
    ds_read_b64_tr_b16 v[100:101], v216 offset:0
    ds_read_b64_tr_b16 v[102:103], v216 offset:5120
    s_waitcnt lgkmcnt(10)
    v_mfma_f32_16x16x32_bf16 v[0:3], v[80:83], v[144:147], v[0:3]
    v_mfma_f32_16x16x32_bf16 v[4:7], v[80:83], v[148:151], v[4:7]
    ds_read_b64_tr_b16 v[104:105], v215 offset:10240
    ds_read_b64_tr_b16 v[106:107], v215 offset:15360
    s_waitcnt lgkmcnt(10)
    v_mfma_f32_16x16x32_bf16 v[8:11], v[84:87], v[144:147], v[8:11]
    v_mfma_f32_16x16x32_bf16 v[12:15], v[84:87], v[148:151], v[12:15]
    ds_read_b64_tr_b16 v[108:109], v216 offset:10240
    ds_read_b64_tr_b16 v[110:111], v216 offset:15360
    s_waitcnt lgkmcnt(10)
    v_mfma_f32_16x16x32_bf16 v[0:3], v[88:91], v[152:155], v[0:3]
    v_mfma_f32_16x16x32_bf16 v[4:7], v[88:91], v[156:159], v[4:7]
    ds_read_b64_tr_b16 v[80:81], v215 offset:20480
    ds_read_b64_tr_b16 v[82:83], v215 offset:25600
    s_waitcnt lgkmcnt(10)
    v_mfma_f32_16x16x32_bf16 v[8:11], v[92:95], v[152:155], v[8:11]
    v_mfma_f32_16x16x32_bf16 v[12:15], v[92:95], v[156:159], v[12:15]
    ds_read_b64_tr_b16 v[84:85], v216 offset:20480
    ds_read_b64_tr_b16 v[86:87], v216 offset:25600
    s_waitcnt lgkmcnt(10)
    v_mfma_f32_16x16x32_bf16 v[0:3], v[96:99], v[160:163], v[0:3]
    v_mfma_f32_16x16x32_bf16 v[4:7], v[96:99], v[164:167], v[4:7]
    ds_read_b64_tr_b16 v[88:89], v215 offset:30720
    ds_read_b64_tr_b16 v[90:91], v215 offset:35840
    s_waitcnt lgkmcnt(10)
    v_mfma_f32_16x16x32_bf16 v[8:11], v[100:103], v[160:163], v[8:11]
    v_mfma_f32_16x16x32_bf16 v[12:15], v[100:103], v[164:167], v[12:15]
    ds_read_b64_tr_b16 v[92:93], v216 offset:30720
    ds_read_b64_tr_b16 v[94:95], v216 offset:35840
    s_waitcnt lgkmcnt(10)
    v_mfma_f32_16x16x32_bf16 v[0:3], v[104:107], v[168:171], v[0:3]
    v_mfma_f32_16x16x32_bf16 v[4:7], v[104:107], v[172:175], v[4:7]
    ds_read_b64_tr_b16 v[96:97], v215 offset:40960
    ds_read_b64_tr_b16 v[98:99], v215 offset:46080
    s_waitcnt lgkmcnt(10)
    v_mfma_f32_16x16x32_bf16 v[8:11], v[108:111], v[168:171], v[8:11]
    v_mfma_f32_16x16x32_bf16 v[12:15], v[108:111], v[172:175], v[12:15]
    ds_read_b64_tr_b16 v[100:101], v216 offset:40960
    ds_read_b64_tr_b16 v[102:103], v216 offset:46080
    s_waitcnt lgkmcnt(10)
    v_mfma_f32_16x16x32_bf16 v[0:3], v[80:83], v[176:179], v[0:3]
    v_mfma_f32_16x16x32_bf16 v[4:7], v[80:83], v[180:183], v[4:7]
    ds_read_b64_tr_b16 v[104:105], v215 offset:51200
    ds_read_b64_tr_b16 v[106:107], v215 offset:56320
    s_waitcnt lgkmcnt(10)
    v_mfma_f32_16x16x32_bf16 v[8:11], v[84:87], v[176:179], v[8:11]
    v_mfma_f32_16x16x32_bf16 v[12:15], v[84:87], v[180:183], v[12:15]
    ds_read_b64_tr_b16 v[108:109], v216 offset:51200
    ds_read_b64_tr_b16 v[110:111], v216 offset:56320
    s_waitcnt lgkmcnt(10)
    v_mfma_f32_16x16x32_bf16 v[0:3], v[88:91], v[184:187], v[0:3]
    v_mfma_f32_16x16x32_bf16 v[4:7], v[88:91], v[188:191], v[4:7]
    ds_read_b64_tr_b16 v[80:81], v213 offset:41024
    ds_read_b64_tr_b16 v[82:83], v213 offset:46144
    s_waitcnt lgkmcnt(10)
    v_mfma_f32_16x16x32_bf16 v[8:11], v[92:95], v[184:187], v[8:11]
    v_mfma_f32_16x16x32_bf16 v[12:15], v[92:95], v[188:191], v[12:15]
    ds_read_b64_tr_b16 v[84:85], v214 offset:41024
    ds_read_b64_tr_b16 v[86:87], v214 offset:46144
    s_waitcnt lgkmcnt(10)
    v_mfma_f32_16x16x32_bf16 v[0:3], v[96:99], v[192:195], v[0:3]
    v_mfma_f32_16x16x32_bf16 v[4:7], v[96:99], v[196:199], v[4:7]
    ds_read_b64_tr_b16 v[88:89], v213 offset:51264
    ds_read_b64_tr_b16 v[90:91], v213 offset:56384
    s_waitcnt lgkmcnt(10)
    v_mfma_f32_16x16x32_bf16 v[8:11], v[100:103], v[192:195], v[8:11]
    v_mfma_f32_16x16x32_bf16 v[12:15], v[100:103], v[196:199], v[12:15]
    ds_read_b64_tr_b16 v[92:93], v214 offset:51264
    ds_read_b64_tr_b16 v[94:95], v214 offset:56384
    s_waitcnt lgkmcnt(10)
    v_mfma_f32_16x16x32_bf16 v[0:3], v[104:107], v[200:203], v[0:3]
    v_mfma_f32_16x16x32_bf16 v[4:7], v[104:107], v[204:207], v[4:7]
    ds_read_b64_tr_b16 v[96:97], v215 offset:64
    ds_read_b64_tr_b16 v[98:99], v215 offset:5184
    s_waitcnt lgkmcnt(10)
    v_mfma_f32_16x16x32_bf16 v[8:11], v[108:111], v[200:203], v[8:11]
    v_mfma_f32_16x16x32_bf16 v[12:15], v[108:111], v[204:207], v[12:15]
    ds_read_b64_tr_b16 v[100:101], v216 offset:64
    ds_read_b64_tr_b16 v[102:103], v216 offset:5184
    s_waitcnt lgkmcnt(10)
    v_mfma_f32_16x16x32_bf16 v[16:19], v[80:83], v[144:147], v[16:19]
    v_mfma_f32_16x16x32_bf16 v[20:23], v[80:83], v[148:151], v[20:23]
    ds_read_b64_tr_b16 v[104:105], v215 offset:10304
    ds_read_b64_tr_b16 v[106:107], v215 offset:15424
    s_waitcnt lgkmcnt(10)
    v_mfma_f32_16x16x32_bf16 v[24:27], v[84:87], v[144:147], v[24:27]
    v_mfma_f32_16x16x32_bf16 v[28:31], v[84:87], v[148:151], v[28:31]
    ds_read_b64_tr_b16 v[108:109], v216 offset:10304
    ds_read_b64_tr_b16 v[110:111], v216 offset:15424
    s_waitcnt lgkmcnt(10)
    v_mfma_f32_16x16x32_bf16 v[16:19], v[88:91], v[152:155], v[16:19]
    v_mfma_f32_16x16x32_bf16 v[20:23], v[88:91], v[156:159], v[20:23]
    ds_read_b64_tr_b16 v[80:81], v215 offset:20544
    ds_read_b64_tr_b16 v[82:83], v215 offset:25664
    s_waitcnt lgkmcnt(10)
    v_mfma_f32_16x16x32_bf16 v[24:27], v[92:95], v[152:155], v[24:27]
    v_mfma_f32_16x16x32_bf16 v[28:31], v[92:95], v[156:159], v[28:31]
    ds_read_b64_tr_b16 v[84:85], v216 offset:20544
    ds_read_b64_tr_b16 v[86:87], v216 offset:25664
    s_waitcnt lgkmcnt(10)
    v_mfma_f32_16x16x32_bf16 v[16:19], v[96:99], v[160:163], v[16:19]
    v_mfma_f32_16x16x32_bf16 v[20:23], v[96:99], v[164:167], v[20:23]
    ds_read_b64_tr_b16 v[88:89], v215 offset:30784
    ds_read_b64_tr_b16 v[90:91], v215 offset:35904
    s_waitcnt lgkmcnt(10)
    v_mfma_f32_16x16x32_bf16 v[24:27], v[100:103], v[160:163], v[24:27]
    v_mfma_f32_16x16x32_bf16 v[28:31], v[100:103], v[164:167], v[28:31]
    ds_read_b64_tr_b16 v[92:93], v216 offset:30784
    ds_read_b64_tr_b16 v[94:95], v216 offset:35904
    s_add_u32 s53, s59, 0
    buffer_store_dwordx4 v[0:3], v220, s[36:39], s53 offen offset:0 sc1
    s_add_u32 s53, s59, 0
    buffer_store_dwordx4 v[8:11], v220, s[36:39], s53 offen offset:1024 sc1
    s_add_u32 s53, s59, 8192
    buffer_store_dwordx4 v[4:7], v220, s[36:39], s53 offen offset:2048 sc1
    s_add_u32 s53, s59, 8192
    buffer_store_dwordx4 v[12:15], v220, s[36:39], s53 offen offset:3072 sc1
    s_waitcnt lgkmcnt(10)
    v_mfma_f32_16x16x32_bf16 v[16:19], v[104:107], v[168:171], v[16:19]
    v_mfma_f32_16x16x32_bf16 v[20:23], v[104:107], v[172:175], v[20:23]
    ds_read_b64_tr_b16 v[96:97], v215 offset:41024
    ds_read_b64_tr_b16 v[98:99], v215 offset:46144
    s_waitcnt lgkmcnt(10)
    v_mfma_f32_16x16x32_bf16 v[24:27], v[108:111], v[168:171], v[24:27]
    v_mfma_f32_16x16x32_bf16 v[28:31], v[108:111], v[172:175], v[28:31]
    ds_read_b64_tr_b16 v[100:101], v216 offset:41024
    ds_read_b64_tr_b16 v[102:103], v216 offset:46144
    s_waitcnt lgkmcnt(10)
    v_mfma_f32_16x16x32_bf16 v[16:19], v[80:83], v[176:179], v[16:19]
    v_mfma_f32_16x16x32_bf16 v[20:23], v[80:83], v[180:183], v[20:23]
    ds_read_b64_tr_b16 v[104:105], v215 offset:51264
    ds_read_b64_tr_b16 v[106:107], v215 offset:56384
    s_waitcnt lgkmcnt(10)
    v_mfma_f32_16x16x32_bf16 v[24:27], v[84:87], v[176:179], v[24:27]
    v_mfma_f32_16x16x32_bf16 v[28:31], v[84:87], v[180:183], v[28:31]
    ds_read_b64_tr_b16 v[108:109], v216 offset:51264
    ds_read_b64_tr_b16 v[110:111], v216 offset:56384
    s_waitcnt lgkmcnt(10)
    v_mfma_f32_16x16x32_bf16 v[16:19], v[88:91], v[184:187], v[16:19]
    v_mfma_f32_16x16x32_bf16 v[20:23], v[88:91], v[188:191], v[20:23]
    ds_read_b64_tr_b16 v[80:81], v213 offset:41088
    ds_read_b64_tr_b16 v[82:83], v213 offset:46208
    s_waitcnt lgkmcnt(10)
    v_mfma_f32_16x16x32_bf16 v[24:27], v[92:95], v[184:187], v[24:27]
    v_mfma_f32_16x16x32_bf16 v[28:31], v[92:95], v[188:191], v[28:31]
    ds_read_b64_tr_b16 v[84:85], v214 offset:41088
    ds_read_b64_tr_b16 v[86:87], v214 offset:46208
    s_waitcnt lgkmcnt(10)
    v_mfma_f32_16x16x32_bf16 v[16:19], v[96:99], v[192:195], v[16:19]
    v_mfma_f32_16x16x32_bf16 v[20:23], v[96:99], v[196:199], v[20:23]
    ds_read_b64_tr_b16 v[88:89], v213 offset:51328
    ds_read_b64_tr_b16 v[90:91], v213 offset:56448
    s_waitcnt lgkmcnt(10)
    v_mfma_f32_16x16x32_bf16 v[24:27], v[100:103], v[192:195], v[24:27]
    v_mfma_f32_16x16x32_bf16 v[28:31], v[100:103], v[196:199], v[28:31]
    ds_read_b64_tr_b16 v[92:93], v214 offset:51328
    ds_read_b64_tr_b16 v[94:95], v214 offset:56448
    s_waitcnt lgkmcnt(10)
    v_mfma_f32_16x16x32_bf16 v[16:19], v[104:107], v[200:203], v[16:19]
    v_mfma_f32_16x16x32_bf16 v[20:23], v[104:107], v[204:207], v[20:23]
    ds_read_b64_tr_b16 v[96:97], v215 offset:128
    ds_read_b64_tr_b16 v[98:99], v215 offset:5248
    s_waitcnt lgkmcnt(10)
    v_mfma_f32_16x16x32_bf16 v[24:27], v[108:111], v[200:203], v[24:27]
    v_mfma_f32_16x16x32_bf16 v[28:31], v[108:111], v[204:207], v[28:31]
    ds_read_b64_tr_b16 v[100:101], v216 offset:128
    ds_read_b64_tr_b16 v[102:103], v216 offset:5248
    s_waitcnt lgkmcnt(10)
    v_mfma_f32_16x16x32_bf16 v[32:35], v[80:83], v[144:147], v[32:35]
    v_mfma_f32_16x16x32_bf16 v[36:39], v[80:83], v[148:151], v[36:39]
    ds_read_b64_tr_b16 v[104:105], v215 offset:10368
    ds_read_b64_tr_b16 v[106:107], v215 offset:15488
    s_waitcnt lgkmcnt(10)
    v_mfma_f32_16x16x32_bf16 v[40:43], v[84:87], v[144:147], v[40:43]
    v_mfma_f32_16x16x32_bf16 v[44:47], v[84:87], v[148:151], v[44:47]
    ds_read_b64_tr_b16 v[108:109], v216 offset:10368
    ds_read_b64_tr_b16 v[110:111], v216 offset:15488
    s_waitcnt lgkmcnt(10)
    v_mfma_f32_16x16x32_bf16 v[32:35], v[88:91], v[152:155], v[32:35]
    v_mfma_f32_16x16x32_bf16 v[36:39], v[88:91], v[156:159], v[36:39]
    ds_read_b64_tr_b16 v[80:81], v215 offset:20608
    ds_read_b64_tr_b16 v[82:83], v215 offset:25728
    s_waitcnt lgkmcnt(10)
    v_mfma_f32_16x16x32_bf16 v[40:43], v[92:95], v[152:155], v[40:43]
    v_mfma_f32_16x16x32_bf16 v[44:47], v[92:95], v[156:159], v[44:47]
    ds_read_b64_tr_b16 v[84:85], v216 offset:20608
    ds_read_b64_tr_b16 v[86:87], v216 offset:25728
    s_waitcnt lgkmcnt(10)
    v_mfma_f32_16x16x32_bf16 v[32:35], v[96:99], v[160:163], v[32:35]
    v_mfma_f32_16x16x32_bf16 v[36:39], v[96:99], v[164:167], v[36:39]
    ds_read_b64_tr_b16 v[88:89], v215 offset:30848
    ds_read_b64_tr_b16 v[90:91], v215 offset:35968
    s_waitcnt lgkmcnt(10)
    v_mfma_f32_16x16x32_bf16 v[40:43], v[100:103], v[160:163], v[40:43]
    v_mfma_f32_16x16x32_bf16 v[44:47], v[100:103], v[164:167], v[44:47]
    ds_read_b64_tr_b16 v[92:93], v216 offset:30848
    ds_read_b64_tr_b16 v[94:95], v216 offset:35968
    s_add_u32 s53, s59, 0
    buffer_store_dwordx4 v[16:19], v220, s[36:39], s53 offen offset:2048 sc1
    s_add_u32 s53, s59, 0
    buffer_store_dwordx4 v[24:27], v220, s[36:39], s53 offen offset:3072 sc1
    s_add_u32 s53, s59, 12288
    buffer_store_dwordx4 v[20:23], v220, s[36:39], s53 offen offset:0 sc1
    s_add_u32 s53, s59, 12288
    buffer_store_dwordx4 v[28:31], v220, s[36:39], s53 offen offset:1024 sc1
    s_waitcnt lgkmcnt(10)
    v_mfma_f32_16x16x32_bf16 v[32:35], v[104:107], v[168:171], v[32:35]
    v_mfma_f32_16x16x32_bf16 v[36:39], v[104:107], v[172:175], v[36:39]
    ds_read_b64_tr_b16 v[96:97], v215 offset:41088
    ds_read_b64_tr_b16 v[98:99], v215 offset:46208
    s_waitcnt lgkmcnt(10)
    v_mfma_f32_16x16x32_bf16 v[40:43], v[108:111], v[168:171], v[40:43]
    v_mfma_f32_16x16x32_bf16 v[44:47], v[108:111], v[172:175], v[44:47]
    ds_read_b64_tr_b16 v[100:101], v216 offset:41088
    ds_read_b64_tr_b16 v[102:103], v216 offset:46208
    s_waitcnt lgkmcnt(10)
    v_mfma_f32_16x16x32_bf16 v[32:35], v[80:83], v[176:179], v[32:35]
    v_mfma_f32_16x16x32_bf16 v[36:39], v[80:83], v[180:183], v[36:39]
    ds_read_b64_tr_b16 v[104:105], v215 offset:51328
    ds_read_b64_tr_b16 v[106:107], v215 offset:56448
    s_waitcnt lgkmcnt(10)
    v_mfma_f32_16x16x32_bf16 v[40:43], v[84:87], v[176:179], v[40:43]
    v_mfma_f32_16x16x32_bf16 v[44:47], v[84:87], v[180:183], v[44:47]
    ds_read_b64_tr_b16 v[108:109], v216 offset:51328
    ds_read_b64_tr_b16 v[110:111], v216 offset:56448
    s_waitcnt lgkmcnt(10)
    v_mfma_f32_16x16x32_bf16 v[32:35], v[88:91], v[184:187], v[32:35]
    v_mfma_f32_16x16x32_bf16 v[36:39], v[88:91], v[188:191], v[36:39]
    ds_read_b64_tr_b16 v[80:81], v213 offset:41216
    ds_read_b64_tr_b16 v[82:83], v213 offset:46336
    s_waitcnt lgkmcnt(10)
    v_mfma_f32_16x16x32_bf16 v[40:43], v[92:95], v[184:187], v[40:43]
    v_mfma_f32_16x16x32_bf16 v[44:47], v[92:95], v[188:191], v[44:47]
    ds_read_b64_tr_b16 v[84:85], v214 offset:41216
    ds_read_b64_tr_b16 v[86:87], v214 offset:46336
    s_waitcnt lgkmcnt(10)
    v_mfma_f32_16x16x32_bf16 v[32:35], v[96:99], v[192:195], v[32:35]
    v_mfma_f32_16x16x32_bf16 v[36:39], v[96:99], v[196:199], v[36:39]
    ds_read_b64_tr_b16 v[88:89], v213 offset:51456
    ds_read_b64_tr_b16 v[90:91], v213 offset:56576
    s_waitcnt lgkmcnt(10)
    v_mfma_f32_16x16x32_bf16 v[40:43], v[100:103], v[192:195], v[40:43]
    v_mfma_f32_16x16x32_bf16 v[44:47], v[100:103], v[196:199], v[44:47]
    ds_read_b64_tr_b16 v[92:93], v214 offset:51456
    ds_read_b64_tr_b16 v[94:95], v214 offset:56576
    s_waitcnt lgkmcnt(10)
    v_mfma_f32_16x16x32_bf16 v[32:35], v[104:107], v[200:203], v[32:35]
    v_mfma_f32_16x16x32_bf16 v[36:39], v[104:107], v[204:207], v[36:39]
    ds_read_b64_tr_b16 v[96:97], v215 offset:256
    ds_read_b64_tr_b16 v[98:99], v215 offset:5376
    s_waitcnt lgkmcnt(10)
    v_mfma_f32_16x16x32_bf16 v[40:43], v[108:111], v[200:203], v[40:43]
    v_mfma_f32_16x16x32_bf16 v[44:47], v[108:111], v[204:207], v[44:47]
    ds_read_b64_tr_b16 v[100:101], v216 offset:256
    ds_read_b64_tr_b16 v[102:103], v216 offset:5376
    s_waitcnt lgkmcnt(10)
    v_mfma_f32_16x16x32_bf16 v[64:67], v[80:83], v[144:147], v[64:67]
    v_mfma_f32_16x16x32_bf16 v[68:71], v[80:83], v[148:151], v[68:71]
    ds_read_b64_tr_b16 v[104:105], v215 offset:10496
    ds_read_b64_tr_b16 v[106:107], v215 offset:15616
    s_waitcnt lgkmcnt(10)
    v_mfma_f32_16x16x32_bf16 v[72:75], v[84:87], v[144:147], v[72:75]
    v_mfma_f32_16x16x32_bf16 v[76:79], v[84:87], v[148:151], v[76:79]
    ds_read_b64_tr_b16 v[108:109], v216 offset:10496
    ds_read_b64_tr_b16 v[110:111], v216 offset:15616
    s_waitcnt lgkmcnt(10)
    v_mfma_f32_16x16x32_bf16 v[64:67], v[88:91], v[152:155], v[64:67]
    v_mfma_f32_16x16x32_bf16 v[68:71], v[88:91], v[156:159], v[68:71]
    ds_read_b64_tr_b16 v[80:81], v215 offset:20736
    ds_read_b64_tr_b16 v[82:83], v215 offset:25856
    s_waitcnt lgkmcnt(10)
    v_mfma_f32_16x16x32_bf16 v[72:75], v[92:95], v[152:155], v[72:75]
    v_mfma_f32_16x16x32_bf16 v[76:79], v[92:95], v[156:159], v[76:79]
    ds_read_b64_tr_b16 v[84:85], v216 offset:20736
    ds_read_b64_tr_b16 v[86:87], v216 offset:25856
    s_waitcnt lgkmcnt(10)
    v_mfma_f32_16x16x32_bf16 v[64:67], v[96:99], v[160:163], v[64:67]
    v_mfma_f32_16x16x32_bf16 v[68:71], v[96:99], v[164:167], v[68:71]
    ds_read_b64_tr_b16 v[88:89], v215 offset:30976
    ds_read_b64_tr_b16 v[90:91], v215 offset:36096
    s_waitcnt lgkmcnt(10)
    v_mfma_f32_16x16x32_bf16 v[72:75], v[100:103], v[160:163], v[72:75]
    v_mfma_f32_16x16x32_bf16 v[76:79], v[100:103], v[164:167], v[76:79]
    ds_read_b64_tr_b16 v[92:93], v216 offset:30976
    ds_read_b64_tr_b16 v[94:95], v216 offset:36096
    s_add_u32 s53, s59, 4096
    buffer_store_dwordx4 v[32:35], v220, s[36:39], s53 offen offset:0 sc1
    s_add_u32 s53, s59, 4096
    buffer_store_dwordx4 v[40:43], v220, s[36:39], s53 offen offset:1024 sc1
    s_add_u32 s53, s59, 12288
    buffer_store_dwordx4 v[36:39], v220, s[36:39], s53 offen offset:2048 sc1
    s_add_u32 s53, s59, 12288
    buffer_store_dwordx4 v[44:47], v220, s[36:39], s53 offen offset:3072 sc1
    s_waitcnt lgkmcnt(10)
    v_mfma_f32_16x16x32_bf16 v[64:67], v[104:107], v[168:171], v[64:67]
    v_mfma_f32_16x16x32_bf16 v[68:71], v[104:107], v[172:175], v[68:71]
    ds_read_b64_tr_b16 v[96:97], v215 offset:41216
    ds_read_b64_tr_b16 v[98:99], v215 offset:46336
    s_waitcnt lgkmcnt(10)
    v_mfma_f32_16x16x32_bf16 v[72:75], v[108:111], v[168:171], v[72:75]
    v_mfma_f32_16x16x32_bf16 v[76:79], v[108:111], v[172:175], v[76:79]
    ds_read_b64_tr_b16 v[100:101], v216 offset:41216
    ds_read_b64_tr_b16 v[102:103], v216 offset:46336
    s_waitcnt lgkmcnt(10)
    v_mfma_f32_16x16x32_bf16 v[64:67], v[80:83], v[176:179], v[64:67]
    v_mfma_f32_16x16x32_bf16 v[68:71], v[80:83], v[180:183], v[68:71]
    ds_read_b64_tr_b16 v[104:105], v215 offset:51456
    ds_read_b64_tr_b16 v[106:107], v215 offset:56576
    s_waitcnt lgkmcnt(10)
    v_mfma_f32_16x16x32_bf16 v[72:75], v[84:87], v[176:179], v[72:75]
    v_mfma_f32_16x16x32_bf16 v[76:79], v[84:87], v[180:183], v[76:79]
    ds_read_b64_tr_b16 v[108:109], v216 offset:51456
    ds_read_b64_tr_b16 v[110:111], v216 offset:56576
    s_waitcnt lgkmcnt(10)
    v_mfma_f32_16x16x32_bf16 v[64:67], v[88:91], v[184:187], v[64:67]
    v_mfma_f32_16x16x32_bf16 v[68:71], v[88:91], v[188:191], v[68:71]
    ds_read_b64_tr_b16 v[80:81], v213 offset:41152
    ds_read_b64_tr_b16 v[82:83], v213 offset:46272
    s_waitcnt lgkmcnt(10)
    v_mfma_f32_16x16x32_bf16 v[72:75], v[92:95], v[184:187], v[72:75]
    v_mfma_f32_16x16x32_bf16 v[76:79], v[92:95], v[188:191], v[76:79]
    ds_read_b64_tr_b16 v[84:85], v214 offset:41152
    ds_read_b64_tr_b16 v[86:87], v214 offset:46272
    s_waitcnt lgkmcnt(10)
    v_mfma_f32_16x16x32_bf16 v[64:67], v[96:99], v[192:195], v[64:67]
    v_mfma_f32_16x16x32_bf16 v[68:71], v[96:99], v[196:199], v[68:71]
    ds_read_b64_tr_b16 v[88:89], v213 offset:51392
    ds_read_b64_tr_b16 v[90:91], v213 offset:56512
    s_waitcnt lgkmcnt(10)
    v_mfma_f32_16x16x32_bf16 v[72:75], v[100:103], v[192:195], v[72:75]
    v_mfma_f32_16x16x32_bf16 v[76:79], v[100:103], v[196:199], v[76:79]
    ds_read_b64_tr_b16 v[92:93], v214 offset:51392
    ds_read_b64_tr_b16 v[94:95], v214 offset:56512
    s_waitcnt lgkmcnt(10)
    v_mfma_f32_16x16x32_bf16 v[64:67], v[104:107], v[200:203], v[64:67]
    v_mfma_f32_16x16x32_bf16 v[68:71], v[104:107], v[204:207], v[68:71]
    ds_read_b64_tr_b16 v[96:97], v215 offset:192
    ds_read_b64_tr_b16 v[98:99], v215 offset:5312
    s_waitcnt lgkmcnt(10)
    v_mfma_f32_16x16x32_bf16 v[72:75], v[108:111], v[200:203], v[72:75]
    v_mfma_f32_16x16x32_bf16 v[76:79], v[108:111], v[204:207], v[76:79]
    ds_read_b64_tr_b16 v[100:101], v216 offset:192
    ds_read_b64_tr_b16 v[102:103], v216 offset:5312
    s_waitcnt lgkmcnt(10)
    v_mfma_f32_16x16x32_bf16 v[48:51], v[80:83], v[144:147], v[48:51]
    v_mfma_f32_16x16x32_bf16 v[52:55], v[80:83], v[148:151], v[52:55]
    ds_read_b64_tr_b16 v[104:105], v215 offset:10432
    ds_read_b64_tr_b16 v[106:107], v215 offset:15552
    s_waitcnt lgkmcnt(10)
    v_mfma_f32_16x16x32_bf16 v[56:59], v[84:87], v[144:147], v[56:59]
    v_mfma_f32_16x16x32_bf16 v[60:63], v[84:87], v[148:151], v[60:63]
    ds_read_b64_tr_b16 v[108:109], v216 offset:10432
    ds_read_b64_tr_b16 v[110:111], v216 offset:15552
    s_waitcnt lgkmcnt(10)
    v_mfma_f32_16x16x32_bf16 v[48:51], v[88:91], v[152:155], v[48:51]
    v_mfma_f32_16x16x32_bf16 v[52:55], v[88:91], v[156:159], v[52:55]
    ds_read_b64_tr_b16 v[80:81], v215 offset:20672
    ds_read_b64_tr_b16 v[82:83], v215 offset:25792
    s_waitcnt lgkmcnt(10)
    v_mfma_f32_16x16x32_bf16 v[56:59], v[92:95], v[152:155], v[56:59]
    v_mfma_f32_16x16x32_bf16 v[60:63], v[92:95], v[156:159], v[60:63]
    ds_read_b64_tr_b16 v[84:85], v216 offset:20672
    ds_read_b64_tr_b16 v[86:87], v216 offset:25792
    s_waitcnt lgkmcnt(10)
    v_mfma_f32_16x16x32_bf16 v[48:51], v[96:99], v[160:163], v[48:51]
    v_mfma_f32_16x16x32_bf16 v[52:55], v[96:99], v[164:167], v[52:55]
    ds_read_b64_tr_b16 v[88:89], v215 offset:30912
    ds_read_b64_tr_b16 v[90:91], v215 offset:36032
    s_waitcnt lgkmcnt(10)
    v_mfma_f32_16x16x32_bf16 v[56:59], v[100:103], v[160:163], v[56:59]
    v_mfma_f32_16x16x32_bf16 v[60:63], v[100:103], v[164:167], v[60:63]
    ds_read_b64_tr_b16 v[92:93], v216 offset:30912
    ds_read_b64_tr_b16 v[94:95], v216 offset:36032
    s_add_u32 s53, s59, 8192
    buffer_store_dwordx4 v[64:67], v220, s[36:39], s53 offen offset:0 sc1
    s_add_u32 s53, s59, 8192
    buffer_store_dwordx4 v[72:75], v220, s[36:39], s53 offen offset:1024 sc1
    s_add_u32 s53, s59, 16384
    buffer_store_dwordx4 v[68:71], v220, s[36:39], s53 offen offset:2048 sc1
    s_add_u32 s53, s59, 16384
    buffer_store_dwordx4 v[76:79], v220, s[36:39], s53 offen offset:3072 sc1
    s_waitcnt lgkmcnt(10)
    v_mfma_f32_16x16x32_bf16 v[48:51], v[104:107], v[168:171], v[48:51]
    v_mfma_f32_16x16x32_bf16 v[52:55], v[104:107], v[172:175], v[52:55]
    ds_read_b64_tr_b16 v[96:97], v215 offset:41152
    ds_read_b64_tr_b16 v[98:99], v215 offset:46272
    s_waitcnt lgkmcnt(10)
    v_mfma_f32_16x16x32_bf16 v[56:59], v[108:111], v[168:171], v[56:59]
    v_mfma_f32_16x16x32_bf16 v[60:63], v[108:111], v[172:175], v[60:63]
    ds_read_b64_tr_b16 v[100:101], v216 offset:41152
    ds_read_b64_tr_b16 v[102:103], v216 offset:46272
    s_waitcnt lgkmcnt(10)
    v_mfma_f32_16x16x32_bf16 v[48:51], v[80:83], v[176:179], v[48:51]
    v_mfma_f32_16x16x32_bf16 v[52:55], v[80:83], v[180:183], v[52:55]
    ds_read_b64_tr_b16 v[104:105], v215 offset:51392
    ds_read_b64_tr_b16 v[106:107], v215 offset:56512
    s_waitcnt lgkmcnt(10)
    v_mfma_f32_16x16x32_bf16 v[56:59], v[84:87], v[176:179], v[56:59]
    v_mfma_f32_16x16x32_bf16 v[60:63], v[84:87], v[180:183], v[60:63]
    ds_read_b64_tr_b16 v[108:109], v216 offset:51392
    ds_read_b64_tr_b16 v[110:111], v216 offset:56512
    s_waitcnt lgkmcnt(10)
    v_mfma_f32_16x16x32_bf16 v[48:51], v[88:91], v[184:187], v[48:51]
    v_mfma_f32_16x16x32_bf16 v[52:55], v[88:91], v[188:191], v[52:55]
    s_waitcnt vmcnt(0)
    s_lshl_b32 s54, s52, 5
    v_mov_b32 v222, 1
    s_mov_b64 exec, 1
    buffer_store_dword v222, v223, s[40:43], s54 offen sc1
    s_mov_b64 exec, -1
    s_waitcnt lgkmcnt(8)
    v_mfma_f32_16x16x32_bf16 v[56:59], v[92:95], v[184:187], v[56:59]
    v_mfma_f32_16x16x32_bf16 v[60:63], v[92:95], v[188:191], v[60:63]
    s_waitcnt lgkmcnt(6)
    v_mfma_f32_16x16x32_bf16 v[48:51], v[96:99], v[192:195], v[48:51]
    v_mfma_f32_16x16x32_bf16 v[52:55], v[96:99], v[196:199], v[52:55]
    s_waitcnt lgkmcnt(4)
    v_mfma_f32_16x16x32_bf16 v[56:59], v[100:103], v[192:195], v[56:59]
    v_mfma_f32_16x16x32_bf16 v[60:63], v[100:103], v[196:199], v[60:63]
    s_waitcnt lgkmcnt(2)
    v_mfma_f32_16x16x32_bf16 v[48:51], v[104:107], v[200:203], v[48:51]
    v_mfma_f32_16x16x32_bf16 v[52:55], v[104:107], v[204:207], v[52:55]
    s_waitcnt lgkmcnt(0)
    v_mfma_f32_16x16x32_bf16 v[56:59], v[108:111], v[200:203], v[56:59]
    v_mfma_f32_16x16x32_bf16 v[60:63], v[108:111], v[204:207], v[60:63]
    s_mov_b64 exec, 15
K2_POLL3:
    buffer_load_dword v222, v224, s[40:43], 0 offen sc1
    s_waitcnt vmcnt(0)
    v_cmp_ne_u32 vcc, 1, v222
    s_cbranch_vccz K2_GOT3
    s_sleep 1
    s_branch K2_POLL3
K2_GOT3:
    s_mov_b64 exec, -1
    s_xor_b32 s58, s52, 8
    s_mul_i32 s58, s58, 20480
    s_add_u32 s53, s58, 4096
    buffer_load_dwordx4 v[112:115], v220, s[36:39], s53 offen offset:2048 sc1
    s_add_u32 s53, s58, 4096
    buffer_load_dwordx4 v[116:119], v220, s[36:39], s53 offen offset:3072 sc1
    s_add_u32 s53, s58, 16384
    buffer_load_dwordx4 v[120:123], v220, s[36:39], s53 offen offset:0 sc1
    s_add_u32 s53, s58, 16384
    buffer_load_dwordx4 v[124:127], v220, s[36:39], s53 offen offset:1024 sc1
    s_xor_b32 s58, s52, 16
    s_mul_i32 s58, s58, 20480
    s_add_u32 s53, s58, 4096
    buffer_load_dwordx4 v[128:131], v220, s[36:39], s53 offen offset:2048 sc1
    s_add_u32 s53, s58, 4096
    buffer_load_dwordx4 v[132:135], v220, s[36:39], s53 offen offset:3072 sc1
    s_add_u32 s53, s58, 16384
    buffer_load_dwordx4 v[136:139], v220, s[36:39], s53 offen offset:0 sc1
    s_add_u32 s53, s58, 16384
    buffer_load_dwordx4 v[140:143], v220, s[36:39], s53 offen offset:1024 sc1
    s_xor_b32 s58, s52, 24
    s_mul_i32 s58, s58, 20480
    s_add_u32 s53, s58, 4096
    buffer_load_dwordx4 v[144:147], v220, s[36:39], s53 offen offset:2048 sc1
    s_add_u32 s53, s58, 4096
    buffer_load_dwordx4 v[148:151], v220, s[36:39], s53 offen offset:3072 sc1
    s_add_u32 s53, s58, 16384
    buffer_load_dwordx4 v[152:155], v220, s[36:39], s53 offen offset:0 sc1
    s_add_u32 s53, s58, 16384
    buffer_load_dwordx4 v[156:159], v220, s[36:39], s53 offen offset:1024 sc1
    s_waitcnt vmcnt(11)
    v_add_f32 v48, v48, v112
    v_add_f32 v49, v49, v113
    v_add_f32 v50, v50, v114
    v_add_f32 v51, v51, v115
    s_waitcnt vmcnt(10)
    v_add_f32 v56, v56, v116
    v_add_f32 v57, v57, v117
    v_add_f32 v58, v58, v118
    v_add_f32 v59, v59, v119
    s_waitcnt vmcnt(9)
    v_add_f32 v52, v52, v120
    v_add_f32 v53, v53, v121
    v_add_f32 v54, v54, v122
    v_add_f32 v55, v55, v123
    s_waitcnt vmcnt(8)
    v_add_f32 v60, v60, v124
    v_add_f32 v61, v61, v125
    v_add_f32 v62, v62, v126
    v_add_f32 v63, v63, v127
    s_waitcnt vmcnt(7)
    v_add_f32 v48, v48, v128
    v_add_f32 v49, v49, v129
    v_add_f32 v50, v50, v130
    v_add_f32 v51, v51, v131
    s_waitcnt vmcnt(6)
    v_add_f32 v56, v56, v132
    v_add_f32 v57, v57, v133
    v_add_f32 v58, v58, v134
    v_add_f32 v59, v59, v135
    s_waitcnt vmcnt(5)
    v_add_f32 v52, v52, v136
    v_add_f32 v53, v53, v137
    v_add_f32 v54, v54, v138
    v_add_f32 v55, v55, v139
    s_waitcnt vmcnt(4)
    v_add_f32 v60, v60, v140
    v_add_f32 v61, v61, v141
    v_add_f32 v62, v62, v142
    v_add_f32 v63, v63, v143
    s_waitcnt vmcnt(3)
    v_add_f32 v48, v48, v144
    v_add_f32 v49, v49, v145
    v_add_f32 v50, v50, v146
    v_add_f32 v51, v51, v147
    s_waitcnt vmcnt(2)
    v_add_f32 v56, v56, v148
    v_add_f32 v57, v57, v149
    v_add_f32 v58, v58, v150
    v_add_f32 v59, v59, v151
    s_waitcnt vmcnt(1)
    v_add_f32 v52, v52, v152
    v_add_f32 v53, v53, v153
    v_add_f32 v54, v54, v154
    v_add_f32 v55, v55, v155
    s_waitcnt vmcnt(0)
    v_add_f32 v60, v60, v156
    v_add_f32 v61, v61, v157
    v_add_f32 v62, v62, v158
    v_add_f32 v63, v63, v159
    v_cvt_pk_bf16_f32 v80, v48, v49
    v_cvt_pk_bf16_f32 v81, v50, v51
    v_cvt_pk_bf16_f32 v82, v56, v57
    v_cvt_pk_bf16_f32 v83, v58, v59
    v_cvt_pk_bf16_f32 v84, v52, v53
    v_cvt_pk_bf16_f32 v85, v54, v55
    v_cvt_pk_bf16_f32 v86, v60, v61
    v_cvt_pk_bf16_f32 v87, v62, v63
    s_nop 0
    v_permlane32_swap_b32 v80, v82
    v_permlane32_swap_b32 v81, v83
    v_permlane32_swap_b32 v84, v86
    v_permlane32_swap_b32 v85, v87
    s_nop 0
    v_permlane16_swap_b32 v80, v82
    v_permlane16_swap_b32 v81, v83
    v_permlane16_swap_b32 v84, v86
    v_permlane16_swap_b32 v85, v87
    s_nop 0
    buffer_store_dwordx4 v[80:83], v219, s[32:35], 0 offen offset:192
    buffer_store_dwordx4 v[84:87], v219, s[32:35], s55 offen offset:192
K2_FIN:
K2_END:
    s_endpgm
.section .rodata,"a"
.p2align 6
.amdhsa_kernel concat_heads__gqa_block_cached__gqa_block_cached__near_ridge_k1_kernel
  .amdhsa_next_free_vgpr 256
  .amdhsa_next_free_sgpr 102
  .amdhsa_accum_offset 256
  .amdhsa_group_segment_fixed_size 0
  .amdhsa_kernarg_size 104
  .amdhsa_user_sgpr_count 2
  .amdhsa_user_sgpr_kernarg_segment_ptr 1
  .amdhsa_system_sgpr_workgroup_id_x 1
.end_amdhsa_kernel
.p2align 6
.amdhsa_kernel concat_heads__gqa_block_cached__gqa_block_cached__near_ridge_k2_kernel
  .amdhsa_next_free_vgpr 256
  .amdhsa_next_free_sgpr 102
  .amdhsa_accum_offset 256
  .amdhsa_group_segment_fixed_size 0
  .amdhsa_kernarg_size 104
  .amdhsa_user_sgpr_count 2
  .amdhsa_user_sgpr_kernarg_segment_ptr 1
  .amdhsa_system_sgpr_workgroup_id_x 1
.end_amdhsa_kernel
```
